```python
import torch

def _softmax(x, axis=-1):
    return torch.softmax(x, dim=axis)
def _gelu(x):
    return torch.nn.functional.gelu(x, approximate="tanh")
def _silu(x):
    return torch.nn.functional.silu(x)
def _sigmoid(x):
    return torch.sigmoid(x)
def _layernorm(x, axis=-1, eps=1e-5):
    m = x.mean(dim=axis, keepdim=True)
    v = x.var(dim=axis, keepdim=True, unbiased=False)
    return (x - m) / torch.sqrt(v + eps)
def _scatter_add(tgt, idx, src, axis=0):
    return tgt.clone().index_add_(axis, idx, src)
def _segment_sum(src, seg, n):
    out = torch.zeros((n,) + src.shape[1:], dtype=src.dtype)
    return out.index_add_(0, seg, src)
def _pad(x, pw):
    flat = tuple(v for pair in reversed(pw) for v in pair)
    return torch.nn.functional.pad(x, flat)

kernel_name = 'concat_heads__gqa_block_cached__mha_block_cached__near_ridge'

def setup_inputs():

    _w = (lambda a: (lambda t: t.to(torch.bfloat16) if t.is_floating_point() else t)(torch.as_tensor(a)))
    def _A_setup():
        B, Sq, D = 8, 96, 640
        Hq, Hkv, Sk, Dh = 32, 32, 512, 128
        assert Hq % Hkv == 0, (Hq, Hkv)
        return {
            "x": _w((lambda *s: torch.randn(*s, dtype=torch.bfloat16) * 0.8)(B, Sq, D)),
            "k_cache": _w((lambda *s: torch.randn(*s, dtype=torch.bfloat16) * 0.8)(B, Hkv, Sk, Dh)),
            "v_cache": _w((lambda *s: torch.randn(*s, dtype=torch.bfloat16) * 0.05)(B, Hkv, Sk, Dh)),
            "wq": _w((lambda *s: torch.randn(*s, dtype=torch.bfloat16) * 0.8)(D, Hq * Dh) * (D ** -0.5)),
            "wo": _w((lambda *s: torch.randn(*s, dtype=torch.bfloat16) * 0.05)(Hq * Dh, D) * ((Hq * Dh) ** -0.5)),
        }
    _A_in = _A_setup()

    def _B_setup():
        B, Sq, D = 8, 96, 640
        H, Sk, Dh = 32, 512, 128
        return {
            "x": _w((lambda *s: torch.randn(*s, dtype=torch.bfloat16) * 0.8)(B, Sq, D)),
            "k_cache": _w((lambda *s: torch.randn(*s, dtype=torch.bfloat16) * 0.8)(B, H, Sk, Dh)),
            "v_cache": _w((lambda *s: torch.randn(*s, dtype=torch.bfloat16) * 0.05)(B, H, Sk, Dh)),
            "wq": _w((lambda *s: torch.randn(*s, dtype=torch.bfloat16) * 0.8)(D, H * Dh) * (D ** -0.5)),
            "wo": _w((lambda *s: torch.randn(*s, dtype=torch.bfloat16) * 0.05)(H * Dh, D) * ((H * Dh) ** -0.5)),
        }
    _B_in = _B_setup()

    return {
        "A_x": _A_in["x"],
        "A_k_cache": _A_in["k_cache"],
        "A_v_cache": _A_in["v_cache"],
        "A_wq": _A_in["wq"],
        "A_wo": _A_in["wo"],
        "B_x": _B_in["x"],
        "B_k_cache": _B_in["k_cache"],
        "B_v_cache": _B_in["v_cache"],
        "B_wq": _B_in["wq"],
        "B_wo": _B_in["wo"],
    }

def reference(A_x, A_k_cache, A_v_cache, A_wq, A_wo, B_x, B_k_cache, B_v_cache, B_wq, B_wo):
    def _A_ref(x, k_cache, v_cache, wq, wo):
        B, Sq, D = x.shape
        Hq, Dh = 32, 128
        Hkv = k_cache.shape[1]
        rep = Hq // Hkv
        q = (lambda x, *d: x.permute(*d))((x @ wq).reshape(B, Sq, Hq, Dh), 0, 2, 1, 3)
        k = (lambda x, n, axis: torch.repeat_interleave(x, n, dim=axis))(k_cache, rep, axis=1)
        v = (lambda x, n, axis: torch.repeat_interleave(x, n, dim=axis))(v_cache, rep, axis=1)
        scores = torch.einsum("bhqd,bhkd->bhqk", q, k) * (Dh ** -0.5)
        p = _softmax(scores, axis=-1)
        o = torch.einsum("bhqk,bhkd->bhqd", p, v)
        return (lambda x, *d: x.permute(*d))(o, 0, 2, 1, 3).reshape(B, Sq, Hq * Dh) @ wo

    def _B_ref(x, k_cache, v_cache, wq, wo):
        B, Sq, D = x.shape
        H, Dh = 32, 128
        q = (lambda x, *d: x.permute(*d))((x @ wq).reshape(B, Sq, H, Dh), 0, 2, 1, 3)
        scores = torch.einsum("bhqd,bhkd->bhqk", q, k_cache) * (Dh ** -0.5)
        p = _softmax(scores, axis=-1)
        o = torch.einsum("bhqk,bhkd->bhqd", p, v_cache)
        return (lambda x, *d: x.permute(*d))(o, 0, 2, 1, 3).reshape(B, Sq, H * Dh) @ wo

    a = _A_ref(A_x, A_k_cache, A_v_cache, A_wq, A_wo)
    b = _B_ref(B_x, B_k_cache, B_v_cache, B_wq, B_wo)
    return torch.concatenate([a, b], axis=-1)
```

```asm
; @launch grid=(256,1,1) block=(512,1,1) lds=163840
.amdgcn_target "amdgcn-amd-amdhsa--gfx950"
.text
.globl concat_heads__gqa_block_cached__mha_block_cached__near_ridge_kernel
.p2align 8
.type concat_heads__gqa_block_cached__mha_block_cached__near_ridge_kernel,@function
concat_heads__gqa_block_cached__mha_block_cached__near_ridge_kernel:
 s_cmp_ge_u32 s2, 256
 s_cbranch_scc1 K_end
 s_and_b32 s3, s2, 7
 s_lshr_b32 s4, s3, 2
 s_mul_i32 s5, s4, 40
 s_load_dwordx8 s[8:15], s[0:1], s5
 s_load_dwordx2 s[18:19], s[0:1], s5 offset:32
 s_load_dwordx2 s[16:17], s[0:1], 96
 s_load_dwordx2 s[76:77], s[0:1], 88
 s_load_dwordx2 s[80:81], s[0:1], 80
 v_lshrrev_b32 v1, 6, v0
 v_and_b32 v250, 63, v0
 v_readfirstlane_b32 s40, v1
 s_and_b32 s60, s3, 3
 s_lshr_b32 s6, s2, 3
 s_and_b32 s7, s6, 7
 s_lshr_b32 s63, s6, 3
 s_lshr_b32 s61, s40, 2
 s_and_b32 s62, s40, 3
 s_lshl_b32 s3, s60, 3
 s_lshl_b32 s6, s63, 1
 s_add_u32 s6, s6, s3
 s_lshl_b32 s43, s7, 5
 s_add_u32 s43, s43, s6
 s_lshl_b32 s44, s4, 3
 s_add_u32 s44, s44, s7
 s_lshl_b32 s44, s44, 2
 s_add_u32 s82, s44, s60
 s_add_u32 s83, s44, s63
 s_cmp_eq_u32 s62, 3
 s_cbranch_scc0 K_att
 s_add_u32 s45, s63, s7
 s_cmp_ge_u32 s45, 5
 s_cselect_b32 s46, 5, 0
 s_sub_u32 s45, s45, s46
 s_cmp_ge_u32 s45, 5
 s_cselect_b32 s46, 5, 0
 s_sub_u32 s45, s45, s46
 s_lshl_b32 s45, s45, 1
 v_lshrrev_b32 v1, 4, v250
 v_and_b32 v2, 15, v250
 v_lshrrev_b32 v17, 3, v250
 v_and_b32 v3, 7, v250
 v_xor_b32 v3, v3, v1
 s_lshl_b32 s49, s61, 2
 v_xor_b32 v3, s49, v3
 v_lshlrev_b32 v3, 4, v3
 v_mul_u32_u24 v17, 1280, v17
 v_add_u32 v8, v17, v3
 s_mul_i32 s49, s61, 10240
 v_add_u32 v8, s49, v8
 v_add_u32 v9, 18432, v8
 v_lshlrev_b32 v3, 2, v1
 v_xor_b32 v3, v2, v3
 v_lshlrev_b32 v3, 4, v3
 v_lshl_add_u32 v16, v1, 8, v3
 v_lshl_add_u32 v4, v1, 13, v3
 v_add_u32 v5, 31744, v4
 v_add_u32 v6, 63488, v4
 v_add_u32 v7, 95232, v4
 s_lshl_b32 s50, s61, 10
 s_lshl_b32 s48, s61, 12
 s_lshl_b32 s47, s61, 17
 s_lshl_b32 s52, s45, 1
 s_mul_i32 s41, s7, 122880
 s_lshl_b32 s42, s6, 8
 s_sub_u32 s46, 5242880, s42
 s_lshl_b32 s43, s43, 17
 s_waitcnt lgkmcnt(0)
 s_add_u32 s20, s8, s41
 s_addc_u32 s21, s9, 0
 s_and_b32 s21, s21, 0xffff
 s_mov_b32 s22, 122880
 s_mov_b32 s23, 0x20000
 s_add_u32 s24, s14, s42
 s_addc_u32 s25, s15, 0
 s_and_b32 s25, s25, 0xffff
 s_mov_b32 s26, s46
 s_mov_b32 s27, 0x20000
 s_add_u32 s59, s45, 0
 s_cmp_ge_u32 s59, 10
 s_cselect_b32 s58, 10, 0
 s_sub_u32 s59, s59, s58
 s_lshl_b32 s59, s59, 7
 s_add_u32 m0, s50, 40960
 s_add_u32 s57, s59, 0
 buffer_load_dwordx4 v8, s[20:23], s57 offen offset:0 lds
 buffer_load_dwordx4 v9, s[20:23], s57 offen offset:2048 lds
 s_add_u32 m0, s50, 45056
 s_add_u32 s57, s59, 40960
 buffer_load_dwordx4 v8, s[20:23], s57 offen offset:0 lds
 buffer_load_dwordx4 v9, s[20:23], s57 offen offset:2048 lds
 s_add_u32 m0, s50, 49152
 s_add_u32 s57, s59, 81920
 buffer_load_dwordx4 v8, s[20:23], s57 offen offset:0 lds
 buffer_load_dwordx4 v9, s[20:23], s57 offen offset:2048 lds
 s_add_u32 s59, s52, 0
 s_cmp_ge_u32 s59, 20
 s_cselect_b32 s58, 20, 0
 s_sub_u32 s59, s59, s58
 s_lshl_b32 s59, s59, 18
 s_add_u32 m0, s48, 114688
 s_add_u32 s57, s59, s47
 buffer_load_dwordx4 v4, s[24:27], s57 offen offset:0 lds
 buffer_load_dwordx4 v5, s[24:27], s57 offen offset:1024 lds
 buffer_load_dwordx4 v6, s[24:27], s57 offen offset:2048 lds
 buffer_load_dwordx4 v7, s[24:27], s57 offen offset:3072 lds
 s_add_u32 s59, s52, 1
 s_cmp_ge_u32 s59, 20
 s_cselect_b32 s58, 20, 0
 s_sub_u32 s59, s59, s58
 s_lshl_b32 s59, s59, 18
 s_add_u32 m0, s48, 122880
 s_add_u32 s57, s59, s47
 buffer_load_dwordx4 v4, s[24:27], s57 offen offset:0 lds
 buffer_load_dwordx4 v5, s[24:27], s57 offen offset:1024 lds
 buffer_load_dwordx4 v6, s[24:27], s57 offen offset:2048 lds
 buffer_load_dwordx4 v7, s[24:27], s57 offen offset:3072 lds
 s_add_u32 s28, s10, s43
 s_addc_u32 s29, s11, 0
 s_and_b32 s29, s29, 0xffff
 s_mov_b32 s30, 262144
 s_mov_b32 s31, 0x20000
 s_add_u32 s32, s12, s43
 s_addc_u32 s33, s13, 0
 s_and_b32 s33, s33, 0xffff
 s_mov_b32 s34, 262144
 s_mov_b32 s35, 0x20000
 s_lshl_b32 s91, s7, 14
 v_xor_b32 v3, v2, v1
 v_lshlrev_b32 v3, 4, v3
 v_lshl_add_u32 v12, v1, 8, v3
 v_xor_b32 v13, 64, v12
 v_xor_b32 v14, 128, v12
 v_xor_b32 v15, 192, v12
 s_mul_i32 s41, s60, 1310720
 s_mul_i32 s42, s63, 320
 s_add_u32 s41, s41, s42
 s_sub_u32 s42, 1310720, s42
 s_add_u32 s64, s18, s41
 s_addc_u32 s65, s19, 0
 s_and_b32 s65, s65, 0xffff
 s_mov_b32 s66, s42
 s_mov_b32 s67, 0x20000
 s_lshr_b32 s41, s2, 3
 s_lshl_b32 s41, s41, 1
 s_add_u32 s41, s41, s61
 s_lshl_b32 s42, s60, 6
 s_add_u32 s41, s41, s42
 s_mul_i32 s41, s41, 20480
 s_mul_i32 s44, s82, 196608
 s_mov_b32 s42, 41943040
 s_add_u32 s84, s18, s41
 s_addc_u32 s85, s19, 0
 s_and_b32 s85, s85, 0xffff
 s_mov_b32 s86, 20480
 s_mov_b32 s87, 0x20000
 s_add_u32 s68, s16, s44
 s_addc_u32 s69, s17, 0
 s_and_b32 s69, s69, 0xffff
 s_mov_b32 s70, 196608
 s_mov_b32 s71, 0x20000
 s_add_u32 s8, s16, s42
 s_addc_u32 s9, s17, 0
 s_and_b32 s9, s9, 0xffff
 s_mov_b32 s10, 98304
 s_mov_b32 s11, 0x20000
 v_lshlrev_b32 v30, 4, v250
 s_lshr_b32 s44, s82, 2
 s_lshl_b32 s44, s44, 4
 v_mov_b32 v29, s44
 s_movk_i32 s49, 3277
 v_add_u32 v1, 0, v250
 v_mul_u32_u24 v2, s49, v1
 v_lshrrev_b32 v2, 16, v2
 v_mul_u32_u24 v3, 20, v2
 v_sub_u32 v3, v1, v3
 v_mul_u32_u24 v2, 1280, v2
 v_lshl_add_u32 v20, v3, 4, v2
 v_add_u32 v1, 64, v250
 v_mul_u32_u24 v2, s49, v1
 v_lshrrev_b32 v2, 16, v2
 v_mul_u32_u24 v3, 20, v2
 v_sub_u32 v3, v1, v3
 v_mul_u32_u24 v2, 1280, v2
 v_lshl_add_u32 v21, v3, 4, v2
 v_subrev_u32 v21, 1024, v21
 v_add_u32 v1, 128, v250
 v_mul_u32_u24 v2, s49, v1
 v_lshrrev_b32 v2, 16, v2
 v_mul_u32_u24 v3, 20, v2
 v_sub_u32 v3, v1, v3
 v_mul_u32_u24 v2, 1280, v2
 v_lshl_add_u32 v22, v3, 4, v2
 v_subrev_u32 v22, 2048, v22
 v_add_u32 v1, 192, v250
 v_mul_u32_u24 v2, s49, v1
 v_lshrrev_b32 v2, 16, v2
 v_mul_u32_u24 v3, 20, v2
 v_sub_u32 v3, v1, v3
 v_mul_u32_u24 v2, 1280, v2
 v_lshl_add_u32 v23, v3, 4, v2
 v_subrev_u32 v23, 3072, v23
 v_add_u32 v1, 256, v250
 v_mul_u32_u24 v2, s49, v1
 v_lshrrev_b32 v2, 16, v2
 v_mul_u32_u24 v3, 20, v2
 v_sub_u32 v3, v1, v3
 v_mul_u32_u24 v2, 1280, v2
 v_lshl_add_u32 v24, v3, 4, v2
 s_add_u32 s59, s45, 1
 s_cmp_ge_u32 s59, 10
 s_cselect_b32 s58, 10, 0
 s_sub_u32 s59, s59, s58
 s_lshl_b32 s59, s59, 7
 s_add_u32 m0, s50, 53248
 s_add_u32 s57, s59, 0
 buffer_load_dwordx4 v8, s[20:23], s57 offen offset:0 lds
 buffer_load_dwordx4 v9, s[20:23], s57 offen offset:2048 lds
 s_add_u32 m0, s50, 57344
 s_add_u32 s57, s59, 40960
 buffer_load_dwordx4 v8, s[20:23], s57 offen offset:0 lds
 buffer_load_dwordx4 v9, s[20:23], s57 offen offset:2048 lds
 s_add_u32 m0, s50, 61440
 s_add_u32 s57, s59, 81920
 buffer_load_dwordx4 v8, s[20:23], s57 offen offset:0 lds
 buffer_load_dwordx4 v9, s[20:23], s57 offen offset:2048 lds
 s_add_u32 s59, s52, 2
 s_cmp_ge_u32 s59, 20
 s_cselect_b32 s58, 20, 0
 s_sub_u32 s59, s59, s58
 s_lshl_b32 s59, s59, 18
 s_add_u32 m0, s48, 131072
 s_add_u32 s57, s59, s47
 buffer_load_dwordx4 v4, s[24:27], s57 offen offset:0 lds
 buffer_load_dwordx4 v5, s[24:27], s57 offen offset:1024 lds
 buffer_load_dwordx4 v6, s[24:27], s57 offen offset:2048 lds
 buffer_load_dwordx4 v7, s[24:27], s57 offen offset:3072 lds
 s_add_u32 s59, s52, 3
 s_cmp_ge_u32 s59, 20
 s_cselect_b32 s58, 20, 0
 s_sub_u32 s59, s59, s58
 s_lshl_b32 s59, s59, 18
 s_add_u32 m0, s48, 139264
 s_add_u32 s57, s59, s47
 buffer_load_dwordx4 v4, s[24:27], s57 offen offset:0 lds
 buffer_load_dwordx4 v5, s[24:27], s57 offen offset:1024 lds
 buffer_load_dwordx4 v6, s[24:27], s57 offen offset:2048 lds
 buffer_load_dwordx4 v7, s[24:27], s57 offen offset:3072 lds
 s_lshr_b32 s44, s2, 3
 s_and_b32 s44, s44, 1
 s_cmp_eq_u32 s44, 1
 s_cbranch_scc1 K_cls1
 s_waitcnt vmcnt(22)
 s_waitcnt vmcnt(18)
 s_barrier
 s_add_u32 s59, s45, 2
 s_cmp_ge_u32 s59, 10
 s_cselect_b32 s58, 10, 0
 s_sub_u32 s59, s59, s58
 s_lshl_b32 s59, s59, 7
 s_add_u32 m0, s50, 65536
 s_add_u32 s57, s59, 0
 buffer_load_dwordx4 v8, s[20:23], s57 offen offset:0 lds
 buffer_load_dwordx4 v9, s[20:23], s57 offen offset:2048 lds
 s_add_u32 m0, s50, 69632
 s_add_u32 s57, s59, 40960
 buffer_load_dwordx4 v8, s[20:23], s57 offen offset:0 lds
 buffer_load_dwordx4 v9, s[20:23], s57 offen offset:2048 lds
 s_add_u32 m0, s50, 73728
 s_add_u32 s57, s59, 81920
 buffer_load_dwordx4 v8, s[20:23], s57 offen offset:0 lds
 buffer_load_dwordx4 v9, s[20:23], s57 offen offset:2048 lds
 s_add_u32 s59, s52, 4
 s_cmp_ge_u32 s59, 20
 s_cselect_b32 s58, 20, 0
 s_sub_u32 s59, s59, s58
 s_lshl_b32 s59, s59, 18
 s_add_u32 m0, s48, 147456
 s_add_u32 s57, s59, s47
 buffer_load_dwordx4 v4, s[24:27], s57 offen offset:0 lds
 buffer_load_dwordx4 v5, s[24:27], s57 offen offset:1024 lds
 buffer_load_dwordx4 v6, s[24:27], s57 offen offset:2048 lds
 buffer_load_dwordx4 v7, s[24:27], s57 offen offset:3072 lds
 s_add_u32 s59, s52, 5
 s_cmp_ge_u32 s59, 20
 s_cselect_b32 s58, 20, 0
 s_sub_u32 s59, s59, s58
 s_lshl_b32 s59, s59, 18
 s_add_u32 m0, s48, 155648
 s_add_u32 s57, s59, s47
 buffer_load_dwordx4 v4, s[24:27], s57 offen offset:0 lds
 buffer_load_dwordx4 v5, s[24:27], s57 offen offset:1024 lds
 buffer_load_dwordx4 v6, s[24:27], s57 offen offset:2048 lds
 buffer_load_dwordx4 v7, s[24:27], s57 offen offset:3072 lds
 s_waitcnt vmcnt(28)
 s_barrier
 s_add_u32 s59, s52, 0
 s_cmp_ge_u32 s59, 20
 s_cselect_b32 s58, 20, 0
 s_sub_u32 s59, s59, s58
 s_lshl_b32 s59, s59, 18
 s_add_u32 m0, s48, 114688
 s_add_u32 s57, s59, s47
 s_add_u32 s57, s57, 256
 buffer_load_dwordx4 v4, s[24:27], s57 offen offset:0 lds
 buffer_load_dwordx4 v5, s[24:27], s57 offen offset:1024 lds
 buffer_load_dwordx4 v6, s[24:27], s57 offen offset:2048 lds
 buffer_load_dwordx4 v7, s[24:27], s57 offen offset:3072 lds
 s_waitcnt vmcnt(26)
 s_waitcnt vmcnt(22)
 s_barrier
 s_add_u32 s59, s45, 3
 s_cmp_ge_u32 s59, 10
 s_cselect_b32 s58, 10, 0
 s_sub_u32 s59, s59, s58
 s_lshl_b32 s59, s59, 7
 s_add_u32 m0, s50, 40960
 s_add_u32 s57, s59, 0
 buffer_load_dwordx4 v8, s[20:23], s57 offen offset:0 lds
 buffer_load_dwordx4 v9, s[20:23], s57 offen offset:2048 lds
 s_add_u32 m0, s50, 45056
 s_add_u32 s57, s59, 40960
 buffer_load_dwordx4 v8, s[20:23], s57 offen offset:0 lds
 buffer_load_dwordx4 v9, s[20:23], s57 offen offset:2048 lds
 s_add_u32 m0, s50, 49152
 s_add_u32 s57, s59, 81920
 buffer_load_dwordx4 v8, s[20:23], s57 offen offset:0 lds
 buffer_load_dwordx4 v9, s[20:23], s57 offen offset:2048 lds
 s_add_u32 s59, s52, 6
 s_cmp_ge_u32 s59, 20
 s_cselect_b32 s58, 20, 0
 s_sub_u32 s59, s59, s58
 s_lshl_b32 s59, s59, 18
 s_add_u32 m0, s48, 122880
 s_add_u32 s57, s59, s47
 buffer_load_dwordx4 v4, s[24:27], s57 offen offset:0 lds
 buffer_load_dwordx4 v5, s[24:27], s57 offen offset:1024 lds
 buffer_load_dwordx4 v6, s[24:27], s57 offen offset:2048 lds
 buffer_load_dwordx4 v7, s[24:27], s57 offen offset:3072 lds
 s_waitcnt vmcnt(28)
 s_barrier
 s_add_u32 s59, s52, 7
 s_cmp_ge_u32 s59, 20
 s_cselect_b32 s58, 20, 0
 s_sub_u32 s59, s59, s58
 s_lshl_b32 s59, s59, 18
 s_add_u32 m0, s48, 131072
 s_add_u32 s57, s59, s47
 buffer_load_dwordx4 v4, s[24:27], s57 offen offset:0 lds
 buffer_load_dwordx4 v5, s[24:27], s57 offen offset:1024 lds
 buffer_load_dwordx4 v6, s[24:27], s57 offen offset:2048 lds
 buffer_load_dwordx4 v7, s[24:27], s57 offen offset:3072 lds
 s_waitcnt vmcnt(26)
 s_waitcnt vmcnt(22)
 s_barrier
 s_add_u32 s59, s52, 1
 s_cmp_ge_u32 s59, 20
 s_cselect_b32 s58, 20, 0
 s_sub_u32 s59, s59, s58
 s_lshl_b32 s59, s59, 18
 s_add_u32 m0, s48, 139264
 s_add_u32 s57, s59, s47
 s_add_u32 s57, s57, 256
 buffer_load_dwordx4 v4, s[24:27], s57 offen offset:0 lds
 buffer_load_dwordx4 v5, s[24:27], s57 offen offset:1024 lds
 buffer_load_dwordx4 v6, s[24:27], s57 offen offset:2048 lds
 buffer_load_dwordx4 v7, s[24:27], s57 offen offset:3072 lds
 s_add_u32 s59, s45, 4
 s_cmp_ge_u32 s59, 10
 s_cselect_b32 s58, 10, 0
 s_sub_u32 s59, s59, s58
 s_lshl_b32 s59, s59, 7
 s_add_u32 m0, s50, 53248
 s_add_u32 s57, s59, 0
 buffer_load_dwordx4 v8, s[20:23], s57 offen offset:0 lds
 buffer_load_dwordx4 v9, s[20:23], s57 offen offset:2048 lds
 s_add_u32 m0, s50, 57344
 s_add_u32 s57, s59, 40960
 buffer_load_dwordx4 v8, s[20:23], s57 offen offset:0 lds
 buffer_load_dwordx4 v9, s[20:23], s57 offen offset:2048 lds
 s_add_u32 m0, s50, 61440
 s_add_u32 s57, s59, 81920
 buffer_load_dwordx4 v8, s[20:23], s57 offen offset:0 lds
 buffer_load_dwordx4 v9, s[20:23], s57 offen offset:2048 lds
 s_add_u32 s57, s91, 0
 s_and_b32 s57, s57, 0x1ffff
 s_add_u32 s57, s57, s48
 s_add_u32 m0, s48, 0
 s_nop 0
 buffer_load_dwordx4 v12, s[28:31], s57 offen offset:0 nt lds
 buffer_load_dwordx4 v13, s[28:31], s57 offen offset:1024 nt lds
 buffer_load_dwordx4 v14, s[28:31], s57 offen offset:2048 nt lds
 buffer_load_dwordx4 v15, s[28:31], s57 offen offset:3072 nt lds
 s_add_u32 s57, s91, 8192
 s_and_b32 s57, s57, 0x1ffff
 s_add_u32 s57, s57, s48
 s_add_u32 m0, s48, 8192
 s_nop 0
 buffer_load_dwordx4 v12, s[28:31], s57 offen offset:0 nt lds
 buffer_load_dwordx4 v13, s[28:31], s57 offen offset:1024 nt lds
 buffer_load_dwordx4 v14, s[28:31], s57 offen offset:2048 nt lds
 buffer_load_dwordx4 v15, s[28:31], s57 offen offset:3072 nt lds
 s_add_u32 s57, s91, 0
 s_and_b32 s57, s57, 0x1ffff
 s_add_u32 s57, s57, s48
 s_add_u32 m0, s48, 81920
 s_nop 0
 buffer_load_dwordx4 v16, s[32:35], s57 offen offset:0 nt lds
 buffer_load_dwordx4 v16, s[32:35], s57 offen offset:1024 nt lds
 buffer_load_dwordx4 v16, s[32:35], s57 offen offset:2048 nt lds
 buffer_load_dwordx4 v16, s[32:35], s57 offen offset:3072 nt lds
 s_add_u32 s57, s91, 16384
 s_and_b32 s57, s57, 0x1ffff
 s_add_u32 s57, s57, s48
 s_add_u32 m0, s48, 16384
 s_nop 0
 buffer_load_dwordx4 v12, s[28:31], s57 offen offset:0 nt lds
 buffer_load_dwordx4 v13, s[28:31], s57 offen offset:1024 nt lds
 buffer_load_dwordx4 v14, s[28:31], s57 offen offset:2048 nt lds
 buffer_load_dwordx4 v15, s[28:31], s57 offen offset:3072 nt lds
 s_waitcnt vmcnt(44)
 s_waitcnt vmcnt(40)
 s_barrier
 s_waitcnt vmcnt(34)
 s_waitcnt vmcnt(30)
 s_barrier
 s_waitcnt vmcnt(26)
 s_waitcnt vmcnt(22)
 s_barrier
 s_add_u32 s59, s52, 8
 s_cmp_ge_u32 s59, 20
 s_cselect_b32 s58, 20, 0
 s_sub_u32 s59, s59, s58
 s_lshl_b32 s59, s59, 18
 s_add_u32 m0, s48, 147456
 s_add_u32 s57, s59, s47
 buffer_load_dwordx4 v4, s[24:27], s57 offen offset:0 lds
 buffer_load_dwordx4 v5, s[24:27], s57 offen offset:1024 lds
 buffer_load_dwordx4 v6, s[24:27], s57 offen offset:2048 lds
 buffer_load_dwordx4 v7, s[24:27], s57 offen offset:3072 lds
 s_add_u32 s59, s52, 9
 s_cmp_ge_u32 s59, 20
 s_cselect_b32 s58, 20, 0
 s_sub_u32 s59, s59, s58
 s_lshl_b32 s59, s59, 18
 s_add_u32 m0, s48, 155648
 s_add_u32 s57, s59, s47
 buffer_load_dwordx4 v4, s[24:27], s57 offen offset:0 lds
 buffer_load_dwordx4 v5, s[24:27], s57 offen offset:1024 lds
 buffer_load_dwordx4 v6, s[24:27], s57 offen offset:2048 lds
 buffer_load_dwordx4 v7, s[24:27], s57 offen offset:3072 lds
 s_add_u32 s59, s52, 2
 s_cmp_ge_u32 s59, 20
 s_cselect_b32 s58, 20, 0
 s_sub_u32 s59, s59, s58
 s_lshl_b32 s59, s59, 18
 s_add_u32 m0, s48, 114688
 s_add_u32 s57, s59, s47
 s_add_u32 s57, s57, 256
 buffer_load_dwordx4 v4, s[24:27], s57 offen offset:0 lds
 buffer_load_dwordx4 v5, s[24:27], s57 offen offset:1024 lds
 buffer_load_dwordx4 v6, s[24:27], s57 offen offset:2048 lds
 buffer_load_dwordx4 v7, s[24:27], s57 offen offset:3072 lds
 s_waitcnt vmcnt(28)
 s_waitcnt vmcnt(8)
 s_barrier
 s_add_u32 s59, s45, 5
 s_cmp_ge_u32 s59, 10
 s_cselect_b32 s58, 10, 0
 s_sub_u32 s59, s59, s58
 s_lshl_b32 s59, s59, 7
 s_add_u32 m0, s50, 65536
 s_add_u32 s57, s59, 0
 buffer_load_dwordx4 v8, s[20:23], s57 offen offset:0 lds
 buffer_load_dwordx4 v9, s[20:23], s57 offen offset:2048 lds
 s_add_u32 m0, s50, 69632
 s_add_u32 s57, s59, 40960
 buffer_load_dwordx4 v8, s[20:23], s57 offen offset:0 lds
 buffer_load_dwordx4 v9, s[20:23], s57 offen offset:2048 lds
 s_add_u32 m0, s50, 73728
 s_add_u32 s57, s59, 81920
 buffer_load_dwordx4 v8, s[20:23], s57 offen offset:0 lds
 buffer_load_dwordx4 v9, s[20:23], s57 offen offset:2048 lds
 s_add_u32 s59, s52, 10
 s_cmp_ge_u32 s59, 20
 s_cselect_b32 s58, 20, 0
 s_sub_u32 s59, s59, s58
 s_lshl_b32 s59, s59, 18
 s_add_u32 m0, s48, 122880
 s_add_u32 s57, s59, s47
 buffer_load_dwordx4 v4, s[24:27], s57 offen offset:0 lds
 buffer_load_dwordx4 v5, s[24:27], s57 offen offset:1024 lds
 buffer_load_dwordx4 v6, s[24:27], s57 offen offset:2048 lds
 buffer_load_dwordx4 v7, s[24:27], s57 offen offset:3072 lds
 s_add_u32 s59, s52, 11
 s_cmp_ge_u32 s59, 20
 s_cselect_b32 s58, 20, 0
 s_sub_u32 s59, s59, s58
 s_lshl_b32 s59, s59, 18
 s_add_u32 m0, s48, 131072
 s_add_u32 s57, s59, s47
 buffer_load_dwordx4 v4, s[24:27], s57 offen offset:0 lds
 buffer_load_dwordx4 v5, s[24:27], s57 offen offset:1024 lds
 buffer_load_dwordx4 v6, s[24:27], s57 offen offset:2048 lds
 buffer_load_dwordx4 v7, s[24:27], s57 offen offset:3072 lds
 s_add_u32 s59, s52, 3
 s_cmp_ge_u32 s59, 20
 s_cselect_b32 s58, 20, 0
 s_sub_u32 s59, s59, s58
 s_lshl_b32 s59, s59, 18
 s_add_u32 m0, s48, 139264
 s_add_u32 s57, s59, s47
 s_add_u32 s57, s57, 256
 buffer_load_dwordx4 v4, s[24:27], s57 offen offset:0 lds
 buffer_load_dwordx4 v5, s[24:27], s57 offen offset:1024 lds
 buffer_load_dwordx4 v6, s[24:27], s57 offen offset:2048 lds
 buffer_load_dwordx4 v7, s[24:27], s57 offen offset:3072 lds
 s_waitcnt vmcnt(22)
 s_waitcnt vmcnt(18)
 s_barrier
 s_add_u32 s59, s45, 6
 s_cmp_ge_u32 s59, 10
 s_cselect_b32 s58, 10, 0
 s_sub_u32 s59, s59, s58
 s_lshl_b32 s59, s59, 7
 s_add_u32 m0, s50, 40960
 s_add_u32 s57, s59, 0
 buffer_load_dwordx4 v8, s[20:23], s57 offen offset:0 lds
 buffer_load_dwordx4 v9, s[20:23], s57 offen offset:2048 lds
 s_add_u32 m0, s50, 45056
 s_add_u32 s57, s59, 40960
 buffer_load_dwordx4 v8, s[20:23], s57 offen offset:0 lds
 buffer_load_dwordx4 v9, s[20:23], s57 offen offset:2048 lds
 s_add_u32 m0, s50, 49152
 s_add_u32 s57, s59, 81920
 buffer_load_dwordx4 v8, s[20:23], s57 offen offset:0 lds
 buffer_load_dwordx4 v9, s[20:23], s57 offen offset:2048 lds
 s_add_u32 s59, s52, 12
 s_cmp_ge_u32 s59, 20
 s_cselect_b32 s58, 20, 0
 s_sub_u32 s59, s59, s58
 s_lshl_b32 s59, s59, 18
 s_add_u32 m0, s48, 147456
 s_add_u32 s57, s59, s47
 buffer_load_dwordx4 v4, s[24:27], s57 offen offset:0 lds
 buffer_load_dwordx4 v5, s[24:27], s57 offen offset:1024 lds
 buffer_load_dwordx4 v6, s[24:27], s57 offen offset:2048 lds
 buffer_load_dwordx4 v7, s[24:27], s57 offen offset:3072 lds
 s_add_u32 s57, s91, 8192
 s_and_b32 s57, s57, 0x1ffff
 s_add_u32 s57, s57, s48
 s_add_u32 m0, s48, 90112
 s_nop 0
 buffer_load_dwordx4 v16, s[32:35], s57 offen offset:0 nt lds
 buffer_load_dwordx4 v16, s[32:35], s57 offen offset:1024 nt lds
 buffer_load_dwordx4 v16, s[32:35], s57 offen offset:2048 nt lds
 buffer_load_dwordx4 v16, s[32:35], s57 offen offset:3072 nt lds
 s_add_u32 s57, s91, 24576
 s_and_b32 s57, s57, 0x1ffff
 s_add_u32 s57, s57, s48
 s_add_u32 m0, s48, 24576
 s_nop 0
 buffer_load_dwordx4 v12, s[28:31], s57 offen offset:0 nt lds
 buffer_load_dwordx4 v13, s[28:31], s57 offen offset:1024 nt lds
 buffer_load_dwordx4 v14, s[28:31], s57 offen offset:2048 nt lds
 buffer_load_dwordx4 v15, s[28:31], s57 offen offset:3072 nt lds
 s_add_u32 s57, s91, 16384
 s_and_b32 s57, s57, 0x1ffff
 s_add_u32 s57, s57, s48
 s_add_u32 m0, s48, 98304
 s_nop 0
 buffer_load_dwordx4 v16, s[32:35], s57 offen offset:0 nt lds
 buffer_load_dwordx4 v16, s[32:35], s57 offen offset:1024 nt lds
 buffer_load_dwordx4 v16, s[32:35], s57 offen offset:2048 nt lds
 buffer_load_dwordx4 v16, s[32:35], s57 offen offset:3072 nt lds
 s_add_u32 s57, s91, 32768
 s_and_b32 s57, s57, 0x1ffff
 s_add_u32 s57, s57, s48
 s_add_u32 m0, s48, 32768
 s_nop 0
 buffer_load_dwordx4 v12, s[28:31], s57 offen offset:0 nt lds
 buffer_load_dwordx4 v13, s[28:31], s57 offen offset:1024 nt lds
 buffer_load_dwordx4 v14, s[28:31], s57 offen offset:2048 nt lds
 buffer_load_dwordx4 v15, s[28:31], s57 offen offset:3072 nt lds
 s_waitcnt vmcnt(38)
 s_waitcnt vmcnt(34)
 s_barrier
 s_waitcnt vmcnt(30)
 s_waitcnt vmcnt(26)
 s_barrier
 s_waitcnt vmcnt(20)
 s_waitcnt vmcnt(16)
 s_barrier
 s_add_u32 s59, s52, 13
 s_cmp_ge_u32 s59, 20
 s_cselect_b32 s58, 20, 0
 s_sub_u32 s59, s59, s58
 s_lshl_b32 s59, s59, 18
 s_add_u32 m0, s48, 155648
 s_add_u32 s57, s59, s47
 buffer_load_dwordx4 v4, s[24:27], s57 offen offset:0 lds
 buffer_load_dwordx4 v5, s[24:27], s57 offen offset:1024 lds
 buffer_load_dwordx4 v6, s[24:27], s57 offen offset:2048 lds
 buffer_load_dwordx4 v7, s[24:27], s57 offen offset:3072 lds
 s_add_u32 s59, s52, 4
 s_cmp_ge_u32 s59, 20
 s_cselect_b32 s58, 20, 0
 s_sub_u32 s59, s59, s58
 s_lshl_b32 s59, s59, 18
 s_add_u32 m0, s48, 114688
 s_add_u32 s57, s59, s47
 s_add_u32 s57, s57, 256
 buffer_load_dwordx4 v4, s[24:27], s57 offen offset:0 lds
 buffer_load_dwordx4 v5, s[24:27], s57 offen offset:1024 lds
 buffer_load_dwordx4 v6, s[24:27], s57 offen offset:2048 lds
 buffer_load_dwordx4 v7, s[24:27], s57 offen offset:3072 lds
 s_add_u32 s59, s45, 7
 s_cmp_ge_u32 s59, 10
 s_cselect_b32 s58, 10, 0
 s_sub_u32 s59, s59, s58
 s_lshl_b32 s59, s59, 7
 s_add_u32 m0, s50, 53248
 s_add_u32 s57, s59, 0
 buffer_load_dwordx4 v8, s[20:23], s57 offen offset:0 lds
 buffer_load_dwordx4 v9, s[20:23], s57 offen offset:2048 lds
 s_add_u32 m0, s50, 57344
 s_add_u32 s57, s59, 40960
 buffer_load_dwordx4 v8, s[20:23], s57 offen offset:0 lds
 buffer_load_dwordx4 v9, s[20:23], s57 offen offset:2048 lds
 s_add_u32 m0, s50, 61440
 s_add_u32 s57, s59, 81920
 buffer_load_dwordx4 v8, s[20:23], s57 offen offset:0 lds
 buffer_load_dwordx4 v9, s[20:23], s57 offen offset:2048 lds
 s_add_u32 s59, s52, 14
 s_cmp_ge_u32 s59, 20
 s_cselect_b32 s58, 20, 0
 s_sub_u32 s59, s59, s58
 s_lshl_b32 s59, s59, 18
 s_add_u32 m0, s48, 122880
 s_add_u32 s57, s59, s47
 buffer_load_dwordx4 v4, s[24:27], s57 offen offset:0 lds
 buffer_load_dwordx4 v5, s[24:27], s57 offen offset:1024 lds
 buffer_load_dwordx4 v6, s[24:27], s57 offen offset:2048 lds
 buffer_load_dwordx4 v7, s[24:27], s57 offen offset:3072 lds
 s_waitcnt vmcnt(14)
 s_waitcnt vmcnt(10)
 s_barrier
 s_add_u32 s59, s52, 15
 s_cmp_ge_u32 s59, 20
 s_cselect_b32 s58, 20, 0
 s_sub_u32 s59, s59, s58
 s_lshl_b32 s59, s59, 18
 s_add_u32 m0, s48, 131072
 s_add_u32 s57, s59, s47
 buffer_load_dwordx4 v4, s[24:27], s57 offen offset:0 lds
 buffer_load_dwordx4 v5, s[24:27], s57 offen offset:1024 lds
 buffer_load_dwordx4 v6, s[24:27], s57 offen offset:2048 lds
 buffer_load_dwordx4 v7, s[24:27], s57 offen offset:3072 lds
 s_add_u32 s59, s52, 5
 s_cmp_ge_u32 s59, 20
 s_cselect_b32 s58, 20, 0
 s_sub_u32 s59, s59, s58
 s_lshl_b32 s59, s59, 18
 s_add_u32 m0, s48, 139264
 s_add_u32 s57, s59, s47
 s_add_u32 s57, s57, 256
 buffer_load_dwordx4 v4, s[24:27], s57 offen offset:0 lds
 buffer_load_dwordx4 v5, s[24:27], s57 offen offset:1024 lds
 buffer_load_dwordx4 v6, s[24:27], s57 offen offset:2048 lds
 buffer_load_dwordx4 v7, s[24:27], s57 offen offset:3072 lds
 s_add_u32 s59, s45, 8
 s_cmp_ge_u32 s59, 10
 s_cselect_b32 s58, 10, 0
 s_sub_u32 s59, s59, s58
 s_lshl_b32 s59, s59, 7
 s_add_u32 m0, s50, 65536
 s_add_u32 s57, s59, 0
 buffer_load_dwordx4 v8, s[20:23], s57 offen offset:0 lds
 buffer_load_dwordx4 v9, s[20:23], s57 offen offset:2048 lds
 s_add_u32 m0, s50, 69632
 s_add_u32 s57, s59, 40960
 buffer_load_dwordx4 v8, s[20:23], s57 offen offset:0 lds
 buffer_load_dwordx4 v9, s[20:23], s57 offen offset:2048 lds
 s_add_u32 m0, s50, 73728
 s_add_u32 s57, s59, 81920
 buffer_load_dwordx4 v8, s[20:23], s57 offen offset:0 lds
 buffer_load_dwordx4 v9, s[20:23], s57 offen offset:2048 lds
 s_add_u32 s59, s52, 16
 s_cmp_ge_u32 s59, 20
 s_cselect_b32 s58, 20, 0
 s_sub_u32 s59, s59, s58
 s_lshl_b32 s59, s59, 18
 s_add_u32 m0, s48, 147456
 s_add_u32 s57, s59, s47
 buffer_load_dwordx4 v4, s[24:27], s57 offen offset:0 lds
 buffer_load_dwordx4 v5, s[24:27], s57 offen offset:1024 lds
 buffer_load_dwordx4 v6, s[24:27], s57 offen offset:2048 lds
 buffer_load_dwordx4 v7, s[24:27], s57 offen offset:3072 lds
 s_waitcnt vmcnt(22)
 s_waitcnt vmcnt(18)
 s_barrier
 s_add_u32 s59, s52, 17
 s_cmp_ge_u32 s59, 20
 s_cselect_b32 s58, 20, 0
 s_sub_u32 s59, s59, s58
 s_lshl_b32 s59, s59, 18
 s_add_u32 m0, s48, 155648
 s_add_u32 s57, s59, s47
 buffer_load_dwordx4 v4, s[24:27], s57 offen offset:0 lds
 buffer_load_dwordx4 v5, s[24:27], s57 offen offset:1024 lds
 buffer_load_dwordx4 v6, s[24:27], s57 offen offset:2048 lds
 buffer_load_dwordx4 v7, s[24:27], s57 offen offset:3072 lds
 s_add_u32 s59, s52, 6
 s_cmp_ge_u32 s59, 20
 s_cselect_b32 s58, 20, 0
 s_sub_u32 s59, s59, s58
 s_lshl_b32 s59, s59, 18
 s_add_u32 m0, s48, 114688
 s_add_u32 s57, s59, s47
 s_add_u32 s57, s57, 256
 buffer_load_dwordx4 v4, s[24:27], s57 offen offset:0 lds
 buffer_load_dwordx4 v5, s[24:27], s57 offen offset:1024 lds
 buffer_load_dwordx4 v6, s[24:27], s57 offen offset:2048 lds
 buffer_load_dwordx4 v7, s[24:27], s57 offen offset:3072 lds
 s_add_u32 s59, s45, 9
 s_cmp_ge_u32 s59, 10
 s_cselect_b32 s58, 10, 0
 s_sub_u32 s59, s59, s58
 s_lshl_b32 s59, s59, 7
 s_add_u32 m0, s50, 40960
 s_add_u32 s57, s59, 0
 buffer_load_dwordx4 v8, s[20:23], s57 offen offset:0 lds
 buffer_load_dwordx4 v9, s[20:23], s57 offen offset:2048 lds
 s_add_u32 m0, s50, 45056
 s_add_u32 s57, s59, 40960
 buffer_load_dwordx4 v8, s[20:23], s57 offen offset:0 lds
 buffer_load_dwordx4 v9, s[20:23], s57 offen offset:2048 lds
 s_add_u32 m0, s50, 49152
 s_add_u32 s57, s59, 81920
 buffer_load_dwordx4 v8, s[20:23], s57 offen offset:0 lds
 buffer_load_dwordx4 v9, s[20:23], s57 offen offset:2048 lds
 s_add_u32 s57, s91, 24576
 s_and_b32 s57, s57, 0x1ffff
 s_add_u32 s57, s57, s48
 s_add_u32 m0, s48, 106496
 s_nop 0
 buffer_load_dwordx4 v16, s[32:35], s57 offen offset:0 nt lds
 buffer_load_dwordx4 v16, s[32:35], s57 offen offset:1024 nt lds
 buffer_load_dwordx4 v16, s[32:35], s57 offen offset:2048 nt lds
 buffer_load_dwordx4 v16, s[32:35], s57 offen offset:3072 nt lds
 s_mov_b32 s57, 0
 buffer_load_dwordx4 v[32:35], v30, s[84:87], s57 offen offset:0
 buffer_load_dwordx4 v[32:35], v30, s[84:87], s57 offen offset:1024
 buffer_load_dwordx4 v[32:35], v30, s[84:87], s57 offen offset:2048
 buffer_load_dwordx4 v[32:35], v30, s[84:87], s57 offen offset:3072
 s_mov_b32 s57, 4096
 buffer_load_dwordx4 v[32:35], v30, s[84:87], s57 offen offset:0
 buffer_load_dwordx4 v[32:35], v30, s[84:87], s57 offen offset:1024
 buffer_load_dwordx4 v[32:35], v30, s[84:87], s57 offen offset:2048
 buffer_load_dwordx4 v[32:35], v30, s[84:87], s57 offen offset:3072
 s_mov_b32 s57, 8192
 buffer_load_dwordx4 v[32:35], v30, s[84:87], s57 offen offset:0
 buffer_load_dwordx4 v[32:35], v30, s[84:87], s57 offen offset:1024
 buffer_load_dwordx4 v[32:35], v30, s[84:87], s57 offen offset:2048
 buffer_load_dwordx4 v[32:35], v30, s[84:87], s57 offen offset:3072
 s_waitcnt vmcnt(44)
 s_waitcnt vmcnt(40)
 s_barrier
 s_waitcnt vmcnt(34)
 s_waitcnt vmcnt(30)
 s_barrier
 s_waitcnt vmcnt(26)
 s_waitcnt vmcnt(22)
 s_barrier
 s_add_u32 s59, s52, 18
 s_cmp_ge_u32 s59, 20
 s_cselect_b32 s58, 20, 0
 s_sub_u32 s59, s59, s58
 s_lshl_b32 s59, s59, 18
 s_add_u32 m0, s48, 122880
 s_add_u32 s57, s59, s47
 buffer_load_dwordx4 v4, s[24:27], s57 offen offset:0 lds
 buffer_load_dwordx4 v5, s[24:27], s57 offen offset:1024 lds
 buffer_load_dwordx4 v6, s[24:27], s57 offen offset:2048 lds
 buffer_load_dwordx4 v7, s[24:27], s57 offen offset:3072 lds
 s_add_u32 s59, s52, 19
 s_cmp_ge_u32 s59, 20
 s_cselect_b32 s58, 20, 0
 s_sub_u32 s59, s59, s58
 s_lshl_b32 s59, s59, 18
 s_add_u32 m0, s48, 131072
 s_add_u32 s57, s59, s47
 buffer_load_dwordx4 v4, s[24:27], s57 offen offset:0 lds
 buffer_load_dwordx4 v5, s[24:27], s57 offen offset:1024 lds
 buffer_load_dwordx4 v6, s[24:27], s57 offen offset:2048 lds
 buffer_load_dwordx4 v7, s[24:27], s57 offen offset:3072 lds
 s_add_u32 s59, s52, 7
 s_cmp_ge_u32 s59, 20
 s_cselect_b32 s58, 20, 0
 s_sub_u32 s59, s59, s58
 s_lshl_b32 s59, s59, 18
 s_add_u32 m0, s48, 139264
 s_add_u32 s57, s59, s47
 s_add_u32 s57, s57, 256
 buffer_load_dwordx4 v4, s[24:27], s57 offen offset:0 lds
 buffer_load_dwordx4 v5, s[24:27], s57 offen offset:1024 lds
 buffer_load_dwordx4 v6, s[24:27], s57 offen offset:2048 lds
 buffer_load_dwordx4 v7, s[24:27], s57 offen offset:3072 lds
 s_mov_b32 s57, 12288
 buffer_load_dwordx4 v[32:35], v30, s[84:87], s57 offen offset:0
 buffer_load_dwordx4 v[32:35], v30, s[84:87], s57 offen offset:1024
 buffer_load_dwordx4 v[32:35], v30, s[84:87], s57 offen offset:2048
 buffer_load_dwordx4 v[32:35], v30, s[84:87], s57 offen offset:3072
 s_mov_b32 s57, 16384
 buffer_load_dwordx4 v[32:35], v30, s[84:87], s57 offen offset:0
 buffer_load_dwordx4 v[32:35], v30, s[84:87], s57 offen offset:1024
 buffer_load_dwordx4 v[32:35], v30, s[84:87], s57 offen offset:2048
 buffer_load_dwordx4 v[32:35], v30, s[84:87], s57 offen offset:3072
 s_waitcnt vmcnt(36)
 s_waitcnt vmcnt(16)
 s_barrier
 s_waitcnt vmcnt(12)
 s_waitcnt vmcnt(8)
 s_barrier
 s_branch K_clsj
K_cls1:
 s_waitcnt vmcnt(22)
 s_waitcnt vmcnt(18)
 s_barrier
 s_add_u32 s59, s45, 2
 s_cmp_ge_u32 s59, 10
 s_cselect_b32 s58, 10, 0
 s_sub_u32 s59, s59, s58
 s_lshl_b32 s59, s59, 7
 s_add_u32 m0, s50, 65536
 s_add_u32 s57, s59, 0
 buffer_load_dwordx4 v8, s[20:23], s57 offen offset:0 lds
 buffer_load_dwordx4 v9, s[20:23], s57 offen offset:2048 lds
 s_add_u32 m0, s50, 69632
 s_add_u32 s57, s59, 40960
 buffer_load_dwordx4 v8, s[20:23], s57 offen offset:0 lds
 buffer_load_dwordx4 v9, s[20:23], s57 offen offset:2048 lds
 s_add_u32 m0, s50, 73728
 s_add_u32 s57, s59, 81920
 buffer_load_dwordx4 v8, s[20:23], s57 offen offset:0 lds
 buffer_load_dwordx4 v9, s[20:23], s57 offen offset:2048 lds
 s_add_u32 s59, s52, 4
 s_cmp_ge_u32 s59, 20
 s_cselect_b32 s58, 20, 0
 s_sub_u32 s59, s59, s58
 s_lshl_b32 s59, s59, 18
 s_add_u32 m0, s48, 147456
 s_add_u32 s57, s59, s47
 buffer_load_dwordx4 v4, s[24:27], s57 offen offset:0 lds
 buffer_load_dwordx4 v5, s[24:27], s57 offen offset:1024 lds
 buffer_load_dwordx4 v6, s[24:27], s57 offen offset:2048 lds
 buffer_load_dwordx4 v7, s[24:27], s57 offen offset:3072 lds
 s_add_u32 s59, s52, 5
 s_cmp_ge_u32 s59, 20
 s_cselect_b32 s58, 20, 0
 s_sub_u32 s59, s59, s58
 s_lshl_b32 s59, s59, 18
 s_add_u32 m0, s48, 155648
 s_add_u32 s57, s59, s47
 buffer_load_dwordx4 v4, s[24:27], s57 offen offset:0 lds
 buffer_load_dwordx4 v5, s[24:27], s57 offen offset:1024 lds
 buffer_load_dwordx4 v6, s[24:27], s57 offen offset:2048 lds
 buffer_load_dwordx4 v7, s[24:27], s57 offen offset:3072 lds
 s_waitcnt vmcnt(28)
 s_barrier
 s_add_u32 s59, s52, 0
 s_cmp_ge_u32 s59, 20
 s_cselect_b32 s58, 20, 0
 s_sub_u32 s59, s59, s58
 s_lshl_b32 s59, s59, 18
 s_add_u32 m0, s48, 114688
 s_add_u32 s57, s59, s47
 s_add_u32 s57, s57, 256
 buffer_load_dwordx4 v4, s[24:27], s57 offen offset:0 lds
 buffer_load_dwordx4 v5, s[24:27], s57 offen offset:1024 lds
 buffer_load_dwordx4 v6, s[24:27], s57 offen offset:2048 lds
 buffer_load_dwordx4 v7, s[24:27], s57 offen offset:3072 lds
 s_waitcnt vmcnt(26)
 s_waitcnt vmcnt(22)
 s_barrier
 s_add_u32 s59, s45, 3
 s_cmp_ge_u32 s59, 10
 s_cselect_b32 s58, 10, 0
 s_sub_u32 s59, s59, s58
 s_lshl_b32 s59, s59, 7
 s_add_u32 m0, s50, 40960
 s_add_u32 s57, s59, 0
 buffer_load_dwordx4 v8, s[20:23], s57 offen offset:0 lds
 buffer_load_dwordx4 v9, s[20:23], s57 offen offset:2048 lds
 s_add_u32 m0, s50, 45056
 s_add_u32 s57, s59, 40960
 buffer_load_dwordx4 v8, s[20:23], s57 offen offset:0 lds
 buffer_load_dwordx4 v9, s[20:23], s57 offen offset:2048 lds
 s_add_u32 m0, s50, 49152
 s_add_u32 s57, s59, 81920
 buffer_load_dwordx4 v8, s[20:23], s57 offen offset:0 lds
 buffer_load_dwordx4 v9, s[20:23], s57 offen offset:2048 lds
 s_add_u32 s59, s52, 6
 s_cmp_ge_u32 s59, 20
 s_cselect_b32 s58, 20, 0
 s_sub_u32 s59, s59, s58
 s_lshl_b32 s59, s59, 18
 s_add_u32 m0, s48, 122880
 s_add_u32 s57, s59, s47
 buffer_load_dwordx4 v4, s[24:27], s57 offen offset:0 lds
 buffer_load_dwordx4 v5, s[24:27], s57 offen offset:1024 lds
 buffer_load_dwordx4 v6, s[24:27], s57 offen offset:2048 lds
 buffer_load_dwordx4 v7, s[24:27], s57 offen offset:3072 lds
 s_waitcnt vmcnt(28)
 s_barrier
 s_add_u32 s59, s52, 7
 s_cmp_ge_u32 s59, 20
 s_cselect_b32 s58, 20, 0
 s_sub_u32 s59, s59, s58
 s_lshl_b32 s59, s59, 18
 s_add_u32 m0, s48, 131072
 s_add_u32 s57, s59, s47
 buffer_load_dwordx4 v4, s[24:27], s57 offen offset:0 lds
 buffer_load_dwordx4 v5, s[24:27], s57 offen offset:1024 lds
 buffer_load_dwordx4 v6, s[24:27], s57 offen offset:2048 lds
 buffer_load_dwordx4 v7, s[24:27], s57 offen offset:3072 lds
 s_waitcnt vmcnt(26)
 s_waitcnt vmcnt(22)
 s_barrier
 s_add_u32 s59, s52, 1
 s_cmp_ge_u32 s59, 20
 s_cselect_b32 s58, 20, 0
 s_sub_u32 s59, s59, s58
 s_lshl_b32 s59, s59, 18
 s_add_u32 m0, s48, 139264
 s_add_u32 s57, s59, s47
 s_add_u32 s57, s57, 256
 buffer_load_dwordx4 v4, s[24:27], s57 offen offset:0 lds
 buffer_load_dwordx4 v5, s[24:27], s57 offen offset:1024 lds
 buffer_load_dwordx4 v6, s[24:27], s57 offen offset:2048 lds
 buffer_load_dwordx4 v7, s[24:27], s57 offen offset:3072 lds
 s_add_u32 s59, s45, 4
 s_cmp_ge_u32 s59, 10
 s_cselect_b32 s58, 10, 0
 s_sub_u32 s59, s59, s58
 s_lshl_b32 s59, s59, 7
 s_add_u32 m0, s50, 53248
 s_add_u32 s57, s59, 0
 buffer_load_dwordx4 v8, s[20:23], s57 offen offset:0 lds
 buffer_load_dwordx4 v9, s[20:23], s57 offen offset:2048 lds
 s_add_u32 m0, s50, 57344
 s_add_u32 s57, s59, 40960
 buffer_load_dwordx4 v8, s[20:23], s57 offen offset:0 lds
 buffer_load_dwordx4 v9, s[20:23], s57 offen offset:2048 lds
 s_add_u32 m0, s50, 61440
 s_add_u32 s57, s59, 81920
 buffer_load_dwordx4 v8, s[20:23], s57 offen offset:0 lds
 buffer_load_dwordx4 v9, s[20:23], s57 offen offset:2048 lds
 s_waitcnt vmcnt(28)
 s_waitcnt vmcnt(24)
 s_barrier
 s_add_u32 s59, s52, 8
 s_cmp_ge_u32 s59, 20
 s_cselect_b32 s58, 20, 0
 s_sub_u32 s59, s59, s58
 s_lshl_b32 s59, s59, 18
 s_add_u32 m0, s48, 147456
 s_add_u32 s57, s59, s47
 buffer_load_dwordx4 v4, s[24:27], s57 offen offset:0 lds
 buffer_load_dwordx4 v5, s[24:27], s57 offen offset:1024 lds
 buffer_load_dwordx4 v6, s[24:27], s57 offen offset:2048 lds
 buffer_load_dwordx4 v7, s[24:27], s57 offen offset:3072 lds
 s_waitcnt vmcnt(22)
 s_waitcnt vmcnt(18)
 s_barrier
 s_add_u32 s59, s52, 9
 s_cmp_ge_u32 s59, 20
 s_cselect_b32 s58, 20, 0
 s_sub_u32 s59, s59, s58
 s_lshl_b32 s59, s59, 18
 s_add_u32 m0, s48, 155648
 s_add_u32 s57, s59, s47
 buffer_load_dwordx4 v4, s[24:27], s57 offen offset:0 lds
 buffer_load_dwordx4 v5, s[24:27], s57 offen offset:1024 lds
 buffer_load_dwordx4 v6, s[24:27], s57 offen offset:2048 lds
 buffer_load_dwordx4 v7, s[24:27], s57 offen offset:3072 lds
 s_add_u32 s59, s52, 2
 s_cmp_ge_u32 s59, 20
 s_cselect_b32 s58, 20, 0
 s_sub_u32 s59, s59, s58
 s_lshl_b32 s59, s59, 18
 s_add_u32 m0, s48, 114688
 s_add_u32 s57, s59, s47
 s_add_u32 s57, s57, 256
 buffer_load_dwordx4 v4, s[24:27], s57 offen offset:0 lds
 buffer_load_dwordx4 v5, s[24:27], s57 offen offset:1024 lds
 buffer_load_dwordx4 v6, s[24:27], s57 offen offset:2048 lds
 buffer_load_dwordx4 v7, s[24:27], s57 offen offset:3072 lds
 s_add_u32 s59, s45, 5
 s_cmp_ge_u32 s59, 10
 s_cselect_b32 s58, 10, 0
 s_sub_u32 s59, s59, s58
 s_lshl_b32 s59, s59, 7
 s_add_u32 m0, s50, 65536
 s_add_u32 s57, s59, 0
 buffer_load_dwordx4 v8, s[20:23], s57 offen offset:0 lds
 buffer_load_dwordx4 v9, s[20:23], s57 offen offset:2048 lds
 s_add_u32 m0, s50, 69632
 s_add_u32 s57, s59, 40960
 buffer_load_dwordx4 v8, s[20:23], s57 offen offset:0 lds
 buffer_load_dwordx4 v9, s[20:23], s57 offen offset:2048 lds
 s_add_u32 m0, s50, 73728
 s_add_u32 s57, s59, 81920
 buffer_load_dwordx4 v8, s[20:23], s57 offen offset:0 lds
 buffer_load_dwordx4 v9, s[20:23], s57 offen offset:2048 lds
 s_add_u32 s57, s91, 0
 s_and_b32 s57, s57, 0x1ffff
 s_add_u32 s57, s57, s48
 s_add_u32 m0, s48, 0
 s_nop 0
 buffer_load_dwordx4 v12, s[28:31], s57 offen offset:0 nt lds
 buffer_load_dwordx4 v13, s[28:31], s57 offen offset:1024 nt lds
 buffer_load_dwordx4 v14, s[28:31], s57 offen offset:2048 nt lds
 buffer_load_dwordx4 v15, s[28:31], s57 offen offset:3072 nt lds
 s_add_u32 s57, s91, 8192
 s_and_b32 s57, s57, 0x1ffff
 s_add_u32 s57, s57, s48
 s_add_u32 m0, s48, 8192
 s_nop 0
 buffer_load_dwordx4 v12, s[28:31], s57 offen offset:0 nt lds
 buffer_load_dwordx4 v13, s[28:31], s57 offen offset:1024 nt lds
 buffer_load_dwordx4 v14, s[28:31], s57 offen offset:2048 nt lds
 buffer_load_dwordx4 v15, s[28:31], s57 offen offset:3072 nt lds
 s_add_u32 s57, s91, 0
 s_and_b32 s57, s57, 0x1ffff
 s_add_u32 s57, s57, s48
 s_add_u32 m0, s48, 81920
 s_nop 0
 buffer_load_dwordx4 v16, s[32:35], s57 offen offset:0 nt lds
 buffer_load_dwordx4 v16, s[32:35], s57 offen offset:1024 nt lds
 buffer_load_dwordx4 v16, s[32:35], s57 offen offset:2048 nt lds
 buffer_load_dwordx4 v16, s[32:35], s57 offen offset:3072 nt lds
 s_add_u32 s57, s91, 16384
 s_and_b32 s57, s57, 0x1ffff
 s_add_u32 s57, s57, s48
 s_add_u32 m0, s48, 16384
 s_nop 0
 buffer_load_dwordx4 v12, s[28:31], s57 offen offset:0 nt lds
 buffer_load_dwordx4 v13, s[28:31], s57 offen offset:1024 nt lds
 buffer_load_dwordx4 v14, s[28:31], s57 offen offset:2048 nt lds
 buffer_load_dwordx4 v15, s[28:31], s57 offen offset:3072 nt lds
 s_waitcnt vmcnt(44)
 s_waitcnt vmcnt(40)
 s_barrier
 s_waitcnt vmcnt(34)
 s_waitcnt vmcnt(30)
 s_barrier
 s_waitcnt vmcnt(26)
 s_waitcnt vmcnt(22)
 s_barrier
 s_add_u32 s59, s52, 10
 s_cmp_ge_u32 s59, 20
 s_cselect_b32 s58, 20, 0
 s_sub_u32 s59, s59, s58
 s_lshl_b32 s59, s59, 18
 s_add_u32 m0, s48, 122880
 s_add_u32 s57, s59, s47
 buffer_load_dwordx4 v4, s[24:27], s57 offen offset:0 lds
 buffer_load_dwordx4 v5, s[24:27], s57 offen offset:1024 lds
 buffer_load_dwordx4 v6, s[24:27], s57 offen offset:2048 lds
 buffer_load_dwordx4 v7, s[24:27], s57 offen offset:3072 lds
 s_add_u32 s59, s52, 11
 s_cmp_ge_u32 s59, 20
 s_cselect_b32 s58, 20, 0
 s_sub_u32 s59, s59, s58
 s_lshl_b32 s59, s59, 18
 s_add_u32 m0, s48, 131072
 s_add_u32 s57, s59, s47
 buffer_load_dwordx4 v4, s[24:27], s57 offen offset:0 lds
 buffer_load_dwordx4 v5, s[24:27], s57 offen offset:1024 lds
 buffer_load_dwordx4 v6, s[24:27], s57 offen offset:2048 lds
 buffer_load_dwordx4 v7, s[24:27], s57 offen offset:3072 lds
 s_add_u32 s59, s52, 3
 s_cmp_ge_u32 s59, 20
 s_cselect_b32 s58, 20, 0
 s_sub_u32 s59, s59, s58
 s_lshl_b32 s59, s59, 18
 s_add_u32 m0, s48, 139264
 s_add_u32 s57, s59, s47
 s_add_u32 s57, s57, 256
 buffer_load_dwordx4 v4, s[24:27], s57 offen offset:0 lds
 buffer_load_dwordx4 v5, s[24:27], s57 offen offset:1024 lds
 buffer_load_dwordx4 v6, s[24:27], s57 offen offset:2048 lds
 buffer_load_dwordx4 v7, s[24:27], s57 offen offset:3072 lds
 s_waitcnt vmcnt(28)
 s_waitcnt vmcnt(8)
 s_barrier
 s_add_u32 s59, s45, 6
 s_cmp_ge_u32 s59, 10
 s_cselect_b32 s58, 10, 0
 s_sub_u32 s59, s59, s58
 s_lshl_b32 s59, s59, 7
 s_add_u32 m0, s50, 40960
 s_add_u32 s57, s59, 0
 buffer_load_dwordx4 v8, s[20:23], s57 offen offset:0 lds
 buffer_load_dwordx4 v9, s[20:23], s57 offen offset:2048 lds
 s_add_u32 m0, s50, 45056
 s_add_u32 s57, s59, 40960
 buffer_load_dwordx4 v8, s[20:23], s57 offen offset:0 lds
 buffer_load_dwordx4 v9, s[20:23], s57 offen offset:2048 lds
 s_add_u32 m0, s50, 49152
 s_add_u32 s57, s59, 81920
 buffer_load_dwordx4 v8, s[20:23], s57 offen offset:0 lds
 buffer_load_dwordx4 v9, s[20:23], s57 offen offset:2048 lds
 s_add_u32 s59, s52, 12
 s_cmp_ge_u32 s59, 20
 s_cselect_b32 s58, 20, 0
 s_sub_u32 s59, s59, s58
 s_lshl_b32 s59, s59, 18
 s_add_u32 m0, s48, 147456
 s_add_u32 s57, s59, s47
 buffer_load_dwordx4 v4, s[24:27], s57 offen offset:0 lds
 buffer_load_dwordx4 v5, s[24:27], s57 offen offset:1024 lds
 buffer_load_dwordx4 v6, s[24:27], s57 offen offset:2048 lds
 buffer_load_dwordx4 v7, s[24:27], s57 offen offset:3072 lds
 s_add_u32 s59, s52, 13
 s_cmp_ge_u32 s59, 20
 s_cselect_b32 s58, 20, 0
 s_sub_u32 s59, s59, s58
 s_lshl_b32 s59, s59, 18
 s_add_u32 m0, s48, 155648
 s_add_u32 s57, s59, s47
 buffer_load_dwordx4 v4, s[24:27], s57 offen offset:0 lds
 buffer_load_dwordx4 v5, s[24:27], s57 offen offset:1024 lds
 buffer_load_dwordx4 v6, s[24:27], s57 offen offset:2048 lds
 buffer_load_dwordx4 v7, s[24:27], s57 offen offset:3072 lds
 s_add_u32 s59, s52, 4
 s_cmp_ge_u32 s59, 20
 s_cselect_b32 s58, 20, 0
 s_sub_u32 s59, s59, s58
 s_lshl_b32 s59, s59, 18
 s_add_u32 m0, s48, 114688
 s_add_u32 s57, s59, s47
 s_add_u32 s57, s57, 256
 buffer_load_dwordx4 v4, s[24:27], s57 offen offset:0 lds
 buffer_load_dwordx4 v5, s[24:27], s57 offen offset:1024 lds
 buffer_load_dwordx4 v6, s[24:27], s57 offen offset:2048 lds
 buffer_load_dwordx4 v7, s[24:27], s57 offen offset:3072 lds
 s_waitcnt vmcnt(22)
 s_waitcnt vmcnt(18)
 s_barrier
 s_add_u32 s59, s45, 7
 s_cmp_ge_u32 s59, 10
 s_cselect_b32 s58, 10, 0
 s_sub_u32 s59, s59, s58
 s_lshl_b32 s59, s59, 7
 s_add_u32 m0, s50, 53248
 s_add_u32 s57, s59, 0
 buffer_load_dwordx4 v8, s[20:23], s57 offen offset:0 lds
 buffer_load_dwordx4 v9, s[20:23], s57 offen offset:2048 lds
 s_add_u32 m0, s50, 57344
 s_add_u32 s57, s59, 40960
 buffer_load_dwordx4 v8, s[20:23], s57 offen offset:0 lds
 buffer_load_dwordx4 v9, s[20:23], s57 offen offset:2048 lds
 s_add_u32 m0, s50, 61440
 s_add_u32 s57, s59, 81920
 buffer_load_dwordx4 v8, s[20:23], s57 offen offset:0 lds
 buffer_load_dwordx4 v9, s[20:23], s57 offen offset:2048 lds
 s_add_u32 s59, s52, 14
 s_cmp_ge_u32 s59, 20
 s_cselect_b32 s58, 20, 0
 s_sub_u32 s59, s59, s58
 s_lshl_b32 s59, s59, 18
 s_add_u32 m0, s48, 122880
 s_add_u32 s57, s59, s47
 buffer_load_dwordx4 v4, s[24:27], s57 offen offset:0 lds
 buffer_load_dwordx4 v5, s[24:27], s57 offen offset:1024 lds
 buffer_load_dwordx4 v6, s[24:27], s57 offen offset:2048 lds
 buffer_load_dwordx4 v7, s[24:27], s57 offen offset:3072 lds
 s_add_u32 s57, s91, 8192
 s_and_b32 s57, s57, 0x1ffff
 s_add_u32 s57, s57, s48
 s_add_u32 m0, s48, 90112
 s_nop 0
 buffer_load_dwordx4 v16, s[32:35], s57 offen offset:0 nt lds
 buffer_load_dwordx4 v16, s[32:35], s57 offen offset:1024 nt lds
 buffer_load_dwordx4 v16, s[32:35], s57 offen offset:2048 nt lds
 buffer_load_dwordx4 v16, s[32:35], s57 offen offset:3072 nt lds
 s_add_u32 s57, s91, 24576
 s_and_b32 s57, s57, 0x1ffff
 s_add_u32 s57, s57, s48
 s_add_u32 m0, s48, 24576
 s_nop 0
 buffer_load_dwordx4 v12, s[28:31], s57 offen offset:0 nt lds
 buffer_load_dwordx4 v13, s[28:31], s57 offen offset:1024 nt lds
 buffer_load_dwordx4 v14, s[28:31], s57 offen offset:2048 nt lds
 buffer_load_dwordx4 v15, s[28:31], s57 offen offset:3072 nt lds
 s_add_u32 s57, s91, 16384
 s_and_b32 s57, s57, 0x1ffff
 s_add_u32 s57, s57, s48
 s_add_u32 m0, s48, 98304
 s_nop 0
 buffer_load_dwordx4 v16, s[32:35], s57 offen offset:0 nt lds
 buffer_load_dwordx4 v16, s[32:35], s57 offen offset:1024 nt lds
 buffer_load_dwordx4 v16, s[32:35], s57 offen offset:2048 nt lds
 buffer_load_dwordx4 v16, s[32:35], s57 offen offset:3072 nt lds
 s_add_u32 s57, s91, 32768
 s_and_b32 s57, s57, 0x1ffff
 s_add_u32 s57, s57, s48
 s_add_u32 m0, s48, 32768
 s_nop 0
 buffer_load_dwordx4 v12, s[28:31], s57 offen offset:0 nt lds
 buffer_load_dwordx4 v13, s[28:31], s57 offen offset:1024 nt lds
 buffer_load_dwordx4 v14, s[28:31], s57 offen offset:2048 nt lds
 buffer_load_dwordx4 v15, s[28:31], s57 offen offset:3072 nt lds
 s_waitcnt vmcnt(38)
 s_waitcnt vmcnt(34)
 s_barrier
 s_waitcnt vmcnt(30)
 s_waitcnt vmcnt(26)
 s_barrier
 s_waitcnt vmcnt(20)
 s_waitcnt vmcnt(16)
 s_barrier
 s_add_u32 s59, s52, 15
 s_cmp_ge_u32 s59, 20
 s_cselect_b32 s58, 20, 0
 s_sub_u32 s59, s59, s58
 s_lshl_b32 s59, s59, 18
 s_add_u32 m0, s48, 131072
 s_add_u32 s57, s59, s47
 buffer_load_dwordx4 v4, s[24:27], s57 offen offset:0 lds
 buffer_load_dwordx4 v5, s[24:27], s57 offen offset:1024 lds
 buffer_load_dwordx4 v6, s[24:27], s57 offen offset:2048 lds
 buffer_load_dwordx4 v7, s[24:27], s57 offen offset:3072 lds
 s_add_u32 s59, s52, 5
 s_cmp_ge_u32 s59, 20
 s_cselect_b32 s58, 20, 0
 s_sub_u32 s59, s59, s58
 s_lshl_b32 s59, s59, 18
 s_add_u32 m0, s48, 139264
 s_add_u32 s57, s59, s47
 s_add_u32 s57, s57, 256
 buffer_load_dwordx4 v4, s[24:27], s57 offen offset:0 lds
 buffer_load_dwordx4 v5, s[24:27], s57 offen offset:1024 lds
 buffer_load_dwordx4 v6, s[24:27], s57 offen offset:2048 lds
 buffer_load_dwordx4 v7, s[24:27], s57 offen offset:3072 lds
 s_add_u32 s59, s45, 8
 s_cmp_ge_u32 s59, 10
 s_cselect_b32 s58, 10, 0
 s_sub_u32 s59, s59, s58
 s_lshl_b32 s59, s59, 7
 s_add_u32 m0, s50, 65536
 s_add_u32 s57, s59, 0
 buffer_load_dwordx4 v8, s[20:23], s57 offen offset:0 lds
 buffer_load_dwordx4 v9, s[20:23], s57 offen offset:2048 lds
 s_add_u32 m0, s50, 69632
 s_add_u32 s57, s59, 40960
 buffer_load_dwordx4 v8, s[20:23], s57 offen offset:0 lds
 buffer_load_dwordx4 v9, s[20:23], s57 offen offset:2048 lds
 s_add_u32 m0, s50, 73728
 s_add_u32 s57, s59, 81920
 buffer_load_dwordx4 v8, s[20:23], s57 offen offset:0 lds
 buffer_load_dwordx4 v9, s[20:23], s57 offen offset:2048 lds
 s_add_u32 s59, s52, 16
 s_cmp_ge_u32 s59, 20
 s_cselect_b32 s58, 20, 0
 s_sub_u32 s59, s59, s58
 s_lshl_b32 s59, s59, 18
 s_add_u32 m0, s48, 147456
 s_add_u32 s57, s59, s47
 buffer_load_dwordx4 v4, s[24:27], s57 offen offset:0 lds
 buffer_load_dwordx4 v5, s[24:27], s57 offen offset:1024 lds
 buffer_load_dwordx4 v6, s[24:27], s57 offen offset:2048 lds
 buffer_load_dwordx4 v7, s[24:27], s57 offen offset:3072 lds
 s_waitcnt vmcnt(14)
 s_waitcnt vmcnt(10)
 s_barrier
 s_add_u32 s59, s52, 17
 s_cmp_ge_u32 s59, 20
 s_cselect_b32 s58, 20, 0
 s_sub_u32 s59, s59, s58
 s_lshl_b32 s59, s59, 18
 s_add_u32 m0, s48, 155648
 s_add_u32 s57, s59, s47
 buffer_load_dwordx4 v4, s[24:27], s57 offen offset:0 lds
 buffer_load_dwordx4 v5, s[24:27], s57 offen offset:1024 lds
 buffer_load_dwordx4 v6, s[24:27], s57 offen offset:2048 lds
 buffer_load_dwordx4 v7, s[24:27], s57 offen offset:3072 lds
 s_add_u32 s59, s52, 6
 s_cmp_ge_u32 s59, 20
 s_cselect_b32 s58, 20, 0
 s_sub_u32 s59, s59, s58
 s_lshl_b32 s59, s59, 18
 s_add_u32 m0, s48, 114688
 s_add_u32 s57, s59, s47
 s_add_u32 s57, s57, 256
 buffer_load_dwordx4 v4, s[24:27], s57 offen offset:0 lds
 buffer_load_dwordx4 v5, s[24:27], s57 offen offset:1024 lds
 buffer_load_dwordx4 v6, s[24:27], s57 offen offset:2048 lds
 buffer_load_dwordx4 v7, s[24:27], s57 offen offset:3072 lds
 s_add_u32 s59, s45, 9
 s_cmp_ge_u32 s59, 10
 s_cselect_b32 s58, 10, 0
 s_sub_u32 s59, s59, s58
 s_lshl_b32 s59, s59, 7
 s_add_u32 m0, s50, 40960
 s_add_u32 s57, s59, 0
 buffer_load_dwordx4 v8, s[20:23], s57 offen offset:0 lds
 buffer_load_dwordx4 v9, s[20:23], s57 offen offset:2048 lds
 s_add_u32 m0, s50, 45056
 s_add_u32 s57, s59, 40960
 buffer_load_dwordx4 v8, s[20:23], s57 offen offset:0 lds
 buffer_load_dwordx4 v9, s[20:23], s57 offen offset:2048 lds
 s_add_u32 m0, s50, 49152
 s_add_u32 s57, s59, 81920
 buffer_load_dwordx4 v8, s[20:23], s57 offen offset:0 lds
 buffer_load_dwordx4 v9, s[20:23], s57 offen offset:2048 lds
 s_add_u32 s59, s52, 18
 s_cmp_ge_u32 s59, 20
 s_cselect_b32 s58, 20, 0
 s_sub_u32 s59, s59, s58
 s_lshl_b32 s59, s59, 18
 s_add_u32 m0, s48, 122880
 s_add_u32 s57, s59, s47
 buffer_load_dwordx4 v4, s[24:27], s57 offen offset:0 lds
 buffer_load_dwordx4 v5, s[24:27], s57 offen offset:1024 lds
 buffer_load_dwordx4 v6, s[24:27], s57 offen offset:2048 lds
 buffer_load_dwordx4 v7, s[24:27], s57 offen offset:3072 lds
 s_waitcnt vmcnt(22)
 s_waitcnt vmcnt(18)
 s_barrier
 s_add_u32 s59, s52, 19
 s_cmp_ge_u32 s59, 20
 s_cselect_b32 s58, 20, 0
 s_sub_u32 s59, s59, s58
 s_lshl_b32 s59, s59, 18
 s_add_u32 m0, s48, 131072
 s_add_u32 s57, s59, s47
 buffer_load_dwordx4 v4, s[24:27], s57 offen offset:0 lds
 buffer_load_dwordx4 v5, s[24:27], s57 offen offset:1024 lds
 buffer_load_dwordx4 v6, s[24:27], s57 offen offset:2048 lds
 buffer_load_dwordx4 v7, s[24:27], s57 offen offset:3072 lds
 s_add_u32 s59, s52, 7
 s_cmp_ge_u32 s59, 20
 s_cselect_b32 s58, 20, 0
 s_sub_u32 s59, s59, s58
 s_lshl_b32 s59, s59, 18
 s_add_u32 m0, s48, 139264
 s_add_u32 s57, s59, s47
 s_add_u32 s57, s57, 256
 buffer_load_dwordx4 v4, s[24:27], s57 offen offset:0 lds
 buffer_load_dwordx4 v5, s[24:27], s57 offen offset:1024 lds
 buffer_load_dwordx4 v6, s[24:27], s57 offen offset:2048 lds
 buffer_load_dwordx4 v7, s[24:27], s57 offen offset:3072 lds
 s_add_u32 s57, s91, 24576
 s_and_b32 s57, s57, 0x1ffff
 s_add_u32 s57, s57, s48
 s_add_u32 m0, s48, 106496
 s_nop 0
 buffer_load_dwordx4 v16, s[32:35], s57 offen offset:0 nt lds
 buffer_load_dwordx4 v16, s[32:35], s57 offen offset:1024 nt lds
 buffer_load_dwordx4 v16, s[32:35], s57 offen offset:2048 nt lds
 buffer_load_dwordx4 v16, s[32:35], s57 offen offset:3072 nt lds
 s_mov_b32 s57, 0
 buffer_load_dwordx4 v[32:35], v30, s[84:87], s57 offen offset:0
 buffer_load_dwordx4 v[32:35], v30, s[84:87], s57 offen offset:1024
 buffer_load_dwordx4 v[32:35], v30, s[84:87], s57 offen offset:2048
 buffer_load_dwordx4 v[32:35], v30, s[84:87], s57 offen offset:3072
 s_mov_b32 s57, 4096
 buffer_load_dwordx4 v[32:35], v30, s[84:87], s57 offen offset:0
 buffer_load_dwordx4 v[32:35], v30, s[84:87], s57 offen offset:1024
 buffer_load_dwordx4 v[32:35], v30, s[84:87], s57 offen offset:2048
 buffer_load_dwordx4 v[32:35], v30, s[84:87], s57 offen offset:3072
 s_mov_b32 s57, 8192
 buffer_load_dwordx4 v[32:35], v30, s[84:87], s57 offen offset:0
 buffer_load_dwordx4 v[32:35], v30, s[84:87], s57 offen offset:1024
 buffer_load_dwordx4 v[32:35], v30, s[84:87], s57 offen offset:2048
 buffer_load_dwordx4 v[32:35], v30, s[84:87], s57 offen offset:3072
 s_waitcnt vmcnt(38)
 s_waitcnt vmcnt(34)
 s_barrier
 s_waitcnt vmcnt(28)
 s_waitcnt vmcnt(24)
 s_barrier
 s_mov_b32 s57, 12288
 buffer_load_dwordx4 v[32:35], v30, s[84:87], s57 offen offset:0
 buffer_load_dwordx4 v[32:35], v30, s[84:87], s57 offen offset:1024
 buffer_load_dwordx4 v[32:35], v30, s[84:87], s57 offen offset:2048
 buffer_load_dwordx4 v[32:35], v30, s[84:87], s57 offen offset:3072
 s_mov_b32 s57, 16384
 buffer_load_dwordx4 v[32:35], v30, s[84:87], s57 offen offset:0
 buffer_load_dwordx4 v[32:35], v30, s[84:87], s57 offen offset:1024
 buffer_load_dwordx4 v[32:35], v30, s[84:87], s57 offen offset:2048
 buffer_load_dwordx4 v[32:35], v30, s[84:87], s57 offen offset:3072
 s_waitcnt vmcnt(28)
 s_waitcnt vmcnt(24)
 s_barrier
 s_waitcnt vmcnt(20)
K_clsj:
 s_mul_i32 s51, s61, 5120
 s_mul_i32 s90, s61, 20480
 s_barrier
 s_add_u32 s57, s91, 40960
 s_and_b32 s57, s57, 0x1ffff
 s_add_u32 s57, s57, s48
 s_add_u32 m0, s48, 40960
 s_nop 0
 buffer_load_dwordx4 v12, s[28:31], s57 offen offset:0 nt lds
 buffer_load_dwordx4 v13, s[28:31], s57 offen offset:1024 nt lds
 buffer_load_dwordx4 v14, s[28:31], s57 offen offset:2048 nt lds
 buffer_load_dwordx4 v15, s[28:31], s57 offen offset:3072 nt lds
 s_add_u32 s57, s91, 32768
 s_and_b32 s57, s57, 0x1ffff
 s_add_u32 s57, s57, s48
 s_add_u32 m0, s48, 73728
 s_nop 0
 buffer_load_dwordx4 v16, s[32:35], s57 offen offset:0 nt lds
 buffer_load_dwordx4 v16, s[32:35], s57 offen offset:1024 nt lds
 buffer_load_dwordx4 v16, s[32:35], s57 offen offset:2048 nt lds
 buffer_load_dwordx4 v16, s[32:35], s57 offen offset:3072 nt lds
 s_add_u32 s57, s91, 49152
 s_and_b32 s57, s57, 0x1ffff
 s_add_u32 s57, s57, s48
 s_add_u32 m0, s48, 49152
 s_nop 0
 buffer_load_dwordx4 v12, s[28:31], s57 offen offset:0 nt lds
 buffer_load_dwordx4 v13, s[28:31], s57 offen offset:1024 nt lds
 s_add_u32 s49, s52, 8
 s_cmp_ge_u32 s49, 20
 s_cselect_b32 s58, 20, 0
 s_sub_u32 s49, s49, s58
 s_lshl_b32 s49, s49, 18
 s_add_u32 s49, s49, s47
 s_add_u32 m0, s48, 114688
 s_add_u32 s57, s49, 256
 buffer_load_dwordx4 v4, s[24:27], s57 offen offset:0 lds
 buffer_load_dwordx4 v5, s[24:27], s57 offen offset:1024 lds
 buffer_load_dwordx4 v6, s[24:27], s57 offen offset:2048 lds
 buffer_load_dwordx4 v7, s[24:27], s57 offen offset:3072 lds
 s_barrier
 s_add_u32 s57, s91, 49152
 s_and_b32 s57, s57, 0x1ffff
 s_add_u32 s57, s57, s48
 s_add_u32 m0, s48, 49152
 s_nop 0
 buffer_load_dwordx4 v14, s[28:31], s57 offen offset:2048 nt lds
 buffer_load_dwordx4 v15, s[28:31], s57 offen offset:3072 nt lds
 s_add_u32 s57, s91, 40960
 s_and_b32 s57, s57, 0x1ffff
 s_add_u32 s57, s57, s48
 s_add_u32 m0, s48, 65536
 s_nop 0
 s_waitcnt vmcnt(15)
 buffer_load_dwordx4 v16, s[32:35], s57 offen offset:0 nt lds
 s_waitcnt vmcnt(15)
 buffer_load_dwordx4 v16, s[32:35], s57 offen offset:1024 nt lds
 s_waitcnt vmcnt(15)
 buffer_load_dwordx4 v16, s[32:35], s57 offen offset:2048 nt lds
 s_waitcnt vmcnt(15)
 buffer_load_dwordx4 v16, s[32:35], s57 offen offset:3072 nt lds
 s_add_u32 s57, s91, 57344
 s_and_b32 s57, s57, 0x1ffff
 s_add_u32 s57, s57, s48
 s_add_u32 m0, s48, 0
 s_nop 0
 s_waitcnt vmcnt(15)
 buffer_load_dwordx4 v12, s[28:31], s57 offen offset:0 nt lds
 s_waitcnt vmcnt(15)
 buffer_load_dwordx4 v13, s[28:31], s57 offen offset:1024 nt lds
 s_add_u32 s49, s52, 9
 s_cmp_ge_u32 s49, 20
 s_cselect_b32 s58, 20, 0
 s_sub_u32 s49, s49, s58
 s_lshl_b32 s49, s49, 18
 s_add_u32 s49, s49, s47
 s_add_u32 m0, s48, 122880
 s_add_u32 s57, s49, 256
 s_waitcnt vmcnt(15)
 buffer_load_dwordx4 v4, s[24:27], s57 offen offset:0 lds
 s_waitcnt vmcnt(15)
 buffer_load_dwordx4 v5, s[24:27], s57 offen offset:1024 lds
 s_waitcnt vmcnt(15)
 buffer_load_dwordx4 v6, s[24:27], s57 offen offset:2048 lds
 s_waitcnt vmcnt(15)
 buffer_load_dwordx4 v7, s[24:27], s57 offen offset:3072 lds
 s_waitcnt vmcnt(12)
 s_barrier
 s_add_u32 s57, s91, 57344
 s_and_b32 s57, s57, 0x1ffff
 s_add_u32 s57, s57, s48
 s_add_u32 m0, s48, 0
 s_nop 0
 buffer_load_dwordx4 v14, s[28:31], s57 offen offset:2048 nt lds
 buffer_load_dwordx4 v15, s[28:31], s57 offen offset:3072 nt lds
 s_add_u32 s57, s91, 49152
 s_and_b32 s57, s57, 0x1ffff
 s_add_u32 s57, s57, s48
 s_add_u32 m0, s48, 81920
 s_nop 0
 buffer_load_dwordx4 v16, s[32:35], s57 offen offset:0 nt lds
 buffer_load_dwordx4 v16, s[32:35], s57 offen offset:1024 nt lds
 s_waitcnt vmcnt(15)
 buffer_load_dwordx4 v16, s[32:35], s57 offen offset:2048 nt lds
 s_waitcnt vmcnt(15)
 buffer_load_dwordx4 v16, s[32:35], s57 offen offset:3072 nt lds
 s_add_u32 s57, s91, 65536
 s_and_b32 s57, s57, 0x1ffff
 s_add_u32 s57, s57, s48
 s_add_u32 m0, s48, 8192
 s_nop 0
 s_waitcnt vmcnt(15)
 buffer_load_dwordx4 v12, s[28:31], s57 offen offset:0 nt lds
 s_waitcnt vmcnt(15)
 buffer_load_dwordx4 v13, s[28:31], s57 offen offset:1024 nt lds
 s_add_u32 s49, s52, 10
 s_cmp_ge_u32 s49, 20
 s_cselect_b32 s58, 20, 0
 s_sub_u32 s49, s49, s58
 s_lshl_b32 s49, s49, 18
 s_add_u32 s49, s49, s47
 s_add_u32 m0, s48, 131072
 s_add_u32 s57, s49, 256
 s_waitcnt vmcnt(15)
 buffer_load_dwordx4 v4, s[24:27], s57 offen offset:0 lds
 s_waitcnt vmcnt(15)
 buffer_load_dwordx4 v5, s[24:27], s57 offen offset:1024 lds
 s_waitcnt vmcnt(15)
 buffer_load_dwordx4 v6, s[24:27], s57 offen offset:2048 lds
 s_waitcnt vmcnt(15)
 buffer_load_dwordx4 v7, s[24:27], s57 offen offset:3072 lds
 s_waitcnt vmcnt(12)
 s_barrier
 s_add_u32 s57, s91, 65536
 s_and_b32 s57, s57, 0x1ffff
 s_add_u32 s57, s57, s48
 s_add_u32 m0, s48, 8192
 s_nop 0
 buffer_load_dwordx4 v14, s[28:31], s57 offen offset:2048 nt lds
 buffer_load_dwordx4 v15, s[28:31], s57 offen offset:3072 nt lds
 s_add_u32 s57, s91, 57344
 s_and_b32 s57, s57, 0x1ffff
 s_add_u32 s57, s57, s48
 s_add_u32 m0, s48, 90112
 s_nop 0
 buffer_load_dwordx4 v16, s[32:35], s57 offen offset:0 nt lds
 buffer_load_dwordx4 v16, s[32:35], s57 offen offset:1024 nt lds
 s_waitcnt vmcnt(15)
 buffer_load_dwordx4 v16, s[32:35], s57 offen offset:2048 nt lds
 s_waitcnt vmcnt(15)
 buffer_load_dwordx4 v16, s[32:35], s57 offen offset:3072 nt lds
 s_add_u32 s57, s91, 73728
 s_and_b32 s57, s57, 0x1ffff
 s_add_u32 s57, s57, s48
 s_add_u32 m0, s48, 16384
 s_nop 0
 s_waitcnt vmcnt(15)
 buffer_load_dwordx4 v12, s[28:31], s57 offen offset:0 nt lds
 s_waitcnt vmcnt(15)
 buffer_load_dwordx4 v13, s[28:31], s57 offen offset:1024 nt lds
 s_add_u32 s49, s52, 11
 s_cmp_ge_u32 s49, 20
 s_cselect_b32 s58, 20, 0
 s_sub_u32 s49, s49, s58
 s_lshl_b32 s49, s49, 18
 s_add_u32 s49, s49, s47
 s_add_u32 m0, s48, 114688
 s_add_u32 s57, s49, 256
 s_waitcnt vmcnt(15)
 buffer_load_dwordx4 v4, s[24:27], s57 offen offset:0 lds
 s_waitcnt vmcnt(15)
 buffer_load_dwordx4 v5, s[24:27], s57 offen offset:1024 lds
 s_waitcnt vmcnt(15)
 buffer_load_dwordx4 v6, s[24:27], s57 offen offset:2048 lds
 s_waitcnt vmcnt(15)
 buffer_load_dwordx4 v7, s[24:27], s57 offen offset:3072 lds
 s_waitcnt vmcnt(12)
 s_barrier
 s_add_u32 s57, s91, 73728
 s_and_b32 s57, s57, 0x1ffff
 s_add_u32 s57, s57, s48
 s_add_u32 m0, s48, 16384
 s_nop 0
 buffer_load_dwordx4 v14, s[28:31], s57 offen offset:2048 nt lds
 buffer_load_dwordx4 v15, s[28:31], s57 offen offset:3072 nt lds
 s_add_u32 s57, s91, 65536
 s_and_b32 s57, s57, 0x1ffff
 s_add_u32 s57, s57, s48
 s_add_u32 m0, s48, 98304
 s_nop 0
 buffer_load_dwordx4 v16, s[32:35], s57 offen offset:0 nt lds
 buffer_load_dwordx4 v16, s[32:35], s57 offen offset:1024 nt lds
 s_waitcnt vmcnt(15)
 buffer_load_dwordx4 v16, s[32:35], s57 offen offset:2048 nt lds
 s_waitcnt vmcnt(15)
 buffer_load_dwordx4 v16, s[32:35], s57 offen offset:3072 nt lds
 s_add_u32 s57, s91, 81920
 s_and_b32 s57, s57, 0x1ffff
 s_add_u32 s57, s57, s48
 s_add_u32 m0, s48, 24576
 s_nop 0
 s_waitcnt vmcnt(15)
 buffer_load_dwordx4 v12, s[28:31], s57 offen offset:0 nt lds
 s_waitcnt vmcnt(15)
 buffer_load_dwordx4 v13, s[28:31], s57 offen offset:1024 nt lds
 s_add_u32 s49, s52, 12
 s_cmp_ge_u32 s49, 20
 s_cselect_b32 s58, 20, 0
 s_sub_u32 s49, s49, s58
 s_lshl_b32 s49, s49, 18
 s_add_u32 s49, s49, s47
 s_add_u32 m0, s48, 122880
 s_add_u32 s57, s49, 256
 s_waitcnt vmcnt(15)
 buffer_load_dwordx4 v4, s[24:27], s57 offen offset:0 lds
 s_waitcnt vmcnt(15)
 buffer_load_dwordx4 v5, s[24:27], s57 offen offset:1024 lds
 s_waitcnt vmcnt(15)
 buffer_load_dwordx4 v6, s[24:27], s57 offen offset:2048 lds
 s_waitcnt vmcnt(15)
 buffer_load_dwordx4 v7, s[24:27], s57 offen offset:3072 lds
 s_waitcnt vmcnt(12)
 s_barrier
 s_add_u32 s57, s91, 81920
 s_and_b32 s57, s57, 0x1ffff
 s_add_u32 s57, s57, s48
 s_add_u32 m0, s48, 24576
 s_nop 0
 buffer_load_dwordx4 v14, s[28:31], s57 offen offset:2048 nt lds
 buffer_load_dwordx4 v15, s[28:31], s57 offen offset:3072 nt lds
 s_add_u32 s57, s91, 73728
 s_and_b32 s57, s57, 0x1ffff
 s_add_u32 s57, s57, s48
 s_add_u32 m0, s48, 106496
 s_nop 0
 buffer_load_dwordx4 v16, s[32:35], s57 offen offset:0 nt lds
 buffer_load_dwordx4 v16, s[32:35], s57 offen offset:1024 nt lds
 s_waitcnt vmcnt(15)
 buffer_load_dwordx4 v16, s[32:35], s57 offen offset:2048 nt lds
 s_waitcnt vmcnt(15)
 buffer_load_dwordx4 v16, s[32:35], s57 offen offset:3072 nt lds
 s_add_u32 s57, s91, 90112
 s_and_b32 s57, s57, 0x1ffff
 s_add_u32 s57, s57, s48
 s_add_u32 m0, s48, 32768
 s_nop 0
 s_waitcnt vmcnt(15)
 buffer_load_dwordx4 v12, s[28:31], s57 offen offset:0 nt lds
 s_waitcnt vmcnt(15)
 buffer_load_dwordx4 v13, s[28:31], s57 offen offset:1024 nt lds
 s_add_u32 s49, s52, 13
 s_cmp_ge_u32 s49, 20
 s_cselect_b32 s58, 20, 0
 s_sub_u32 s49, s49, s58
 s_lshl_b32 s49, s49, 18
 s_add_u32 s49, s49, s47
 s_add_u32 m0, s48, 131072
 s_add_u32 s57, s49, 256
 s_waitcnt vmcnt(15)
 buffer_load_dwordx4 v4, s[24:27], s57 offen offset:0 lds
 s_waitcnt vmcnt(15)
 buffer_load_dwordx4 v5, s[24:27], s57 offen offset:1024 lds
 s_waitcnt vmcnt(15)
 buffer_load_dwordx4 v6, s[24:27], s57 offen offset:2048 lds
 s_waitcnt vmcnt(15)
 buffer_load_dwordx4 v7, s[24:27], s57 offen offset:3072 lds
 s_waitcnt vmcnt(12)
 s_barrier
 s_add_u32 s57, s91, 90112
 s_and_b32 s57, s57, 0x1ffff
 s_add_u32 s57, s57, s48
 s_add_u32 m0, s48, 32768
 s_nop 0
 buffer_load_dwordx4 v14, s[28:31], s57 offen offset:2048 nt lds
 buffer_load_dwordx4 v15, s[28:31], s57 offen offset:3072 nt lds
 s_add_u32 s57, s91, 81920
 s_and_b32 s57, s57, 0x1ffff
 s_add_u32 s57, s57, s48
 s_add_u32 m0, s48, 73728
 s_nop 0
 buffer_load_dwordx4 v16, s[32:35], s57 offen offset:0 nt lds
 buffer_load_dwordx4 v16, s[32:35], s57 offen offset:1024 nt lds
 s_waitcnt vmcnt(15)
 buffer_load_dwordx4 v16, s[32:35], s57 offen offset:2048 nt lds
 s_waitcnt vmcnt(15)
 buffer_load_dwordx4 v16, s[32:35], s57 offen offset:3072 nt lds
 s_add_u32 s57, s91, 98304
 s_and_b32 s57, s57, 0x1ffff
 s_add_u32 s57, s57, s48
 s_add_u32 m0, s48, 40960
 s_nop 0
 s_waitcnt vmcnt(15)
 buffer_load_dwordx4 v12, s[28:31], s57 offen offset:0 nt lds
 s_waitcnt vmcnt(15)
 buffer_load_dwordx4 v13, s[28:31], s57 offen offset:1024 nt lds
 s_add_u32 s49, s52, 14
 s_cmp_ge_u32 s49, 20
 s_cselect_b32 s58, 20, 0
 s_sub_u32 s49, s49, s58
 s_lshl_b32 s49, s49, 18
 s_add_u32 s49, s49, s47
 s_add_u32 m0, s48, 114688
 s_add_u32 s57, s49, 256
 s_waitcnt vmcnt(15)
 buffer_load_dwordx4 v4, s[24:27], s57 offen offset:0 lds
 s_waitcnt vmcnt(15)
 buffer_load_dwordx4 v5, s[24:27], s57 offen offset:1024 lds
 s_waitcnt vmcnt(15)
 buffer_load_dwordx4 v6, s[24:27], s57 offen offset:2048 lds
 s_waitcnt vmcnt(15)
 buffer_load_dwordx4 v7, s[24:27], s57 offen offset:3072 lds
 s_waitcnt vmcnt(12)
 s_barrier
 s_add_u32 s57, s91, 98304
 s_and_b32 s57, s57, 0x1ffff
 s_add_u32 s57, s57, s48
 s_add_u32 m0, s48, 40960
 s_nop 0
 buffer_load_dwordx4 v14, s[28:31], s57 offen offset:2048 nt lds
 buffer_load_dwordx4 v15, s[28:31], s57 offen offset:3072 nt lds
 s_add_u32 s57, s91, 90112
 s_and_b32 s57, s57, 0x1ffff
 s_add_u32 s57, s57, s48
 s_add_u32 m0, s48, 65536
 s_nop 0
 buffer_load_dwordx4 v16, s[32:35], s57 offen offset:0 nt lds
 buffer_load_dwordx4 v16, s[32:35], s57 offen offset:1024 nt lds
 s_waitcnt vmcnt(15)
 buffer_load_dwordx4 v16, s[32:35], s57 offen offset:2048 nt lds
 s_waitcnt vmcnt(15)
 buffer_load_dwordx4 v16, s[32:35], s57 offen offset:3072 nt lds
 s_add_u32 s57, s91, 106496
 s_and_b32 s57, s57, 0x1ffff
 s_add_u32 s57, s57, s48
 s_add_u32 m0, s48, 0
 s_nop 0
 s_waitcnt vmcnt(15)
 buffer_load_dwordx4 v12, s[28:31], s57 offen offset:0 nt lds
 s_waitcnt vmcnt(15)
 buffer_load_dwordx4 v13, s[28:31], s57 offen offset:1024 nt lds
 s_add_u32 s49, s52, 15
 s_cmp_ge_u32 s49, 20
 s_cselect_b32 s58, 20, 0
 s_sub_u32 s49, s49, s58
 s_lshl_b32 s49, s49, 18
 s_add_u32 s49, s49, s47
 s_add_u32 m0, s48, 122880
 s_add_u32 s57, s49, 256
 s_waitcnt vmcnt(15)
 buffer_load_dwordx4 v4, s[24:27], s57 offen offset:0 lds
 s_waitcnt vmcnt(15)
 buffer_load_dwordx4 v5, s[24:27], s57 offen offset:1024 lds
 s_waitcnt vmcnt(15)
 buffer_load_dwordx4 v6, s[24:27], s57 offen offset:2048 lds
 s_waitcnt vmcnt(15)
 buffer_load_dwordx4 v7, s[24:27], s57 offen offset:3072 lds
 s_waitcnt vmcnt(12)
 s_barrier
 s_add_u32 s57, s91, 106496
 s_and_b32 s57, s57, 0x1ffff
 s_add_u32 s57, s57, s48
 s_add_u32 m0, s48, 0
 s_nop 0
 buffer_load_dwordx4 v14, s[28:31], s57 offen offset:2048 nt lds
 buffer_load_dwordx4 v15, s[28:31], s57 offen offset:3072 nt lds
 s_add_u32 s57, s91, 98304
 s_and_b32 s57, s57, 0x1ffff
 s_add_u32 s57, s57, s48
 s_add_u32 m0, s48, 81920
 s_nop 0
 buffer_load_dwordx4 v16, s[32:35], s57 offen offset:0 nt lds
 buffer_load_dwordx4 v16, s[32:35], s57 offen offset:1024 nt lds
 s_waitcnt vmcnt(15)
 buffer_load_dwordx4 v16, s[32:35], s57 offen offset:2048 nt lds
 s_waitcnt vmcnt(15)
 buffer_load_dwordx4 v16, s[32:35], s57 offen offset:3072 nt lds
 s_add_u32 s57, s91, 114688
 s_and_b32 s57, s57, 0x1ffff
 s_add_u32 s57, s57, s48
 s_add_u32 m0, s48, 8192
 s_nop 0
 s_waitcnt vmcnt(15)
 buffer_load_dwordx4 v12, s[28:31], s57 offen offset:0 nt lds
 s_waitcnt vmcnt(15)
 buffer_load_dwordx4 v13, s[28:31], s57 offen offset:1024 nt lds
 s_add_u32 s49, s52, 16
 s_cmp_ge_u32 s49, 20
 s_cselect_b32 s58, 20, 0
 s_sub_u32 s49, s49, s58
 s_lshl_b32 s49, s49, 18
 s_add_u32 s49, s49, s47
 s_add_u32 m0, s48, 131072
 s_add_u32 s57, s49, 256
 s_waitcnt vmcnt(15)
 buffer_load_dwordx4 v4, s[24:27], s57 offen offset:0 lds
 s_waitcnt vmcnt(15)
 buffer_load_dwordx4 v5, s[24:27], s57 offen offset:1024 lds
 s_waitcnt vmcnt(15)
 buffer_load_dwordx4 v6, s[24:27], s57 offen offset:2048 lds
 s_waitcnt vmcnt(15)
 buffer_load_dwordx4 v7, s[24:27], s57 offen offset:3072 lds
 s_waitcnt vmcnt(12)
 s_barrier
 global_load_dword v31, v29, s[76:77] sc1
 s_add_u32 s57, s91, 114688
 s_and_b32 s57, s57, 0x1ffff
 s_add_u32 s57, s57, s48
 s_add_u32 m0, s48, 8192
 s_nop 0
 buffer_load_dwordx4 v14, s[28:31], s57 offen offset:2048 nt lds
 buffer_load_dwordx4 v15, s[28:31], s57 offen offset:3072 nt lds
 s_add_u32 s57, s91, 106496
 s_and_b32 s57, s57, 0x1ffff
 s_add_u32 s57, s57, s48
 s_add_u32 m0, s48, 90112
 s_nop 0
 buffer_load_dwordx4 v16, s[32:35], s57 offen offset:0 nt lds
 s_waitcnt vmcnt(15)
 buffer_load_dwordx4 v16, s[32:35], s57 offen offset:1024 nt lds
 s_waitcnt vmcnt(15)
 buffer_load_dwordx4 v16, s[32:35], s57 offen offset:2048 nt lds
 s_waitcnt vmcnt(15)
 buffer_load_dwordx4 v16, s[32:35], s57 offen offset:3072 nt lds
 s_add_u32 s57, s91, 122880
 s_and_b32 s57, s57, 0x1ffff
 s_add_u32 s57, s57, s48
 s_add_u32 m0, s48, 16384
 s_nop 0
 s_waitcnt vmcnt(15)
 buffer_load_dwordx4 v12, s[28:31], s57 offen offset:0 nt lds
 s_waitcnt vmcnt(15)
 buffer_load_dwordx4 v13, s[28:31], s57 offen offset:1024 nt lds
 s_add_u32 s49, s52, 17
 s_cmp_ge_u32 s49, 20
 s_cselect_b32 s58, 20, 0
 s_sub_u32 s49, s49, s58
 s_lshl_b32 s49, s49, 18
 s_add_u32 s49, s49, s47
 s_add_u32 m0, s48, 114688
 s_add_u32 s57, s49, 256
 s_waitcnt vmcnt(15)
 buffer_load_dwordx4 v4, s[24:27], s57 offen offset:0 lds
 s_waitcnt vmcnt(15)
 buffer_load_dwordx4 v5, s[24:27], s57 offen offset:1024 lds
 s_waitcnt vmcnt(15)
 buffer_load_dwordx4 v6, s[24:27], s57 offen offset:2048 lds
 s_waitcnt vmcnt(15)
 buffer_load_dwordx4 v7, s[24:27], s57 offen offset:3072 lds
 s_waitcnt vmcnt(13)
 s_barrier
 s_add_u32 s57, s91, 122880
 s_and_b32 s57, s57, 0x1ffff
 s_add_u32 s57, s57, s48
 s_add_u32 m0, s48, 16384
 s_nop 0
 buffer_load_dwordx4 v14, s[28:31], s57 offen offset:2048 nt lds
 buffer_load_dwordx4 v15, s[28:31], s57 offen offset:3072 nt lds
 s_add_u32 s57, s91, 114688
 s_and_b32 s57, s57, 0x1ffff
 s_add_u32 s57, s57, s48
 s_add_u32 m0, s48, 98304
 s_nop 0
 buffer_load_dwordx4 v16, s[32:35], s57 offen offset:0 nt lds
 s_waitcnt vmcnt(15)
 buffer_load_dwordx4 v16, s[32:35], s57 offen offset:1024 nt lds
 s_waitcnt vmcnt(15)
 buffer_load_dwordx4 v16, s[32:35], s57 offen offset:2048 nt lds
 s_waitcnt vmcnt(15)
 buffer_load_dwordx4 v16, s[32:35], s57 offen offset:3072 nt lds
 s_add_u32 s57, s91, 8192
 s_and_b32 s57, s57, 0x1ffff
 s_add_u32 s57, s57, s48
 s_add_u32 s57, s57, 131072
 s_add_u32 m0, s48, 24576
 s_nop 0
 s_waitcnt vmcnt(15)
 buffer_load_dwordx4 v12, s[28:31], s57 offen offset:0 nt lds
 s_waitcnt vmcnt(15)
 buffer_load_dwordx4 v13, s[28:31], s57 offen offset:1024 nt lds
 s_add_u32 s49, s52, 18
 s_cmp_ge_u32 s49, 20
 s_cselect_b32 s58, 20, 0
 s_sub_u32 s49, s49, s58
 s_lshl_b32 s49, s49, 18
 s_add_u32 s49, s49, s47
 s_add_u32 m0, s48, 122880
 s_add_u32 s57, s49, 256
 s_waitcnt vmcnt(15)
 buffer_load_dwordx4 v4, s[24:27], s57 offen offset:0 lds
 s_waitcnt vmcnt(15)
 buffer_load_dwordx4 v5, s[24:27], s57 offen offset:1024 lds
 s_waitcnt vmcnt(15)
 buffer_load_dwordx4 v6, s[24:27], s57 offen offset:2048 lds
 s_waitcnt vmcnt(15)
 buffer_load_dwordx4 v7, s[24:27], s57 offen offset:3072 lds
 s_waitcnt vmcnt(12)
 s_barrier
 s_add_u32 s57, s91, 8192
 s_and_b32 s57, s57, 0x1ffff
 s_add_u32 s57, s57, s48
 s_add_u32 s57, s57, 131072
 s_add_u32 m0, s48, 24576
 s_nop 0
 buffer_load_dwordx4 v14, s[28:31], s57 offen offset:2048 nt lds
 buffer_load_dwordx4 v15, s[28:31], s57 offen offset:3072 nt lds
 s_add_u32 s57, s91, 122880
 s_and_b32 s57, s57, 0x1ffff
 s_add_u32 s57, s57, s48
 s_add_u32 m0, s48, 106496
 s_nop 0
 buffer_load_dwordx4 v16, s[32:35], s57 offen offset:0 nt lds
 buffer_load_dwordx4 v16, s[32:35], s57 offen offset:1024 nt lds
 s_waitcnt vmcnt(15)
 buffer_load_dwordx4 v16, s[32:35], s57 offen offset:2048 nt lds
 s_waitcnt vmcnt(15)
 buffer_load_dwordx4 v16, s[32:35], s57 offen offset:3072 nt lds
 s_add_u32 s57, s91, 16384
 s_and_b32 s57, s57, 0x1ffff
 s_add_u32 s57, s57, s48
 s_add_u32 s57, s57, 131072
 s_add_u32 m0, s48, 32768
 s_nop 0
 s_waitcnt vmcnt(15)
 buffer_load_dwordx4 v12, s[28:31], s57 offen offset:0 nt lds
 s_waitcnt vmcnt(15)
 buffer_load_dwordx4 v13, s[28:31], s57 offen offset:1024 nt lds
 s_add_u32 s49, s52, 19
 s_cmp_ge_u32 s49, 20
 s_cselect_b32 s58, 20, 0
 s_sub_u32 s49, s49, s58
 s_lshl_b32 s49, s49, 18
 s_add_u32 s49, s49, s47
 s_add_u32 m0, s48, 131072
 s_add_u32 s57, s49, 256
 s_waitcnt vmcnt(15)
 buffer_load_dwordx4 v4, s[24:27], s57 offen offset:0 lds
 s_waitcnt vmcnt(15)
 buffer_load_dwordx4 v5, s[24:27], s57 offen offset:1024 lds
 s_waitcnt vmcnt(15)
 buffer_load_dwordx4 v6, s[24:27], s57 offen offset:2048 lds
 s_waitcnt vmcnt(15)
 buffer_load_dwordx4 v7, s[24:27], s57 offen offset:3072 lds
 s_waitcnt vmcnt(12)
 s_barrier
 s_add_u32 s57, s91, 16384
 s_and_b32 s57, s57, 0x1ffff
 s_add_u32 s57, s57, s48
 s_add_u32 s57, s57, 131072
 s_add_u32 m0, s48, 32768
 s_nop 0
 buffer_load_dwordx4 v14, s[28:31], s57 offen offset:2048 nt lds
 buffer_load_dwordx4 v15, s[28:31], s57 offen offset:3072 nt lds
 s_add_u32 s57, s91, 8192
 s_and_b32 s57, s57, 0x1ffff
 s_add_u32 s57, s57, s48
 s_add_u32 s57, s57, 131072
 s_add_u32 m0, s48, 73728
 s_nop 0
 buffer_load_dwordx4 v16, s[32:35], s57 offen offset:0 nt lds
 buffer_load_dwordx4 v16, s[32:35], s57 offen offset:1024 nt lds
 s_waitcnt vmcnt(15)
 buffer_load_dwordx4 v16, s[32:35], s57 offen offset:2048 nt lds
 s_waitcnt vmcnt(15)
 buffer_load_dwordx4 v16, s[32:35], s57 offen offset:3072 nt lds
 s_add_u32 s57, s91, 24576
 s_and_b32 s57, s57, 0x1ffff
 s_add_u32 s57, s57, s48
 s_add_u32 s57, s57, 131072
 s_add_u32 m0, s48, 40960
 s_nop 0
 s_waitcnt vmcnt(15)
 buffer_load_dwordx4 v12, s[28:31], s57 offen offset:0 nt lds
 s_waitcnt vmcnt(15)
 buffer_load_dwordx4 v13, s[28:31], s57 offen offset:1024 nt lds
 s_add_u32 s49, s63, 0
 s_and_b32 s49, s49, 3
 s_lshl_b32 s49, s49, 1
 s_add_u32 s49, s49, 0
 s_mul_i32 s49, s49, 163840
 s_add_u32 s49, s49, s90
 s_add_u32 m0, s51, 145408
 s_add_u32 s57, s49, 0
 s_waitcnt vmcnt(15)
 buffer_load_dwordx4 v20, s[64:67], s57 offen offset:0 lds
 s_waitcnt vmcnt(15)
 buffer_load_dwordx4 v21, s[64:67], s57 offen offset:1024 lds
 s_waitcnt vmcnt(15)
 buffer_load_dwordx4 v22, s[64:67], s57 offen offset:2048 lds
 s_waitcnt vmcnt(15)
 buffer_load_dwordx4 v23, s[64:67], s57 offen offset:3072 lds
 s_waitcnt vmcnt(12)
 s_barrier
K_init_5001:
 v_readfirstlane_b32 s94, v31
 s_cmp_lg_u32 s94, 0
 s_cbranch_scc1 K_init_5001_done
 s_sleep 4
 global_load_dword v31, v29, s[76:77] sc1
 s_waitcnt vmcnt(0)
 s_branch K_init_5001
K_init_5001_done:
 s_lshl_b32 s44, s82, 9
 s_add_u32 s79, s44, 0
 s_lshl_b32 s44, s63, 7
 v_mov_b32 v26, s44
 v_and_b32 v28, 3, v250
 v_min_u32 v28, 2, v28
 s_add_u32 s44, s63, 1
 v_add_u32 v28, s44, v28
 v_and_b32 v28, 3, v28
 v_lshlrev_b32 v28, 7, v28
 v_mov_b32 v27, s94
 s_add_u32 s57, s91, 24576
 s_and_b32 s57, s57, 0x1ffff
 s_add_u32 s57, s57, s48
 s_add_u32 s57, s57, 131072
 s_add_u32 m0, s48, 40960
 s_nop 0
 buffer_load_dwordx4 v14, s[28:31], s57 offen offset:2048 nt lds
 buffer_load_dwordx4 v15, s[28:31], s57 offen offset:3072 nt lds
 s_add_u32 s57, s91, 16384
 s_and_b32 s57, s57, 0x1ffff
 s_add_u32 s57, s57, s48
 s_add_u32 s57, s57, 131072
 s_add_u32 m0, s48, 65536
 s_nop 0
 buffer_load_dwordx4 v16, s[32:35], s57 offen offset:0 nt lds
 buffer_load_dwordx4 v16, s[32:35], s57 offen offset:1024 nt lds
 s_waitcnt vmcnt(15)
 buffer_load_dwordx4 v16, s[32:35], s57 offen offset:2048 nt lds
 s_waitcnt vmcnt(15)
 buffer_load_dwordx4 v16, s[32:35], s57 offen offset:3072 nt lds
 s_add_u32 s57, s91, 32768
 s_and_b32 s57, s57, 0x1ffff
 s_add_u32 s57, s57, s48
 s_add_u32 s57, s57, 131072
 s_add_u32 m0, s48, 0
 s_nop 0
 s_waitcnt vmcnt(15)
 buffer_load_dwordx4 v12, s[28:31], s57 offen offset:0 nt lds
 s_waitcnt vmcnt(15)
 buffer_load_dwordx4 v13, s[28:31], s57 offen offset:1024 nt lds
 s_add_u32 s49, s63, 0
 s_and_b32 s49, s49, 3
 s_lshl_b32 s49, s49, 1
 s_add_u32 s49, s49, 0
 s_mul_i32 s49, s49, 163840
 s_add_u32 s49, s49, s90
 s_add_u32 m0, s51, 149504
 s_add_u32 s57, s49, 0
 s_waitcnt vmcnt(15)
 buffer_load_dwordx4 v24, s[64:67], s57 offen lds
 s_add_u32 s49, s63, 0
 s_and_b32 s49, s49, 3
 s_lshl_b32 s49, s49, 1
 s_add_u32 s49, s49, 0
 s_mul_i32 s49, s49, 163840
 s_add_u32 s49, s49, s90
 s_add_u32 m0, s51, 114688
 s_add_u32 s57, s49, 40960
 s_waitcnt vmcnt(15)
 buffer_load_dwordx4 v20, s[64:67], s57 offen offset:0 lds
 s_waitcnt vmcnt(15)
 buffer_load_dwordx4 v21, s[64:67], s57 offen offset:1024 lds
 s_waitcnt vmcnt(15)
 buffer_load_dwordx4 v22, s[64:67], s57 offen offset:2048 lds
 s_barrier
 s_add_u32 s57, s91, 32768
 s_and_b32 s57, s57, 0x1ffff
 s_add_u32 s57, s57, s48
 s_add_u32 s57, s57, 131072
 s_add_u32 m0, s48, 0
 s_nop 0
 s_waitcnt vmcnt(15)
 buffer_load_dwordx4 v14, s[28:31], s57 offen offset:2048 nt lds
 s_waitcnt vmcnt(15)
 buffer_load_dwordx4 v15, s[28:31], s57 offen offset:3072 nt lds
 s_add_u32 s57, s91, 24576
 s_and_b32 s57, s57, 0x1ffff
 s_add_u32 s57, s57, s48
 s_add_u32 s57, s57, 131072
 s_add_u32 m0, s48, 81920
 s_nop 0
 s_waitcnt vmcnt(15)
 buffer_load_dwordx4 v16, s[32:35], s57 offen offset:0 nt lds
 s_waitcnt vmcnt(15)
 buffer_load_dwordx4 v16, s[32:35], s57 offen offset:1024 nt lds
 s_waitcnt vmcnt(15)
 buffer_load_dwordx4 v16, s[32:35], s57 offen offset:2048 nt lds
 s_waitcnt vmcnt(15)
 buffer_load_dwordx4 v16, s[32:35], s57 offen offset:3072 nt lds
 s_add_u32 s57, s91, 40960
 s_and_b32 s57, s57, 0x1ffff
 s_add_u32 s57, s57, s48
 s_add_u32 s57, s57, 131072
 s_add_u32 m0, s48, 8192
 s_nop 0
 s_waitcnt vmcnt(15)
 buffer_load_dwordx4 v12, s[28:31], s57 offen offset:0 nt lds
 s_waitcnt vmcnt(15)
 buffer_load_dwordx4 v13, s[28:31], s57 offen offset:1024 nt lds
 s_add_u32 s49, s63, 0
 s_and_b32 s49, s49, 3
 s_lshl_b32 s49, s49, 1
 s_add_u32 s49, s49, 0
 s_mul_i32 s49, s49, 163840
 s_add_u32 s49, s49, s90
 s_add_u32 m0, s51, 114688
 s_add_u32 s57, s49, 40960
 s_waitcnt vmcnt(15)
 buffer_load_dwordx4 v23, s[64:67], s57 offen offset:3072 lds
 s_add_u32 m0, s51, 118784
 s_add_u32 s57, s49, 40960
 s_waitcnt vmcnt(15)
 buffer_load_dwordx4 v24, s[64:67], s57 offen lds
 s_add_u32 s49, s63, 0
 s_and_b32 s49, s49, 3
 s_lshl_b32 s49, s49, 1
 s_add_u32 s49, s49, 0
 s_mul_i32 s49, s49, 163840
 s_add_u32 s49, s49, s90
 s_add_u32 m0, s51, 124928
 s_add_u32 s57, s49, 81920
 s_waitcnt vmcnt(15)
 buffer_load_dwordx4 v20, s[64:67], s57 offen offset:0 lds
 s_waitcnt vmcnt(15)
 buffer_load_dwordx4 v21, s[64:67], s57 offen offset:1024 lds
 s_waitcnt vmcnt(15)
 s_barrier
 s_add_u32 s57, s91, 40960
 s_and_b32 s57, s57, 0x1ffff
 s_add_u32 s57, s57, s48
 s_add_u32 s57, s57, 131072
 s_add_u32 m0, s48, 8192
 s_nop 0
 buffer_load_dwordx4 v14, s[28:31], s57 offen offset:2048 nt lds
 s_waitcnt vmcnt(15)
 buffer_load_dwordx4 v15, s[28:31], s57 offen offset:3072 nt lds
 s_add_u32 s57, s91, 32768
 s_and_b32 s57, s57, 0x1ffff
 s_add_u32 s57, s57, s48
 s_add_u32 s57, s57, 131072
 s_add_u32 m0, s48, 90112
 s_nop 0
 s_waitcnt vmcnt(15)
 buffer_load_dwordx4 v16, s[32:35], s57 offen offset:0 nt lds
 s_waitcnt vmcnt(15)
 buffer_load_dwordx4 v16, s[32:35], s57 offen offset:1024 nt lds
 s_waitcnt vmcnt(15)
 buffer_load_dwordx4 v16, s[32:35], s57 offen offset:2048 nt lds
 s_waitcnt vmcnt(15)
 buffer_load_dwordx4 v16, s[32:35], s57 offen offset:3072 nt lds
 s_add_u32 s57, s91, 49152
 s_and_b32 s57, s57, 0x1ffff
 s_add_u32 s57, s57, s48
 s_add_u32 s57, s57, 131072
 s_add_u32 m0, s48, 16384
 s_nop 0
 s_waitcnt vmcnt(15)
 buffer_load_dwordx4 v12, s[28:31], s57 offen offset:0 nt lds
 s_waitcnt vmcnt(15)
 buffer_load_dwordx4 v13, s[28:31], s57 offen offset:1024 nt lds
 s_add_u32 s49, s63, 0
 s_and_b32 s49, s49, 3
 s_lshl_b32 s49, s49, 1
 s_add_u32 s49, s49, 0
 s_mul_i32 s49, s49, 163840
 s_add_u32 s49, s49, s90
 s_add_u32 m0, s51, 124928
 s_add_u32 s57, s49, 81920
 s_waitcnt vmcnt(15)
 buffer_load_dwordx4 v22, s[64:67], s57 offen offset:2048 lds
 s_waitcnt vmcnt(15)
 buffer_load_dwordx4 v23, s[64:67], s57 offen offset:3072 lds
 s_add_u32 m0, s51, 129024
 s_add_u32 s57, s49, 81920
 s_waitcnt vmcnt(15)
 buffer_load_dwordx4 v24, s[64:67], s57 offen lds
 s_add_u32 s49, s63, 0
 s_and_b32 s49, s49, 3
 s_lshl_b32 s49, s49, 1
 s_add_u32 s49, s49, 0
 s_mul_i32 s49, s49, 163840
 s_add_u32 s49, s49, s90
 s_add_u32 m0, s51, 135168
 s_add_u32 s57, s49, 122880
 s_waitcnt vmcnt(15)
 buffer_load_dwordx4 v20, s[64:67], s57 offen offset:0 lds
 s_waitcnt vmcnt(14)
 s_barrier
 s_add_u32 s57, s91, 49152
 s_and_b32 s57, s57, 0x1ffff
 s_add_u32 s57, s57, s48
 s_add_u32 s57, s57, 131072
 s_add_u32 m0, s48, 16384
 s_nop 0
 buffer_load_dwordx4 v14, s[28:31], s57 offen offset:2048 nt lds
 buffer_load_dwordx4 v15, s[28:31], s57 offen offset:3072 nt lds
 s_add_u32 s57, s91, 40960
 s_and_b32 s57, s57, 0x1ffff
 s_add_u32 s57, s57, s48
 s_add_u32 s57, s57, 131072
 s_add_u32 m0, s48, 98304
 s_nop 0
 s_waitcnt vmcnt(15)
 buffer_load_dwordx4 v16, s[32:35], s57 offen offset:0 nt lds
 s_waitcnt vmcnt(15)
 buffer_load_dwordx4 v16, s[32:35], s57 offen offset:1024 nt lds
 s_waitcnt vmcnt(15)
 buffer_load_dwordx4 v16, s[32:35], s57 offen offset:2048 nt lds
 s_waitcnt vmcnt(15)
 buffer_load_dwordx4 v16, s[32:35], s57 offen offset:3072 nt lds
 s_add_u32 s57, s91, 57344
 s_and_b32 s57, s57, 0x1ffff
 s_add_u32 s57, s57, s48
 s_add_u32 s57, s57, 131072
 s_add_u32 m0, s48, 49152
 s_nop 0
 s_waitcnt vmcnt(15)
 buffer_load_dwordx4 v12, s[28:31], s57 offen offset:0 nt lds
 s_waitcnt vmcnt(15)
 buffer_load_dwordx4 v13, s[28:31], s57 offen offset:1024 nt lds
 s_add_u32 s49, s63, 0
 s_and_b32 s49, s49, 3
 s_lshl_b32 s49, s49, 1
 s_add_u32 s49, s49, 0
 s_mul_i32 s49, s49, 163840
 s_add_u32 s49, s49, s90
 s_add_u32 m0, s51, 135168
 s_add_u32 s57, s49, 122880
 s_waitcnt vmcnt(15)
 buffer_load_dwordx4 v21, s[64:67], s57 offen offset:1024 lds
 s_waitcnt vmcnt(15)
 buffer_load_dwordx4 v22, s[64:67], s57 offen offset:2048 lds
 s_waitcnt vmcnt(15)
 buffer_load_dwordx4 v23, s[64:67], s57 offen offset:3072 lds
 s_add_u32 m0, s51, 139264
 s_add_u32 s57, s49, 122880
 s_waitcnt vmcnt(15)
 buffer_load_dwordx4 v24, s[64:67], s57 offen lds
 s_waitcnt vmcnt(13)
 s_barrier
 s_add_u32 s57, s91, 57344
 s_and_b32 s57, s57, 0x1ffff
 s_add_u32 s57, s57, s48
 s_add_u32 s57, s57, 131072
 s_add_u32 m0, s48, 49152
 s_nop 0
 buffer_load_dwordx4 v14, s[28:31], s57 offen offset:2048 nt lds
 buffer_load_dwordx4 v15, s[28:31], s57 offen offset:3072 nt lds
 s_add_u32 s57, s91, 49152
 s_and_b32 s57, s57, 0x1ffff
 s_add_u32 s57, s57, s48
 s_add_u32 s57, s57, 131072
 s_add_u32 m0, s48, 106496
 s_nop 0
 buffer_load_dwordx4 v16, s[32:35], s57 offen offset:0 nt lds
 s_waitcnt vmcnt(15)
 buffer_load_dwordx4 v16, s[32:35], s57 offen offset:1024 nt lds
 s_waitcnt vmcnt(15)
 buffer_load_dwordx4 v16, s[32:35], s57 offen offset:2048 nt lds
 s_waitcnt vmcnt(15)
 buffer_load_dwordx4 v16, s[32:35], s57 offen offset:3072 nt lds
 s_waitcnt vmcnt(6)
 s_barrier
 s_add_u32 s57, s91, 65536
 s_and_b32 s57, s57, 0x1ffff
 s_add_u32 s57, s57, s48
 s_add_u32 s57, s57, 131072
 s_add_u32 m0, s48, 24576
 s_nop 0
 buffer_load_dwordx4 v12, s[28:31], s57 offen offset:0 nt lds
 buffer_load_dwordx4 v13, s[28:31], s57 offen offset:1024 nt lds
 buffer_load_dwordx4 v14, s[28:31], s57 offen offset:2048 nt lds
 buffer_load_dwordx4 v15, s[28:31], s57 offen offset:3072 nt lds
 s_add_u32 s57, s91, 57344
 s_and_b32 s57, s57, 0x1ffff
 s_add_u32 s57, s57, s48
 s_add_u32 s57, s57, 131072
 s_add_u32 m0, s48, 73728
 s_nop 0
 buffer_load_dwordx4 v16, s[32:35], s57 offen offset:0 nt lds
 buffer_load_dwordx4 v16, s[32:35], s57 offen offset:1024 nt lds
 s_barrier
 s_add_u32 s57, s91, 57344
 s_and_b32 s57, s57, 0x1ffff
 s_add_u32 s57, s57, s48
 s_add_u32 s57, s57, 131072
 s_add_u32 m0, s48, 73728
 s_nop 0
 buffer_load_dwordx4 v16, s[32:35], s57 offen offset:2048 nt lds
 buffer_load_dwordx4 v16, s[32:35], s57 offen offset:3072 nt lds
 s_add_u32 s57, s91, 73728
 s_and_b32 s57, s57, 0x1ffff
 s_add_u32 s57, s57, s48
 s_add_u32 s57, s57, 131072
 s_add_u32 m0, s48, 0
 s_nop 0
 buffer_load_dwordx4 v12, s[28:31], s57 offen offset:0 nt lds
 buffer_load_dwordx4 v13, s[28:31], s57 offen offset:1024 nt lds
 s_waitcnt vmcnt(15)
 buffer_load_dwordx4 v14, s[28:31], s57 offen offset:2048 nt lds
 s_waitcnt vmcnt(15)
 buffer_load_dwordx4 v15, s[28:31], s57 offen offset:3072 nt lds
 s_barrier
 s_add_u32 s57, s91, 65536
 s_and_b32 s57, s57, 0x1ffff
 s_add_u32 s57, s57, s48
 s_add_u32 s57, s57, 131072
 s_add_u32 m0, s48, 81920
 s_nop 0
 s_waitcnt vmcnt(15)
 buffer_load_dwordx4 v16, s[32:35], s57 offen offset:0 nt lds
 s_waitcnt vmcnt(15)
 buffer_load_dwordx4 v16, s[32:35], s57 offen offset:1024 nt lds
 s_waitcnt vmcnt(15)
 buffer_load_dwordx4 v16, s[32:35], s57 offen offset:2048 nt lds
 s_waitcnt vmcnt(15)
 buffer_load_dwordx4 v16, s[32:35], s57 offen offset:3072 nt lds
 s_add_u32 s57, s91, 81920
 s_and_b32 s57, s57, 0x1ffff
 s_add_u32 s57, s57, s48
 s_add_u32 s57, s57, 131072
 s_add_u32 m0, s48, 8192
 s_nop 0
 s_waitcnt vmcnt(15)
 buffer_load_dwordx4 v12, s[28:31], s57 offen offset:0 nt lds
 s_waitcnt vmcnt(15)
 buffer_load_dwordx4 v13, s[28:31], s57 offen offset:1024 nt lds
 s_barrier
 s_add_u32 s57, s91, 81920
 s_and_b32 s57, s57, 0x1ffff
 s_add_u32 s57, s57, s48
 s_add_u32 s57, s57, 131072
 s_add_u32 m0, s48, 8192
 s_nop 0
 s_waitcnt vmcnt(15)
 buffer_load_dwordx4 v14, s[28:31], s57 offen offset:2048 nt lds
 s_waitcnt vmcnt(15)
 buffer_load_dwordx4 v15, s[28:31], s57 offen offset:3072 nt lds
 s_add_u32 s57, s91, 73728
 s_and_b32 s57, s57, 0x1ffff
 s_add_u32 s57, s57, s48
 s_add_u32 s57, s57, 131072
 s_add_u32 m0, s48, 90112
 s_nop 0
 s_waitcnt vmcnt(15)
 buffer_load_dwordx4 v16, s[32:35], s57 offen offset:0 nt lds
 s_waitcnt vmcnt(15)
 buffer_load_dwordx4 v16, s[32:35], s57 offen offset:1024 nt lds
 s_waitcnt vmcnt(15)
 buffer_load_dwordx4 v16, s[32:35], s57 offen offset:2048 nt lds
 s_waitcnt vmcnt(15)
 buffer_load_dwordx4 v16, s[32:35], s57 offen offset:3072 nt lds
 s_add_u32 s49, s63, 1
 s_and_b32 s49, s49, 3
 s_lshl_b32 s49, s49, 1
 s_add_u32 s49, s49, 0
 s_mul_i32 s49, s49, 163840
 s_add_u32 s49, s49, s90
 s_add_u32 m0, s51, 145408
 s_add_u32 s57, s49, 0
 s_waitcnt vmcnt(15)
 buffer_load_dwordx4 v20, s[64:67], s57 offen offset:0 lds
 s_waitcnt vmcnt(15)
 buffer_load_dwordx4 v21, s[64:67], s57 offen offset:1024 lds
 s_waitcnt vmcnt(15)
 buffer_load_dwordx4 v22, s[64:67], s57 offen offset:2048 lds
 s_barrier
 s_add_u32 s57, s91, 90112
 s_and_b32 s57, s57, 0x1ffff
 s_add_u32 s57, s57, s48
 s_add_u32 s57, s57, 131072
 s_add_u32 m0, s48, 16384
 s_nop 0
 s_waitcnt vmcnt(15)
 buffer_load_dwordx4 v12, s[28:31], s57 offen offset:0 nt lds
 s_waitcnt vmcnt(15)
 buffer_load_dwordx4 v13, s[28:31], s57 offen offset:1024 nt lds
 s_waitcnt vmcnt(15)
 buffer_load_dwordx4 v14, s[28:31], s57 offen offset:2048 nt lds
 s_waitcnt vmcnt(15)
 buffer_load_dwordx4 v15, s[28:31], s57 offen offset:3072 nt lds
 s_add_u32 s57, s91, 81920
 s_and_b32 s57, s57, 0x1ffff
 s_add_u32 s57, s57, s48
 s_add_u32 s57, s57, 131072
 s_add_u32 m0, s48, 98304
 s_nop 0
 s_waitcnt vmcnt(15)
 buffer_load_dwordx4 v16, s[32:35], s57 offen offset:0 nt lds
 s_waitcnt vmcnt(15)
 buffer_load_dwordx4 v16, s[32:35], s57 offen offset:1024 nt lds
 s_add_u32 s49, s63, 1
 s_and_b32 s49, s49, 3
 s_lshl_b32 s49, s49, 1
 s_add_u32 s49, s49, 0
 s_mul_i32 s49, s49, 163840
 s_add_u32 s49, s49, s90
 s_add_u32 m0, s51, 145408
 s_add_u32 s57, s49, 0
 s_waitcnt vmcnt(15)
 buffer_load_dwordx4 v23, s[64:67], s57 offen offset:3072 lds
 s_add_u32 m0, s51, 149504
 s_add_u32 s57, s49, 0
 s_waitcnt vmcnt(15)
 buffer_load_dwordx4 v24, s[64:67], s57 offen lds
 s_add_u32 s49, s63, 1
 s_and_b32 s49, s49, 3
 s_lshl_b32 s49, s49, 1
 s_add_u32 s49, s49, 0
 s_mul_i32 s49, s49, 163840
 s_add_u32 s49, s49, s90
 s_add_u32 m0, s51, 114688
 s_add_u32 s57, s49, 40960
 s_waitcnt vmcnt(15)
 buffer_load_dwordx4 v20, s[64:67], s57 offen offset:0 lds
 s_barrier
 s_cmp_eq_u32 s61, 1
 s_cbranch_scc0 K_sig_5002
 s_mov_b64 exec, 1
 buffer_store_dword v27, v26, s[8:11], s79 offen sc1
 s_mov_b64 exec, -1
K_sig_5002:
 s_add_u32 s57, s91, 81920
 s_and_b32 s57, s57, 0x1ffff
 s_add_u32 s57, s57, s48
 s_add_u32 s57, s57, 131072
 s_add_u32 m0, s48, 98304
 s_nop 0
 s_waitcnt vmcnt(15)
 buffer_load_dwordx4 v16, s[32:35], s57 offen offset:2048 nt lds
 s_waitcnt vmcnt(15)
 buffer_load_dwordx4 v16, s[32:35], s57 offen offset:3072 nt lds
 s_add_u32 s57, s91, 98304
 s_and_b32 s57, s57, 0x1ffff
 s_add_u32 s57, s57, s48
 s_add_u32 s57, s57, 131072
 s_add_u32 m0, s48, 24576
 s_nop 0
 s_waitcnt vmcnt(15)
 buffer_load_dwordx4 v12, s[28:31], s57 offen offset:0 nt lds
 s_waitcnt vmcnt(15)
 buffer_load_dwordx4 v13, s[28:31], s57 offen offset:1024 nt lds
 s_waitcnt vmcnt(15)
 buffer_load_dwordx4 v14, s[28:31], s57 offen offset:2048 nt lds
 s_waitcnt vmcnt(15)
 buffer_load_dwordx4 v15, s[28:31], s57 offen offset:3072 nt lds
 s_add_u32 s49, s63, 1
 s_and_b32 s49, s49, 3
 s_lshl_b32 s49, s49, 1
 s_add_u32 s49, s49, 0
 s_mul_i32 s49, s49, 163840
 s_add_u32 s49, s49, s90
 s_add_u32 m0, s51, 114688
 s_add_u32 s57, s49, 40960
 s_waitcnt vmcnt(15)
 buffer_load_dwordx4 v21, s[64:67], s57 offen offset:1024 lds
 s_waitcnt vmcnt(15)
 buffer_load_dwordx4 v22, s[64:67], s57 offen offset:2048 lds
 s_waitcnt vmcnt(15)
 buffer_load_dwordx4 v23, s[64:67], s57 offen offset:3072 lds
 s_waitcnt vmcnt(10)
 s_barrier
 s_add_u32 s57, s91, 90112
 s_and_b32 s57, s57, 0x1ffff
 s_add_u32 s57, s57, s48
 s_add_u32 s57, s57, 131072
 s_add_u32 m0, s48, 106496
 s_nop 0
 buffer_load_dwordx4 v16, s[32:35], s57 offen offset:0 nt lds
 buffer_load_dwordx4 v16, s[32:35], s57 offen offset:1024 nt lds
 buffer_load_dwordx4 v16, s[32:35], s57 offen offset:2048 nt lds
 buffer_load_dwordx4 v16, s[32:35], s57 offen offset:3072 nt lds
 s_add_u32 s57, s91, 106496
 s_and_b32 s57, s57, 0x1ffff
 s_add_u32 s57, s57, s48
 s_add_u32 s57, s57, 131072
 s_add_u32 m0, s48, 0
 s_nop 0
 buffer_load_dwordx4 v12, s[28:31], s57 offen offset:0 nt lds
 s_add_u32 s49, s63, 1
 s_and_b32 s49, s49, 3
 s_lshl_b32 s49, s49, 1
 s_add_u32 s49, s49, 0
 s_mul_i32 s49, s49, 163840
 s_add_u32 s49, s49, s90
 s_add_u32 m0, s51, 118784
 s_add_u32 s57, s49, 40960
 buffer_load_dwordx4 v24, s[64:67], s57 offen lds
 s_add_u32 s49, s63, 1
 s_and_b32 s49, s49, 3
 s_lshl_b32 s49, s49, 1
 s_add_u32 s49, s49, 0
 s_mul_i32 s49, s49, 163840
 s_add_u32 s49, s49, s90
 s_add_u32 m0, s51, 124928
 s_add_u32 s57, s49, 81920
 s_waitcnt vmcnt(15)
 buffer_load_dwordx4 v20, s[64:67], s57 offen offset:0 lds
 s_waitcnt vmcnt(15)
 buffer_load_dwordx4 v21, s[64:67], s57 offen offset:1024 lds
 s_barrier
 s_add_u32 s57, s91, 106496
 s_and_b32 s57, s57, 0x1ffff
 s_add_u32 s57, s57, s48
 s_add_u32 s57, s57, 131072
 s_add_u32 m0, s48, 0
 s_nop 0
 s_waitcnt vmcnt(15)
 buffer_load_dwordx4 v13, s[28:31], s57 offen offset:1024 nt lds
 s_waitcnt vmcnt(15)
 buffer_load_dwordx4 v14, s[28:31], s57 offen offset:2048 nt lds
 s_waitcnt vmcnt(15)
 buffer_load_dwordx4 v15, s[28:31], s57 offen offset:3072 nt lds
 s_add_u32 s57, s91, 98304
 s_and_b32 s57, s57, 0x1ffff
 s_add_u32 s57, s57, s48
 s_add_u32 s57, s57, 131072
 s_add_u32 m0, s48, 81920
 s_nop 0
 s_waitcnt vmcnt(15)
 buffer_load_dwordx4 v16, s[32:35], s57 offen offset:0 nt lds
 s_waitcnt vmcnt(15)
 buffer_load_dwordx4 v16, s[32:35], s57 offen offset:1024 nt lds
 s_waitcnt vmcnt(15)
 buffer_load_dwordx4 v16, s[32:35], s57 offen offset:2048 nt lds
 s_add_u32 s49, s63, 1
 s_and_b32 s49, s49, 3
 s_lshl_b32 s49, s49, 1
 s_add_u32 s49, s49, 0
 s_mul_i32 s49, s49, 163840
 s_add_u32 s49, s49, s90
 s_add_u32 m0, s51, 124928
 s_add_u32 s57, s49, 81920
 s_waitcnt vmcnt(15)
 buffer_load_dwordx4 v22, s[64:67], s57 offen offset:2048 lds
 s_waitcnt vmcnt(15)
 buffer_load_dwordx4 v23, s[64:67], s57 offen offset:3072 lds
 s_add_u32 m0, s51, 129024
 s_add_u32 s57, s49, 81920
 s_waitcnt vmcnt(15)
 buffer_load_dwordx4 v24, s[64:67], s57 offen lds
 s_waitcnt vmcnt(11)
 s_barrier
 s_add_u32 s57, s91, 98304
 s_and_b32 s57, s57, 0x1ffff
 s_add_u32 s57, s57, s48
 s_add_u32 s57, s57, 131072
 s_add_u32 m0, s48, 81920
 s_nop 0
 buffer_load_dwordx4 v16, s[32:35], s57 offen offset:3072 nt lds
 s_add_u32 s57, s91, 114688
 s_and_b32 s57, s57, 0x1ffff
 s_add_u32 s57, s57, s48
 s_add_u32 s57, s57, 131072
 s_add_u32 m0, s48, 8192
 s_nop 0
 buffer_load_dwordx4 v12, s[28:31], s57 offen offset:0 nt lds
 buffer_load_dwordx4 v13, s[28:31], s57 offen offset:1024 nt lds
 buffer_load_dwordx4 v14, s[28:31], s57 offen offset:2048 nt lds
 buffer_load_dwordx4 v15, s[28:31], s57 offen offset:3072 nt lds
 s_add_u32 s57, s91, 106496
 s_and_b32 s57, s57, 0x1ffff
 s_add_u32 s57, s57, s48
 s_add_u32 s57, s57, 131072
 s_add_u32 m0, s48, 90112
 s_nop 0
 s_waitcnt vmcnt(15)
 buffer_load_dwordx4 v16, s[32:35], s57 offen offset:0 nt lds
 s_waitcnt vmcnt(15)
 buffer_load_dwordx4 v16, s[32:35], s57 offen offset:1024 nt lds
 s_waitcnt vmcnt(15)
 buffer_load_dwordx4 v16, s[32:35], s57 offen offset:2048 nt lds
 s_add_u32 s49, s63, 1
 s_and_b32 s49, s49, 3
 s_lshl_b32 s49, s49, 1
 s_add_u32 s49, s49, 0
 s_mul_i32 s49, s49, 163840
 s_add_u32 s49, s49, s90
 s_add_u32 m0, s51, 135168
 s_add_u32 s57, s49, 122880
 s_waitcnt vmcnt(15)
 buffer_load_dwordx4 v20, s[64:67], s57 offen offset:0 lds
 s_waitcnt vmcnt(15)
 buffer_load_dwordx4 v21, s[64:67], s57 offen offset:1024 lds
 s_waitcnt vmcnt(15)
 buffer_load_dwordx4 v22, s[64:67], s57 offen offset:2048 lds
 s_waitcnt vmcnt(11)
 s_barrier
 s_add_u32 s57, s91, 106496
 s_and_b32 s57, s57, 0x1ffff
 s_add_u32 s57, s57, s48
 s_add_u32 s57, s57, 131072
 s_add_u32 m0, s48, 90112
 s_nop 0
 buffer_load_dwordx4 v16, s[32:35], s57 offen offset:3072 nt lds
 s_add_u32 s57, s91, 122880
 s_and_b32 s57, s57, 0x1ffff
 s_add_u32 s57, s57, s48
 s_add_u32 s57, s57, 131072
 s_add_u32 m0, s48, 16384
 s_nop 0
 buffer_load_dwordx4 v12, s[28:31], s57 offen offset:0 nt lds
 buffer_load_dwordx4 v13, s[28:31], s57 offen offset:1024 nt lds
 buffer_load_dwordx4 v14, s[28:31], s57 offen offset:2048 nt lds
 buffer_load_dwordx4 v15, s[28:31], s57 offen offset:3072 nt lds
 s_add_u32 s57, s91, 114688
 s_and_b32 s57, s57, 0x1ffff
 s_add_u32 s57, s57, s48
 s_add_u32 s57, s57, 131072
 s_add_u32 m0, s48, 98304
 s_nop 0
 s_waitcnt vmcnt(15)
 buffer_load_dwordx4 v16, s[32:35], s57 offen offset:0 nt lds
 s_waitcnt vmcnt(15)
 buffer_load_dwordx4 v16, s[32:35], s57 offen offset:1024 nt lds
 s_waitcnt vmcnt(15)
 buffer_load_dwordx4 v16, s[32:35], s57 offen offset:2048 nt lds
 s_add_u32 s49, s63, 1
 s_and_b32 s49, s49, 3
 s_lshl_b32 s49, s49, 1
 s_add_u32 s49, s49, 0
 s_mul_i32 s49, s49, 163840
 s_add_u32 s49, s49, s90
 s_add_u32 m0, s51, 135168
 s_add_u32 s57, s49, 122880
 s_waitcnt vmcnt(15)
 buffer_load_dwordx4 v23, s[64:67], s57 offen offset:3072 lds
 s_add_u32 m0, s51, 139264
 s_add_u32 s57, s49, 122880
 s_waitcnt vmcnt(15)
 buffer_load_dwordx4 v24, s[64:67], s57 offen lds
 s_add_u32 s49, s63, 2
 s_and_b32 s49, s49, 3
 s_lshl_b32 s49, s49, 1
 s_add_u32 s49, s49, 0
 s_mul_i32 s49, s49, 163840
 s_add_u32 s49, s49, s90
 s_add_u32 m0, s51, 40960
 s_add_u32 s57, s49, 0
 s_waitcnt vmcnt(15)
 buffer_load_dwordx4 v20, s[64:67], s57 offen offset:0 lds
 buffer_load_dword v31, v28, s[8:11], s79 offen sc1
 s_barrier
 s_add_u32 s57, s91, 114688
 s_and_b32 s57, s57, 0x1ffff
 s_add_u32 s57, s57, s48
 s_add_u32 s57, s57, 131072
 s_add_u32 m0, s48, 98304
 s_nop 0
 s_waitcnt vmcnt(15)
 buffer_load_dwordx4 v16, s[32:35], s57 offen offset:3072 nt lds
 s_add_u32 s57, s91, 131072
 s_and_b32 s57, s57, 0x1ffff
 s_add_u32 s57, s57, s48
 s_add_u32 s57, s57, 131072
 s_add_u32 m0, s48, 0
 s_nop 0
 s_waitcnt vmcnt(15)
 buffer_load_dwordx4 v12, s[28:31], s57 offen offset:0 nt lds
 s_waitcnt vmcnt(15)
 buffer_load_dwordx4 v13, s[28:31], s57 offen offset:1024 nt lds
 s_waitcnt vmcnt(15)
 buffer_load_dwordx4 v14, s[28:31], s57 offen offset:2048 nt lds
 s_waitcnt vmcnt(15)
 buffer_load_dwordx4 v15, s[28:31], s57 offen offset:3072 nt lds
 s_add_u32 s57, s91, 122880
 s_and_b32 s57, s57, 0x1ffff
 s_add_u32 s57, s57, s48
 s_add_u32 s57, s57, 131072
 s_add_u32 m0, s48, 106496
 s_nop 0
 s_waitcnt vmcnt(15)
 buffer_load_dwordx4 v16, s[32:35], s57 offen offset:0 nt lds
 s_waitcnt vmcnt(15)
 buffer_load_dwordx4 v16, s[32:35], s57 offen offset:1024 nt lds
 s_waitcnt vmcnt(15)
 buffer_load_dwordx4 v16, s[32:35], s57 offen offset:2048 nt lds
 s_add_u32 s49, s63, 2
 s_and_b32 s49, s49, 3
 s_lshl_b32 s49, s49, 1
 s_add_u32 s49, s49, 0
 s_mul_i32 s49, s49, 163840
 s_add_u32 s49, s49, s90
 s_add_u32 m0, s51, 40960
 s_add_u32 s57, s49, 0
 s_waitcnt vmcnt(15)
 buffer_load_dwordx4 v21, s[64:67], s57 offen offset:1024 lds
 s_waitcnt vmcnt(15)
 buffer_load_dwordx4 v22, s[64:67], s57 offen offset:2048 lds
 s_waitcnt vmcnt(15)
 buffer_load_dwordx4 v23, s[64:67], s57 offen offset:3072 lds
 s_waitcnt vmcnt(13)
 s_barrier
 s_waitcnt vmcnt(11)
K_poll_5003:
 v_cmp_eq_u32 vcc, s94, v31
 s_and_b32 s49, vcc_lo, 7
 s_cmp_eq_u32 s49, 7
 s_cbranch_scc1 K_poll_5003_ok
 s_sleep 1
 buffer_load_dword v31, v28, s[8:11], s79 offen sc1
 s_waitcnt vmcnt(0)
 s_branch K_poll_5003
K_poll_5003_ok:
 s_lshl_b32 s44, s82, 9
 s_add_u32 s79, s44, 32768
 s_lshl_b32 s44, s63, 7
 v_mov_b32 v26, s44
 v_and_b32 v28, 3, v250
 v_min_u32 v28, 2, v28
 s_add_u32 s44, s63, 1
 v_add_u32 v28, s44, v28
 v_and_b32 v28, 3, v28
 v_lshlrev_b32 v28, 7, v28
 v_mov_b32 v27, s94
 s_add_u32 s57, s91, 122880
 s_and_b32 s57, s57, 0x1ffff
 s_add_u32 s57, s57, s48
 s_add_u32 s57, s57, 131072
 s_add_u32 m0, s48, 106496
 s_nop 0
 buffer_load_dwordx4 v16, s[32:35], s57 offen offset:3072 nt lds
 s_add_u32 s57, s91, 131072
 s_and_b32 s57, s57, 0x1ffff
 s_add_u32 s57, s57, s48
 s_add_u32 s57, s57, 131072
 s_add_u32 m0, s48, 81920
 s_nop 0
 buffer_load_dwordx4 v16, s[32:35], s57 offen offset:0 nt lds
 buffer_load_dwordx4 v16, s[32:35], s57 offen offset:1024 nt lds
 buffer_load_dwordx4 v16, s[32:35], s57 offen offset:2048 nt lds
 buffer_load_dwordx4 v16, s[32:35], s57 offen offset:3072 nt lds
 s_add_u32 s49, s63, 2
 s_and_b32 s49, s49, 3
 s_lshl_b32 s49, s49, 1
 s_add_u32 s49, s49, 0
 s_mul_i32 s49, s49, 163840
 s_add_u32 s49, s49, s90
 s_add_u32 m0, s51, 45056
 s_add_u32 s57, s49, 0
 s_waitcnt vmcnt(15)
 buffer_load_dwordx4 v24, s[64:67], s57 offen lds
 s_add_u32 s49, s63, 1
 s_and_b32 s49, s49, 3
 s_lshl_b32 s49, s49, 1
 s_add_u32 s49, s49, 0
 s_mul_i32 s49, s49, 24576
 s_add_u32 s49, s49, s50
 s_add_u32 m0, s50, 155648
 s_add_u32 s57, s49, 0
 s_waitcnt vmcnt(15)
 buffer_load_dwordx4 v30, s[68:71], s57 offen sc1 lds
 s_add_u32 m0, s50, 157696
 s_add_u32 s57, s49, 8192
 s_waitcnt vmcnt(15)
 buffer_load_dwordx4 v30, s[68:71], s57 offen sc1 lds
 s_add_u32 m0, s50, 159744
 s_add_u32 s57, s49, 16384
 s_waitcnt vmcnt(15)
 buffer_load_dwordx4 v30, s[68:71], s57 offen sc1 lds
 s_waitcnt vmcnt(15)
 s_barrier
 s_add_u32 s49, s63, 1
 s_and_b32 s49, s49, 3
 s_lshl_b32 s49, s49, 1
 s_add_u32 s49, s49, 0
 s_mul_i32 s49, s49, 24576
 s_add_u32 s49, s49, s50
 s_add_u32 m0, s50, 51200
 s_add_u32 s57, s49, 2048
 buffer_load_dwordx4 v30, s[68:71], s57 offen sc1 lds
 s_add_u32 m0, s50, 53248
 s_add_u32 s57, s49, 10240
 s_waitcnt vmcnt(15)
 buffer_load_dwordx4 v30, s[68:71], s57 offen sc1 lds
 s_add_u32 m0, s50, 55296
 s_add_u32 s57, s49, 18432
 s_waitcnt vmcnt(15)
 buffer_load_dwordx4 v30, s[68:71], s57 offen sc1 lds
 s_add_u32 s49, s63, 1
 s_and_b32 s49, s49, 3
 s_lshl_b32 s49, s49, 1
 s_add_u32 s49, s49, 0
 s_mul_i32 s49, s49, 24576
 s_add_u32 s49, s49, s50
 s_add_u32 m0, s50, 57344
 s_add_u32 s57, s49, 4096
 s_waitcnt vmcnt(15)
 buffer_load_dwordx4 v30, s[68:71], s57 offen sc1 lds
 s_add_u32 m0, s50, 59392
 s_add_u32 s57, s49, 12288
 s_waitcnt vmcnt(15)
 buffer_load_dwordx4 v30, s[68:71], s57 offen sc1 lds
 s_add_u32 m0, s50, 61440
 s_add_u32 s57, s49, 20480
 s_waitcnt vmcnt(15)
 buffer_load_dwordx4 v30, s[68:71], s57 offen sc1 lds
 s_add_u32 s49, s63, 1
 s_and_b32 s49, s49, 3
 s_lshl_b32 s49, s49, 1
 s_add_u32 s49, s49, 0
 s_mul_i32 s49, s49, 24576
 s_add_u32 s49, s49, s50
 s_add_u32 m0, s50, 63488
 s_add_u32 s57, s49, 6144
 s_waitcnt vmcnt(15)
 buffer_load_dwordx4 v30, s[68:71], s57 offen sc1 lds
 s_add_u32 m0, s50, 65536
 s_add_u32 s57, s49, 14336
 s_waitcnt vmcnt(15)
 buffer_load_dwordx4 v30, s[68:71], s57 offen sc1 lds
 s_add_u32 m0, s50, 67584
 s_add_u32 s57, s49, 22528
 s_waitcnt vmcnt(15)
 buffer_load_dwordx4 v30, s[68:71], s57 offen sc1 lds
 s_add_u32 s49, s63, 2
 s_and_b32 s49, s49, 3
 s_lshl_b32 s49, s49, 1
 s_add_u32 s49, s49, 0
 s_mul_i32 s49, s49, 24576
 s_add_u32 s49, s49, s50
 s_add_u32 m0, s50, 69632
 s_add_u32 s57, s49, 0
 s_waitcnt vmcnt(15)
 buffer_load_dwordx4 v30, s[68:71], s57 offen sc1 lds
 s_add_u32 m0, s50, 71680
 s_add_u32 s57, s49, 8192
 s_waitcnt vmcnt(15)
 buffer_load_dwordx4 v30, s[68:71], s57 offen sc1 lds
 s_add_u32 m0, s50, 73728
 s_add_u32 s57, s49, 16384
 s_waitcnt vmcnt(15)
 buffer_load_dwordx4 v30, s[68:71], s57 offen sc1 lds
 s_waitcnt vmcnt(15)
 s_waitcnt vmcnt(12)
 s_barrier
 s_add_u32 s49, s63, 2
 s_and_b32 s49, s49, 3
 s_lshl_b32 s49, s49, 1
 s_add_u32 s49, s49, 0
 s_mul_i32 s49, s49, 163840
 s_add_u32 s49, s49, s90
 s_add_u32 m0, s51, 24576
 s_add_u32 s57, s49, 40960
 buffer_load_dwordx4 v20, s[64:67], s57 offen offset:0 lds
 buffer_load_dwordx4 v21, s[64:67], s57 offen offset:1024 lds
 buffer_load_dwordx4 v22, s[64:67], s57 offen offset:2048 lds
 buffer_load_dwordx4 v23, s[64:67], s57 offen offset:3072 lds
 s_add_u32 m0, s51, 28672
 s_add_u32 s57, s49, 40960
 s_waitcnt vmcnt(15)
 buffer_load_dwordx4 v24, s[64:67], s57 offen lds
 s_add_u32 s49, s63, 2
 s_and_b32 s49, s49, 3
 s_lshl_b32 s49, s49, 1
 s_add_u32 s49, s49, 0
 s_mul_i32 s49, s49, 24576
 s_add_u32 s49, s49, s50
 s_add_u32 m0, s50, 75776
 s_add_u32 s57, s49, 2048
 s_waitcnt vmcnt(15)
 buffer_load_dwordx4 v30, s[68:71], s57 offen sc1 lds
 s_add_u32 m0, s50, 77824
 s_add_u32 s57, s49, 10240
 s_waitcnt vmcnt(15)
 buffer_load_dwordx4 v30, s[68:71], s57 offen sc1 lds
 s_add_u32 m0, s50, 79872
 s_add_u32 s57, s49, 18432
 s_waitcnt vmcnt(15)
 buffer_load_dwordx4 v30, s[68:71], s57 offen sc1 lds
 s_add_u32 s49, s63, 2
 s_and_b32 s49, s49, 3
 s_lshl_b32 s49, s49, 1
 s_add_u32 s49, s49, 0
 s_mul_i32 s49, s49, 163840
 s_add_u32 s49, s49, s90
 s_add_u32 m0, s51, 92160
 s_add_u32 s57, s49, 81920
 s_waitcnt vmcnt(15)
 buffer_load_dwordx4 v20, s[64:67], s57 offen offset:0 lds
 s_waitcnt vmcnt(15)
 buffer_load_dwordx4 v21, s[64:67], s57 offen offset:1024 lds
 s_waitcnt vmcnt(15)
 buffer_load_dwordx4 v22, s[64:67], s57 offen offset:2048 lds
 s_waitcnt vmcnt(15)
 buffer_load_dwordx4 v23, s[64:67], s57 offen offset:3072 lds
 s_waitcnt vmcnt(15)
 s_waitcnt vmcnt(12)
 s_barrier
 s_add_u32 s49, s63, 2
 s_and_b32 s49, s49, 3
 s_lshl_b32 s49, s49, 1
 s_add_u32 s49, s49, 0
 s_mul_i32 s49, s49, 163840
 s_add_u32 s49, s49, s90
 s_add_u32 m0, s51, 96256
 s_add_u32 s57, s49, 81920
 buffer_load_dwordx4 v24, s[64:67], s57 offen lds
 s_add_u32 s49, s63, 2
 s_and_b32 s49, s49, 3
 s_lshl_b32 s49, s49, 1
 s_add_u32 s49, s49, 0
 s_mul_i32 s49, s49, 24576
 s_add_u32 s49, s49, s50
 s_add_u32 m0, s50, 155648
 s_add_u32 s57, s49, 4096
 buffer_load_dwordx4 v30, s[68:71], s57 offen sc1 lds
 s_add_u32 m0, s50, 157696
 s_add_u32 s57, s49, 12288
 buffer_load_dwordx4 v30, s[68:71], s57 offen sc1 lds
 s_add_u32 m0, s50, 159744
 s_add_u32 s57, s49, 20480
 buffer_load_dwordx4 v30, s[68:71], s57 offen sc1 lds
 s_add_u32 s49, s63, 2
 s_and_b32 s49, s49, 3
 s_lshl_b32 s49, s49, 1
 s_add_u32 s49, s49, 0
 s_mul_i32 s49, s49, 163840
 s_add_u32 s49, s49, s90
 s_add_u32 m0, s51, 145408
 s_add_u32 s57, s49, 122880
 s_waitcnt vmcnt(15)
 buffer_load_dwordx4 v20, s[64:67], s57 offen offset:0 lds
 s_waitcnt vmcnt(15)
 buffer_load_dwordx4 v21, s[64:67], s57 offen offset:1024 lds
 s_waitcnt vmcnt(15)
 buffer_load_dwordx4 v22, s[64:67], s57 offen offset:2048 lds
 s_waitcnt vmcnt(15)
 buffer_load_dwordx4 v23, s[64:67], s57 offen offset:3072 lds
 s_add_u32 m0, s51, 149504
 s_add_u32 s57, s49, 122880
 s_waitcnt vmcnt(15)
 buffer_load_dwordx4 v24, s[64:67], s57 offen lds
 s_add_u32 s49, s63, 2
 s_and_b32 s49, s49, 3
 s_lshl_b32 s49, s49, 1
 s_add_u32 s49, s49, 0
 s_mul_i32 s49, s49, 24576
 s_add_u32 s49, s49, s50
 s_add_u32 m0, s50, 34816
 s_add_u32 s57, s49, 6144
 s_waitcnt vmcnt(15)
 buffer_load_dwordx4 v30, s[68:71], s57 offen sc1 lds
 s_add_u32 m0, s50, 36864
 s_add_u32 s57, s49, 14336
 s_waitcnt vmcnt(15)
 buffer_load_dwordx4 v30, s[68:71], s57 offen sc1 lds
 s_add_u32 m0, s50, 38912
 s_add_u32 s57, s49, 22528
 s_waitcnt vmcnt(15)
 buffer_load_dwordx4 v30, s[68:71], s57 offen sc1 lds
 s_barrier
 s_add_u32 s49, s63, 3
 s_and_b32 s49, s49, 3
 s_lshl_b32 s49, s49, 1
 s_add_u32 s49, s49, 0
 s_mul_i32 s49, s49, 163840
 s_add_u32 s49, s49, s90
 s_add_u32 m0, s51, 114688
 s_add_u32 s57, s49, 0
 buffer_load_dwordx4 v20, s[64:67], s57 offen offset:0 lds
 buffer_load_dwordx4 v21, s[64:67], s57 offen offset:1024 lds
 buffer_load_dwordx4 v22, s[64:67], s57 offen offset:2048 lds
 buffer_load_dwordx4 v23, s[64:67], s57 offen offset:3072 lds
 s_add_u32 m0, s51, 118784
 s_add_u32 s57, s49, 0
 buffer_load_dwordx4 v24, s[64:67], s57 offen lds
 s_add_u32 s49, s63, 3
 s_and_b32 s49, s49, 3
 s_lshl_b32 s49, s49, 1
 s_add_u32 s49, s49, 0
 s_mul_i32 s49, s49, 24576
 s_add_u32 s49, s49, s50
 s_add_u32 m0, s50, 51200
 s_add_u32 s57, s49, 0
 buffer_load_dwordx4 v30, s[68:71], s57 offen sc1 lds
 s_add_u32 m0, s50, 53248
 s_add_u32 s57, s49, 8192
 buffer_load_dwordx4 v30, s[68:71], s57 offen sc1 lds
 s_add_u32 m0, s50, 55296
 s_add_u32 s57, s49, 16384
 buffer_load_dwordx4 v30, s[68:71], s57 offen sc1 lds
 s_add_u32 s49, s63, 3
 s_and_b32 s49, s49, 3
 s_lshl_b32 s49, s49, 1
 s_add_u32 s49, s49, 0
 s_mul_i32 s49, s49, 163840
 s_add_u32 s49, s49, s90
 s_add_u32 m0, s51, 81920
 s_add_u32 s57, s49, 40960
 buffer_load_dwordx4 v20, s[64:67], s57 offen offset:0 lds
 buffer_load_dwordx4 v21, s[64:67], s57 offen offset:1024 lds
 buffer_load_dwordx4 v22, s[64:67], s57 offen offset:2048 lds
 buffer_load_dwordx4 v23, s[64:67], s57 offen offset:3072 lds
 s_add_u32 m0, s51, 86016
 s_add_u32 s57, s49, 40960
 buffer_load_dwordx4 v24, s[64:67], s57 offen lds
 s_add_u32 s49, s63, 3
 s_and_b32 s49, s49, 3
 s_lshl_b32 s49, s49, 1
 s_add_u32 s49, s49, 0
 s_mul_i32 s49, s49, 163840
 s_add_u32 s49, s49, s90
 s_add_u32 m0, s51, 102400
 s_add_u32 s57, s49, 81920
 buffer_load_dwordx4 v20, s[64:67], s57 offen offset:0 lds
 buffer_load_dwordx4 v21, s[64:67], s57 offen offset:1024 lds
 buffer_load_dwordx4 v22, s[64:67], s57 offen offset:2048 lds
 buffer_load_dwordx4 v23, s[64:67], s57 offen offset:3072 lds
 s_add_u32 m0, s51, 106496
 s_add_u32 s57, s49, 81920
 buffer_load_dwordx4 v24, s[64:67], s57 offen lds
 s_waitcnt vmcnt(29)
 s_waitcnt vmcnt(26)
 s_waitcnt vmcnt(21)
 s_waitcnt vmcnt(18)
 s_barrier
 s_add_u32 s49, s63, 3
 s_and_b32 s49, s49, 3
 s_lshl_b32 s49, s49, 1
 s_add_u32 s49, s49, 0
 s_mul_i32 s49, s49, 24576
 s_add_u32 s49, s49, s50
 s_add_u32 m0, s50, 57344
 s_add_u32 s57, s49, 2048
 buffer_load_dwordx4 v30, s[68:71], s57 offen sc1 lds
 s_add_u32 m0, s50, 59392
 s_add_u32 s57, s49, 10240
 buffer_load_dwordx4 v30, s[68:71], s57 offen sc1 lds
 s_add_u32 m0, s50, 61440
 s_add_u32 s57, s49, 18432
 buffer_load_dwordx4 v30, s[68:71], s57 offen sc1 lds
 s_add_u32 s49, s63, 3
 s_and_b32 s49, s49, 3
 s_lshl_b32 s49, s49, 1
 s_add_u32 s49, s49, 0
 s_mul_i32 s49, s49, 24576
 s_add_u32 s49, s49, s50
 s_add_u32 m0, s50, 63488
 s_add_u32 s57, s49, 4096
 buffer_load_dwordx4 v30, s[68:71], s57 offen sc1 lds
 s_add_u32 m0, s50, 65536
 s_add_u32 s57, s49, 12288
 buffer_load_dwordx4 v30, s[68:71], s57 offen sc1 lds
 s_add_u32 m0, s50, 67584
 s_add_u32 s57, s49, 20480
 buffer_load_dwordx4 v30, s[68:71], s57 offen sc1 lds
 s_add_u32 s49, s63, 3
 s_and_b32 s49, s49, 3
 s_lshl_b32 s49, s49, 1
 s_add_u32 s49, s49, 0
 s_mul_i32 s49, s49, 163840
 s_add_u32 s49, s49, s90
 s_add_u32 m0, s51, 124928
 s_add_u32 s57, s49, 122880
 buffer_load_dwordx4 v20, s[64:67], s57 offen offset:0 lds
 buffer_load_dwordx4 v21, s[64:67], s57 offen offset:1024 lds
 buffer_load_dwordx4 v22, s[64:67], s57 offen offset:2048 lds
 buffer_load_dwordx4 v23, s[64:67], s57 offen offset:3072 lds
 s_add_u32 m0, s51, 129024
 s_add_u32 s57, s49, 122880
 buffer_load_dwordx4 v24, s[64:67], s57 offen lds
 s_add_u32 s49, s63, 3
 s_and_b32 s49, s49, 3
 s_lshl_b32 s49, s49, 1
 s_add_u32 s49, s49, 0
 s_mul_i32 s49, s49, 24576
 s_add_u32 s49, s49, s50
 s_add_u32 m0, s50, 69632
 s_add_u32 s57, s49, 6144
 buffer_load_dwordx4 v30, s[68:71], s57 offen sc1 lds
 s_add_u32 m0, s50, 71680
 s_add_u32 s57, s49, 14336
 buffer_load_dwordx4 v30, s[68:71], s57 offen sc1 lds
 s_add_u32 m0, s50, 73728
 s_add_u32 s57, s49, 22528
 buffer_load_dwordx4 v30, s[68:71], s57 offen sc1 lds
 s_add_u32 s49, s63, 0
 s_and_b32 s49, s49, 3
 s_lshl_b32 s49, s49, 1
 s_add_u32 s49, s49, 1
 s_mul_i32 s49, s49, 163840
 s_add_u32 s49, s49, s90
 s_add_u32 m0, s51, 135168
 s_add_u32 s57, s49, 0
 buffer_load_dwordx4 v20, s[64:67], s57 offen offset:0 lds
 buffer_load_dwordx4 v21, s[64:67], s57 offen offset:1024 lds
 buffer_load_dwordx4 v22, s[64:67], s57 offen offset:2048 lds
 buffer_load_dwordx4 v23, s[64:67], s57 offen offset:3072 lds
 s_add_u32 m0, s51, 139264
 s_add_u32 s57, s49, 0
 buffer_load_dwordx4 v24, s[64:67], s57 offen lds
 s_waitcnt vmcnt(32)
 s_waitcnt vmcnt(29)
 s_waitcnt vmcnt(24)
 s_waitcnt vmcnt(16)
 s_barrier
 s_cmp_eq_u32 s61, 1
 s_cbranch_scc0 K_sig_5004
 s_mov_b64 exec, 1
 buffer_store_dword v27, v26, s[8:11], s79 offen sc1
 s_mov_b64 exec, -1
K_sig_5004:
 s_add_u32 s49, s63, 0
 s_and_b32 s49, s49, 3
 s_lshl_b32 s49, s49, 1
 s_add_u32 s49, s49, 1
 s_mul_i32 s49, s49, 163840
 s_add_u32 s49, s49, s90
 s_add_u32 m0, s51, 40960
 s_add_u32 s57, s49, 40960
 buffer_load_dwordx4 v20, s[64:67], s57 offen offset:0 lds
 buffer_load_dwordx4 v21, s[64:67], s57 offen offset:1024 lds
 buffer_load_dwordx4 v22, s[64:67], s57 offen offset:2048 lds
 buffer_load_dwordx4 v23, s[64:67], s57 offen offset:3072 lds
 s_add_u32 m0, s51, 45056
 s_add_u32 s57, s49, 40960
 buffer_load_dwordx4 v24, s[64:67], s57 offen lds
 s_add_u32 s49, s63, 0
 s_and_b32 s49, s49, 3
 s_lshl_b32 s49, s49, 1
 s_add_u32 s49, s49, 1
 s_mul_i32 s49, s49, 163840
 s_add_u32 s49, s49, s90
 s_add_u32 m0, s51, 24576
 s_add_u32 s57, s49, 81920
 buffer_load_dwordx4 v20, s[64:67], s57 offen offset:0 lds
 buffer_load_dwordx4 v21, s[64:67], s57 offen offset:1024 lds
 buffer_load_dwordx4 v22, s[64:67], s57 offen offset:2048 lds
 buffer_load_dwordx4 v23, s[64:67], s57 offen offset:3072 lds
 s_add_u32 m0, s51, 28672
 s_add_u32 s57, s49, 81920
 buffer_load_dwordx4 v24, s[64:67], s57 offen lds
 s_add_u32 s49, s63, 0
 s_and_b32 s49, s49, 3
 s_lshl_b32 s49, s49, 1
 s_add_u32 s49, s49, 1
 s_mul_i32 s49, s49, 163840
 s_add_u32 s49, s49, s90
 s_add_u32 m0, s51, 92160
 s_add_u32 s57, s49, 122880
 buffer_load_dwordx4 v20, s[64:67], s57 offen offset:0 lds
 buffer_load_dwordx4 v21, s[64:67], s57 offen offset:1024 lds
 buffer_load_dwordx4 v22, s[64:67], s57 offen offset:2048 lds
 buffer_load_dwordx4 v23, s[64:67], s57 offen offset:3072 lds
 s_add_u32 m0, s51, 96256
 s_add_u32 s57, s49, 122880
 buffer_load_dwordx4 v24, s[64:67], s57 offen lds
 s_waitcnt vmcnt(28)
 s_waitcnt vmcnt(23)
 s_waitcnt vmcnt(20)
 s_barrier
 s_add_u32 s49, s63, 1
 s_and_b32 s49, s49, 3
 s_lshl_b32 s49, s49, 1
 s_add_u32 s49, s49, 1
 s_mul_i32 s49, s49, 163840
 s_add_u32 s49, s49, s90
 s_add_u32 m0, s51, 114688
 s_add_u32 s57, s49, 0
 buffer_load_dwordx4 v20, s[64:67], s57 offen offset:0 lds
 buffer_load_dwordx4 v21, s[64:67], s57 offen offset:1024 lds
 buffer_load_dwordx4 v22, s[64:67], s57 offen offset:2048 lds
 buffer_load_dwordx4 v23, s[64:67], s57 offen offset:3072 lds
 s_add_u32 m0, s51, 118784
 s_add_u32 s57, s49, 0
 buffer_load_dwordx4 v24, s[64:67], s57 offen lds
 s_add_u32 s49, s63, 1
 s_and_b32 s49, s49, 3
 s_lshl_b32 s49, s49, 1
 s_add_u32 s49, s49, 1
 s_mul_i32 s49, s49, 163840
 s_add_u32 s49, s49, s90
 s_add_u32 m0, s51, 145408
 s_add_u32 s57, s49, 40960
 buffer_load_dwordx4 v20, s[64:67], s57 offen offset:0 lds
 buffer_load_dwordx4 v21, s[64:67], s57 offen offset:1024 lds
 buffer_load_dwordx4 v22, s[64:67], s57 offen offset:2048 lds
 buffer_load_dwordx4 v23, s[64:67], s57 offen offset:3072 lds
 s_add_u32 m0, s51, 149504
 s_add_u32 s57, s49, 40960
 buffer_load_dwordx4 v24, s[64:67], s57 offen lds
 s_waitcnt vmcnt(25)
 s_waitcnt vmcnt(20)
 s_barrier
 s_add_u32 s49, s63, 1
 s_and_b32 s49, s49, 3
 s_lshl_b32 s49, s49, 1
 s_add_u32 s49, s49, 1
 s_mul_i32 s49, s49, 163840
 s_add_u32 s49, s49, s90
 s_add_u32 m0, s51, 81920
 s_add_u32 s57, s49, 81920
 buffer_load_dwordx4 v20, s[64:67], s57 offen offset:0 lds
 buffer_load_dwordx4 v21, s[64:67], s57 offen offset:1024 lds
 buffer_load_dwordx4 v22, s[64:67], s57 offen offset:2048 lds
 buffer_load_dwordx4 v23, s[64:67], s57 offen offset:3072 lds
 s_add_u32 m0, s51, 86016
 s_add_u32 s57, s49, 81920
 buffer_load_dwordx4 v24, s[64:67], s57 offen lds
 s_add_u32 s49, s63, 1
 s_and_b32 s49, s49, 3
 s_lshl_b32 s49, s49, 1
 s_add_u32 s49, s49, 1
 s_mul_i32 s49, s49, 163840
 s_add_u32 s49, s49, s90
 s_add_u32 m0, s51, 102400
 s_add_u32 s57, s49, 122880
 buffer_load_dwordx4 v20, s[64:67], s57 offen offset:0 lds
 buffer_load_dwordx4 v21, s[64:67], s57 offen offset:1024 lds
 buffer_load_dwordx4 v22, s[64:67], s57 offen offset:2048 lds
 buffer_load_dwordx4 v23, s[64:67], s57 offen offset:3072 lds
 s_add_u32 m0, s51, 106496
 s_add_u32 s57, s49, 122880
 buffer_load_dwordx4 v24, s[64:67], s57 offen lds
 buffer_load_dword v31, v28, s[8:11], s79 offen sc1
 s_waitcnt vmcnt(26)
 s_waitcnt vmcnt(21)
 s_barrier
 s_waitcnt vmcnt(0)
K_poll_5005:
 v_cmp_eq_u32 vcc, s94, v31
 s_and_b32 s49, vcc_lo, 7
 s_cmp_eq_u32 s49, 7
 s_cbranch_scc1 K_poll_5005_ok
 s_sleep 1
 buffer_load_dword v31, v28, s[8:11], s79 offen sc1
 s_waitcnt vmcnt(0)
 s_branch K_poll_5005
K_poll_5005_ok:
 s_lshl_b32 s44, s83, 9
 s_add_u32 s79, s44, 65536
 s_lshl_b32 s44, s60, 7
 v_mov_b32 v26, s44
 v_and_b32 v28, 3, v250
 v_min_u32 v28, 2, v28
 s_add_u32 s44, s60, 1
 v_add_u32 v28, s44, v28
 v_and_b32 v28, 3, v28
 v_lshlrev_b32 v28, 7, v28
 v_mov_b32 v27, s94
 s_add_u32 s49, s63, 1
 s_and_b32 s49, s49, 3
 s_lshl_b32 s49, s49, 1
 s_add_u32 s49, s49, 1
 s_mul_i32 s49, s49, 24576
 s_add_u32 s49, s49, s50
 s_add_u32 m0, s50, 155648
 s_add_u32 s57, s49, 0
 buffer_load_dwordx4 v30, s[68:71], s57 offen sc1 lds
 s_add_u32 m0, s50, 157696
 s_add_u32 s57, s49, 8192
 buffer_load_dwordx4 v30, s[68:71], s57 offen sc1 lds
 s_add_u32 m0, s50, 159744
 s_add_u32 s57, s49, 16384
 buffer_load_dwordx4 v30, s[68:71], s57 offen sc1 lds
 s_add_u32 s49, s63, 1
 s_and_b32 s49, s49, 3
 s_lshl_b32 s49, s49, 1
 s_add_u32 s49, s49, 1
 s_mul_i32 s49, s49, 24576
 s_add_u32 s49, s49, s50
 s_add_u32 m0, s50, 51200
 s_add_u32 s57, s49, 2048
 buffer_load_dwordx4 v30, s[68:71], s57 offen sc1 lds
 s_add_u32 m0, s50, 53248
 s_add_u32 s57, s49, 10240
 buffer_load_dwordx4 v30, s[68:71], s57 offen sc1 lds
 s_add_u32 m0, s50, 55296
 s_add_u32 s57, s49, 18432
 buffer_load_dwordx4 v30, s[68:71], s57 offen sc1 lds
 s_add_u32 s49, s63, 1
 s_and_b32 s49, s49, 3
 s_lshl_b32 s49, s49, 1
 s_add_u32 s49, s49, 1
 s_mul_i32 s49, s49, 24576
 s_add_u32 s49, s49, s50
 s_add_u32 m0, s50, 57344
 s_add_u32 s57, s49, 4096
 buffer_load_dwordx4 v30, s[68:71], s57 offen sc1 lds
 s_add_u32 m0, s50, 59392
 s_add_u32 s57, s49, 12288
 buffer_load_dwordx4 v30, s[68:71], s57 offen sc1 lds
 s_add_u32 m0, s50, 61440
 s_add_u32 s57, s49, 20480
 buffer_load_dwordx4 v30, s[68:71], s57 offen sc1 lds
 s_add_u32 s49, s63, 1
 s_and_b32 s49, s49, 3
 s_lshl_b32 s49, s49, 1
 s_add_u32 s49, s49, 1
 s_mul_i32 s49, s49, 24576
 s_add_u32 s49, s49, s50
 s_add_u32 m0, s50, 63488
 s_add_u32 s57, s49, 6144
 buffer_load_dwordx4 v30, s[68:71], s57 offen sc1 lds
 s_add_u32 m0, s50, 65536
 s_add_u32 s57, s49, 14336
 buffer_load_dwordx4 v30, s[68:71], s57 offen sc1 lds
 s_add_u32 m0, s50, 67584
 s_add_u32 s57, s49, 22528
 buffer_load_dwordx4 v30, s[68:71], s57 offen sc1 lds
 s_add_u32 s49, s63, 2
 s_and_b32 s49, s49, 3
 s_lshl_b32 s49, s49, 1
 s_add_u32 s49, s49, 1
 s_mul_i32 s49, s49, 163840
 s_add_u32 s49, s49, s90
 s_add_u32 m0, s51, 124928
 s_add_u32 s57, s49, 0
 buffer_load_dwordx4 v20, s[64:67], s57 offen offset:0 lds
 buffer_load_dwordx4 v21, s[64:67], s57 offen offset:1024 lds
 buffer_load_dwordx4 v22, s[64:67], s57 offen offset:2048 lds
 buffer_load_dwordx4 v23, s[64:67], s57 offen offset:3072 lds
 s_add_u32 m0, s51, 129024
 s_add_u32 s57, s49, 0
 buffer_load_dwordx4 v24, s[64:67], s57 offen lds
 s_add_u32 s49, s63, 2
 s_and_b32 s49, s49, 3
 s_lshl_b32 s49, s49, 1
 s_add_u32 s49, s49, 1
 s_mul_i32 s49, s49, 24576
 s_add_u32 s49, s49, s50
 s_add_u32 m0, s50, 69632
 s_add_u32 s57, s49, 0
 buffer_load_dwordx4 v30, s[68:71], s57 offen sc1 lds
 s_add_u32 m0, s50, 71680
 s_add_u32 s57, s49, 8192
 buffer_load_dwordx4 v30, s[68:71], s57 offen sc1 lds
 s_add_u32 m0, s50, 73728
 s_add_u32 s57, s49, 16384
 buffer_load_dwordx4 v30, s[68:71], s57 offen sc1 lds
 s_waitcnt vmcnt(17)
 s_waitcnt vmcnt(14)
 s_barrier
 s_add_u32 s49, s63, 2
 s_and_b32 s49, s49, 3
 s_lshl_b32 s49, s49, 1
 s_add_u32 s49, s49, 1
 s_mul_i32 s49, s49, 163840
 s_add_u32 s49, s49, s90
 s_add_u32 m0, s51, 135168
 s_add_u32 s57, s49, 40960
 buffer_load_dwordx4 v20, s[64:67], s57 offen offset:0 lds
 buffer_load_dwordx4 v21, s[64:67], s57 offen offset:1024 lds
 buffer_load_dwordx4 v22, s[64:67], s57 offen offset:2048 lds
 buffer_load_dwordx4 v23, s[64:67], s57 offen offset:3072 lds
 s_add_u32 m0, s51, 139264
 s_add_u32 s57, s49, 40960
 buffer_load_dwordx4 v24, s[64:67], s57 offen lds
 s_add_u32 s49, s63, 2
 s_and_b32 s49, s49, 3
 s_lshl_b32 s49, s49, 1
 s_add_u32 s49, s49, 1
 s_mul_i32 s49, s49, 24576
 s_add_u32 s49, s49, s50
 s_add_u32 m0, s50, 75776
 s_add_u32 s57, s49, 2048
 buffer_load_dwordx4 v30, s[68:71], s57 offen sc1 lds
 s_add_u32 m0, s50, 77824
 s_add_u32 s57, s49, 10240
 buffer_load_dwordx4 v30, s[68:71], s57 offen sc1 lds
 s_add_u32 m0, s50, 79872
 s_add_u32 s57, s49, 18432
 buffer_load_dwordx4 v30, s[68:71], s57 offen sc1 lds
 s_add_u32 s49, s63, 2
 s_and_b32 s49, s49, 3
 s_lshl_b32 s49, s49, 1
 s_add_u32 s49, s49, 1
 s_mul_i32 s49, s49, 163840
 s_add_u32 s49, s49, s90
 s_add_u32 m0, s51, 40960
 s_add_u32 s57, s49, 81920
 buffer_load_dwordx4 v20, s[64:67], s57 offen offset:0 lds
 buffer_load_dwordx4 v21, s[64:67], s57 offen offset:1024 lds
 buffer_load_dwordx4 v22, s[64:67], s57 offen offset:2048 lds
 buffer_load_dwordx4 v23, s[64:67], s57 offen offset:3072 lds
 s_add_u32 m0, s51, 45056
 s_add_u32 s57, s49, 81920
 buffer_load_dwordx4 v24, s[64:67], s57 offen lds
 s_add_u32 s49, s63, 2
 s_and_b32 s49, s49, 3
 s_lshl_b32 s49, s49, 1
 s_add_u32 s49, s49, 1
 s_mul_i32 s49, s49, 24576
 s_add_u32 s49, s49, s50
 s_add_u32 m0, s50, 34816
 s_add_u32 s57, s49, 4096
 buffer_load_dwordx4 v30, s[68:71], s57 offen sc1 lds
 s_add_u32 m0, s50, 36864
 s_add_u32 s57, s49, 12288
 buffer_load_dwordx4 v30, s[68:71], s57 offen sc1 lds
 s_add_u32 m0, s50, 38912
 s_add_u32 s57, s49, 20480
 buffer_load_dwordx4 v30, s[68:71], s57 offen sc1 lds
 s_add_u32 s49, s63, 2
 s_and_b32 s49, s49, 3
 s_lshl_b32 s49, s49, 1
 s_add_u32 s49, s49, 1
 s_mul_i32 s49, s49, 163840
 s_add_u32 s49, s49, s90
 s_add_u32 m0, s51, 24576
 s_add_u32 s57, s49, 122880
 buffer_load_dwordx4 v20, s[64:67], s57 offen offset:0 lds
 buffer_load_dwordx4 v21, s[64:67], s57 offen offset:1024 lds
 buffer_load_dwordx4 v22, s[64:67], s57 offen offset:2048 lds
 buffer_load_dwordx4 v23, s[64:67], s57 offen offset:3072 lds
 s_add_u32 m0, s51, 28672
 s_add_u32 s57, s49, 122880
 buffer_load_dwordx4 v24, s[64:67], s57 offen lds
 s_waitcnt vmcnt(32)
 s_waitcnt vmcnt(29)
 s_barrier
 s_add_u32 s49, s63, 2
 s_and_b32 s49, s49, 3
 s_lshl_b32 s49, s49, 1
 s_add_u32 s49, s49, 1
 s_mul_i32 s49, s49, 24576
 s_add_u32 s49, s49, s50
 s_add_u32 m0, s50, 155648
 s_add_u32 s57, s49, 6144
 buffer_load_dwordx4 v30, s[68:71], s57 offen sc1 lds
 s_add_u32 m0, s50, 157696
 s_add_u32 s57, s49, 14336
 buffer_load_dwordx4 v30, s[68:71], s57 offen sc1 lds
 s_add_u32 m0, s50, 159744
 s_add_u32 s57, s49, 22528
 buffer_load_dwordx4 v30, s[68:71], s57 offen sc1 lds
 s_add_u32 s49, s63, 3
 s_and_b32 s49, s49, 3
 s_lshl_b32 s49, s49, 1
 s_add_u32 s49, s49, 1
 s_mul_i32 s49, s49, 163840
 s_add_u32 s49, s49, s90
 s_add_u32 m0, s51, 114688
 s_add_u32 s57, s49, 0
 buffer_load_dwordx4 v20, s[64:67], s57 offen offset:0 lds
 buffer_load_dwordx4 v21, s[64:67], s57 offen offset:1024 lds
 buffer_load_dwordx4 v22, s[64:67], s57 offen offset:2048 lds
 buffer_load_dwordx4 v23, s[64:67], s57 offen offset:3072 lds
 s_add_u32 m0, s51, 118784
 s_add_u32 s57, s49, 0
 buffer_load_dwordx4 v24, s[64:67], s57 offen lds
 s_add_u32 s49, s63, 3
 s_and_b32 s49, s49, 3
 s_lshl_b32 s49, s49, 1
 s_add_u32 s49, s49, 1
 s_mul_i32 s49, s49, 24576
 s_add_u32 s49, s49, s50
 s_add_u32 m0, s50, 0
 s_add_u32 s57, s49, 0
 buffer_load_dwordx4 v30, s[68:71], s57 offen sc1 lds
 s_add_u32 m0, s50, 2048
 s_add_u32 s57, s49, 8192
 buffer_load_dwordx4 v30, s[68:71], s57 offen sc1 lds
 s_add_u32 m0, s50, 4096
 s_add_u32 s57, s49, 16384
 buffer_load_dwordx4 v30, s[68:71], s57 offen sc1 lds
 s_add_u32 s49, s63, 3
 s_and_b32 s49, s49, 3
 s_lshl_b32 s49, s49, 1
 s_add_u32 s49, s49, 1
 s_mul_i32 s49, s49, 163840
 s_add_u32 s49, s49, s90
 s_add_u32 m0, s51, 92160
 s_add_u32 s57, s49, 40960
 buffer_load_dwordx4 v20, s[64:67], s57 offen offset:0 lds
 buffer_load_dwordx4 v21, s[64:67], s57 offen offset:1024 lds
 buffer_load_dwordx4 v22, s[64:67], s57 offen offset:2048 lds
 buffer_load_dwordx4 v23, s[64:67], s57 offen offset:3072 lds
 s_add_u32 m0, s51, 96256
 s_add_u32 s57, s49, 40960
 buffer_load_dwordx4 v24, s[64:67], s57 offen lds
 s_add_u32 s49, s63, 3
 s_and_b32 s49, s49, 3
 s_lshl_b32 s49, s49, 1
 s_add_u32 s49, s49, 1
 s_mul_i32 s49, s49, 24576
 s_add_u32 s49, s49, s50
 s_add_u32 m0, s50, 6144
 s_add_u32 s57, s49, 2048
 buffer_load_dwordx4 v30, s[68:71], s57 offen sc1 lds
 s_add_u32 m0, s50, 8192
 s_add_u32 s57, s49, 10240
 buffer_load_dwordx4 v30, s[68:71], s57 offen sc1 lds
 s_add_u32 m0, s50, 10240
 s_add_u32 s57, s49, 18432
 buffer_load_dwordx4 v30, s[68:71], s57 offen sc1 lds
 s_waitcnt vmcnt(43)
 s_waitcnt vmcnt(40)
 s_waitcnt vmcnt(35)
 s_waitcnt vmcnt(32)
 s_barrier
 s_add_u32 s49, s63, 3
 s_and_b32 s49, s49, 3
 s_lshl_b32 s49, s49, 1
 s_add_u32 s49, s49, 1
 s_mul_i32 s49, s49, 163840
 s_add_u32 s49, s49, s90
 s_add_u32 m0, s51, 145408
 s_add_u32 s57, s49, 81920
 buffer_load_dwordx4 v20, s[64:67], s57 offen offset:0 lds
 buffer_load_dwordx4 v21, s[64:67], s57 offen offset:1024 lds
 buffer_load_dwordx4 v22, s[64:67], s57 offen offset:2048 lds
 buffer_load_dwordx4 v23, s[64:67], s57 offen offset:3072 lds
 s_add_u32 m0, s51, 149504
 s_add_u32 s57, s49, 81920
 buffer_load_dwordx4 v24, s[64:67], s57 offen lds
 s_add_u32 s49, s63, 3
 s_and_b32 s49, s49, 3
 s_lshl_b32 s49, s49, 1
 s_add_u32 s49, s49, 1
 s_mul_i32 s49, s49, 24576
 s_add_u32 s49, s49, s50
 s_add_u32 m0, s50, 51200
 s_add_u32 s57, s49, 4096
 buffer_load_dwordx4 v30, s[68:71], s57 offen sc1 lds
 s_add_u32 m0, s50, 53248
 s_add_u32 s57, s49, 12288
 buffer_load_dwordx4 v30, s[68:71], s57 offen sc1 lds
 s_add_u32 m0, s50, 55296
 s_add_u32 s57, s49, 20480
 buffer_load_dwordx4 v30, s[68:71], s57 offen sc1 lds
 s_add_u32 s49, s63, 3
 s_and_b32 s49, s49, 3
 s_lshl_b32 s49, s49, 1
 s_add_u32 s49, s49, 1
 s_mul_i32 s49, s49, 163840
 s_add_u32 s49, s49, s90
 s_add_u32 m0, s51, 81920
 s_add_u32 s57, s49, 122880
 buffer_load_dwordx4 v20, s[64:67], s57 offen offset:0 lds
 buffer_load_dwordx4 v21, s[64:67], s57 offen offset:1024 lds
 buffer_load_dwordx4 v22, s[64:67], s57 offen offset:2048 lds
 buffer_load_dwordx4 v23, s[64:67], s57 offen offset:3072 lds
 s_add_u32 m0, s51, 86016
 s_add_u32 s57, s49, 122880
 buffer_load_dwordx4 v24, s[64:67], s57 offen lds
 s_add_u32 s49, s63, 3
 s_and_b32 s49, s49, 3
 s_lshl_b32 s49, s49, 1
 s_add_u32 s49, s49, 1
 s_mul_i32 s49, s49, 24576
 s_add_u32 s49, s49, s50
 s_add_u32 m0, s50, 57344
 s_add_u32 s57, s49, 6144
 buffer_load_dwordx4 v30, s[68:71], s57 offen sc1 lds
 s_add_u32 m0, s50, 59392
 s_add_u32 s57, s49, 14336
 buffer_load_dwordx4 v30, s[68:71], s57 offen sc1 lds
 s_add_u32 m0, s50, 61440
 s_add_u32 s57, s49, 22528
 buffer_load_dwordx4 v30, s[68:71], s57 offen sc1 lds
 s_waitcnt vmcnt(43)
 s_waitcnt vmcnt(40)
 s_waitcnt vmcnt(35)
 s_waitcnt vmcnt(32)
 s_barrier
 s_waitcnt vmcnt(27)
 s_waitcnt vmcnt(24)
 s_waitcnt vmcnt(19)
 s_waitcnt vmcnt(16)
 s_barrier
 s_waitcnt vmcnt(11)
 s_waitcnt vmcnt(8)
 s_waitcnt vmcnt(3)
 s_waitcnt vmcnt(0)
 s_barrier
 s_cmp_eq_u32 s61, 1
 s_cbranch_scc0 K_end
 s_barrier
 s_cmp_eq_u32 s61, 1
 s_cbranch_scc0 K_sig_5006
 s_mov_b64 exec, 1
 buffer_store_dword v27, v26, s[8:11], s79 offen sc1
 s_mov_b64 exec, -1
K_sig_5006:
 buffer_load_dword v31, v28, s[8:11], s79 offen sc1
 s_waitcnt vmcnt(0)
K_poll_5007:
 v_cmp_eq_u32 vcc, s94, v31
 s_and_b32 s49, vcc_lo, 7
 s_cmp_eq_u32 s49, 7
 s_cbranch_scc1 K_poll_5007_ok
 s_sleep 1
 buffer_load_dword v31, v28, s[8:11], s79 offen sc1
 s_waitcnt vmcnt(0)
 s_branch K_poll_5007
K_poll_5007_ok:
 s_barrier
K_end:
 s_endpgm
K_att:
 v_bfe_u32 v1, v250, 2, 2
 v_lshrrev_b32 v2, 5, v250
 v_mul_u32_u24 v2, 8, v2
 v_add_u32 v2, v2, v1
 v_mul_u32_u24 v232, 256, v2
 v_lshlrev_b32 v1, 6, v1
 v_add_u32 v232, v232, v1
 v_bfe_u32 v1, v250, 4, 1
 v_lshlrev_b32 v1, 5, v1
 v_add_u32 v232, v232, v1
 v_and_b32 v1, 1, v250
 v_lshlrev_b32 v1, 4, v1
 v_add_u32 v232, v232, v1
 v_bfe_u32 v1, v250, 1, 1
 v_lshlrev_b32 v1, 3, v1
 v_add_u32 v232, v232, v1
 v_add_u32 v232, 114688, v232
 v_xor_b32 v233, 64, v232
 v_xor_b32 v234, 128, v232
 v_xor_b32 v235, 192, v232
 v_and_b32 v1, 31, v250
 v_lshrrev_b32 v2, 5, v250
 v_bfe_u32 v3, v1, 1, 3
 v_xor_b32 v2, v2, v3
 v_lshlrev_b32 v2, 4, v2
 v_lshl_add_u32 v2, v1, 7, v2
 s_lshl_b32 s49, s62, 12
 s_add_u32 s49, s49, 40960
 v_add_u32 v236, s49, v2
 v_xor_b32 v237, 32, v236
 v_xor_b32 v238, 64, v236
 v_xor_b32 v239, 96, v236
 v_lshlrev_b32 v243, 4, v250
 s_waitcnt lgkmcnt(0)
 s_lshl_b32 s44, s4, 8
 s_add_u32 s44, s44, s43
 s_add_u32 s44, s44, s61
 s_mul_i32 s44, s44, 24576
 s_lshl_b32 s42, s83, 2
 s_mul_i32 s45, s42, 30720
 s_add_u32 s45, s45, 16777216
 s_mul_i32 s46, s60, 30720
 s_add_u32 s46, s46, s45
 s_add_u32 s36, s16, s44
 s_addc_u32 s37, s17, 0
 s_and_b32 s37, s37, 0xffff
 s_mov_b32 s38, 24576
 s_mov_b32 s39, 0x20000
 s_add_u32 s96, s16, s45
 s_addc_u32 s97, s17, 0
 s_and_b32 s97, s97, 0xffff
 s_mov_b32 s98, 122880
 s_mov_b32 s99, 0x20000
 s_add_u32 s72, s16, s46
 s_addc_u32 s73, s17, 0
 s_and_b32 s73, s73, 0xffff
 s_mov_b32 s74, 30720
 s_mov_b32 s75, 0x20000
 s_mov_b32 s12, s80
 s_and_b32 s13, s81, 0xffff
 s_mov_b32 s14, 1966080
 s_mov_b32 s15, 0x20000
 s_mul_i32 s41, s7, 96
 s_lshl_b32 s42, s62, 5
 s_add_u32 s41, s41, s42
 s_lshl_b32 s42, s60, 3
 s_add_u32 s41, s41, s42
 s_mul_i32 s41, s41, 2560
 s_mul_i32 s42, s4, 1280
 s_add_u32 s41, s41, s42
 s_mul_i32 s42, s63, 320
 s_add_u32 s41, s41, s42
 s_mul_i32 s42, s61, 160
 s_add_u32 s100, s41, s42
 s_mov_b32 s53, 0x3e0293ee
 s_mov_b32 s54, 0x45800000
 s_lshl_b32 s55, s62, 13
 s_add_u32 s56, s55, 4096
 s_cmp_eq_u32 s61, 0
 s_cbranch_scc0 K_B
 v_and_b32 v244, 31, v250
 v_lshrrev_b32 v245, 5, v250
 v_and_b32 v246, 15, v244
 v_xor_b32 v245, v245, v246
 v_lshlrev_b32 v245, 4, v245
 v_lshl_add_u32 v216, v244, 8, v245
 v_xor_b32 v217, 32, v216
 v_xor_b32 v218, 64, v216
 v_xor_b32 v219, 96, v216
 v_xor_b32 v220, 128, v216
 v_xor_b32 v221, 160, v216
 v_xor_b32 v222, 192, v216
 v_xor_b32 v223, 224, v216
 v_bfe_u32 v244, v250, 2, 2
 v_lshrrev_b32 v245, 5, v250
 v_mul_u32_u24 v245, 4, v245
 v_add_u32 v245, v245, v244
 v_mul_u32_u24 v224, 256, v245
 v_lshlrev_b32 v244, 6, v244
 v_add_u32 v224, v224, v244
 v_bfe_u32 v244, v250, 4, 1
 v_lshlrev_b32 v244, 5, v244
 v_add_u32 v224, v224, v244
 v_and_b32 v244, 1, v250
 v_lshlrev_b32 v244, 4, v244
 v_add_u32 v224, v224, v244
 v_bfe_u32 v244, v250, 1, 1
 v_lshlrev_b32 v244, 3, v244
 v_add_u32 v224, v224, v244
 v_add_u32 v224, 49152, v224
 v_xor_b32 v225, 64, v224
 v_xor_b32 v226, 128, v224
 v_xor_b32 v227, 192, v224
 v_mov_b32 v228, 0
 v_mov_b32 v229, 0
 s_barrier
 ds_read_b128 v[128:131], v236 offset:0
 ds_read_b64_tr_b16 v[96:97], v232 offset:0
 ds_read_b64_tr_b16 v[98:99], v232 offset:1024
 ds_read_b64_tr_b16 v[100:101], v233 offset:0
 ds_read_b64_tr_b16 v[102:103], v233 offset:1024
 ds_read_b64_tr_b16 v[104:105], v234 offset:0
 ds_read_b64_tr_b16 v[106:107], v234 offset:1024
 ds_read_b64_tr_b16 v[108:109], v235 offset:0
 ds_read_b64_tr_b16 v[110:111], v235 offset:1024
 ds_read_b128 v[132:135], v237 offset:0
 ds_read_b64_tr_b16 v[112:113], v232 offset:4096
 ds_read_b64_tr_b16 v[114:115], v232 offset:5120
 ds_read_b64_tr_b16 v[116:117], v233 offset:4096
 ds_read_b64_tr_b16 v[118:119], v233 offset:5120
 s_waitcnt lgkmcnt(10)
 ds_read_b64_tr_b16 v[120:121], v234 offset:4096
 ds_read_b64_tr_b16 v[122:123], v234 offset:5120
 ds_read_b64_tr_b16 v[124:125], v235 offset:4096
 ds_read_b64_tr_b16 v[126:127], v235 offset:5120
 s_waitcnt lgkmcnt(0)
 s_barrier
 v_mfma_f32_32x32x16_bf16 v[152:167], v[96:99], v[128:131], 0
 ds_read_b128 v[144:147], v238 offset:0
 ds_read_b64_tr_b16 v[64:65], v232 offset:8192
 ds_read_b64_tr_b16 v[66:67], v232 offset:9216
 v_mfma_f32_32x32x16_bf16 v[168:183], v[100:103], v[128:131], 0
 ds_read_b64_tr_b16 v[68:69], v233 offset:8192
 ds_read_b64_tr_b16 v[70:71], v233 offset:9216
 ds_read_b64_tr_b16 v[72:73], v234 offset:8192
 v_mfma_f32_32x32x16_bf16 v[184:199], v[104:107], v[128:131], 0
 ds_read_b64_tr_b16 v[74:75], v234 offset:9216
 ds_read_b64_tr_b16 v[76:77], v235 offset:8192
 ds_read_b64_tr_b16 v[78:79], v235 offset:9216
 v_mfma_f32_32x32x16_bf16 v[200:215], v[108:111], v[128:131], 0
 ds_read_b128 v[148:151], v239 offset:0
 ds_read_b64_tr_b16 v[80:81], v232 offset:12288
 ds_read_b64_tr_b16 v[82:83], v232 offset:13312
 v_mfma_f32_32x32x16_bf16 v[152:167], v[112:115], v[132:135], v[152:167]
 ds_read_b64_tr_b16 v[84:85], v233 offset:12288
 ds_read_b64_tr_b16 v[86:87], v233 offset:13312
 s_waitcnt lgkmcnt(10)
 ds_read_b64_tr_b16 v[88:89], v234 offset:12288
 v_mfma_f32_32x32x16_bf16 v[168:183], v[116:119], v[132:135], v[168:183]
 ds_read_b64_tr_b16 v[90:91], v234 offset:13312
 ds_read_b64_tr_b16 v[92:93], v235 offset:12288
 ds_read_b64_tr_b16 v[94:95], v235 offset:13312
 v_mfma_f32_32x32x16_bf16 v[184:199], v[120:123], v[132:135], v[184:199]
 v_mfma_f32_32x32x16_bf16 v[200:215], v[124:127], v[132:135], v[200:215]
 s_waitcnt lgkmcnt(0)
 s_barrier
 v_mfma_f32_32x32x16_bf16 v[152:167], v[64:67], v[144:147], v[152:167]
 ds_read_b128 v[128:131], v236 offset:12288
 ds_read_b64_tr_b16 v[96:97], v232 offset:16384
 ds_read_b64_tr_b16 v[98:99], v232 offset:17408
 v_mfma_f32_32x32x16_bf16 v[168:183], v[68:71], v[144:147], v[168:183]
 ds_read_b64_tr_b16 v[100:101], v233 offset:16384
 ds_read_b64_tr_b16 v[102:103], v233 offset:17408
 ds_read_b64_tr_b16 v[104:105], v234 offset:16384
 v_mfma_f32_32x32x16_bf16 v[184:199], v[72:75], v[144:147], v[184:199]
 ds_read_b64_tr_b16 v[106:107], v234 offset:17408
 ds_read_b64_tr_b16 v[108:109], v235 offset:16384
 ds_read_b64_tr_b16 v[110:111], v235 offset:17408
 v_mfma_f32_32x32x16_bf16 v[200:215], v[76:79], v[144:147], v[200:215]
 ds_read_b128 v[132:135], v237 offset:12288
 ds_read_b64_tr_b16 v[112:113], v232 offset:20480
 ds_read_b64_tr_b16 v[114:115], v232 offset:21504
 v_mfma_f32_32x32x16_bf16 v[152:167], v[80:83], v[148:151], v[152:167]
 ds_read_b64_tr_b16 v[116:117], v233 offset:20480
 ds_read_b64_tr_b16 v[118:119], v233 offset:21504
 s_waitcnt lgkmcnt(10)
 ds_read_b64_tr_b16 v[120:121], v234 offset:20480
 v_mfma_f32_32x32x16_bf16 v[168:183], v[84:87], v[148:151], v[168:183]
 ds_read_b64_tr_b16 v[122:123], v234 offset:21504
 ds_read_b64_tr_b16 v[124:125], v235 offset:20480
 ds_read_b64_tr_b16 v[126:127], v235 offset:21504
 v_mfma_f32_32x32x16_bf16 v[184:199], v[88:91], v[148:151], v[184:199]
 v_mfma_f32_32x32x16_bf16 v[200:215], v[92:95], v[148:151], v[200:215]
 s_waitcnt lgkmcnt(0)
 s_barrier
 v_mfma_f32_32x32x16_bf16 v[152:167], v[96:99], v[128:131], v[152:167]
 ds_read_b128 v[144:147], v238 offset:12288
 ds_read_b64_tr_b16 v[64:65], v232 offset:24576
 ds_read_b64_tr_b16 v[66:67], v232 offset:25600
 v_mfma_f32_32x32x16_bf16 v[168:183], v[100:103], v[128:131], v[168:183]
 ds_read_b64_tr_b16 v[68:69], v233 offset:24576
 ds_read_b64_tr_b16 v[70:71], v233 offset:25600
 ds_read_b64_tr_b16 v[72:73], v234 offset:24576
 v_mfma_f32_32x32x16_bf16 v[184:199], v[104:107], v[128:131], v[184:199]
 ds_read_b64_tr_b16 v[74:75], v234 offset:25600
 ds_read_b64_tr_b16 v[76:77], v235 offset:24576
 ds_read_b64_tr_b16 v[78:79], v235 offset:25600
 v_mfma_f32_32x32x16_bf16 v[200:215], v[108:111], v[128:131], v[200:215]
 ds_read_b128 v[148:151], v239 offset:12288
 ds_read_b64_tr_b16 v[80:81], v232 offset:28672
 ds_read_b64_tr_b16 v[82:83], v232 offset:29696
 v_mfma_f32_32x32x16_bf16 v[152:167], v[112:115], v[132:135], v[152:167]
 ds_read_b64_tr_b16 v[84:85], v233 offset:28672
 ds_read_b64_tr_b16 v[86:87], v233 offset:29696
 s_waitcnt lgkmcnt(10)
 ds_read_b64_tr_b16 v[88:89], v234 offset:28672
 v_mfma_f32_32x32x16_bf16 v[168:183], v[116:119], v[132:135], v[168:183]
 ds_read_b64_tr_b16 v[90:91], v234 offset:29696
 ds_read_b64_tr_b16 v[92:93], v235 offset:28672
 ds_read_b64_tr_b16 v[94:95], v235 offset:29696
 v_mfma_f32_32x32x16_bf16 v[184:199], v[120:123], v[132:135], v[184:199]
 v_mfma_f32_32x32x16_bf16 v[200:215], v[124:127], v[132:135], v[200:215]
 s_waitcnt lgkmcnt(0)
 s_barrier
 v_mfma_f32_32x32x16_bf16 v[152:167], v[64:67], v[144:147], v[152:167]
 ds_read_b128 v[128:131], v236 offset:24576
 ds_read_b64_tr_b16 v[96:97], v232 offset:32768
 ds_read_b64_tr_b16 v[98:99], v232 offset:33792
 v_mfma_f32_32x32x16_bf16 v[168:183], v[68:71], v[144:147], v[168:183]
 ds_read_b64_tr_b16 v[100:101], v233 offset:32768
 ds_read_b64_tr_b16 v[102:103], v233 offset:33792
 ds_read_b64_tr_b16 v[104:105], v234 offset:32768
 v_mfma_f32_32x32x16_bf16 v[184:199], v[72:75], v[144:147], v[184:199]
 ds_read_b64_tr_b16 v[106:107], v234 offset:33792
 ds_read_b64_tr_b16 v[108:109], v235 offset:32768
 ds_read_b64_tr_b16 v[110:111], v235 offset:33792
 v_mfma_f32_32x32x16_bf16 v[200:215], v[76:79], v[144:147], v[200:215]
 ds_read_b128 v[132:135], v237 offset:24576
 ds_read_b64_tr_b16 v[112:113], v232 offset:36864
 ds_read_b64_tr_b16 v[114:115], v232 offset:37888
 v_mfma_f32_32x32x16_bf16 v[152:167], v[80:83], v[148:151], v[152:167]
 ds_read_b64_tr_b16 v[116:117], v233 offset:36864
 ds_read_b64_tr_b16 v[118:119], v233 offset:37888
 s_waitcnt lgkmcnt(10)
 ds_read_b64_tr_b16 v[120:121], v234 offset:36864
 v_mfma_f32_32x32x16_bf16 v[168:183], v[84:87], v[148:151], v[168:183]
 ds_read_b64_tr_b16 v[122:123], v234 offset:37888
 ds_read_b64_tr_b16 v[124:125], v235 offset:36864
 ds_read_b64_tr_b16 v[126:127], v235 offset:37888
 v_mfma_f32_32x32x16_bf16 v[184:199], v[88:91], v[148:151], v[184:199]
 v_mfma_f32_32x32x16_bf16 v[200:215], v[92:95], v[148:151], v[200:215]
 s_waitcnt lgkmcnt(0)
 s_barrier
 v_mfma_f32_32x32x16_bf16 v[152:167], v[96:99], v[128:131], v[152:167]
 ds_read_b128 v[144:147], v238 offset:24576
 ds_read_b64_tr_b16 v[64:65], v232 offset:40960
 ds_read_b64_tr_b16 v[66:67], v232 offset:41984
 v_mfma_f32_32x32x16_bf16 v[168:183], v[100:103], v[128:131], v[168:183]
 ds_read_b64_tr_b16 v[68:69], v233 offset:40960
 ds_read_b64_tr_b16 v[70:71], v233 offset:41984
 ds_read_b64_tr_b16 v[72:73], v234 offset:40960
 v_mfma_f32_32x32x16_bf16 v[184:199], v[104:107], v[128:131], v[184:199]
 ds_read_b64_tr_b16 v[74:75], v234 offset:41984
 ds_read_b64_tr_b16 v[76:77], v235 offset:40960
 ds_read_b64_tr_b16 v[78:79], v235 offset:41984
 v_mfma_f32_32x32x16_bf16 v[200:215], v[108:111], v[128:131], v[200:215]
 ds_read_b128 v[148:151], v239 offset:24576
 ds_read_b64_tr_b16 v[80:81], v232 offset:45056
 ds_read_b64_tr_b16 v[82:83], v232 offset:46080
 v_mfma_f32_32x32x16_bf16 v[152:167], v[112:115], v[132:135], v[152:167]
 ds_read_b64_tr_b16 v[84:85], v233 offset:45056
 ds_read_b64_tr_b16 v[86:87], v233 offset:46080
 s_waitcnt lgkmcnt(10)
 ds_read_b64_tr_b16 v[88:89], v234 offset:45056
 v_mfma_f32_32x32x16_bf16 v[168:183], v[116:119], v[132:135], v[168:183]
 ds_read_b64_tr_b16 v[90:91], v234 offset:46080
 ds_read_b64_tr_b16 v[92:93], v235 offset:45056
 ds_read_b64_tr_b16 v[94:95], v235 offset:46080
 v_mfma_f32_32x32x16_bf16 v[184:199], v[120:123], v[132:135], v[184:199]
 v_mfma_f32_32x32x16_bf16 v[200:215], v[124:127], v[132:135], v[200:215]
 s_waitcnt lgkmcnt(0)
 s_barrier
 v_mfma_f32_32x32x16_bf16 v[152:167], v[64:67], v[144:147], v[152:167]
 ds_read_b128 v[128:131], v236 offset:0
 ds_read_b64_tr_b16 v[96:97], v232 offset:8192
 ds_read_b64_tr_b16 v[98:99], v232 offset:9216
 v_mfma_f32_32x32x16_bf16 v[168:183], v[68:71], v[144:147], v[168:183]
 ds_read_b64_tr_b16 v[100:101], v233 offset:8192
 ds_read_b64_tr_b16 v[102:103], v233 offset:9216
 ds_read_b64_tr_b16 v[104:105], v234 offset:8192
 v_mfma_f32_32x32x16_bf16 v[184:199], v[72:75], v[144:147], v[184:199]
 ds_read_b64_tr_b16 v[106:107], v234 offset:9216
 ds_read_b64_tr_b16 v[108:109], v235 offset:8192
 ds_read_b64_tr_b16 v[110:111], v235 offset:9216
 v_mfma_f32_32x32x16_bf16 v[200:215], v[76:79], v[144:147], v[200:215]
 ds_read_b128 v[132:135], v237 offset:0
 ds_read_b64_tr_b16 v[112:113], v232 offset:12288
 ds_read_b64_tr_b16 v[114:115], v232 offset:13312
 v_mfma_f32_32x32x16_bf16 v[152:167], v[80:83], v[148:151], v[152:167]
 ds_read_b64_tr_b16 v[116:117], v233 offset:12288
 ds_read_b64_tr_b16 v[118:119], v233 offset:13312
 s_waitcnt lgkmcnt(10)
 ds_read_b64_tr_b16 v[120:121], v234 offset:12288
 v_mfma_f32_32x32x16_bf16 v[168:183], v[84:87], v[148:151], v[168:183]
 ds_read_b64_tr_b16 v[122:123], v234 offset:13312
 ds_read_b64_tr_b16 v[124:125], v235 offset:12288
 ds_read_b64_tr_b16 v[126:127], v235 offset:13312
 v_mfma_f32_32x32x16_bf16 v[184:199], v[88:91], v[148:151], v[184:199]
 v_mfma_f32_32x32x16_bf16 v[200:215], v[92:95], v[148:151], v[200:215]
 s_waitcnt lgkmcnt(0)
 s_barrier
 v_mfma_f32_32x32x16_bf16 v[152:167], v[96:99], v[128:131], v[152:167]
 ds_read_b128 v[144:147], v238 offset:0
 ds_read_b64_tr_b16 v[64:65], v232 offset:16384
 ds_read_b64_tr_b16 v[66:67], v232 offset:17408
 v_mfma_f32_32x32x16_bf16 v[168:183], v[100:103], v[128:131], v[168:183]
 ds_read_b64_tr_b16 v[68:69], v233 offset:16384
 ds_read_b64_tr_b16 v[70:71], v233 offset:17408
 ds_read_b64_tr_b16 v[72:73], v234 offset:16384
 v_mfma_f32_32x32x16_bf16 v[184:199], v[104:107], v[128:131], v[184:199]
 ds_read_b64_tr_b16 v[74:75], v234 offset:17408
 ds_read_b64_tr_b16 v[76:77], v235 offset:16384
 ds_read_b64_tr_b16 v[78:79], v235 offset:17408
 v_mfma_f32_32x32x16_bf16 v[200:215], v[108:111], v[128:131], v[200:215]
 ds_read_b128 v[148:151], v239 offset:0
 ds_read_b64_tr_b16 v[80:81], v232 offset:20480
 ds_read_b64_tr_b16 v[82:83], v232 offset:21504
 v_mfma_f32_32x32x16_bf16 v[152:167], v[112:115], v[132:135], v[152:167]
 ds_read_b64_tr_b16 v[84:85], v233 offset:20480
 ds_read_b64_tr_b16 v[86:87], v233 offset:21504
 s_waitcnt lgkmcnt(10)
 ds_read_b64_tr_b16 v[88:89], v234 offset:20480
 v_mfma_f32_32x32x16_bf16 v[168:183], v[116:119], v[132:135], v[168:183]
 ds_read_b64_tr_b16 v[90:91], v234 offset:21504
 ds_read_b64_tr_b16 v[92:93], v235 offset:20480
 ds_read_b64_tr_b16 v[94:95], v235 offset:21504
 v_mfma_f32_32x32x16_bf16 v[184:199], v[120:123], v[132:135], v[184:199]
 v_mfma_f32_32x32x16_bf16 v[200:215], v[124:127], v[132:135], v[200:215]
 s_waitcnt lgkmcnt(0)
 s_barrier
 v_mfma_f32_32x32x16_bf16 v[152:167], v[64:67], v[144:147], v[152:167]
 ds_read_b128 v[128:131], v236 offset:12288
 ds_read_b64_tr_b16 v[96:97], v232 offset:32768
 ds_read_b64_tr_b16 v[98:99], v232 offset:33792
 v_mfma_f32_32x32x16_bf16 v[168:183], v[68:71], v[144:147], v[168:183]
 ds_read_b64_tr_b16 v[100:101], v233 offset:32768
 ds_read_b64_tr_b16 v[102:103], v233 offset:33792
 ds_read_b64_tr_b16 v[104:105], v234 offset:32768
 v_mfma_f32_32x32x16_bf16 v[184:199], v[72:75], v[144:147], v[184:199]
 ds_read_b64_tr_b16 v[106:107], v234 offset:33792
 ds_read_b64_tr_b16 v[108:109], v235 offset:32768
 ds_read_b64_tr_b16 v[110:111], v235 offset:33792
 v_mfma_f32_32x32x16_bf16 v[200:215], v[76:79], v[144:147], v[200:215]
 ds_read_b128 v[132:135], v237 offset:12288
 ds_read_b64_tr_b16 v[112:113], v232 offset:36864
 ds_read_b64_tr_b16 v[114:115], v232 offset:37888
 v_mfma_f32_32x32x16_bf16 v[152:167], v[80:83], v[148:151], v[152:167]
 ds_read_b64_tr_b16 v[116:117], v233 offset:36864
 ds_read_b64_tr_b16 v[118:119], v233 offset:37888
 s_waitcnt lgkmcnt(10)
 ds_read_b64_tr_b16 v[120:121], v234 offset:36864
 v_mfma_f32_32x32x16_bf16 v[168:183], v[84:87], v[148:151], v[168:183]
 ds_read_b64_tr_b16 v[122:123], v234 offset:37888
 ds_read_b64_tr_b16 v[124:125], v235 offset:36864
 ds_read_b64_tr_b16 v[126:127], v235 offset:37888
 v_mfma_f32_32x32x16_bf16 v[184:199], v[88:91], v[148:151], v[184:199]
 v_mfma_f32_32x32x16_bf16 v[200:215], v[92:95], v[148:151], v[200:215]
 s_waitcnt lgkmcnt(0)
 s_barrier
 v_mfma_f32_32x32x16_bf16 v[152:167], v[96:99], v[128:131], v[152:167]
 ds_read_b128 v[144:147], v238 offset:12288
 ds_read_b64_tr_b16 v[64:65], v232 offset:40960
 ds_read_b64_tr_b16 v[66:67], v232 offset:41984
 v_mfma_f32_32x32x16_bf16 v[168:183], v[100:103], v[128:131], v[168:183]
 ds_read_b64_tr_b16 v[68:69], v233 offset:40960
 ds_read_b64_tr_b16 v[70:71], v233 offset:41984
 ds_read_b64_tr_b16 v[72:73], v234 offset:40960
 v_mfma_f32_32x32x16_bf16 v[184:199], v[104:107], v[128:131], v[184:199]
 ds_read_b64_tr_b16 v[74:75], v234 offset:41984
 ds_read_b64_tr_b16 v[76:77], v235 offset:40960
 ds_read_b64_tr_b16 v[78:79], v235 offset:41984
 v_mfma_f32_32x32x16_bf16 v[200:215], v[108:111], v[128:131], v[200:215]
 ds_read_b128 v[148:151], v239 offset:12288
 ds_read_b64_tr_b16 v[80:81], v232 offset:45056
 ds_read_b64_tr_b16 v[82:83], v232 offset:46080
 v_mfma_f32_32x32x16_bf16 v[152:167], v[112:115], v[132:135], v[152:167]
 ds_read_b64_tr_b16 v[84:85], v233 offset:45056
 ds_read_b64_tr_b16 v[86:87], v233 offset:46080
 s_waitcnt lgkmcnt(10)
 ds_read_b64_tr_b16 v[88:89], v234 offset:45056
 v_mfma_f32_32x32x16_bf16 v[168:183], v[116:119], v[132:135], v[168:183]
 ds_read_b64_tr_b16 v[90:91], v234 offset:46080
 ds_read_b64_tr_b16 v[92:93], v235 offset:45056
 ds_read_b64_tr_b16 v[94:95], v235 offset:46080
 v_mfma_f32_32x32x16_bf16 v[184:199], v[120:123], v[132:135], v[184:199]
 v_mfma_f32_32x32x16_bf16 v[200:215], v[124:127], v[132:135], v[200:215]
 s_waitcnt lgkmcnt(0)
 s_barrier
 v_mfma_f32_32x32x16_bf16 v[152:167], v[64:67], v[144:147], v[152:167]
 ds_read_b128 v[128:131], v236 offset:24576
 ds_read_b64_tr_b16 v[96:97], v232 offset:8192
 ds_read_b64_tr_b16 v[98:99], v232 offset:9216
 v_mfma_f32_32x32x16_bf16 v[168:183], v[68:71], v[144:147], v[168:183]
 ds_read_b64_tr_b16 v[100:101], v233 offset:8192
 ds_read_b64_tr_b16 v[102:103], v233 offset:9216
 ds_read_b64_tr_b16 v[104:105], v234 offset:8192
 v_mfma_f32_32x32x16_bf16 v[184:199], v[72:75], v[144:147], v[184:199]
 ds_read_b64_tr_b16 v[106:107], v234 offset:9216
 ds_read_b64_tr_b16 v[108:109], v235 offset:8192
 ds_read_b64_tr_b16 v[110:111], v235 offset:9216
 v_mfma_f32_32x32x16_bf16 v[200:215], v[76:79], v[144:147], v[200:215]
 ds_read_b128 v[132:135], v237 offset:24576
 ds_read_b64_tr_b16 v[112:113], v232 offset:12288
 ds_read_b64_tr_b16 v[114:115], v232 offset:13312
 v_mfma_f32_32x32x16_bf16 v[152:167], v[80:83], v[148:151], v[152:167]
 ds_read_b64_tr_b16 v[116:117], v233 offset:12288
 ds_read_b64_tr_b16 v[118:119], v233 offset:13312
 s_waitcnt lgkmcnt(10)
 ds_read_b64_tr_b16 v[120:121], v234 offset:12288
 v_mfma_f32_32x32x16_bf16 v[168:183], v[84:87], v[148:151], v[168:183]
 ds_read_b64_tr_b16 v[122:123], v234 offset:13312
 ds_read_b64_tr_b16 v[124:125], v235 offset:12288
 ds_read_b64_tr_b16 v[126:127], v235 offset:13312
 v_mfma_f32_32x32x16_bf16 v[184:199], v[88:91], v[148:151], v[184:199]
 v_mfma_f32_32x32x16_bf16 v[200:215], v[92:95], v[148:151], v[200:215]
 s_waitcnt lgkmcnt(0)
 s_barrier
 v_mfma_f32_32x32x16_bf16 v[152:167], v[96:99], v[128:131], v[152:167]
 ds_read_b128 v[144:147], v238 offset:24576
 ds_read_b64_tr_b16 v[64:65], v232 offset:16384
 ds_read_b64_tr_b16 v[66:67], v232 offset:17408
 v_mfma_f32_32x32x16_bf16 v[168:183], v[100:103], v[128:131], v[168:183]
 ds_read_b64_tr_b16 v[68:69], v233 offset:16384
 ds_read_b64_tr_b16 v[70:71], v233 offset:17408
 ds_read_b64_tr_b16 v[72:73], v234 offset:16384
 v_mfma_f32_32x32x16_bf16 v[184:199], v[104:107], v[128:131], v[184:199]
 ds_read_b64_tr_b16 v[74:75], v234 offset:17408
 ds_read_b64_tr_b16 v[76:77], v235 offset:16384
 ds_read_b64_tr_b16 v[78:79], v235 offset:17408
 v_mfma_f32_32x32x16_bf16 v[200:215], v[108:111], v[128:131], v[200:215]
 ds_read_b128 v[148:151], v239 offset:24576
 ds_read_b64_tr_b16 v[80:81], v232 offset:20480
 ds_read_b64_tr_b16 v[82:83], v232 offset:21504
 v_mfma_f32_32x32x16_bf16 v[152:167], v[112:115], v[132:135], v[152:167]
 ds_read_b64_tr_b16 v[84:85], v233 offset:20480
 ds_read_b64_tr_b16 v[86:87], v233 offset:21504
 s_waitcnt lgkmcnt(10)
 ds_read_b64_tr_b16 v[88:89], v234 offset:20480
 v_mfma_f32_32x32x16_bf16 v[168:183], v[116:119], v[132:135], v[168:183]
 ds_read_b64_tr_b16 v[90:91], v234 offset:21504
 ds_read_b64_tr_b16 v[92:93], v235 offset:20480
 ds_read_b64_tr_b16 v[94:95], v235 offset:21504
 v_mfma_f32_32x32x16_bf16 v[184:199], v[120:123], v[132:135], v[184:199]
 v_mfma_f32_32x32x16_bf16 v[200:215], v[124:127], v[132:135], v[200:215]
 s_waitcnt lgkmcnt(0)
 s_barrier
 v_mfma_f32_32x32x16_bf16 v[152:167], v[64:67], v[144:147], v[152:167]
 ds_read_b128 v[128:131], v236 offset:0
 ds_read_b64_tr_b16 v[96:97], v232 offset:32768
 ds_read_b64_tr_b16 v[98:99], v232 offset:33792
 v_mfma_f32_32x32x16_bf16 v[168:183], v[68:71], v[144:147], v[168:183]
 ds_read_b64_tr_b16 v[100:101], v233 offset:32768
 ds_read_b64_tr_b16 v[102:103], v233 offset:33792
 ds_read_b64_tr_b16 v[104:105], v234 offset:32768
 v_mfma_f32_32x32x16_bf16 v[184:199], v[72:75], v[144:147], v[184:199]
 ds_read_b64_tr_b16 v[106:107], v234 offset:33792
 ds_read_b64_tr_b16 v[108:109], v235 offset:32768
 ds_read_b64_tr_b16 v[110:111], v235 offset:33792
 v_mfma_f32_32x32x16_bf16 v[200:215], v[76:79], v[144:147], v[200:215]
 ds_read_b128 v[132:135], v237 offset:0
 ds_read_b64_tr_b16 v[112:113], v232 offset:36864
 ds_read_b64_tr_b16 v[114:115], v232 offset:37888
 v_mfma_f32_32x32x16_bf16 v[152:167], v[80:83], v[148:151], v[152:167]
 ds_read_b64_tr_b16 v[116:117], v233 offset:36864
 ds_read_b64_tr_b16 v[118:119], v233 offset:37888
 s_waitcnt lgkmcnt(10)
 ds_read_b64_tr_b16 v[120:121], v234 offset:36864
 v_mfma_f32_32x32x16_bf16 v[168:183], v[84:87], v[148:151], v[168:183]
 ds_read_b64_tr_b16 v[122:123], v234 offset:37888
 ds_read_b64_tr_b16 v[124:125], v235 offset:36864
 ds_read_b64_tr_b16 v[126:127], v235 offset:37888
 v_mfma_f32_32x32x16_bf16 v[184:199], v[88:91], v[148:151], v[184:199]
 v_mfma_f32_32x32x16_bf16 v[200:215], v[92:95], v[148:151], v[200:215]
 s_waitcnt lgkmcnt(0)
 s_barrier
 v_mfma_f32_32x32x16_bf16 v[152:167], v[96:99], v[128:131], v[152:167]
 ds_read_b128 v[144:147], v238 offset:0
 ds_read_b64_tr_b16 v[64:65], v232 offset:40960
 ds_read_b64_tr_b16 v[66:67], v232 offset:41984
 v_mfma_f32_32x32x16_bf16 v[168:183], v[100:103], v[128:131], v[168:183]
 ds_read_b64_tr_b16 v[68:69], v233 offset:40960
 ds_read_b64_tr_b16 v[70:71], v233 offset:41984
 ds_read_b64_tr_b16 v[72:73], v234 offset:40960
 v_mfma_f32_32x32x16_bf16 v[184:199], v[104:107], v[128:131], v[184:199]
 ds_read_b64_tr_b16 v[74:75], v234 offset:41984
 ds_read_b64_tr_b16 v[76:77], v235 offset:40960
 ds_read_b64_tr_b16 v[78:79], v235 offset:41984
 v_mfma_f32_32x32x16_bf16 v[200:215], v[108:111], v[128:131], v[200:215]
 ds_read_b128 v[148:151], v239 offset:0
 ds_read_b64_tr_b16 v[80:81], v232 offset:45056
 ds_read_b64_tr_b16 v[82:83], v232 offset:46080
 v_mfma_f32_32x32x16_bf16 v[152:167], v[112:115], v[132:135], v[152:167]
 ds_read_b64_tr_b16 v[84:85], v233 offset:45056
 ds_read_b64_tr_b16 v[86:87], v233 offset:46080
 s_waitcnt lgkmcnt(10)
 ds_read_b64_tr_b16 v[88:89], v234 offset:45056
 v_mfma_f32_32x32x16_bf16 v[168:183], v[116:119], v[132:135], v[168:183]
 ds_read_b64_tr_b16 v[90:91], v234 offset:46080
 ds_read_b64_tr_b16 v[92:93], v235 offset:45056
 ds_read_b64_tr_b16 v[94:95], v235 offset:46080
 v_mfma_f32_32x32x16_bf16 v[184:199], v[120:123], v[132:135], v[184:199]
 v_mfma_f32_32x32x16_bf16 v[200:215], v[124:127], v[132:135], v[200:215]
 s_waitcnt lgkmcnt(0)
 s_barrier
 v_mfma_f32_32x32x16_bf16 v[152:167], v[64:67], v[144:147], v[152:167]
 ds_read_b128 v[128:131], v236 offset:12288
 ds_read_b64_tr_b16 v[96:97], v232 offset:8192
 ds_read_b64_tr_b16 v[98:99], v232 offset:9216
 v_mfma_f32_32x32x16_bf16 v[168:183], v[68:71], v[144:147], v[168:183]
 ds_read_b64_tr_b16 v[100:101], v233 offset:8192
 ds_read_b64_tr_b16 v[102:103], v233 offset:9216
 ds_read_b64_tr_b16 v[104:105], v234 offset:8192
 v_mfma_f32_32x32x16_bf16 v[184:199], v[72:75], v[144:147], v[184:199]
 ds_read_b64_tr_b16 v[106:107], v234 offset:9216
 ds_read_b64_tr_b16 v[108:109], v235 offset:8192
 ds_read_b64_tr_b16 v[110:111], v235 offset:9216
 v_mfma_f32_32x32x16_bf16 v[200:215], v[76:79], v[144:147], v[200:215]
 ds_read_b128 v[132:135], v237 offset:12288
 ds_read_b64_tr_b16 v[112:113], v232 offset:12288
 ds_read_b64_tr_b16 v[114:115], v232 offset:13312
 v_mfma_f32_32x32x16_bf16 v[152:167], v[80:83], v[148:151], v[152:167]
 ds_read_b64_tr_b16 v[116:117], v233 offset:12288
 ds_read_b64_tr_b16 v[118:119], v233 offset:13312
 s_waitcnt lgkmcnt(10)
 ds_read_b64_tr_b16 v[120:121], v234 offset:12288
 v_mfma_f32_32x32x16_bf16 v[168:183], v[84:87], v[148:151], v[168:183]
 ds_read_b64_tr_b16 v[122:123], v234 offset:13312
 ds_read_b64_tr_b16 v[124:125], v235 offset:12288
 ds_read_b64_tr_b16 v[126:127], v235 offset:13312
 v_mfma_f32_32x32x16_bf16 v[184:199], v[88:91], v[148:151], v[184:199]
 v_mfma_f32_32x32x16_bf16 v[200:215], v[92:95], v[148:151], v[200:215]
 s_waitcnt lgkmcnt(0)
 s_barrier
 v_mfma_f32_32x32x16_bf16 v[152:167], v[96:99], v[128:131], v[152:167]
 ds_read_b128 v[144:147], v238 offset:12288
 ds_read_b64_tr_b16 v[64:65], v232 offset:16384
 ds_read_b64_tr_b16 v[66:67], v232 offset:17408
 v_mfma_f32_32x32x16_bf16 v[168:183], v[100:103], v[128:131], v[168:183]
 ds_read_b64_tr_b16 v[68:69], v233 offset:16384
 ds_read_b64_tr_b16 v[70:71], v233 offset:17408
 ds_read_b64_tr_b16 v[72:73], v234 offset:16384
 v_mfma_f32_32x32x16_bf16 v[184:199], v[104:107], v[128:131], v[184:199]
 ds_read_b64_tr_b16 v[74:75], v234 offset:17408
 ds_read_b64_tr_b16 v[76:77], v235 offset:16384
 ds_read_b64_tr_b16 v[78:79], v235 offset:17408
 v_mfma_f32_32x32x16_bf16 v[200:215], v[108:111], v[128:131], v[200:215]
 ds_read_b128 v[148:151], v239 offset:12288
 ds_read_b64_tr_b16 v[80:81], v232 offset:20480
 ds_read_b64_tr_b16 v[82:83], v232 offset:21504
 v_mfma_f32_32x32x16_bf16 v[152:167], v[112:115], v[132:135], v[152:167]
 ds_read_b64_tr_b16 v[84:85], v233 offset:20480
 ds_read_b64_tr_b16 v[86:87], v233 offset:21504
 s_waitcnt lgkmcnt(10)
 ds_read_b64_tr_b16 v[88:89], v234 offset:20480
 v_mfma_f32_32x32x16_bf16 v[168:183], v[116:119], v[132:135], v[168:183]
 ds_read_b64_tr_b16 v[90:91], v234 offset:21504
 ds_read_b64_tr_b16 v[92:93], v235 offset:20480
 ds_read_b64_tr_b16 v[94:95], v235 offset:21504
 v_mfma_f32_32x32x16_bf16 v[184:199], v[120:123], v[132:135], v[184:199]
 v_mfma_f32_32x32x16_bf16 v[200:215], v[124:127], v[132:135], v[200:215]
 s_waitcnt lgkmcnt(0)
 s_barrier
 v_mfma_f32_32x32x16_bf16 v[152:167], v[64:67], v[144:147], v[152:167]
 ds_read_b128 v[128:131], v236 offset:24576
 ds_read_b64_tr_b16 v[96:97], v232 offset:32768
 ds_read_b64_tr_b16 v[98:99], v232 offset:33792
 v_mfma_f32_32x32x16_bf16 v[168:183], v[68:71], v[144:147], v[168:183]
 ds_read_b64_tr_b16 v[100:101], v233 offset:32768
 ds_read_b64_tr_b16 v[102:103], v233 offset:33792
 ds_read_b64_tr_b16 v[104:105], v234 offset:32768
 v_mfma_f32_32x32x16_bf16 v[184:199], v[72:75], v[144:147], v[184:199]
 ds_read_b64_tr_b16 v[106:107], v234 offset:33792
 ds_read_b64_tr_b16 v[108:109], v235 offset:32768
 ds_read_b64_tr_b16 v[110:111], v235 offset:33792
 v_mfma_f32_32x32x16_bf16 v[200:215], v[76:79], v[144:147], v[200:215]
 ds_read_b128 v[132:135], v237 offset:24576
 ds_read_b64_tr_b16 v[112:113], v232 offset:36864
 ds_read_b64_tr_b16 v[114:115], v232 offset:37888
 v_mfma_f32_32x32x16_bf16 v[152:167], v[80:83], v[148:151], v[152:167]
 ds_read_b64_tr_b16 v[116:117], v233 offset:36864
 ds_read_b64_tr_b16 v[118:119], v233 offset:37888
 s_waitcnt lgkmcnt(10)
 ds_read_b64_tr_b16 v[120:121], v234 offset:36864
 v_mfma_f32_32x32x16_bf16 v[168:183], v[84:87], v[148:151], v[168:183]
 ds_read_b64_tr_b16 v[122:123], v234 offset:37888
 ds_read_b64_tr_b16 v[124:125], v235 offset:36864
 ds_read_b64_tr_b16 v[126:127], v235 offset:37888
 v_mfma_f32_32x32x16_bf16 v[184:199], v[88:91], v[148:151], v[184:199]
 v_mfma_f32_32x32x16_bf16 v[200:215], v[92:95], v[148:151], v[200:215]
 s_waitcnt lgkmcnt(0)
 s_barrier
 v_mfma_f32_32x32x16_bf16 v[152:167], v[96:99], v[128:131], v[152:167]
 ds_read_b128 v[144:147], v238 offset:24576
 ds_read_b64_tr_b16 v[64:65], v232 offset:40960
 ds_read_b64_tr_b16 v[66:67], v232 offset:41984
 v_mfma_f32_32x32x16_bf16 v[168:183], v[100:103], v[128:131], v[168:183]
 ds_read_b64_tr_b16 v[68:69], v233 offset:40960
 ds_read_b64_tr_b16 v[70:71], v233 offset:41984
 ds_read_b64_tr_b16 v[72:73], v234 offset:40960
 v_mfma_f32_32x32x16_bf16 v[184:199], v[104:107], v[128:131], v[184:199]
 ds_read_b64_tr_b16 v[74:75], v234 offset:41984
 ds_read_b64_tr_b16 v[76:77], v235 offset:40960
 ds_read_b64_tr_b16 v[78:79], v235 offset:41984
 v_mfma_f32_32x32x16_bf16 v[200:215], v[108:111], v[128:131], v[200:215]
 ds_read_b128 v[148:151], v239 offset:24576
 ds_read_b64_tr_b16 v[80:81], v232 offset:45056
 ds_read_b64_tr_b16 v[82:83], v232 offset:46080
 v_mfma_f32_32x32x16_bf16 v[152:167], v[112:115], v[132:135], v[152:167]
 ds_read_b64_tr_b16 v[84:85], v233 offset:45056
 ds_read_b64_tr_b16 v[86:87], v233 offset:46080
 s_waitcnt lgkmcnt(10)
 ds_read_b64_tr_b16 v[88:89], v234 offset:45056
 v_mfma_f32_32x32x16_bf16 v[168:183], v[116:119], v[132:135], v[168:183]
 ds_read_b64_tr_b16 v[90:91], v234 offset:46080
 ds_read_b64_tr_b16 v[92:93], v235 offset:45056
 ds_read_b64_tr_b16 v[94:95], v235 offset:46080
 v_mfma_f32_32x32x16_bf16 v[184:199], v[120:123], v[132:135], v[184:199]
 v_mfma_f32_32x32x16_bf16 v[200:215], v[124:127], v[132:135], v[200:215]
 s_waitcnt lgkmcnt(0)
 s_barrier
 v_mfma_f32_32x32x16_bf16 v[152:167], v[64:67], v[144:147], v[152:167]
 ds_read_b128 v[128:131], v236 offset:0
 ds_read_b64_tr_b16 v[96:97], v232 offset:8192
 ds_read_b64_tr_b16 v[98:99], v232 offset:9216
 v_mfma_f32_32x32x16_bf16 v[168:183], v[68:71], v[144:147], v[168:183]
 ds_read_b64_tr_b16 v[100:101], v233 offset:8192
 ds_read_b64_tr_b16 v[102:103], v233 offset:9216
 ds_read_b64_tr_b16 v[104:105], v234 offset:8192
 v_mfma_f32_32x32x16_bf16 v[184:199], v[72:75], v[144:147], v[184:199]
 ds_read_b64_tr_b16 v[106:107], v234 offset:9216
 ds_read_b64_tr_b16 v[108:109], v235 offset:8192
 ds_read_b64_tr_b16 v[110:111], v235 offset:9216
 v_mfma_f32_32x32x16_bf16 v[200:215], v[76:79], v[144:147], v[200:215]
 ds_read_b128 v[132:135], v237 offset:0
 ds_read_b64_tr_b16 v[112:113], v232 offset:12288
 ds_read_b64_tr_b16 v[114:115], v232 offset:13312
 v_mfma_f32_32x32x16_bf16 v[152:167], v[80:83], v[148:151], v[152:167]
 ds_read_b64_tr_b16 v[116:117], v233 offset:12288
 ds_read_b64_tr_b16 v[118:119], v233 offset:13312
 s_waitcnt lgkmcnt(10)
 ds_read_b64_tr_b16 v[120:121], v234 offset:12288
 v_mfma_f32_32x32x16_bf16 v[168:183], v[84:87], v[148:151], v[168:183]
 ds_read_b64_tr_b16 v[122:123], v234 offset:13312
 ds_read_b64_tr_b16 v[124:125], v235 offset:12288
 ds_read_b64_tr_b16 v[126:127], v235 offset:13312
 v_mfma_f32_32x32x16_bf16 v[184:199], v[88:91], v[148:151], v[184:199]
 v_mfma_f32_32x32x16_bf16 v[200:215], v[92:95], v[148:151], v[200:215]
 s_waitcnt lgkmcnt(0)
 s_barrier
 v_mfma_f32_32x32x16_bf16 v[152:167], v[96:99], v[128:131], v[152:167]
 ds_read_b128 v[144:147], v238 offset:0
 ds_read_b64_tr_b16 v[64:65], v232 offset:16384
 ds_read_b64_tr_b16 v[66:67], v232 offset:17408
 v_mfma_f32_32x32x16_bf16 v[168:183], v[100:103], v[128:131], v[168:183]
 ds_read_b64_tr_b16 v[68:69], v233 offset:16384
 ds_read_b64_tr_b16 v[70:71], v233 offset:17408
 ds_read_b64_tr_b16 v[72:73], v234 offset:16384
 v_mfma_f32_32x32x16_bf16 v[184:199], v[104:107], v[128:131], v[184:199]
 ds_read_b64_tr_b16 v[74:75], v234 offset:17408
 ds_read_b64_tr_b16 v[76:77], v235 offset:16384
 ds_read_b64_tr_b16 v[78:79], v235 offset:17408
 v_mfma_f32_32x32x16_bf16 v[200:215], v[108:111], v[128:131], v[200:215]
 ds_read_b128 v[148:151], v239 offset:0
 ds_read_b64_tr_b16 v[80:81], v232 offset:20480
 ds_read_b64_tr_b16 v[82:83], v232 offset:21504
 v_mfma_f32_32x32x16_bf16 v[152:167], v[112:115], v[132:135], v[152:167]
 ds_read_b64_tr_b16 v[84:85], v233 offset:20480
 ds_read_b64_tr_b16 v[86:87], v233 offset:21504
 s_waitcnt lgkmcnt(10)
 ds_read_b64_tr_b16 v[88:89], v234 offset:20480
 v_mfma_f32_32x32x16_bf16 v[168:183], v[116:119], v[132:135], v[168:183]
 ds_read_b64_tr_b16 v[90:91], v234 offset:21504
 ds_read_b64_tr_b16 v[92:93], v235 offset:20480
 ds_read_b64_tr_b16 v[94:95], v235 offset:21504
 v_mfma_f32_32x32x16_bf16 v[184:199], v[120:123], v[132:135], v[184:199]
 v_mfma_f32_32x32x16_bf16 v[200:215], v[124:127], v[132:135], v[200:215]
 s_waitcnt lgkmcnt(0)
 s_barrier
 s_setprio 2
 ds_read_b128 v[96:99], v216 offset:0
 ds_read_b128 v[100:103], v217 offset:0
 ds_read_b128 v[104:107], v218 offset:0
 ds_read_b128 v[108:111], v219 offset:0
 ds_read_b128 v[112:115], v220 offset:0
 ds_read_b128 v[116:119], v221 offset:0
 ds_read_b128 v[120:123], v222 offset:0
 ds_read_b128 v[124:127], v223 offset:0
 v_mfma_f32_32x32x16_bf16 v[152:167], v[64:67], v[144:147], v[152:167]
 v_mfma_f32_32x32x16_bf16 v[152:167], v[80:83], v[148:151], v[152:167]
 v_mfma_f32_32x32x16_bf16 v[168:183], v[68:71], v[144:147], v[168:183]
 v_mfma_f32_32x32x16_bf16 v[168:183], v[84:87], v[148:151], v[168:183]
 v_mfma_f32_32x32x16_bf16 v[184:199], v[72:75], v[144:147], v[184:199]
 v_mfma_f32_32x32x16_bf16 v[184:199], v[88:91], v[148:151], v[184:199]
 v_mfma_f32_32x32x16_bf16 v[200:215], v[76:79], v[144:147], v[200:215]
 v_mfma_f32_32x32x16_bf16 v[200:215], v[92:95], v[148:151], v[200:215]
 s_nop 5
 v_mul_f32 v152, s53, v152
 v_mul_f32 v153, s53, v153
 v_cvt_pk_bf16_f32 v64, v152, v153
 v_mul_f32 v154, s53, v154
 v_mul_f32 v155, s53, v155
 v_cvt_pk_bf16_f32 v65, v154, v155
 v_mul_f32 v156, s53, v156
 v_mul_f32 v157, s53, v157
 v_cvt_pk_bf16_f32 v66, v156, v157
 v_mul_f32 v158, s53, v158
 v_mul_f32 v159, s53, v159
 v_cvt_pk_bf16_f32 v67, v158, v159
 v_mul_f32 v160, s53, v160
 v_mul_f32 v161, s53, v161
 v_cvt_pk_bf16_f32 v68, v160, v161
 v_mul_f32 v162, s53, v162
 v_mul_f32 v163, s53, v163
 v_cvt_pk_bf16_f32 v69, v162, v163
 v_mul_f32 v164, s53, v164
 v_mul_f32 v165, s53, v165
 v_cvt_pk_bf16_f32 v70, v164, v165
 v_mul_f32 v166, s53, v166
 v_mul_f32 v167, s53, v167
 v_cvt_pk_bf16_f32 v71, v166, v167
 v_mul_f32 v168, s53, v168
 v_mul_f32 v169, s53, v169
 v_cvt_pk_bf16_f32 v72, v168, v169
 v_mul_f32 v170, s53, v170
 v_mul_f32 v171, s53, v171
 v_cvt_pk_bf16_f32 v73, v170, v171
 s_waitcnt lgkmcnt(7)
 v_mfma_f32_32x32x16_bf16 v[128:143], v[96:99], v[64:67], 0
 v_mul_f32 v172, s53, v172
 v_mul_f32 v173, s53, v173
 v_cvt_pk_bf16_f32 v74, v172, v173
 v_mul_f32 v174, s53, v174
 v_mul_f32 v175, s53, v175
 v_cvt_pk_bf16_f32 v75, v174, v175
 v_mul_f32 v176, s53, v176
 v_mul_f32 v177, s53, v177
 v_cvt_pk_bf16_f32 v76, v176, v177
 v_mul_f32 v178, s53, v178
 v_mul_f32 v179, s53, v179
 v_cvt_pk_bf16_f32 v77, v178, v179
 s_waitcnt lgkmcnt(6)
 v_mfma_f32_32x32x16_bf16 v[128:143], v[100:103], v[68:71], v[128:143]
 v_mul_f32 v180, s53, v180
 v_mul_f32 v181, s53, v181
 v_cvt_pk_bf16_f32 v78, v180, v181
 v_mul_f32 v182, s53, v182
 v_mul_f32 v183, s53, v183
 v_cvt_pk_bf16_f32 v79, v182, v183
 v_mul_f32 v184, s53, v184
 v_mul_f32 v185, s53, v185
 v_cvt_pk_bf16_f32 v80, v184, v185
 v_mul_f32 v186, s53, v186
 v_mul_f32 v187, s53, v187
 v_cvt_pk_bf16_f32 v81, v186, v187
 s_waitcnt lgkmcnt(5)
 v_mfma_f32_32x32x16_bf16 v[128:143], v[104:107], v[72:75], v[128:143]
 v_mul_f32 v188, s53, v188
 v_mul_f32 v189, s53, v189
 v_cvt_pk_bf16_f32 v82, v188, v189
 v_mul_f32 v190, s53, v190
 v_mul_f32 v191, s53, v191
 v_cvt_pk_bf16_f32 v83, v190, v191
 v_mul_f32 v192, s53, v192
 v_mul_f32 v193, s53, v193
 v_cvt_pk_bf16_f32 v84, v192, v193
 v_mul_f32 v194, s53, v194
 v_mul_f32 v195, s53, v195
 v_cvt_pk_bf16_f32 v85, v194, v195
 s_waitcnt lgkmcnt(4)
 v_mfma_f32_32x32x16_bf16 v[128:143], v[108:111], v[76:79], v[128:143]
 v_mul_f32 v196, s53, v196
 v_mul_f32 v197, s53, v197
 v_cvt_pk_bf16_f32 v86, v196, v197
 v_mul_f32 v198, s53, v198
 v_mul_f32 v199, s53, v199
 v_cvt_pk_bf16_f32 v87, v198, v199
 v_mul_f32 v200, s53, v200
 v_mul_f32 v201, s53, v201
 v_cvt_pk_bf16_f32 v88, v200, v201
 v_mul_f32 v202, s53, v202
 v_mul_f32 v203, s53, v203
 v_cvt_pk_bf16_f32 v89, v202, v203
 s_waitcnt lgkmcnt(3)
 v_mfma_f32_32x32x16_bf16 v[128:143], v[112:115], v[80:83], v[128:143]
 v_mul_f32 v204, s53, v204
 v_mul_f32 v205, s53, v205
 v_cvt_pk_bf16_f32 v90, v204, v205
 v_mul_f32 v206, s53, v206
 v_mul_f32 v207, s53, v207
 v_cvt_pk_bf16_f32 v91, v206, v207
 v_mul_f32 v208, s53, v208
 v_mul_f32 v209, s53, v209
 v_cvt_pk_bf16_f32 v92, v208, v209
 v_mul_f32 v210, s53, v210
 v_mul_f32 v211, s53, v211
 v_cvt_pk_bf16_f32 v93, v210, v211
 s_waitcnt lgkmcnt(2)
 v_mfma_f32_32x32x16_bf16 v[128:143], v[116:119], v[84:87], v[128:143]
 v_mul_f32 v212, s53, v212
 v_mul_f32 v213, s53, v213
 v_cvt_pk_bf16_f32 v94, v212, v213
 v_mul_f32 v214, s53, v214
 v_mul_f32 v215, s53, v215
 v_cvt_pk_bf16_f32 v95, v214, v215
 s_nop 1
 s_waitcnt lgkmcnt(1)
 v_mfma_f32_32x32x16_bf16 v[128:143], v[120:123], v[88:91], v[128:143]
 s_waitcnt lgkmcnt(0)
 v_mfma_f32_32x32x16_bf16 v[128:143], v[124:127], v[92:95], v[128:143]
 ds_read_b128 v[152:155], v216 offset:8192
 ds_read_b128 v[156:159], v217 offset:8192
 ds_read_b128 v[160:163], v218 offset:8192
 ds_read_b128 v[164:167], v219 offset:8192
 ds_read_b128 v[168:171], v220 offset:8192
 ds_read_b128 v[172:175], v221 offset:8192
 ds_read_b128 v[176:179], v222 offset:8192
 ds_read_b128 v[180:183], v223 offset:8192
 s_nop 3
 v_max3_f32 v244, v128, v129, v130
 v_max3_f32 v245, v131, v132, v133
 v_max3_f32 v246, v134, v135, v136
 v_max3_f32 v247, v137, v138, v139
 v_max3_f32 v248, v140, v141, v142
 v_max3_f32 v244, v244, v245, v143
 v_max3_f32 v246, v246, v247, v248
 v_max_f32 v244, v244, v246
 v_mov_b32 v245, v244
 s_nop 1
 v_permlane32_swap_b32 v244, v245
 v_max_f32 v244, v244, v245
 v_sub_f32 v96, v128, v244
 v_sub_f32 v128, 0, v244
 v_sub_f32 v97, v129, v244
 v_sub_f32 v129, 0, v244
 v_sub_f32 v98, v130, v244
 v_sub_f32 v130, 0, v244
 v_sub_f32 v99, v131, v244
 v_sub_f32 v131, 0, v244
 v_sub_f32 v100, v132, v244
 v_sub_f32 v132, 0, v244
 v_sub_f32 v101, v133, v244
 v_sub_f32 v133, 0, v244
 v_sub_f32 v102, v134, v244
 v_sub_f32 v134, 0, v244
 v_sub_f32 v103, v135, v244
 v_sub_f32 v135, 0, v244
 v_sub_f32 v104, v136, v244
 v_sub_f32 v136, 0, v244
 v_sub_f32 v105, v137, v244
 v_sub_f32 v137, 0, v244
 v_sub_f32 v106, v138, v244
 v_sub_f32 v138, 0, v244
 v_sub_f32 v107, v139, v244
 v_sub_f32 v139, 0, v244
 v_sub_f32 v108, v140, v244
 v_sub_f32 v140, 0, v244
 v_sub_f32 v109, v141, v244
 v_sub_f32 v141, 0, v244
 v_sub_f32 v110, v142, v244
 v_sub_f32 v142, 0, v244
 v_sub_f32 v111, v143, v244
 v_sub_f32 v143, 0, v244
 v_exp_f32 v244, v96
 v_exp_f32 v245, v97
 v_exp_f32 v246, v98
 v_exp_f32 v247, v99
 v_add_f32 v230, v244, v245
 v_cvt_pk_bf16_f32 v144, v244, v245
 v_exp_f32 v248, v100
 v_add_f32 v231, v246, v247
 v_exp_f32 v249, v101
 v_cvt_pk_bf16_f32 v145, v246, v247
 v_exp_f32 v244, v102
 v_add_f32 v230, v230, v248
 v_exp_f32 v245, v103
 v_add_f32 v231, v231, v249
 v_cvt_pk_bf16_f32 v146, v248, v249
 v_exp_f32 v246, v104
 v_add_f32 v230, v230, v244
 v_exp_f32 v247, v105
 s_waitcnt lgkmcnt(0)
 s_barrier
 v_mfma_f32_32x32x16_bf16 v[112:127], v[152:155], v[64:67], v[128:143]
 ds_read_b64_tr_b16 v[184:185], v224 offset:32768
 ds_read_b64_tr_b16 v[186:187], v224 offset:34816
 v_add_f32 v231, v231, v245
 v_cvt_pk_bf16_f32 v147, v244, v245
 v_exp_f32 v248, v106
 v_mfma_f32_32x32x16_bf16 v[112:127], v[156:159], v[68:71], v[112:127]
 ds_read_b64_tr_b16 v[188:189], v225 offset:32768
 ds_read_b64_tr_b16 v[190:191], v225 offset:34816
 v_add_f32 v230, v230, v246
 v_exp_f32 v249, v107
 v_add_f32 v231, v231, v247
 v_mfma_f32_32x32x16_bf16 v[112:127], v[160:163], v[72:75], v[112:127]
 ds_read_b64_tr_b16 v[192:193], v226 offset:32768
 ds_read_b64_tr_b16 v[194:195], v226 offset:34816
 v_cvt_pk_bf16_f32 v148, v246, v247
 v_exp_f32 v244, v108
 v_add_f32 v230, v230, v248
 v_mfma_f32_32x32x16_bf16 v[112:127], v[164:167], v[76:79], v[112:127]
 ds_read_b64_tr_b16 v[196:197], v227 offset:32768
 ds_read_b64_tr_b16 v[198:199], v227 offset:34816
 v_exp_f32 v245, v109
 v_add_f32 v231, v231, v249
 v_cvt_pk_bf16_f32 v149, v248, v249
 v_mfma_f32_32x32x16_bf16 v[112:127], v[168:171], v[80:83], v[112:127]
 ds_read_b64_tr_b16 v[200:201], v224 offset:36864
 ds_read_b64_tr_b16 v[202:203], v224 offset:38912
 v_exp_f32 v246, v110
 v_add_f32 v230, v230, v244
 v_exp_f32 v247, v111
 v_mfma_f32_32x32x16_bf16 v[112:127], v[172:175], v[84:87], v[112:127]
 ds_read_b64_tr_b16 v[204:205], v225 offset:36864
 ds_read_b64_tr_b16 v[206:207], v225 offset:38912
 v_add_f32 v231, v231, v245
 v_cvt_pk_bf16_f32 v150, v244, v245
 v_add_f32 v230, v230, v246
 v_mfma_f32_32x32x16_bf16 v[112:127], v[176:179], v[88:91], v[112:127]
 ds_read_b64_tr_b16 v[208:209], v226 offset:36864
 ds_read_b64_tr_b16 v[210:211], v226 offset:38912
 v_add_f32 v231, v231, v247
 v_cvt_pk_bf16_f32 v151, v246, v247
 v_add_f32 v230, v230, v231
 v_mfma_f32_32x32x16_bf16 v[112:127], v[180:183], v[92:95], v[112:127]
 v_cmp_nge_f32 vcc, s54, v230
 s_waitcnt lgkmcnt(6)
 s_cbranch_vccnz K_rare_1
K_back_2:
 v_mfma_f32_32x32x16_bf16 v[0:15], v[184:187], v[144:147], 0
 ds_read_b64_tr_b16 v[212:213], v227 offset:36864
 ds_read_b64_tr_b16 v[214:215], v227 offset:38912
 v_add_f32 v228, v228, v230
 v_mfma_f32_32x32x16_bf16 v[16:31], v[188:191], v[144:147], 0
 ds_read_b128 v[152:155], v216 offset:16384
 ds_read_b128 v[156:159], v217 offset:16384
 v_mfma_f32_32x32x16_bf16 v[32:47], v[192:195], v[144:147], 0
 ds_read_b128 v[160:163], v218 offset:16384
 ds_read_b128 v[164:167], v219 offset:16384
 v_exp_f32 v244, v112
 v_exp_f32 v245, v113
 v_exp_f32 v246, v114
 v_mfma_f32_32x32x16_bf16 v[48:63], v[196:199], v[144:147], 0
 ds_read_b128 v[168:171], v220 offset:16384
 v_exp_f32 v247, v115
 v_add_f32 v230, v244, v245
 v_cvt_pk_bf16_f32 v232, v244, v245
 s_waitcnt lgkmcnt(5)
 v_mfma_f32_32x32x16_bf16 v[0:15], v[200:203], v[148:151], v[0:15]
 ds_read_b128 v[172:175], v221 offset:16384
 v_exp_f32 v248, v116
 v_add_f32 v231, v246, v247
 v_exp_f32 v249, v117
 v_mfma_f32_32x32x16_bf16 v[16:31], v[204:207], v[148:151], v[16:31]
 ds_read_b128 v[176:179], v222 offset:16384
 v_cvt_pk_bf16_f32 v233, v246, v247
 v_exp_f32 v244, v118
 v_add_f32 v230, v230, v248
 v_mfma_f32_32x32x16_bf16 v[32:47], v[208:211], v[148:151], v[32:47]
 ds_read_b128 v[180:183], v223 offset:16384
 v_exp_f32 v245, v119
 v_add_f32 v231, v231, v249
 v_cvt_pk_bf16_f32 v234, v248, v249
 v_mfma_f32_32x32x16_bf16 v[48:63], v[212:215], v[148:151], v[48:63]
 v_exp_f32 v246, v120
 v_add_f32 v230, v230, v244
 v_exp_f32 v247, v121
 s_waitcnt lgkmcnt(0)
 s_barrier
 v_mfma_f32_32x32x16_bf16 v[96:111], v[152:155], v[64:67], v[128:143]
 ds_read_b64_tr_b16 v[184:185], v224 offset:40960
 ds_read_b64_tr_b16 v[186:187], v224 offset:43008
 v_add_f32 v231, v231, v245
 v_cvt_pk_bf16_f32 v235, v244, v245
 v_exp_f32 v248, v122
 v_mfma_f32_32x32x16_bf16 v[96:111], v[156:159], v[68:71], v[96:111]
 ds_read_b64_tr_b16 v[188:189], v225 offset:40960
 ds_read_b64_tr_b16 v[190:191], v225 offset:43008
 v_add_f32 v230, v230, v246
 v_exp_f32 v249, v123
 v_add_f32 v231, v231, v247
 v_mfma_f32_32x32x16_bf16 v[96:111], v[160:163], v[72:75], v[96:111]
 ds_read_b64_tr_b16 v[192:193], v226 offset:40960
 ds_read_b64_tr_b16 v[194:195], v226 offset:43008
 v_cvt_pk_bf16_f32 v236, v246, v247
 v_exp_f32 v244, v124
 v_add_f32 v230, v230, v248
 v_mfma_f32_32x32x16_bf16 v[96:111], v[164:167], v[76:79], v[96:111]
 ds_read_b64_tr_b16 v[196:197], v227 offset:40960
 ds_read_b64_tr_b16 v[198:199], v227 offset:43008
 v_exp_f32 v245, v125
 v_add_f32 v231, v231, v249
 v_cvt_pk_bf16_f32 v237, v248, v249
 v_mfma_f32_32x32x16_bf16 v[96:111], v[168:171], v[80:83], v[96:111]
 ds_read_b64_tr_b16 v[200:201], v224 offset:45056
 ds_read_b64_tr_b16 v[202:203], v224 offset:47104
 v_exp_f32 v246, v126
 v_add_f32 v230, v230, v244
 v_exp_f32 v247, v127
 v_mfma_f32_32x32x16_bf16 v[96:111], v[172:175], v[84:87], v[96:111]
 ds_read_b64_tr_b16 v[204:205], v225 offset:45056
 ds_read_b64_tr_b16 v[206:207], v225 offset:47104
 v_add_f32 v231, v231, v245
 v_cvt_pk_bf16_f32 v238, v244, v245
 v_add_f32 v230, v230, v246
 v_mfma_f32_32x32x16_bf16 v[96:111], v[176:179], v[88:91], v[96:111]
 ds_read_b64_tr_b16 v[208:209], v226 offset:45056
 ds_read_b64_tr_b16 v[210:211], v226 offset:47104
 v_add_f32 v231, v231, v247
 v_cvt_pk_bf16_f32 v239, v246, v247
 v_add_f32 v230, v230, v231
 v_mfma_f32_32x32x16_bf16 v[96:111], v[180:183], v[92:95], v[96:111]
 v_cmp_nge_f32 vcc, s54, v230
 s_waitcnt lgkmcnt(6)
 s_cbranch_vccnz K_rare_3
K_back_4:
 v_mfma_f32_32x32x16_bf16 v[0:15], v[184:187], v[232:235], v[0:15]
 ds_read_b64_tr_b16 v[212:213], v227 offset:45056
 ds_read_b64_tr_b16 v[214:215], v227 offset:47104
 v_add_f32 v228, v228, v230
 v_mfma_f32_32x32x16_bf16 v[16:31], v[188:191], v[232:235], v[16:31]
 ds_read_b128 v[152:155], v216 offset:24576
 ds_read_b128 v[156:159], v217 offset:24576
 v_mfma_f32_32x32x16_bf16 v[32:47], v[192:195], v[232:235], v[32:47]
 ds_read_b128 v[160:163], v218 offset:24576
 ds_read_b128 v[164:167], v219 offset:24576
 v_exp_f32 v244, v96
 v_exp_f32 v245, v97
 v_exp_f32 v246, v98
 v_mfma_f32_32x32x16_bf16 v[48:63], v[196:199], v[232:235], v[48:63]
 ds_read_b128 v[168:171], v220 offset:24576
 v_exp_f32 v247, v99
 v_add_f32 v230, v244, v245
 v_cvt_pk_bf16_f32 v144, v244, v245
 s_waitcnt lgkmcnt(5)
 v_mfma_f32_32x32x16_bf16 v[0:15], v[200:203], v[236:239], v[0:15]
 ds_read_b128 v[172:175], v221 offset:24576
 v_exp_f32 v248, v100
 v_add_f32 v231, v246, v247
 v_exp_f32 v249, v101
 v_mfma_f32_32x32x16_bf16 v[16:31], v[204:207], v[236:239], v[16:31]
 ds_read_b128 v[176:179], v222 offset:24576
 v_cvt_pk_bf16_f32 v145, v246, v247
 v_exp_f32 v244, v102
 v_add_f32 v230, v230, v248
 v_mfma_f32_32x32x16_bf16 v[32:47], v[208:211], v[236:239], v[32:47]
 ds_read_b128 v[180:183], v223 offset:24576
 v_exp_f32 v245, v103
 v_add_f32 v231, v231, v249
 v_cvt_pk_bf16_f32 v146, v248, v249
 v_mfma_f32_32x32x16_bf16 v[48:63], v[212:215], v[236:239], v[48:63]
 v_exp_f32 v246, v104
 v_add_f32 v230, v230, v244
 v_exp_f32 v247, v105
 s_waitcnt lgkmcnt(0)
 s_barrier
 v_mfma_f32_32x32x16_bf16 v[112:127], v[152:155], v[64:67], v[128:143]
 ds_read_b64_tr_b16 v[184:185], v224 offset:49152
 ds_read_b64_tr_b16 v[186:187], v224 offset:51200
 v_add_f32 v231, v231, v245
 v_cvt_pk_bf16_f32 v147, v244, v245
 v_exp_f32 v248, v106
 v_mfma_f32_32x32x16_bf16 v[112:127], v[156:159], v[68:71], v[112:127]
 ds_read_b64_tr_b16 v[188:189], v225 offset:49152
 ds_read_b64_tr_b16 v[190:191], v225 offset:51200
 v_add_f32 v230, v230, v246
 v_exp_f32 v249, v107
 v_add_f32 v231, v231, v247
 v_mfma_f32_32x32x16_bf16 v[112:127], v[160:163], v[72:75], v[112:127]
 ds_read_b64_tr_b16 v[192:193], v226 offset:49152
 ds_read_b64_tr_b16 v[194:195], v226 offset:51200
 v_cvt_pk_bf16_f32 v148, v246, v247
 v_exp_f32 v244, v108
 v_add_f32 v230, v230, v248
 v_mfma_f32_32x32x16_bf16 v[112:127], v[164:167], v[76:79], v[112:127]
 ds_read_b64_tr_b16 v[196:197], v227 offset:49152
 ds_read_b64_tr_b16 v[198:199], v227 offset:51200
 v_exp_f32 v245, v109
 v_add_f32 v231, v231, v249
 v_cvt_pk_bf16_f32 v149, v248, v249
 v_mfma_f32_32x32x16_bf16 v[112:127], v[168:171], v[80:83], v[112:127]
 ds_read_b64_tr_b16 v[200:201], v224 offset:53248
 ds_read_b64_tr_b16 v[202:203], v224 offset:55296
 v_exp_f32 v246, v110
 v_add_f32 v230, v230, v244
 v_exp_f32 v247, v111
 v_mfma_f32_32x32x16_bf16 v[112:127], v[172:175], v[84:87], v[112:127]
 ds_read_b64_tr_b16 v[204:205], v225 offset:53248
 ds_read_b64_tr_b16 v[206:207], v225 offset:55296
 v_add_f32 v231, v231, v245
 v_cvt_pk_bf16_f32 v150, v244, v245
 v_add_f32 v230, v230, v246
 v_mfma_f32_32x32x16_bf16 v[112:127], v[176:179], v[88:91], v[112:127]
 ds_read_b64_tr_b16 v[208:209], v226 offset:53248
 ds_read_b64_tr_b16 v[210:211], v226 offset:55296
 v_add_f32 v231, v231, v247
 v_cvt_pk_bf16_f32 v151, v246, v247
 v_add_f32 v230, v230, v231
 v_mfma_f32_32x32x16_bf16 v[112:127], v[180:183], v[92:95], v[112:127]
 v_cmp_nge_f32 vcc, s54, v230
 s_waitcnt lgkmcnt(6)
 s_cbranch_vccnz K_rare_5
K_back_6:
 v_mfma_f32_32x32x16_bf16 v[0:15], v[184:187], v[144:147], v[0:15]
 ds_read_b64_tr_b16 v[212:213], v227 offset:53248
 ds_read_b64_tr_b16 v[214:215], v227 offset:55296
 v_add_f32 v228, v228, v230
 v_mfma_f32_32x32x16_bf16 v[16:31], v[188:191], v[144:147], v[16:31]
 ds_read_b128 v[152:155], v216 offset:32768
 ds_read_b128 v[156:159], v217 offset:32768
 v_mfma_f32_32x32x16_bf16 v[32:47], v[192:195], v[144:147], v[32:47]
 ds_read_b128 v[160:163], v218 offset:32768
 ds_read_b128 v[164:167], v219 offset:32768
 v_exp_f32 v244, v112
 v_exp_f32 v245, v113
 v_exp_f32 v246, v114
 v_mfma_f32_32x32x16_bf16 v[48:63], v[196:199], v[144:147], v[48:63]
 ds_read_b128 v[168:171], v220 offset:32768
 v_exp_f32 v247, v115
 v_add_f32 v230, v244, v245
 v_cvt_pk_bf16_f32 v232, v244, v245
 s_waitcnt lgkmcnt(5)
 v_mfma_f32_32x32x16_bf16 v[0:15], v[200:203], v[148:151], v[0:15]
 ds_read_b128 v[172:175], v221 offset:32768
 v_exp_f32 v248, v116
 v_add_f32 v231, v246, v247
 v_exp_f32 v249, v117
 v_mfma_f32_32x32x16_bf16 v[16:31], v[204:207], v[148:151], v[16:31]
 ds_read_b128 v[176:179], v222 offset:32768
 v_cvt_pk_bf16_f32 v233, v246, v247
 v_exp_f32 v244, v118
 v_add_f32 v230, v230, v248
 v_mfma_f32_32x32x16_bf16 v[32:47], v[208:211], v[148:151], v[32:47]
 ds_read_b128 v[180:183], v223 offset:32768
 v_exp_f32 v245, v119
 v_add_f32 v231, v231, v249
 v_cvt_pk_bf16_f32 v234, v248, v249
 v_mfma_f32_32x32x16_bf16 v[48:63], v[212:215], v[148:151], v[48:63]
 v_exp_f32 v246, v120
 v_add_f32 v230, v230, v244
 v_exp_f32 v247, v121
 s_waitcnt lgkmcnt(0)
 s_barrier
 v_mfma_f32_32x32x16_bf16 v[96:111], v[152:155], v[64:67], v[128:143]
 ds_read_b64_tr_b16 v[184:185], v224 offset:57344
 ds_read_b64_tr_b16 v[186:187], v224 offset:59392
 v_add_f32 v231, v231, v245
 v_cvt_pk_bf16_f32 v235, v244, v245
 v_exp_f32 v248, v122
 v_mfma_f32_32x32x16_bf16 v[96:111], v[156:159], v[68:71], v[96:111]
 ds_read_b64_tr_b16 v[188:189], v225 offset:57344
 ds_read_b64_tr_b16 v[190:191], v225 offset:59392
 v_add_f32 v230, v230, v246
 v_exp_f32 v249, v123
 v_add_f32 v231, v231, v247
 v_mfma_f32_32x32x16_bf16 v[96:111], v[160:163], v[72:75], v[96:111]
 ds_read_b64_tr_b16 v[192:193], v226 offset:57344
 ds_read_b64_tr_b16 v[194:195], v226 offset:59392
 v_cvt_pk_bf16_f32 v236, v246, v247
 v_exp_f32 v244, v124
 v_add_f32 v230, v230, v248
 v_mfma_f32_32x32x16_bf16 v[96:111], v[164:167], v[76:79], v[96:111]
 ds_read_b64_tr_b16 v[196:197], v227 offset:57344
 ds_read_b64_tr_b16 v[198:199], v227 offset:59392
 v_exp_f32 v245, v125
 v_add_f32 v231, v231, v249
 v_cvt_pk_bf16_f32 v237, v248, v249
 v_mfma_f32_32x32x16_bf16 v[96:111], v[168:171], v[80:83], v[96:111]
 ds_read_b64_tr_b16 v[200:201], v224 offset:61440
 ds_read_b64_tr_b16 v[202:203], v224 offset:63488
 v_exp_f32 v246, v126
 v_add_f32 v230, v230, v244
 v_exp_f32 v247, v127
 v_mfma_f32_32x32x16_bf16 v[96:111], v[172:175], v[84:87], v[96:111]
 ds_read_b64_tr_b16 v[204:205], v225 offset:61440
 ds_read_b64_tr_b16 v[206:207], v225 offset:63488
 v_add_f32 v231, v231, v245
 v_cvt_pk_bf16_f32 v238, v244, v245
 v_add_f32 v230, v230, v246
 v_mfma_f32_32x32x16_bf16 v[96:111], v[176:179], v[88:91], v[96:111]
 ds_read_b64_tr_b16 v[208:209], v226 offset:61440
 ds_read_b64_tr_b16 v[210:211], v226 offset:63488
 v_add_f32 v231, v231, v247
 v_cvt_pk_bf16_f32 v239, v246, v247
 v_add_f32 v230, v230, v231
 v_mfma_f32_32x32x16_bf16 v[96:111], v[180:183], v[92:95], v[96:111]
 v_cmp_nge_f32 vcc, s54, v230
 s_waitcnt lgkmcnt(6)
 s_cbranch_vccnz K_rare_7
K_back_8:
 v_mfma_f32_32x32x16_bf16 v[0:15], v[184:187], v[232:235], v[0:15]
 ds_read_b64_tr_b16 v[212:213], v227 offset:61440
 ds_read_b64_tr_b16 v[214:215], v227 offset:63488
 v_add_f32 v228, v228, v230
 v_mfma_f32_32x32x16_bf16 v[16:31], v[188:191], v[232:235], v[16:31]
 ds_read_b128 v[152:155], v216 offset:40960
 ds_read_b128 v[156:159], v217 offset:40960
 v_mfma_f32_32x32x16_bf16 v[32:47], v[192:195], v[232:235], v[32:47]
 ds_read_b128 v[160:163], v218 offset:40960
 ds_read_b128 v[164:167], v219 offset:40960
 v_exp_f32 v244, v96
 v_exp_f32 v245, v97
 v_exp_f32 v246, v98
 v_mfma_f32_32x32x16_bf16 v[48:63], v[196:199], v[232:235], v[48:63]
 ds_read_b128 v[168:171], v220 offset:40960
 v_exp_f32 v247, v99
 v_add_f32 v230, v244, v245
 v_cvt_pk_bf16_f32 v144, v244, v245
 s_waitcnt lgkmcnt(5)
 v_mfma_f32_32x32x16_bf16 v[0:15], v[200:203], v[236:239], v[0:15]
 ds_read_b128 v[172:175], v221 offset:40960
 v_exp_f32 v248, v100
 v_add_f32 v231, v246, v247
 v_exp_f32 v249, v101
 v_mfma_f32_32x32x16_bf16 v[16:31], v[204:207], v[236:239], v[16:31]
 ds_read_b128 v[176:179], v222 offset:40960
 v_cvt_pk_bf16_f32 v145, v246, v247
 v_exp_f32 v244, v102
 v_add_f32 v230, v230, v248
 v_mfma_f32_32x32x16_bf16 v[32:47], v[208:211], v[236:239], v[32:47]
 ds_read_b128 v[180:183], v223 offset:40960
 v_exp_f32 v245, v103
 v_add_f32 v231, v231, v249
 v_cvt_pk_bf16_f32 v146, v248, v249
 v_mfma_f32_32x32x16_bf16 v[48:63], v[212:215], v[236:239], v[48:63]
 v_exp_f32 v246, v104
 v_add_f32 v230, v230, v244
 v_exp_f32 v247, v105
 s_waitcnt lgkmcnt(0)
 s_barrier
 v_mfma_f32_32x32x16_bf16 v[112:127], v[152:155], v[64:67], v[128:143]
 ds_read_b64_tr_b16 v[184:185], v224 offset:24576
 ds_read_b64_tr_b16 v[186:187], v224 offset:26624
 v_add_f32 v231, v231, v245
 v_cvt_pk_bf16_f32 v147, v244, v245
 v_exp_f32 v248, v106
 v_mfma_f32_32x32x16_bf16 v[112:127], v[156:159], v[68:71], v[112:127]
 ds_read_b64_tr_b16 v[188:189], v225 offset:24576
 ds_read_b64_tr_b16 v[190:191], v225 offset:26624
 v_add_f32 v230, v230, v246
 v_exp_f32 v249, v107
 v_add_f32 v231, v231, v247
 v_mfma_f32_32x32x16_bf16 v[112:127], v[160:163], v[72:75], v[112:127]
 ds_read_b64_tr_b16 v[192:193], v226 offset:24576
 ds_read_b64_tr_b16 v[194:195], v226 offset:26624
 v_cvt_pk_bf16_f32 v148, v246, v247
 v_exp_f32 v244, v108
 v_add_f32 v230, v230, v248
 v_mfma_f32_32x32x16_bf16 v[112:127], v[164:167], v[76:79], v[112:127]
 ds_read_b64_tr_b16 v[196:197], v227 offset:24576
 ds_read_b64_tr_b16 v[198:199], v227 offset:26624
 v_exp_f32 v245, v109
 v_add_f32 v231, v231, v249
 v_cvt_pk_bf16_f32 v149, v248, v249
 v_mfma_f32_32x32x16_bf16 v[112:127], v[168:171], v[80:83], v[112:127]
 ds_read_b64_tr_b16 v[200:201], v224 offset:28672
 ds_read_b64_tr_b16 v[202:203], v224 offset:30720
 v_exp_f32 v246, v110
 v_add_f32 v230, v230, v244
 v_exp_f32 v247, v111
 v_mfma_f32_32x32x16_bf16 v[112:127], v[172:175], v[84:87], v[112:127]
 ds_read_b64_tr_b16 v[204:205], v225 offset:28672
 ds_read_b64_tr_b16 v[206:207], v225 offset:30720
 v_add_f32 v231, v231, v245
 v_cvt_pk_bf16_f32 v150, v244, v245
 v_add_f32 v230, v230, v246
 v_mfma_f32_32x32x16_bf16 v[112:127], v[176:179], v[88:91], v[112:127]
 ds_read_b64_tr_b16 v[208:209], v226 offset:28672
 ds_read_b64_tr_b16 v[210:211], v226 offset:30720
 v_add_f32 v231, v231, v247
 v_cvt_pk_bf16_f32 v151, v246, v247
 v_add_f32 v230, v230, v231
 v_mfma_f32_32x32x16_bf16 v[112:127], v[180:183], v[92:95], v[112:127]
 v_cmp_nge_f32 vcc, s54, v230
 s_waitcnt lgkmcnt(6)
 s_cbranch_vccnz K_rare_9
K_back_10:
 v_mfma_f32_32x32x16_bf16 v[0:15], v[184:187], v[144:147], v[0:15]
 ds_read_b64_tr_b16 v[212:213], v227 offset:28672
 ds_read_b64_tr_b16 v[214:215], v227 offset:30720
 v_add_f32 v228, v228, v230
 v_mfma_f32_32x32x16_bf16 v[16:31], v[188:191], v[144:147], v[16:31]
 ds_read_b128 v[152:155], v216 offset:49152
 ds_read_b128 v[156:159], v217 offset:49152
 v_mfma_f32_32x32x16_bf16 v[32:47], v[192:195], v[144:147], v[32:47]
 ds_read_b128 v[160:163], v218 offset:49152
 ds_read_b128 v[164:167], v219 offset:49152
 v_exp_f32 v244, v112
 v_exp_f32 v245, v113
 v_exp_f32 v246, v114
 v_mfma_f32_32x32x16_bf16 v[48:63], v[196:199], v[144:147], v[48:63]
 ds_read_b128 v[168:171], v220 offset:49152
 v_exp_f32 v247, v115
 v_add_f32 v230, v244, v245
 v_cvt_pk_bf16_f32 v232, v244, v245
 s_waitcnt lgkmcnt(5)
 v_mfma_f32_32x32x16_bf16 v[0:15], v[200:203], v[148:151], v[0:15]
 ds_read_b128 v[172:175], v221 offset:49152
 v_exp_f32 v248, v116
 v_add_f32 v231, v246, v247
 v_exp_f32 v249, v117
 v_mfma_f32_32x32x16_bf16 v[16:31], v[204:207], v[148:151], v[16:31]
 ds_read_b128 v[176:179], v222 offset:49152
 v_cvt_pk_bf16_f32 v233, v246, v247
 v_exp_f32 v244, v118
 v_add_f32 v230, v230, v248
 v_mfma_f32_32x32x16_bf16 v[32:47], v[208:211], v[148:151], v[32:47]
 ds_read_b128 v[180:183], v223 offset:49152
 v_exp_f32 v245, v119
 v_add_f32 v231, v231, v249
 v_cvt_pk_bf16_f32 v234, v248, v249
 v_mfma_f32_32x32x16_bf16 v[48:63], v[212:215], v[148:151], v[48:63]
 v_exp_f32 v246, v120
 v_add_f32 v230, v230, v244
 v_exp_f32 v247, v121
 s_waitcnt lgkmcnt(0)
 s_barrier
 v_mfma_f32_32x32x16_bf16 v[96:111], v[152:155], v[64:67], v[128:143]
 ds_read_b64_tr_b16 v[184:185], v224 offset:16384
 ds_read_b64_tr_b16 v[186:187], v224 offset:18432
 v_add_f32 v231, v231, v245
 v_cvt_pk_bf16_f32 v235, v244, v245
 v_exp_f32 v248, v122
 v_mfma_f32_32x32x16_bf16 v[96:111], v[156:159], v[68:71], v[96:111]
 ds_read_b64_tr_b16 v[188:189], v225 offset:16384
 ds_read_b64_tr_b16 v[190:191], v225 offset:18432
 v_add_f32 v230, v230, v246
 v_exp_f32 v249, v123
 v_add_f32 v231, v231, v247
 v_mfma_f32_32x32x16_bf16 v[96:111], v[160:163], v[72:75], v[96:111]
 ds_read_b64_tr_b16 v[192:193], v226 offset:16384
 ds_read_b64_tr_b16 v[194:195], v226 offset:18432
 v_cvt_pk_bf16_f32 v236, v246, v247
 v_exp_f32 v244, v124
 v_add_f32 v230, v230, v248
 v_mfma_f32_32x32x16_bf16 v[96:111], v[164:167], v[76:79], v[96:111]
 ds_read_b64_tr_b16 v[196:197], v227 offset:16384
 ds_read_b64_tr_b16 v[198:199], v227 offset:18432
 v_exp_f32 v245, v125
 v_add_f32 v231, v231, v249
 v_cvt_pk_bf16_f32 v237, v248, v249
 v_mfma_f32_32x32x16_bf16 v[96:111], v[168:171], v[80:83], v[96:111]
 ds_read_b64_tr_b16 v[200:201], v224 offset:20480
 ds_read_b64_tr_b16 v[202:203], v224 offset:22528
 v_exp_f32 v246, v126
 v_add_f32 v230, v230, v244
 v_exp_f32 v247, v127
 v_mfma_f32_32x32x16_bf16 v[96:111], v[172:175], v[84:87], v[96:111]
 ds_read_b64_tr_b16 v[204:205], v225 offset:20480
 ds_read_b64_tr_b16 v[206:207], v225 offset:22528
 v_add_f32 v231, v231, v245
 v_cvt_pk_bf16_f32 v238, v244, v245
 v_add_f32 v230, v230, v246
 v_mfma_f32_32x32x16_bf16 v[96:111], v[176:179], v[88:91], v[96:111]
 ds_read_b64_tr_b16 v[208:209], v226 offset:20480
 ds_read_b64_tr_b16 v[210:211], v226 offset:22528
 v_add_f32 v231, v231, v247
 v_cvt_pk_bf16_f32 v239, v246, v247
 v_add_f32 v230, v230, v231
 v_mfma_f32_32x32x16_bf16 v[96:111], v[180:183], v[92:95], v[96:111]
 v_cmp_nge_f32 vcc, s54, v230
 s_waitcnt lgkmcnt(6)
 s_cbranch_vccnz K_rare_11
K_back_12:
 v_mfma_f32_32x32x16_bf16 v[0:15], v[184:187], v[232:235], v[0:15]
 ds_read_b64_tr_b16 v[212:213], v227 offset:20480
 ds_read_b64_tr_b16 v[214:215], v227 offset:22528
 v_add_f32 v228, v228, v230
 v_mfma_f32_32x32x16_bf16 v[16:31], v[188:191], v[232:235], v[16:31]
 ds_read_b128 v[152:155], v216 offset:0
 ds_read_b128 v[156:159], v217 offset:0
 v_mfma_f32_32x32x16_bf16 v[32:47], v[192:195], v[232:235], v[32:47]
 ds_read_b128 v[160:163], v218 offset:0
 ds_read_b128 v[164:167], v219 offset:0
 v_exp_f32 v244, v96
 v_exp_f32 v245, v97
 v_exp_f32 v246, v98
 v_mfma_f32_32x32x16_bf16 v[48:63], v[196:199], v[232:235], v[48:63]
 ds_read_b128 v[168:171], v220 offset:0
 v_exp_f32 v247, v99
 v_add_f32 v230, v244, v245
 v_cvt_pk_bf16_f32 v144, v244, v245
 s_waitcnt lgkmcnt(5)
 v_mfma_f32_32x32x16_bf16 v[0:15], v[200:203], v[236:239], v[0:15]
 ds_read_b128 v[172:175], v221 offset:0
 v_exp_f32 v248, v100
 v_add_f32 v231, v246, v247
 v_exp_f32 v249, v101
 v_mfma_f32_32x32x16_bf16 v[16:31], v[204:207], v[236:239], v[16:31]
 ds_read_b128 v[176:179], v222 offset:0
 v_cvt_pk_bf16_f32 v145, v246, v247
 v_exp_f32 v244, v102
 v_add_f32 v230, v230, v248
 v_mfma_f32_32x32x16_bf16 v[32:47], v[208:211], v[236:239], v[32:47]
 ds_read_b128 v[180:183], v223 offset:0
 v_exp_f32 v245, v103
 v_add_f32 v231, v231, v249
 v_cvt_pk_bf16_f32 v146, v248, v249
 v_mfma_f32_32x32x16_bf16 v[48:63], v[212:215], v[236:239], v[48:63]
 v_exp_f32 v246, v104
 v_add_f32 v230, v230, v244
 v_exp_f32 v247, v105
 s_waitcnt lgkmcnt(0)
 s_barrier
 v_mfma_f32_32x32x16_bf16 v[112:127], v[152:155], v[64:67], v[128:143]
 ds_read_b64_tr_b16 v[184:185], v224 offset:32768
 ds_read_b64_tr_b16 v[186:187], v224 offset:34816
 v_add_f32 v231, v231, v245
 v_cvt_pk_bf16_f32 v147, v244, v245
 v_exp_f32 v248, v106
 v_mfma_f32_32x32x16_bf16 v[112:127], v[156:159], v[68:71], v[112:127]
 ds_read_b64_tr_b16 v[188:189], v225 offset:32768
 ds_read_b64_tr_b16 v[190:191], v225 offset:34816
 v_add_f32 v230, v230, v246
 v_exp_f32 v249, v107
 v_add_f32 v231, v231, v247
 v_mfma_f32_32x32x16_bf16 v[112:127], v[160:163], v[72:75], v[112:127]
 ds_read_b64_tr_b16 v[192:193], v226 offset:32768
 ds_read_b64_tr_b16 v[194:195], v226 offset:34816
 v_cvt_pk_bf16_f32 v148, v246, v247
 v_exp_f32 v244, v108
 v_add_f32 v230, v230, v248
 v_mfma_f32_32x32x16_bf16 v[112:127], v[164:167], v[76:79], v[112:127]
 ds_read_b64_tr_b16 v[196:197], v227 offset:32768
 ds_read_b64_tr_b16 v[198:199], v227 offset:34816
 v_exp_f32 v245, v109
 v_add_f32 v231, v231, v249
 v_cvt_pk_bf16_f32 v149, v248, v249
 v_mfma_f32_32x32x16_bf16 v[112:127], v[168:171], v[80:83], v[112:127]
 ds_read_b64_tr_b16 v[200:201], v224 offset:36864
 ds_read_b64_tr_b16 v[202:203], v224 offset:38912
 v_exp_f32 v246, v110
 v_add_f32 v230, v230, v244
 v_exp_f32 v247, v111
 v_mfma_f32_32x32x16_bf16 v[112:127], v[172:175], v[84:87], v[112:127]
 ds_read_b64_tr_b16 v[204:205], v225 offset:36864
 ds_read_b64_tr_b16 v[206:207], v225 offset:38912
 v_add_f32 v231, v231, v245
 v_cvt_pk_bf16_f32 v150, v244, v245
 v_add_f32 v230, v230, v246
 v_mfma_f32_32x32x16_bf16 v[112:127], v[176:179], v[88:91], v[112:127]
 ds_read_b64_tr_b16 v[208:209], v226 offset:36864
 ds_read_b64_tr_b16 v[210:211], v226 offset:38912
 v_add_f32 v231, v231, v247
 v_cvt_pk_bf16_f32 v151, v246, v247
 v_add_f32 v230, v230, v231
 v_mfma_f32_32x32x16_bf16 v[112:127], v[180:183], v[92:95], v[112:127]
 v_cmp_nge_f32 vcc, s54, v230
 s_waitcnt lgkmcnt(6)
 s_cbranch_vccnz K_rare_13
K_back_14:
 v_mfma_f32_32x32x16_bf16 v[0:15], v[184:187], v[144:147], v[0:15]
 ds_read_b64_tr_b16 v[212:213], v227 offset:36864
 ds_read_b64_tr_b16 v[214:215], v227 offset:38912
 v_add_f32 v228, v228, v230
 v_mfma_f32_32x32x16_bf16 v[16:31], v[188:191], v[144:147], v[16:31]
 ds_read_b128 v[152:155], v216 offset:8192
 ds_read_b128 v[156:159], v217 offset:8192
 v_mfma_f32_32x32x16_bf16 v[32:47], v[192:195], v[144:147], v[32:47]
 ds_read_b128 v[160:163], v218 offset:8192
 ds_read_b128 v[164:167], v219 offset:8192
 v_exp_f32 v244, v112
 v_exp_f32 v245, v113
 v_exp_f32 v246, v114
 v_mfma_f32_32x32x16_bf16 v[48:63], v[196:199], v[144:147], v[48:63]
 ds_read_b128 v[168:171], v220 offset:8192
 v_exp_f32 v247, v115
 v_add_f32 v230, v244, v245
 v_cvt_pk_bf16_f32 v232, v244, v245
 s_waitcnt lgkmcnt(5)
 v_mfma_f32_32x32x16_bf16 v[0:15], v[200:203], v[148:151], v[0:15]
 ds_read_b128 v[172:175], v221 offset:8192
 v_exp_f32 v248, v116
 v_add_f32 v231, v246, v247
 v_exp_f32 v249, v117
 v_mfma_f32_32x32x16_bf16 v[16:31], v[204:207], v[148:151], v[16:31]
 ds_read_b128 v[176:179], v222 offset:8192
 v_cvt_pk_bf16_f32 v233, v246, v247
 v_exp_f32 v244, v118
 v_add_f32 v230, v230, v248
 v_mfma_f32_32x32x16_bf16 v[32:47], v[208:211], v[148:151], v[32:47]
 ds_read_b128 v[180:183], v223 offset:8192
 v_exp_f32 v245, v119
 v_add_f32 v231, v231, v249
 v_cvt_pk_bf16_f32 v234, v248, v249
 v_mfma_f32_32x32x16_bf16 v[48:63], v[212:215], v[148:151], v[48:63]
 v_exp_f32 v246, v120
 v_add_f32 v230, v230, v244
 v_exp_f32 v247, v121
 s_waitcnt lgkmcnt(0)
 s_barrier
 v_mfma_f32_32x32x16_bf16 v[96:111], v[152:155], v[64:67], v[128:143]
 ds_read_b64_tr_b16 v[184:185], v224 offset:40960
 ds_read_b64_tr_b16 v[186:187], v224 offset:43008
 v_add_f32 v231, v231, v245
 v_cvt_pk_bf16_f32 v235, v244, v245
 v_exp_f32 v248, v122
 v_mfma_f32_32x32x16_bf16 v[96:111], v[156:159], v[68:71], v[96:111]
 ds_read_b64_tr_b16 v[188:189], v225 offset:40960
 ds_read_b64_tr_b16 v[190:191], v225 offset:43008
 v_add_f32 v230, v230, v246
 v_exp_f32 v249, v123
 v_add_f32 v231, v231, v247
 v_mfma_f32_32x32x16_bf16 v[96:111], v[160:163], v[72:75], v[96:111]
 ds_read_b64_tr_b16 v[192:193], v226 offset:40960
 ds_read_b64_tr_b16 v[194:195], v226 offset:43008
 v_cvt_pk_bf16_f32 v236, v246, v247
 v_exp_f32 v244, v124
 v_add_f32 v230, v230, v248
 v_mfma_f32_32x32x16_bf16 v[96:111], v[164:167], v[76:79], v[96:111]
 ds_read_b64_tr_b16 v[196:197], v227 offset:40960
 ds_read_b64_tr_b16 v[198:199], v227 offset:43008
 v_exp_f32 v245, v125
 v_add_f32 v231, v231, v249
 v_cvt_pk_bf16_f32 v237, v248, v249
 v_mfma_f32_32x32x16_bf16 v[96:111], v[168:171], v[80:83], v[96:111]
 ds_read_b64_tr_b16 v[200:201], v224 offset:45056
 ds_read_b64_tr_b16 v[202:203], v224 offset:47104
 v_exp_f32 v246, v126
 v_add_f32 v230, v230, v244
 v_exp_f32 v247, v127
 v_mfma_f32_32x32x16_bf16 v[96:111], v[172:175], v[84:87], v[96:111]
 ds_read_b64_tr_b16 v[204:205], v225 offset:45056
 ds_read_b64_tr_b16 v[206:207], v225 offset:47104
 v_add_f32 v231, v231, v245
 v_cvt_pk_bf16_f32 v238, v244, v245
 v_add_f32 v230, v230, v246
 v_mfma_f32_32x32x16_bf16 v[96:111], v[176:179], v[88:91], v[96:111]
 ds_read_b64_tr_b16 v[208:209], v226 offset:45056
 ds_read_b64_tr_b16 v[210:211], v226 offset:47104
 v_add_f32 v231, v231, v247
 v_cvt_pk_bf16_f32 v239, v246, v247
 v_add_f32 v230, v230, v231
 v_mfma_f32_32x32x16_bf16 v[96:111], v[180:183], v[92:95], v[96:111]
 v_cmp_nge_f32 vcc, s54, v230
 s_waitcnt lgkmcnt(6)
 s_cbranch_vccnz K_rare_15
K_back_16:
 v_mfma_f32_32x32x16_bf16 v[0:15], v[184:187], v[232:235], v[0:15]
 ds_read_b64_tr_b16 v[212:213], v227 offset:45056
 ds_read_b64_tr_b16 v[214:215], v227 offset:47104
 v_add_f32 v228, v228, v230
 v_mfma_f32_32x32x16_bf16 v[16:31], v[188:191], v[232:235], v[16:31]
 ds_read_b128 v[152:155], v216 offset:16384
 ds_read_b128 v[156:159], v217 offset:16384
 v_mfma_f32_32x32x16_bf16 v[32:47], v[192:195], v[232:235], v[32:47]
 ds_read_b128 v[160:163], v218 offset:16384
 ds_read_b128 v[164:167], v219 offset:16384
 v_exp_f32 v244, v96
 v_exp_f32 v245, v97
 v_exp_f32 v246, v98
 v_mfma_f32_32x32x16_bf16 v[48:63], v[196:199], v[232:235], v[48:63]
 ds_read_b128 v[168:171], v220 offset:16384
 v_exp_f32 v247, v99
 v_add_f32 v230, v244, v245
 v_cvt_pk_bf16_f32 v144, v244, v245
 s_waitcnt lgkmcnt(5)
 v_mfma_f32_32x32x16_bf16 v[0:15], v[200:203], v[236:239], v[0:15]
 ds_read_b128 v[172:175], v221 offset:16384
 v_exp_f32 v248, v100
 v_add_f32 v231, v246, v247
 v_exp_f32 v249, v101
 v_mfma_f32_32x32x16_bf16 v[16:31], v[204:207], v[236:239], v[16:31]
 ds_read_b128 v[176:179], v222 offset:16384
 v_cvt_pk_bf16_f32 v145, v246, v247
 v_exp_f32 v244, v102
 v_add_f32 v230, v230, v248
 v_mfma_f32_32x32x16_bf16 v[32:47], v[208:211], v[236:239], v[32:47]
 ds_read_b128 v[180:183], v223 offset:16384
 v_exp_f32 v245, v103
 v_add_f32 v231, v231, v249
 v_cvt_pk_bf16_f32 v146, v248, v249
 v_mfma_f32_32x32x16_bf16 v[48:63], v[212:215], v[236:239], v[48:63]
 v_exp_f32 v246, v104
 v_add_f32 v230, v230, v244
 v_exp_f32 v247, v105
 s_waitcnt lgkmcnt(0)
 s_barrier
 v_mfma_f32_32x32x16_bf16 v[112:127], v[152:155], v[64:67], v[128:143]
 ds_read_b64_tr_b16 v[184:185], v224 offset:49152
 ds_read_b64_tr_b16 v[186:187], v224 offset:51200
 v_add_f32 v231, v231, v245
 v_cvt_pk_bf16_f32 v147, v244, v245
 v_exp_f32 v248, v106
 v_mfma_f32_32x32x16_bf16 v[112:127], v[156:159], v[68:71], v[112:127]
 ds_read_b64_tr_b16 v[188:189], v225 offset:49152
 ds_read_b64_tr_b16 v[190:191], v225 offset:51200
 v_add_f32 v230, v230, v246
 v_exp_f32 v249, v107
 v_add_f32 v231, v231, v247
 v_mfma_f32_32x32x16_bf16 v[112:127], v[160:163], v[72:75], v[112:127]
 ds_read_b64_tr_b16 v[192:193], v226 offset:49152
 ds_read_b64_tr_b16 v[194:195], v226 offset:51200
 v_cvt_pk_bf16_f32 v148, v246, v247
 v_exp_f32 v244, v108
 v_add_f32 v230, v230, v248
 v_mfma_f32_32x32x16_bf16 v[112:127], v[164:167], v[76:79], v[112:127]
 ds_read_b64_tr_b16 v[196:197], v227 offset:49152
 ds_read_b64_tr_b16 v[198:199], v227 offset:51200
 v_exp_f32 v245, v109
 v_add_f32 v231, v231, v249
 v_cvt_pk_bf16_f32 v149, v248, v249
 v_mfma_f32_32x32x16_bf16 v[112:127], v[168:171], v[80:83], v[112:127]
 ds_read_b64_tr_b16 v[200:201], v224 offset:53248
 ds_read_b64_tr_b16 v[202:203], v224 offset:55296
 v_exp_f32 v246, v110
 v_add_f32 v230, v230, v244
 v_exp_f32 v247, v111
 v_mfma_f32_32x32x16_bf16 v[112:127], v[172:175], v[84:87], v[112:127]
 ds_read_b64_tr_b16 v[204:205], v225 offset:53248
 ds_read_b64_tr_b16 v[206:207], v225 offset:55296
 v_add_f32 v231, v231, v245
 v_cvt_pk_bf16_f32 v150, v244, v245
 v_add_f32 v230, v230, v246
 v_mfma_f32_32x32x16_bf16 v[112:127], v[176:179], v[88:91], v[112:127]
 ds_read_b64_tr_b16 v[208:209], v226 offset:53248
 ds_read_b64_tr_b16 v[210:211], v226 offset:55296
 v_add_f32 v231, v231, v247
 v_cvt_pk_bf16_f32 v151, v246, v247
 v_add_f32 v230, v230, v231
 v_mfma_f32_32x32x16_bf16 v[112:127], v[180:183], v[92:95], v[112:127]
 v_cmp_nge_f32 vcc, s54, v230
 s_waitcnt lgkmcnt(6)
 s_cbranch_vccnz K_rare_17
K_back_18:
 v_mfma_f32_32x32x16_bf16 v[0:15], v[184:187], v[144:147], v[0:15]
 ds_read_b64_tr_b16 v[212:213], v227 offset:53248
 ds_read_b64_tr_b16 v[214:215], v227 offset:55296
 v_add_f32 v228, v228, v230
 v_mfma_f32_32x32x16_bf16 v[16:31], v[188:191], v[144:147], v[16:31]
 ds_read_b128 v[152:155], v216 offset:24576
 ds_read_b128 v[156:159], v217 offset:24576
 v_mfma_f32_32x32x16_bf16 v[32:47], v[192:195], v[144:147], v[32:47]
 ds_read_b128 v[160:163], v218 offset:24576
 ds_read_b128 v[164:167], v219 offset:24576
 v_exp_f32 v244, v112
 v_exp_f32 v245, v113
 v_exp_f32 v246, v114
 v_mfma_f32_32x32x16_bf16 v[48:63], v[196:199], v[144:147], v[48:63]
 ds_read_b128 v[168:171], v220 offset:24576
 v_exp_f32 v247, v115
 v_add_f32 v230, v244, v245
 v_cvt_pk_bf16_f32 v232, v244, v245
 s_waitcnt lgkmcnt(5)
 v_mfma_f32_32x32x16_bf16 v[0:15], v[200:203], v[148:151], v[0:15]
 ds_read_b128 v[172:175], v221 offset:24576
 v_exp_f32 v248, v116
 v_add_f32 v231, v246, v247
 v_exp_f32 v249, v117
 v_mfma_f32_32x32x16_bf16 v[16:31], v[204:207], v[148:151], v[16:31]
 ds_read_b128 v[176:179], v222 offset:24576
 v_cvt_pk_bf16_f32 v233, v246, v247
 v_exp_f32 v244, v118
 v_add_f32 v230, v230, v248
 v_mfma_f32_32x32x16_bf16 v[32:47], v[208:211], v[148:151], v[32:47]
 ds_read_b128 v[180:183], v223 offset:24576
 v_exp_f32 v245, v119
 v_add_f32 v231, v231, v249
 v_cvt_pk_bf16_f32 v234, v248, v249
 v_mfma_f32_32x32x16_bf16 v[48:63], v[212:215], v[148:151], v[48:63]
 v_exp_f32 v246, v120
 v_add_f32 v230, v230, v244
 v_exp_f32 v247, v121
 s_waitcnt lgkmcnt(0)
 s_barrier
 v_mfma_f32_32x32x16_bf16 v[96:111], v[152:155], v[64:67], v[128:143]
 ds_read_b64_tr_b16 v[184:185], v224 offset:57344
 ds_read_b64_tr_b16 v[186:187], v224 offset:59392
 v_add_f32 v231, v231, v245
 v_cvt_pk_bf16_f32 v235, v244, v245
 v_exp_f32 v248, v122
 v_mfma_f32_32x32x16_bf16 v[96:111], v[156:159], v[68:71], v[96:111]
 ds_read_b64_tr_b16 v[188:189], v225 offset:57344
 ds_read_b64_tr_b16 v[190:191], v225 offset:59392
 v_add_f32 v230, v230, v246
 v_exp_f32 v249, v123
 v_add_f32 v231, v231, v247
 v_mfma_f32_32x32x16_bf16 v[96:111], v[160:163], v[72:75], v[96:111]
 ds_read_b64_tr_b16 v[192:193], v226 offset:57344
 ds_read_b64_tr_b16 v[194:195], v226 offset:59392
 v_cvt_pk_bf16_f32 v236, v246, v247
 v_exp_f32 v244, v124
 v_add_f32 v230, v230, v248
 v_mfma_f32_32x32x16_bf16 v[96:111], v[164:167], v[76:79], v[96:111]
 ds_read_b64_tr_b16 v[196:197], v227 offset:57344
 ds_read_b64_tr_b16 v[198:199], v227 offset:59392
 v_exp_f32 v245, v125
 v_add_f32 v231, v231, v249
 v_cvt_pk_bf16_f32 v237, v248, v249
 v_mfma_f32_32x32x16_bf16 v[96:111], v[168:171], v[80:83], v[96:111]
 ds_read_b64_tr_b16 v[200:201], v224 offset:61440
 ds_read_b64_tr_b16 v[202:203], v224 offset:63488
 v_exp_f32 v246, v126
 v_add_f32 v230, v230, v244
 v_exp_f32 v247, v127
 v_mfma_f32_32x32x16_bf16 v[96:111], v[172:175], v[84:87], v[96:111]
 ds_read_b64_tr_b16 v[204:205], v225 offset:61440
 ds_read_b64_tr_b16 v[206:207], v225 offset:63488
 v_add_f32 v231, v231, v245
 v_cvt_pk_bf16_f32 v238, v244, v245
 v_add_f32 v230, v230, v246
 v_mfma_f32_32x32x16_bf16 v[96:111], v[176:179], v[88:91], v[96:111]
 ds_read_b64_tr_b16 v[208:209], v226 offset:61440
 ds_read_b64_tr_b16 v[210:211], v226 offset:63488
 v_add_f32 v231, v231, v247
 v_cvt_pk_bf16_f32 v239, v246, v247
 v_add_f32 v230, v230, v231
 v_mfma_f32_32x32x16_bf16 v[96:111], v[180:183], v[92:95], v[96:111]
 v_cmp_nge_f32 vcc, s54, v230
 s_waitcnt lgkmcnt(6)
 s_cbranch_vccnz K_rare_19
K_back_20:
 v_mfma_f32_32x32x16_bf16 v[0:15], v[184:187], v[232:235], v[0:15]
 ds_read_b64_tr_b16 v[212:213], v227 offset:61440
 ds_read_b64_tr_b16 v[214:215], v227 offset:63488
 v_add_f32 v228, v228, v230
 v_mfma_f32_32x32x16_bf16 v[16:31], v[188:191], v[232:235], v[16:31]
 ds_read_b128 v[152:155], v216 offset:32768
 ds_read_b128 v[156:159], v217 offset:32768
 v_mfma_f32_32x32x16_bf16 v[32:47], v[192:195], v[232:235], v[32:47]
 ds_read_b128 v[160:163], v218 offset:32768
 ds_read_b128 v[164:167], v219 offset:32768
 v_exp_f32 v244, v96
 v_exp_f32 v245, v97
 v_exp_f32 v246, v98
 v_mfma_f32_32x32x16_bf16 v[48:63], v[196:199], v[232:235], v[48:63]
 ds_read_b128 v[168:171], v220 offset:32768
 v_exp_f32 v247, v99
 v_add_f32 v230, v244, v245
 v_cvt_pk_bf16_f32 v144, v244, v245
 s_waitcnt lgkmcnt(5)
 v_mfma_f32_32x32x16_bf16 v[0:15], v[200:203], v[236:239], v[0:15]
 ds_read_b128 v[172:175], v221 offset:32768
 v_exp_f32 v248, v100
 v_add_f32 v231, v246, v247
 v_exp_f32 v249, v101
 v_mfma_f32_32x32x16_bf16 v[16:31], v[204:207], v[236:239], v[16:31]
 ds_read_b128 v[176:179], v222 offset:32768
 v_cvt_pk_bf16_f32 v145, v246, v247
 v_exp_f32 v244, v102
 v_add_f32 v230, v230, v248
 v_mfma_f32_32x32x16_bf16 v[32:47], v[208:211], v[236:239], v[32:47]
 ds_read_b128 v[180:183], v223 offset:32768
 v_exp_f32 v245, v103
 v_add_f32 v231, v231, v249
 v_cvt_pk_bf16_f32 v146, v248, v249
 v_mfma_f32_32x32x16_bf16 v[48:63], v[212:215], v[236:239], v[48:63]
 v_exp_f32 v246, v104
 v_add_f32 v230, v230, v244
 v_exp_f32 v247, v105
 s_waitcnt lgkmcnt(0)
 s_barrier
 v_mfma_f32_32x32x16_bf16 v[112:127], v[152:155], v[64:67], v[128:143]
 ds_read_b64_tr_b16 v[184:185], v224 offset:24576
 ds_read_b64_tr_b16 v[186:187], v224 offset:26624
 v_add_f32 v231, v231, v245
 v_cvt_pk_bf16_f32 v147, v244, v245
 v_exp_f32 v248, v106
 v_mfma_f32_32x32x16_bf16 v[112:127], v[156:159], v[68:71], v[112:127]
 ds_read_b64_tr_b16 v[188:189], v225 offset:24576
 ds_read_b64_tr_b16 v[190:191], v225 offset:26624
 v_add_f32 v230, v230, v246
 v_exp_f32 v249, v107
 v_add_f32 v231, v231, v247
 v_mfma_f32_32x32x16_bf16 v[112:127], v[160:163], v[72:75], v[112:127]
 ds_read_b64_tr_b16 v[192:193], v226 offset:24576
 ds_read_b64_tr_b16 v[194:195], v226 offset:26624
 v_cvt_pk_bf16_f32 v148, v246, v247
 v_exp_f32 v244, v108
 v_add_f32 v230, v230, v248
 v_mfma_f32_32x32x16_bf16 v[112:127], v[164:167], v[76:79], v[112:127]
 ds_read_b64_tr_b16 v[196:197], v227 offset:24576
 ds_read_b64_tr_b16 v[198:199], v227 offset:26624
 v_exp_f32 v245, v109
 v_add_f32 v231, v231, v249
 v_cvt_pk_bf16_f32 v149, v248, v249
 v_mfma_f32_32x32x16_bf16 v[112:127], v[168:171], v[80:83], v[112:127]
 ds_read_b64_tr_b16 v[200:201], v224 offset:28672
 ds_read_b64_tr_b16 v[202:203], v224 offset:30720
 v_exp_f32 v246, v110
 v_add_f32 v230, v230, v244
 v_exp_f32 v247, v111
 v_mfma_f32_32x32x16_bf16 v[112:127], v[172:175], v[84:87], v[112:127]
 ds_read_b64_tr_b16 v[204:205], v225 offset:28672
 ds_read_b64_tr_b16 v[206:207], v225 offset:30720
 v_add_f32 v231, v231, v245
 v_cvt_pk_bf16_f32 v150, v244, v245
 v_add_f32 v230, v230, v246
 v_mfma_f32_32x32x16_bf16 v[112:127], v[176:179], v[88:91], v[112:127]
 ds_read_b64_tr_b16 v[208:209], v226 offset:28672
 ds_read_b64_tr_b16 v[210:211], v226 offset:30720
 v_add_f32 v231, v231, v247
 v_cvt_pk_bf16_f32 v151, v246, v247
 v_add_f32 v230, v230, v231
 v_mfma_f32_32x32x16_bf16 v[112:127], v[180:183], v[92:95], v[112:127]
 v_cmp_nge_f32 vcc, s54, v230
 s_waitcnt lgkmcnt(6)
 s_cbranch_vccnz K_rare_21
K_back_22:
 v_mfma_f32_32x32x16_bf16 v[0:15], v[184:187], v[144:147], v[0:15]
 ds_read_b64_tr_b16 v[212:213], v227 offset:28672
 ds_read_b64_tr_b16 v[214:215], v227 offset:30720
 v_add_f32 v228, v228, v230
 v_mfma_f32_32x32x16_bf16 v[16:31], v[188:191], v[144:147], v[16:31]
 ds_read_b128 v[152:155], v216 offset:40960
 ds_read_b128 v[156:159], v217 offset:40960
 v_mfma_f32_32x32x16_bf16 v[32:47], v[192:195], v[144:147], v[32:47]
 ds_read_b128 v[160:163], v218 offset:40960
 ds_read_b128 v[164:167], v219 offset:40960
 v_exp_f32 v244, v112
 v_exp_f32 v245, v113
 v_exp_f32 v246, v114
 v_mfma_f32_32x32x16_bf16 v[48:63], v[196:199], v[144:147], v[48:63]
 ds_read_b128 v[168:171], v220 offset:40960
 v_exp_f32 v247, v115
 v_add_f32 v230, v244, v245
 v_cvt_pk_bf16_f32 v232, v244, v245
 s_waitcnt lgkmcnt(5)
 v_mfma_f32_32x32x16_bf16 v[0:15], v[200:203], v[148:151], v[0:15]
 ds_read_b128 v[172:175], v221 offset:40960
 v_exp_f32 v248, v116
 v_add_f32 v231, v246, v247
 v_exp_f32 v249, v117
 v_mfma_f32_32x32x16_bf16 v[16:31], v[204:207], v[148:151], v[16:31]
 ds_read_b128 v[176:179], v222 offset:40960
 v_cvt_pk_bf16_f32 v233, v246, v247
 v_exp_f32 v244, v118
 v_add_f32 v230, v230, v248
 v_mfma_f32_32x32x16_bf16 v[32:47], v[208:211], v[148:151], v[32:47]
 ds_read_b128 v[180:183], v223 offset:40960
 v_exp_f32 v245, v119
 v_add_f32 v231, v231, v249
 v_cvt_pk_bf16_f32 v234, v248, v249
 v_mfma_f32_32x32x16_bf16 v[48:63], v[212:215], v[148:151], v[48:63]
 v_exp_f32 v246, v120
 v_add_f32 v230, v230, v244
 v_exp_f32 v247, v121
 s_waitcnt lgkmcnt(0)
 s_barrier
 v_mfma_f32_32x32x16_bf16 v[96:111], v[152:155], v[64:67], v[128:143]
 ds_read_b64_tr_b16 v[184:185], v224 offset:16384
 ds_read_b64_tr_b16 v[186:187], v224 offset:18432
 v_add_f32 v231, v231, v245
 v_cvt_pk_bf16_f32 v235, v244, v245
 v_exp_f32 v248, v122
 v_mfma_f32_32x32x16_bf16 v[96:111], v[156:159], v[68:71], v[96:111]
 ds_read_b64_tr_b16 v[188:189], v225 offset:16384
 ds_read_b64_tr_b16 v[190:191], v225 offset:18432
 v_add_f32 v230, v230, v246
 v_exp_f32 v249, v123
 v_add_f32 v231, v231, v247
 v_mfma_f32_32x32x16_bf16 v[96:111], v[160:163], v[72:75], v[96:111]
 ds_read_b64_tr_b16 v[192:193], v226 offset:16384
 ds_read_b64_tr_b16 v[194:195], v226 offset:18432
 v_cvt_pk_bf16_f32 v236, v246, v247
 v_exp_f32 v244, v124
 v_add_f32 v230, v230, v248
 v_mfma_f32_32x32x16_bf16 v[96:111], v[164:167], v[76:79], v[96:111]
 ds_read_b64_tr_b16 v[196:197], v227 offset:16384
 ds_read_b64_tr_b16 v[198:199], v227 offset:18432
 v_exp_f32 v245, v125
 v_add_f32 v231, v231, v249
 v_cvt_pk_bf16_f32 v237, v248, v249
 v_mfma_f32_32x32x16_bf16 v[96:111], v[168:171], v[80:83], v[96:111]
 ds_read_b64_tr_b16 v[200:201], v224 offset:20480
 ds_read_b64_tr_b16 v[202:203], v224 offset:22528
 v_exp_f32 v246, v126
 v_add_f32 v230, v230, v244
 v_exp_f32 v247, v127
 v_mfma_f32_32x32x16_bf16 v[96:111], v[172:175], v[84:87], v[96:111]
 ds_read_b64_tr_b16 v[204:205], v225 offset:20480
 ds_read_b64_tr_b16 v[206:207], v225 offset:22528
 v_add_f32 v231, v231, v245
 v_cvt_pk_bf16_f32 v238, v244, v245
 v_add_f32 v230, v230, v246
 v_mfma_f32_32x32x16_bf16 v[96:111], v[176:179], v[88:91], v[96:111]
 ds_read_b64_tr_b16 v[208:209], v226 offset:20480
 ds_read_b64_tr_b16 v[210:211], v226 offset:22528
 v_add_f32 v231, v231, v247
 v_cvt_pk_bf16_f32 v239, v246, v247
 v_add_f32 v230, v230, v231
 v_mfma_f32_32x32x16_bf16 v[96:111], v[180:183], v[92:95], v[96:111]
 v_cmp_nge_f32 vcc, s54, v230
 s_waitcnt lgkmcnt(6)
 s_cbranch_vccnz K_rare_23
K_back_24:
 v_mfma_f32_32x32x16_bf16 v[0:15], v[184:187], v[232:235], v[0:15]
 ds_read_b64_tr_b16 v[212:213], v227 offset:20480
 ds_read_b64_tr_b16 v[214:215], v227 offset:22528
 v_add_f32 v228, v228, v230
 v_mfma_f32_32x32x16_bf16 v[16:31], v[188:191], v[232:235], v[16:31]
 ds_read_b128 v[152:155], v216 offset:0
 ds_read_b128 v[156:159], v217 offset:0
 v_mfma_f32_32x32x16_bf16 v[32:47], v[192:195], v[232:235], v[32:47]
 ds_read_b128 v[160:163], v218 offset:0
 ds_read_b128 v[164:167], v219 offset:0
 v_exp_f32 v244, v96
 v_exp_f32 v245, v97
 v_exp_f32 v246, v98
 v_mfma_f32_32x32x16_bf16 v[48:63], v[196:199], v[232:235], v[48:63]
 ds_read_b128 v[168:171], v220 offset:0
 v_exp_f32 v247, v99
 v_add_f32 v230, v244, v245
 v_cvt_pk_bf16_f32 v144, v244, v245
 s_waitcnt lgkmcnt(5)
 v_mfma_f32_32x32x16_bf16 v[0:15], v[200:203], v[236:239], v[0:15]
 ds_read_b128 v[172:175], v221 offset:0
 v_exp_f32 v248, v100
 v_add_f32 v231, v246, v247
 v_exp_f32 v249, v101
 v_mfma_f32_32x32x16_bf16 v[16:31], v[204:207], v[236:239], v[16:31]
 ds_read_b128 v[176:179], v222 offset:0
 v_cvt_pk_bf16_f32 v145, v246, v247
 v_exp_f32 v244, v102
 v_add_f32 v230, v230, v248
 v_mfma_f32_32x32x16_bf16 v[32:47], v[208:211], v[236:239], v[32:47]
 ds_read_b128 v[180:183], v223 offset:0
 v_exp_f32 v245, v103
 v_add_f32 v231, v231, v249
 v_cvt_pk_bf16_f32 v146, v248, v249
 v_mfma_f32_32x32x16_bf16 v[48:63], v[212:215], v[236:239], v[48:63]
 v_exp_f32 v246, v104
 v_add_f32 v230, v230, v244
 v_exp_f32 v247, v105
 s_waitcnt lgkmcnt(0)
 s_barrier
 v_mfma_f32_32x32x16_bf16 v[112:127], v[152:155], v[64:67], v[128:143]
 ds_read_b64_tr_b16 v[184:185], v224 offset:32768
 ds_read_b64_tr_b16 v[186:187], v224 offset:34816
 v_add_f32 v231, v231, v245
 v_cvt_pk_bf16_f32 v147, v244, v245
 v_exp_f32 v248, v106
 v_mfma_f32_32x32x16_bf16 v[112:127], v[156:159], v[68:71], v[112:127]
 ds_read_b64_tr_b16 v[188:189], v225 offset:32768
 ds_read_b64_tr_b16 v[190:191], v225 offset:34816
 v_add_f32 v230, v230, v246
 v_exp_f32 v249, v107
 v_add_f32 v231, v231, v247
 v_mfma_f32_32x32x16_bf16 v[112:127], v[160:163], v[72:75], v[112:127]
 ds_read_b64_tr_b16 v[192:193], v226 offset:32768
 ds_read_b64_tr_b16 v[194:195], v226 offset:34816
 v_cvt_pk_bf16_f32 v148, v246, v247
 v_exp_f32 v244, v108
 v_add_f32 v230, v230, v248
 v_mfma_f32_32x32x16_bf16 v[112:127], v[164:167], v[76:79], v[112:127]
 ds_read_b64_tr_b16 v[196:197], v227 offset:32768
 ds_read_b64_tr_b16 v[198:199], v227 offset:34816
 v_exp_f32 v245, v109
 v_add_f32 v231, v231, v249
 v_cvt_pk_bf16_f32 v149, v248, v249
 v_mfma_f32_32x32x16_bf16 v[112:127], v[168:171], v[80:83], v[112:127]
 ds_read_b64_tr_b16 v[200:201], v224 offset:36864
 ds_read_b64_tr_b16 v[202:203], v224 offset:38912
 v_exp_f32 v246, v110
 v_add_f32 v230, v230, v244
 v_exp_f32 v247, v111
 v_mfma_f32_32x32x16_bf16 v[112:127], v[172:175], v[84:87], v[112:127]
 ds_read_b64_tr_b16 v[204:205], v225 offset:36864
 ds_read_b64_tr_b16 v[206:207], v225 offset:38912
 v_add_f32 v231, v231, v245
 v_cvt_pk_bf16_f32 v150, v244, v245
 v_add_f32 v230, v230, v246
 v_mfma_f32_32x32x16_bf16 v[112:127], v[176:179], v[88:91], v[112:127]
 ds_read_b64_tr_b16 v[208:209], v226 offset:36864
 ds_read_b64_tr_b16 v[210:211], v226 offset:38912
 v_add_f32 v231, v231, v247
 v_cvt_pk_bf16_f32 v151, v246, v247
 v_add_f32 v230, v230, v231
 v_mfma_f32_32x32x16_bf16 v[112:127], v[180:183], v[92:95], v[112:127]
 v_cmp_nge_f32 vcc, s54, v230
 s_waitcnt lgkmcnt(6)
 s_cbranch_vccnz K_rare_25
K_back_26:
 v_mfma_f32_32x32x16_bf16 v[0:15], v[184:187], v[144:147], v[0:15]
 ds_read_b64_tr_b16 v[212:213], v227 offset:36864
 ds_read_b64_tr_b16 v[214:215], v227 offset:38912
 v_add_f32 v228, v228, v230
 v_mfma_f32_32x32x16_bf16 v[16:31], v[188:191], v[144:147], v[16:31]
 ds_read_b128 v[152:155], v216 offset:8192
 ds_read_b128 v[156:159], v217 offset:8192
 v_mfma_f32_32x32x16_bf16 v[32:47], v[192:195], v[144:147], v[32:47]
 ds_read_b128 v[160:163], v218 offset:8192
 ds_read_b128 v[164:167], v219 offset:8192
 v_exp_f32 v244, v112
 v_exp_f32 v245, v113
 v_exp_f32 v246, v114
 v_mfma_f32_32x32x16_bf16 v[48:63], v[196:199], v[144:147], v[48:63]
 ds_read_b128 v[168:171], v220 offset:8192
 v_exp_f32 v247, v115
 v_add_f32 v230, v244, v245
 v_cvt_pk_bf16_f32 v232, v244, v245
 s_waitcnt lgkmcnt(5)
 v_mfma_f32_32x32x16_bf16 v[0:15], v[200:203], v[148:151], v[0:15]
 ds_read_b128 v[172:175], v221 offset:8192
 v_exp_f32 v248, v116
 v_add_f32 v231, v246, v247
 v_exp_f32 v249, v117
 v_mfma_f32_32x32x16_bf16 v[16:31], v[204:207], v[148:151], v[16:31]
 ds_read_b128 v[176:179], v222 offset:8192
 v_cvt_pk_bf16_f32 v233, v246, v247
 v_exp_f32 v244, v118
 v_add_f32 v230, v230, v248
 v_mfma_f32_32x32x16_bf16 v[32:47], v[208:211], v[148:151], v[32:47]
 ds_read_b128 v[180:183], v223 offset:8192
 v_exp_f32 v245, v119
 v_add_f32 v231, v231, v249
 v_cvt_pk_bf16_f32 v234, v248, v249
 v_mfma_f32_32x32x16_bf16 v[48:63], v[212:215], v[148:151], v[48:63]
 v_exp_f32 v246, v120
 v_add_f32 v230, v230, v244
 v_exp_f32 v247, v121
 s_waitcnt lgkmcnt(0)
 s_barrier
 v_mfma_f32_32x32x16_bf16 v[96:111], v[152:155], v[64:67], v[128:143]
 ds_read_b64_tr_b16 v[184:185], v224 offset:40960
 ds_read_b64_tr_b16 v[186:187], v224 offset:43008
 v_add_f32 v231, v231, v245
 v_cvt_pk_bf16_f32 v235, v244, v245
 v_exp_f32 v248, v122
 v_mfma_f32_32x32x16_bf16 v[96:111], v[156:159], v[68:71], v[96:111]
 ds_read_b64_tr_b16 v[188:189], v225 offset:40960
 ds_read_b64_tr_b16 v[190:191], v225 offset:43008
 v_add_f32 v230, v230, v246
 v_exp_f32 v249, v123
 v_add_f32 v231, v231, v247
 v_mfma_f32_32x32x16_bf16 v[96:111], v[160:163], v[72:75], v[96:111]
 ds_read_b64_tr_b16 v[192:193], v226 offset:40960
 ds_read_b64_tr_b16 v[194:195], v226 offset:43008
 v_cvt_pk_bf16_f32 v236, v246, v247
 v_exp_f32 v244, v124
 v_add_f32 v230, v230, v248
 v_mfma_f32_32x32x16_bf16 v[96:111], v[164:167], v[76:79], v[96:111]
 ds_read_b64_tr_b16 v[196:197], v227 offset:40960
 ds_read_b64_tr_b16 v[198:199], v227 offset:43008
 v_exp_f32 v245, v125
 v_add_f32 v231, v231, v249
 v_cvt_pk_bf16_f32 v237, v248, v249
 v_mfma_f32_32x32x16_bf16 v[96:111], v[168:171], v[80:83], v[96:111]
 ds_read_b64_tr_b16 v[200:201], v224 offset:45056
 ds_read_b64_tr_b16 v[202:203], v224 offset:47104
 v_exp_f32 v246, v126
 v_add_f32 v230, v230, v244
 v_exp_f32 v247, v127
 v_mfma_f32_32x32x16_bf16 v[96:111], v[172:175], v[84:87], v[96:111]
 ds_read_b64_tr_b16 v[204:205], v225 offset:45056
 ds_read_b64_tr_b16 v[206:207], v225 offset:47104
 v_add_f32 v231, v231, v245
 v_cvt_pk_bf16_f32 v238, v244, v245
 v_add_f32 v230, v230, v246
 v_mfma_f32_32x32x16_bf16 v[96:111], v[176:179], v[88:91], v[96:111]
 ds_read_b64_tr_b16 v[208:209], v226 offset:45056
 ds_read_b64_tr_b16 v[210:211], v226 offset:47104
 v_add_f32 v231, v231, v247
 v_cvt_pk_bf16_f32 v239, v246, v247
 v_add_f32 v230, v230, v231
 v_mfma_f32_32x32x16_bf16 v[96:111], v[180:183], v[92:95], v[96:111]
 v_cmp_nge_f32 vcc, s54, v230
 s_waitcnt lgkmcnt(6)
 s_cbranch_vccnz K_rare_27
K_back_28:
 v_mfma_f32_32x32x16_bf16 v[0:15], v[184:187], v[232:235], v[0:15]
 ds_read_b64_tr_b16 v[212:213], v227 offset:45056
 ds_read_b64_tr_b16 v[214:215], v227 offset:47104
 v_add_f32 v228, v228, v230
 v_mfma_f32_32x32x16_bf16 v[16:31], v[188:191], v[232:235], v[16:31]
 ds_read_b128 v[152:155], v216 offset:16384
 ds_read_b128 v[156:159], v217 offset:16384
 v_mfma_f32_32x32x16_bf16 v[32:47], v[192:195], v[232:235], v[32:47]
 ds_read_b128 v[160:163], v218 offset:16384
 ds_read_b128 v[164:167], v219 offset:16384
 v_exp_f32 v244, v96
 v_exp_f32 v245, v97
 v_exp_f32 v246, v98
 v_mfma_f32_32x32x16_bf16 v[48:63], v[196:199], v[232:235], v[48:63]
 ds_read_b128 v[168:171], v220 offset:16384
 v_exp_f32 v247, v99
 v_add_f32 v230, v244, v245
 v_cvt_pk_bf16_f32 v144, v244, v245
 s_waitcnt lgkmcnt(5)
 v_mfma_f32_32x32x16_bf16 v[0:15], v[200:203], v[236:239], v[0:15]
 ds_read_b128 v[172:175], v221 offset:16384
 v_exp_f32 v248, v100
 v_add_f32 v231, v246, v247
 v_exp_f32 v249, v101
 v_mfma_f32_32x32x16_bf16 v[16:31], v[204:207], v[236:239], v[16:31]
 ds_read_b128 v[176:179], v222 offset:16384
 v_cvt_pk_bf16_f32 v145, v246, v247
 v_exp_f32 v244, v102
 v_add_f32 v230, v230, v248
 v_mfma_f32_32x32x16_bf16 v[32:47], v[208:211], v[236:239], v[32:47]
 ds_read_b128 v[180:183], v223 offset:16384
 v_exp_f32 v245, v103
 v_add_f32 v231, v231, v249
 v_cvt_pk_bf16_f32 v146, v248, v249
 v_mfma_f32_32x32x16_bf16 v[48:63], v[212:215], v[236:239], v[48:63]
 v_exp_f32 v246, v104
 v_add_f32 v230, v230, v244
 v_exp_f32 v247, v105
 s_waitcnt lgkmcnt(0)
 s_barrier
 v_mfma_f32_32x32x16_bf16 v[112:127], v[152:155], v[64:67], v[128:143]
 ds_read_b64_tr_b16 v[184:185], v224 offset:49152
 ds_read_b64_tr_b16 v[186:187], v224 offset:51200
 v_add_f32 v231, v231, v245
 v_cvt_pk_bf16_f32 v147, v244, v245
 v_exp_f32 v248, v106
 v_mfma_f32_32x32x16_bf16 v[112:127], v[156:159], v[68:71], v[112:127]
 ds_read_b64_tr_b16 v[188:189], v225 offset:49152
 ds_read_b64_tr_b16 v[190:191], v225 offset:51200
 v_add_f32 v230, v230, v246
 v_exp_f32 v249, v107
 v_add_f32 v231, v231, v247
 v_mfma_f32_32x32x16_bf16 v[112:127], v[160:163], v[72:75], v[112:127]
 ds_read_b64_tr_b16 v[192:193], v226 offset:49152
 ds_read_b64_tr_b16 v[194:195], v226 offset:51200
 v_cvt_pk_bf16_f32 v148, v246, v247
 v_exp_f32 v244, v108
 v_add_f32 v230, v230, v248
 v_mfma_f32_32x32x16_bf16 v[112:127], v[164:167], v[76:79], v[112:127]
 ds_read_b64_tr_b16 v[196:197], v227 offset:49152
 ds_read_b64_tr_b16 v[198:199], v227 offset:51200
 v_exp_f32 v245, v109
 v_add_f32 v231, v231, v249
 v_cvt_pk_bf16_f32 v149, v248, v249
 v_mfma_f32_32x32x16_bf16 v[112:127], v[168:171], v[80:83], v[112:127]
 ds_read_b64_tr_b16 v[200:201], v224 offset:53248
 ds_read_b64_tr_b16 v[202:203], v224 offset:55296
 v_exp_f32 v246, v110
 v_add_f32 v230, v230, v244
 v_exp_f32 v247, v111
 v_mfma_f32_32x32x16_bf16 v[112:127], v[172:175], v[84:87], v[112:127]
 ds_read_b64_tr_b16 v[204:205], v225 offset:53248
 ds_read_b64_tr_b16 v[206:207], v225 offset:55296
 v_add_f32 v231, v231, v245
 v_cvt_pk_bf16_f32 v150, v244, v245
 v_add_f32 v230, v230, v246
 v_mfma_f32_32x32x16_bf16 v[112:127], v[176:179], v[88:91], v[112:127]
 ds_read_b64_tr_b16 v[208:209], v226 offset:53248
 ds_read_b64_tr_b16 v[210:211], v226 offset:55296
 v_add_f32 v231, v231, v247
 v_cvt_pk_bf16_f32 v151, v246, v247
 v_add_f32 v230, v230, v231
 v_mfma_f32_32x32x16_bf16 v[112:127], v[180:183], v[92:95], v[112:127]
 v_cmp_nge_f32 vcc, s54, v230
 s_waitcnt lgkmcnt(6)
 s_cbranch_vccnz K_rare_29
K_back_30:
 v_mfma_f32_32x32x16_bf16 v[0:15], v[184:187], v[144:147], v[0:15]
 ds_read_b64_tr_b16 v[212:213], v227 offset:53248
 ds_read_b64_tr_b16 v[214:215], v227 offset:55296
 v_add_f32 v228, v228, v230
 v_mfma_f32_32x32x16_bf16 v[16:31], v[188:191], v[144:147], v[16:31]
 s_nop 3
 v_mfma_f32_32x32x16_bf16 v[32:47], v[192:195], v[144:147], v[32:47]
 v_exp_f32 v244, v112
 v_exp_f32 v245, v113
 v_exp_f32 v246, v114
 v_mfma_f32_32x32x16_bf16 v[48:63], v[196:199], v[144:147], v[48:63]
 v_exp_f32 v247, v115
 v_add_f32 v230, v244, v245
 v_cvt_pk_bf16_f32 v232, v244, v245
 s_waitcnt lgkmcnt(0)
 v_mfma_f32_32x32x16_bf16 v[0:15], v[200:203], v[148:151], v[0:15]
 v_exp_f32 v248, v116
 v_add_f32 v231, v246, v247
 v_exp_f32 v249, v117
 v_mfma_f32_32x32x16_bf16 v[16:31], v[204:207], v[148:151], v[16:31]
 v_cvt_pk_bf16_f32 v233, v246, v247
 v_exp_f32 v244, v118
 v_add_f32 v230, v230, v248
 v_mfma_f32_32x32x16_bf16 v[32:47], v[208:211], v[148:151], v[32:47]
 v_exp_f32 v245, v119
 v_add_f32 v231, v231, v249
 v_cvt_pk_bf16_f32 v234, v248, v249
 v_mfma_f32_32x32x16_bf16 v[48:63], v[212:215], v[148:151], v[48:63]
 v_exp_f32 v246, v120
 v_add_f32 v230, v230, v244
 v_exp_f32 v247, v121
 s_barrier
 ds_read_b64_tr_b16 v[184:185], v224 offset:57344
 ds_read_b64_tr_b16 v[186:187], v224 offset:59392
 v_add_f32 v231, v231, v245
 v_cvt_pk_bf16_f32 v235, v244, v245
 v_exp_f32 v248, v122
 ds_read_b64_tr_b16 v[188:189], v225 offset:57344
 ds_read_b64_tr_b16 v[190:191], v225 offset:59392
 v_add_f32 v230, v230, v246
 v_exp_f32 v249, v123
 v_add_f32 v231, v231, v247
 ds_read_b64_tr_b16 v[192:193], v226 offset:57344
 ds_read_b64_tr_b16 v[194:195], v226 offset:59392
 v_cvt_pk_bf16_f32 v236, v246, v247
 v_exp_f32 v244, v124
 v_add_f32 v230, v230, v248
 ds_read_b64_tr_b16 v[196:197], v227 offset:57344
 ds_read_b64_tr_b16 v[198:199], v227 offset:59392
 v_exp_f32 v245, v125
 v_add_f32 v231, v231, v249
 v_cvt_pk_bf16_f32 v237, v248, v249
 ds_read_b64_tr_b16 v[200:201], v224 offset:61440
 ds_read_b64_tr_b16 v[202:203], v224 offset:63488
 v_exp_f32 v246, v126
 v_add_f32 v230, v230, v244
 v_exp_f32 v247, v127
 ds_read_b64_tr_b16 v[204:205], v225 offset:61440
 ds_read_b64_tr_b16 v[206:207], v225 offset:63488
 v_add_f32 v231, v231, v245
 v_cvt_pk_bf16_f32 v238, v244, v245
 v_add_f32 v230, v230, v246
 ds_read_b64_tr_b16 v[208:209], v226 offset:61440
 ds_read_b64_tr_b16 v[210:211], v226 offset:63488
 v_add_f32 v231, v231, v247
 v_cvt_pk_bf16_f32 v239, v246, v247
 v_add_f32 v230, v230, v231
 v_cmp_nge_f32 vcc, s54, v230
 s_waitcnt lgkmcnt(6)
 s_cbranch_vccnz K_rare_31
K_back_32:
 v_mfma_f32_32x32x16_bf16 v[0:15], v[184:187], v[232:235], v[0:15]
 ds_read_b64_tr_b16 v[212:213], v227 offset:61440
 ds_read_b64_tr_b16 v[214:215], v227 offset:63488
 v_add_f32 v228, v228, v230
 v_mfma_f32_32x32x16_bf16 v[16:31], v[188:191], v[232:235], v[16:31]
 v_mfma_f32_32x32x16_bf16 v[32:47], v[192:195], v[232:235], v[32:47]
 v_mfma_f32_32x32x16_bf16 v[48:63], v[196:199], v[232:235], v[48:63]
 s_waitcnt lgkmcnt(0)
 v_mfma_f32_32x32x16_bf16 v[0:15], v[200:203], v[236:239], v[0:15]
 v_mfma_f32_32x32x16_bf16 v[16:31], v[204:207], v[236:239], v[16:31]
 v_mfma_f32_32x32x16_bf16 v[32:47], v[208:211], v[236:239], v[32:47]
 v_mfma_f32_32x32x16_bf16 v[48:63], v[212:215], v[236:239], v[48:63]
 s_barrier
 s_setprio 0
 s_nop 4
 s_nop 0
 s_nop 0
 v_mov_b32 v229, v228
 s_nop 1
 v_permlane32_swap_b32 v228, v229
 v_add_f32 v228, v228, v229
 v_rcp_f32 v228, v228
 s_nop 3
 v_mul_f32 v0, v0, v228
 v_mul_f32 v1, v1, v228
 v_mul_f32 v2, v2, v228
 v_mul_f32 v3, v3, v228
 v_mul_f32 v4, v4, v228
 v_mul_f32 v5, v5, v228
 v_mul_f32 v6, v6, v228
 v_mul_f32 v7, v7, v228
 v_cvt_pk_bf16_f32 v152, v0, v1
 v_cvt_pk_bf16_f32 v153, v2, v3
 v_cvt_pk_bf16_f32 v154, v4, v5
 v_cvt_pk_bf16_f32 v155, v6, v7
 buffer_store_dwordx4 v[152:155], v243, s[36:39], s55 offen offset:0 sc1
 v_mul_f32 v8, v8, v228
 v_mul_f32 v9, v9, v228
 v_mul_f32 v10, v10, v228
 v_mul_f32 v11, v11, v228
 v_mul_f32 v12, v12, v228
 v_mul_f32 v13, v13, v228
 v_mul_f32 v14, v14, v228
 v_mul_f32 v15, v15, v228
 v_cvt_pk_bf16_f32 v156, v8, v9
 v_cvt_pk_bf16_f32 v157, v10, v11
 v_cvt_pk_bf16_f32 v158, v12, v13
 v_cvt_pk_bf16_f32 v159, v14, v15
 buffer_store_dwordx4 v[156:159], v243, s[36:39], s55 offen offset:1024 sc1
 v_mul_f32 v16, v16, v228
 v_mul_f32 v17, v17, v228
 v_mul_f32 v18, v18, v228
 v_mul_f32 v19, v19, v228
 v_mul_f32 v20, v20, v228
 v_mul_f32 v21, v21, v228
 v_mul_f32 v22, v22, v228
 v_mul_f32 v23, v23, v228
 v_cvt_pk_bf16_f32 v160, v16, v17
 v_cvt_pk_bf16_f32 v161, v18, v19
 v_cvt_pk_bf16_f32 v162, v20, v21
 v_cvt_pk_bf16_f32 v163, v22, v23
 buffer_store_dwordx4 v[160:163], v243, s[36:39], s55 offen offset:2048 sc1
 s_barrier
 v_mul_f32 v24, v24, v228
 v_mul_f32 v25, v25, v228
 v_mul_f32 v26, v26, v228
 v_mul_f32 v27, v27, v228
 v_mul_f32 v28, v28, v228
 v_mul_f32 v29, v29, v228
 v_mul_f32 v30, v30, v228
 v_mul_f32 v31, v31, v228
 v_cvt_pk_bf16_f32 v164, v24, v25
 v_cvt_pk_bf16_f32 v165, v26, v27
 v_cvt_pk_bf16_f32 v166, v28, v29
 v_cvt_pk_bf16_f32 v167, v30, v31
 buffer_store_dwordx4 v[164:167], v243, s[36:39], s55 offen offset:3072 sc1
 v_mul_f32 v32, v32, v228
 v_mul_f32 v33, v33, v228
 v_mul_f32 v34, v34, v228
 v_mul_f32 v35, v35, v228
 v_mul_f32 v36, v36, v228
 v_mul_f32 v37, v37, v228
 v_mul_f32 v38, v38, v228
 v_mul_f32 v39, v39, v228
 v_cvt_pk_bf16_f32 v168, v32, v33
 v_cvt_pk_bf16_f32 v169, v34, v35
 v_cvt_pk_bf16_f32 v170, v36, v37
 v_cvt_pk_bf16_f32 v171, v38, v39
 buffer_store_dwordx4 v[168:171], v243, s[36:39], s56 offen offset:0 sc1
 v_mul_f32 v40, v40, v228
 v_mul_f32 v41, v41, v228
 v_mul_f32 v42, v42, v228
 v_mul_f32 v43, v43, v228
 v_mul_f32 v44, v44, v228
 v_mul_f32 v45, v45, v228
 v_mul_f32 v46, v46, v228
 v_mul_f32 v47, v47, v228
 v_cvt_pk_bf16_f32 v172, v40, v41
 v_cvt_pk_bf16_f32 v173, v42, v43
 v_cvt_pk_bf16_f32 v174, v44, v45
 v_cvt_pk_bf16_f32 v175, v46, v47
 buffer_store_dwordx4 v[172:175], v243, s[36:39], s56 offen offset:1024 sc1
 s_barrier
 v_mul_f32 v48, v48, v228
 v_mul_f32 v49, v49, v228
 v_mul_f32 v50, v50, v228
 v_mul_f32 v51, v51, v228
 v_mul_f32 v52, v52, v228
 v_mul_f32 v53, v53, v228
 v_mul_f32 v54, v54, v228
 v_mul_f32 v55, v55, v228
 v_cvt_pk_bf16_f32 v176, v48, v49
 v_cvt_pk_bf16_f32 v177, v50, v51
 v_cvt_pk_bf16_f32 v178, v52, v53
 v_cvt_pk_bf16_f32 v179, v54, v55
 buffer_store_dwordx4 v[176:179], v243, s[36:39], s56 offen offset:2048 sc1
 v_mul_f32 v56, v56, v228
 v_mul_f32 v57, v57, v228
 v_mul_f32 v58, v58, v228
 v_mul_f32 v59, v59, v228
 v_mul_f32 v60, v60, v228
 v_mul_f32 v61, v61, v228
 v_mul_f32 v62, v62, v228
 v_mul_f32 v63, v63, v228
 v_cvt_pk_bf16_f32 v180, v56, v57
 v_cvt_pk_bf16_f32 v181, v58, v59
 v_cvt_pk_bf16_f32 v182, v60, v61
 v_cvt_pk_bf16_f32 v183, v62, v63
 buffer_store_dwordx4 v[180:183], v243, s[36:39], s56 offen offset:3072 sc1
 v_bfe_u32 v244, v250, 2, 2
 v_lshrrev_b32 v245, 5, v250
 v_mul_u32_u24 v245, 8, v245
 v_add_u32 v245, v245, v244
 v_mul_u32_u24 v232, 320, v245
 v_bfe_u32 v244, v250, 4, 1
 v_lshlrev_b32 v244, 5, v244
 v_add_u32 v232, v232, v244
 v_and_b32 v244, 1, v250
 v_lshlrev_b32 v244, 4, v244
 v_add_u32 v232, v232, v244
 v_bfe_u32 v244, v250, 1, 1
 v_lshlrev_b32 v244, 3, v244
 v_add_u32 v232, v232, v244
 v_add_u32 v233, 61440, v232
 v_add_u32 v234, 122880, v232
 s_lshl_b32 s49, s62, 11
 v_add_u32 v236, s49, v243
 v_add_u32 v237, 61440, v236
 v_add_u32 v238, 122880, v236
 s_barrier
 ds_read_b64_tr_b16 v[80:81], v234 offset:22528
 ds_read_b64_tr_b16 v[82:83], v234 offset:23808
 ds_read_b64_tr_b16 v[84:85], v234 offset:22592
 ds_read_b64_tr_b16 v[86:87], v234 offset:23872
 ds_read_b64_tr_b16 v[88:89], v234 offset:22656
 ds_read_b64_tr_b16 v[90:91], v234 offset:23936
 ds_read_b64_tr_b16 v[92:93], v234 offset:22720
 ds_read_b64_tr_b16 v[94:95], v234 offset:24000
 ds_read_b64_tr_b16 v[96:97], v234 offset:22784
 ds_read_b64_tr_b16 v[98:99], v234 offset:24064
 ds_read_b64_tr_b16 v[100:101], v234 offset:27648
 ds_read_b64_tr_b16 v[102:103], v234 offset:28928
 s_waitcnt lgkmcnt(10)
 v_mfma_f32_32x32x16_bf16 v[0:15], v[80:83], v[152:155], 0
 ds_read_b64_tr_b16 v[104:105], v234 offset:27712
 ds_read_b64_tr_b16 v[106:107], v234 offset:28992
 s_waitcnt lgkmcnt(10)
 v_mfma_f32_32x32x16_bf16 v[16:31], v[84:87], v[152:155], 0
 ds_read_b64_tr_b16 v[108:109], v234 offset:27776
 ds_read_b64_tr_b16 v[110:111], v234 offset:29056
 s_waitcnt lgkmcnt(10)
 v_mfma_f32_32x32x16_bf16 v[32:47], v[88:91], v[152:155], 0
 ds_read_b64_tr_b16 v[80:81], v234 offset:27840
 ds_read_b64_tr_b16 v[82:83], v234 offset:29120
 s_waitcnt lgkmcnt(10)
 v_mfma_f32_32x32x16_bf16 v[48:63], v[92:95], v[152:155], 0
 ds_read_b64_tr_b16 v[84:85], v234 offset:27904
 ds_read_b64_tr_b16 v[86:87], v234 offset:29184
 s_waitcnt lgkmcnt(10)
 v_mfma_f32_32x32x16_bf16 v[64:79], v[96:99], v[152:155], 0
 ds_read_b64_tr_b16 v[88:89], v233 offset:53248
 ds_read_b64_tr_b16 v[90:91], v233 offset:54528
 s_waitcnt lgkmcnt(10)
 v_mfma_f32_32x32x16_bf16 v[0:15], v[100:103], v[156:159], v[0:15]
 ds_read_b64_tr_b16 v[92:93], v233 offset:53312
 ds_read_b64_tr_b16 v[94:95], v233 offset:54592
 s_waitcnt lgkmcnt(10)
 v_mfma_f32_32x32x16_bf16 v[16:31], v[104:107], v[156:159], v[16:31]
 ds_read_b64_tr_b16 v[96:97], v233 offset:53376
 ds_read_b64_tr_b16 v[98:99], v233 offset:54656
 s_waitcnt lgkmcnt(10)
 v_mfma_f32_32x32x16_bf16 v[32:47], v[108:111], v[156:159], v[32:47]
 ds_read_b64_tr_b16 v[100:101], v233 offset:53440
 ds_read_b64_tr_b16 v[102:103], v233 offset:54720
 s_waitcnt lgkmcnt(10)
 v_mfma_f32_32x32x16_bf16 v[48:63], v[80:83], v[156:159], v[48:63]
 ds_read_b64_tr_b16 v[104:105], v233 offset:53504
 ds_read_b64_tr_b16 v[106:107], v233 offset:54784
 s_waitcnt lgkmcnt(10)
 v_mfma_f32_32x32x16_bf16 v[64:79], v[84:87], v[156:159], v[64:79]
 ds_read_b64_tr_b16 v[108:109], v233 offset:58368
 ds_read_b64_tr_b16 v[110:111], v233 offset:59648
 s_barrier
 s_waitcnt lgkmcnt(10)
 v_mfma_f32_32x32x16_bf16 v[0:15], v[88:91], v[160:163], v[0:15]
 ds_read_b64_tr_b16 v[80:81], v233 offset:58432
 ds_read_b64_tr_b16 v[82:83], v233 offset:59712
 s_waitcnt lgkmcnt(10)
 v_mfma_f32_32x32x16_bf16 v[16:31], v[92:95], v[160:163], v[16:31]
 ds_read_b64_tr_b16 v[84:85], v233 offset:58496
 ds_read_b64_tr_b16 v[86:87], v233 offset:59776
 s_waitcnt lgkmcnt(10)
 v_mfma_f32_32x32x16_bf16 v[32:47], v[96:99], v[160:163], v[32:47]
 ds_read_b64_tr_b16 v[88:89], v233 offset:58560
 ds_read_b64_tr_b16 v[90:91], v233 offset:59840
 s_waitcnt lgkmcnt(10)
 v_mfma_f32_32x32x16_bf16 v[48:63], v[100:103], v[160:163], v[48:63]
 ds_read_b64_tr_b16 v[92:93], v233 offset:58624
 ds_read_b64_tr_b16 v[94:95], v233 offset:59904
 s_waitcnt lgkmcnt(10)
 v_mfma_f32_32x32x16_bf16 v[64:79], v[104:107], v[160:163], v[64:79]
 ds_read_b64_tr_b16 v[96:97], v234 offset:2048
 ds_read_b64_tr_b16 v[98:99], v234 offset:3328
 s_waitcnt lgkmcnt(10)
 v_mfma_f32_32x32x16_bf16 v[0:15], v[108:111], v[164:167], v[0:15]
 ds_read_b64_tr_b16 v[100:101], v234 offset:2112
 ds_read_b64_tr_b16 v[102:103], v234 offset:3392
 s_waitcnt lgkmcnt(10)
 v_mfma_f32_32x32x16_bf16 v[16:31], v[80:83], v[164:167], v[16:31]
 ds_read_b64_tr_b16 v[104:105], v234 offset:2176
 ds_read_b64_tr_b16 v[106:107], v234 offset:3456
 s_waitcnt lgkmcnt(10)
 v_mfma_f32_32x32x16_bf16 v[32:47], v[84:87], v[164:167], v[32:47]
 ds_read_b64_tr_b16 v[108:109], v234 offset:2240
 ds_read_b64_tr_b16 v[110:111], v234 offset:3520
 s_waitcnt lgkmcnt(10)
 v_mfma_f32_32x32x16_bf16 v[48:63], v[88:91], v[164:167], v[48:63]
 ds_read_b64_tr_b16 v[80:81], v234 offset:2304
 ds_read_b64_tr_b16 v[82:83], v234 offset:3584
 s_waitcnt lgkmcnt(10)
 v_mfma_f32_32x32x16_bf16 v[64:79], v[92:95], v[164:167], v[64:79]
 ds_read_b64_tr_b16 v[84:85], v234 offset:7168
 ds_read_b64_tr_b16 v[86:87], v234 offset:8448
 s_barrier
 s_waitcnt lgkmcnt(10)
 v_mfma_f32_32x32x16_bf16 v[0:15], v[96:99], v[168:171], v[0:15]
 ds_read_b64_tr_b16 v[88:89], v234 offset:7232
 ds_read_b64_tr_b16 v[90:91], v234 offset:8512
 s_waitcnt lgkmcnt(10)
 v_mfma_f32_32x32x16_bf16 v[16:31], v[100:103], v[168:171], v[16:31]
 ds_read_b64_tr_b16 v[92:93], v234 offset:7296
 ds_read_b64_tr_b16 v[94:95], v234 offset:8576
 s_waitcnt lgkmcnt(10)
 v_mfma_f32_32x32x16_bf16 v[32:47], v[104:107], v[168:171], v[32:47]
 ds_read_b64_tr_b16 v[96:97], v234 offset:7360
 ds_read_b64_tr_b16 v[98:99], v234 offset:8640
 s_waitcnt lgkmcnt(10)
 v_mfma_f32_32x32x16_bf16 v[48:63], v[108:111], v[168:171], v[48:63]
 ds_read_b64_tr_b16 v[100:101], v234 offset:7424
 ds_read_b64_tr_b16 v[102:103], v234 offset:8704
 s_waitcnt lgkmcnt(10)
 v_mfma_f32_32x32x16_bf16 v[64:79], v[80:83], v[168:171], v[64:79]
 ds_read_b64_tr_b16 v[104:105], v234 offset:12288
 ds_read_b64_tr_b16 v[106:107], v234 offset:13568
 s_waitcnt lgkmcnt(10)
 v_mfma_f32_32x32x16_bf16 v[0:15], v[84:87], v[172:175], v[0:15]
 ds_read_b64_tr_b16 v[108:109], v234 offset:12352
 ds_read_b64_tr_b16 v[110:111], v234 offset:13632
 s_waitcnt lgkmcnt(10)
 v_mfma_f32_32x32x16_bf16 v[16:31], v[88:91], v[172:175], v[16:31]
 ds_read_b64_tr_b16 v[80:81], v234 offset:12416
 ds_read_b64_tr_b16 v[82:83], v234 offset:13696
 s_waitcnt lgkmcnt(10)
 v_mfma_f32_32x32x16_bf16 v[32:47], v[92:95], v[172:175], v[32:47]
 ds_read_b64_tr_b16 v[84:85], v234 offset:12480
 ds_read_b64_tr_b16 v[86:87], v234 offset:13760
 s_waitcnt lgkmcnt(10)
 v_mfma_f32_32x32x16_bf16 v[48:63], v[96:99], v[172:175], v[48:63]
 ds_read_b64_tr_b16 v[88:89], v234 offset:12544
 ds_read_b64_tr_b16 v[90:91], v234 offset:13824
 s_waitcnt lgkmcnt(10)
 v_mfma_f32_32x32x16_bf16 v[64:79], v[100:103], v[172:175], v[64:79]
 ds_read_b64_tr_b16 v[92:93], v234 offset:17408
 ds_read_b64_tr_b16 v[94:95], v234 offset:18688
 s_waitcnt vmcnt(0)
 s_barrier
 s_waitcnt lgkmcnt(10)
 v_mfma_f32_32x32x16_bf16 v[0:15], v[104:107], v[176:179], v[0:15]
 ds_read_b64_tr_b16 v[96:97], v234 offset:17472
 ds_read_b64_tr_b16 v[98:99], v234 offset:18752
 s_waitcnt lgkmcnt(10)
 v_mfma_f32_32x32x16_bf16 v[16:31], v[108:111], v[176:179], v[16:31]
 ds_read_b64_tr_b16 v[100:101], v234 offset:17536
 ds_read_b64_tr_b16 v[102:103], v234 offset:18816
 s_waitcnt lgkmcnt(10)
 v_mfma_f32_32x32x16_bf16 v[32:47], v[80:83], v[176:179], v[32:47]
 ds_read_b64_tr_b16 v[104:105], v234 offset:17600
 ds_read_b64_tr_b16 v[106:107], v234 offset:18880
 s_waitcnt lgkmcnt(10)
 v_mfma_f32_32x32x16_bf16 v[48:63], v[84:87], v[176:179], v[48:63]
 ds_read_b64_tr_b16 v[108:109], v234 offset:17664
 ds_read_b64_tr_b16 v[110:111], v234 offset:18944
 s_waitcnt lgkmcnt(10)
 v_mfma_f32_32x32x16_bf16 v[64:79], v[88:91], v[176:179], v[64:79]
 s_waitcnt lgkmcnt(8)
 v_mfma_f32_32x32x16_bf16 v[0:15], v[92:95], v[180:183], v[0:15]
 s_waitcnt lgkmcnt(6)
 v_mfma_f32_32x32x16_bf16 v[16:31], v[96:99], v[180:183], v[16:31]
 s_waitcnt lgkmcnt(4)
 v_mfma_f32_32x32x16_bf16 v[32:47], v[100:103], v[180:183], v[32:47]
 s_waitcnt lgkmcnt(2)
 v_mfma_f32_32x32x16_bf16 v[48:63], v[104:107], v[180:183], v[48:63]
 s_waitcnt lgkmcnt(0)
 v_mfma_f32_32x32x16_bf16 v[64:79], v[108:111], v[180:183], v[64:79]
 s_barrier
 s_barrier
 s_barrier
 s_barrier
 s_barrier
 s_barrier
 s_barrier
 s_barrier
 ds_read_b128 v[112:115], v238 offset:32768
 ds_read_b64_tr_b16 v[80:81], v234 offset:22528
 ds_read_b64_tr_b16 v[82:83], v234 offset:23808
 ds_read_b64_tr_b16 v[84:85], v234 offset:22592
 ds_read_b64_tr_b16 v[86:87], v234 offset:23872
 ds_read_b64_tr_b16 v[88:89], v234 offset:22656
 ds_read_b64_tr_b16 v[90:91], v234 offset:23936
 ds_read_b64_tr_b16 v[92:93], v234 offset:22720
 ds_read_b64_tr_b16 v[94:95], v234 offset:24000
 ds_read_b64_tr_b16 v[96:97], v234 offset:22784
 ds_read_b64_tr_b16 v[98:99], v234 offset:24064
 ds_read_b128 v[116:119], v238 offset:33792
 ds_read_b64_tr_b16 v[100:101], v234 offset:27648
 ds_read_b64_tr_b16 v[102:103], v234 offset:28928
 s_waitcnt lgkmcnt(11)
 v_mfma_f32_32x32x16_bf16 v[0:15], v[80:83], v[112:115], v[0:15]
 ds_read_b64_tr_b16 v[104:105], v234 offset:27712
 ds_read_b64_tr_b16 v[106:107], v234 offset:28992
 s_waitcnt lgkmcnt(11)
 v_mfma_f32_32x32x16_bf16 v[16:31], v[84:87], v[112:115], v[16:31]
 ds_read_b64_tr_b16 v[108:109], v234 offset:27776
 ds_read_b64_tr_b16 v[110:111], v234 offset:29056
 s_waitcnt lgkmcnt(11)
 v_mfma_f32_32x32x16_bf16 v[32:47], v[88:91], v[112:115], v[32:47]
 ds_read_b64_tr_b16 v[80:81], v234 offset:27840
 ds_read_b64_tr_b16 v[82:83], v234 offset:29120
 s_waitcnt lgkmcnt(11)
 v_mfma_f32_32x32x16_bf16 v[48:63], v[92:95], v[112:115], v[48:63]
 ds_read_b64_tr_b16 v[84:85], v234 offset:27904
 ds_read_b64_tr_b16 v[86:87], v234 offset:29184
 s_waitcnt lgkmcnt(11)
 v_mfma_f32_32x32x16_bf16 v[64:79], v[96:99], v[112:115], v[64:79]
 s_waitcnt lgkmcnt(8)
 v_mfma_f32_32x32x16_bf16 v[0:15], v[100:103], v[116:119], v[0:15]
 s_waitcnt lgkmcnt(6)
 v_mfma_f32_32x32x16_bf16 v[16:31], v[104:107], v[116:119], v[16:31]
 s_waitcnt lgkmcnt(4)
 v_mfma_f32_32x32x16_bf16 v[32:47], v[108:111], v[116:119], v[32:47]
 s_waitcnt lgkmcnt(2)
 v_mfma_f32_32x32x16_bf16 v[48:63], v[80:83], v[116:119], v[48:63]
 s_waitcnt lgkmcnt(0)
 v_mfma_f32_32x32x16_bf16 v[64:79], v[84:87], v[116:119], v[64:79]
 s_barrier
 ds_read_b128 v[120:123], v236 offset:51200
 ds_read_b64_tr_b16 v[88:89], v233 offset:53248
 ds_read_b64_tr_b16 v[90:91], v233 offset:54528
 ds_read_b64_tr_b16 v[92:93], v233 offset:53312
 ds_read_b64_tr_b16 v[94:95], v233 offset:54592
 ds_read_b64_tr_b16 v[96:97], v233 offset:53376
 ds_read_b64_tr_b16 v[98:99], v233 offset:54656
 ds_read_b64_tr_b16 v[100:101], v233 offset:53440
 ds_read_b64_tr_b16 v[102:103], v233 offset:54720
 ds_read_b64_tr_b16 v[104:105], v233 offset:53504
 ds_read_b64_tr_b16 v[106:107], v233 offset:54784
 ds_read_b128 v[124:127], v236 offset:52224
 ds_read_b64_tr_b16 v[108:109], v233 offset:58368
 ds_read_b64_tr_b16 v[110:111], v233 offset:59648
 s_waitcnt lgkmcnt(11)
 v_mfma_f32_32x32x16_bf16 v[0:15], v[88:91], v[120:123], v[0:15]
 ds_read_b64_tr_b16 v[80:81], v233 offset:58432
 ds_read_b64_tr_b16 v[82:83], v233 offset:59712
 s_waitcnt lgkmcnt(11)
 v_mfma_f32_32x32x16_bf16 v[16:31], v[92:95], v[120:123], v[16:31]
 ds_read_b64_tr_b16 v[84:85], v233 offset:58496
 ds_read_b64_tr_b16 v[86:87], v233 offset:59776
 s_waitcnt lgkmcnt(11)
 v_mfma_f32_32x32x16_bf16 v[32:47], v[96:99], v[120:123], v[32:47]
 ds_read_b64_tr_b16 v[88:89], v233 offset:58560
 ds_read_b64_tr_b16 v[90:91], v233 offset:59840
 s_waitcnt lgkmcnt(11)
 v_mfma_f32_32x32x16_bf16 v[48:63], v[100:103], v[120:123], v[48:63]
 ds_read_b64_tr_b16 v[92:93], v233 offset:58624
 ds_read_b64_tr_b16 v[94:95], v233 offset:59904
 s_waitcnt lgkmcnt(11)
 v_mfma_f32_32x32x16_bf16 v[64:79], v[104:107], v[120:123], v[64:79]
 ds_read_b128 v[112:115], v236 offset:57344
 ds_read_b64_tr_b16 v[96:97], v234 offset:2048
 ds_read_b64_tr_b16 v[98:99], v234 offset:3328
 s_waitcnt lgkmcnt(11)
 v_mfma_f32_32x32x16_bf16 v[0:15], v[108:111], v[124:127], v[0:15]
 ds_read_b64_tr_b16 v[100:101], v234 offset:2112
 ds_read_b64_tr_b16 v[102:103], v234 offset:3392
 s_waitcnt lgkmcnt(11)
 v_mfma_f32_32x32x16_bf16 v[16:31], v[80:83], v[124:127], v[16:31]
 ds_read_b64_tr_b16 v[104:105], v234 offset:2176
 ds_read_b64_tr_b16 v[106:107], v234 offset:3456
 s_waitcnt lgkmcnt(11)
 v_mfma_f32_32x32x16_bf16 v[32:47], v[84:87], v[124:127], v[32:47]
 ds_read_b64_tr_b16 v[108:109], v234 offset:2240
 ds_read_b64_tr_b16 v[110:111], v234 offset:3520
 s_waitcnt lgkmcnt(11)
 v_mfma_f32_32x32x16_bf16 v[48:63], v[88:91], v[124:127], v[48:63]
 ds_read_b64_tr_b16 v[80:81], v234 offset:2304
 ds_read_b64_tr_b16 v[82:83], v234 offset:3584
 s_waitcnt lgkmcnt(11)
 v_mfma_f32_32x32x16_bf16 v[64:79], v[92:95], v[124:127], v[64:79]
 ds_read_b128 v[116:119], v236 offset:58368
 ds_read_b64_tr_b16 v[84:85], v234 offset:7168
 ds_read_b64_tr_b16 v[86:87], v234 offset:8448
 s_barrier
 s_waitcnt lgkmcnt(11)
 v_mfma_f32_32x32x16_bf16 v[0:15], v[96:99], v[112:115], v[0:15]
 ds_read_b64_tr_b16 v[88:89], v234 offset:7232
 ds_read_b64_tr_b16 v[90:91], v234 offset:8512
 s_waitcnt lgkmcnt(11)
 v_mfma_f32_32x32x16_bf16 v[16:31], v[100:103], v[112:115], v[16:31]
 ds_read_b64_tr_b16 v[92:93], v234 offset:7296
 ds_read_b64_tr_b16 v[94:95], v234 offset:8576
 s_waitcnt lgkmcnt(11)
 v_mfma_f32_32x32x16_bf16 v[32:47], v[104:107], v[112:115], v[32:47]
 ds_read_b64_tr_b16 v[96:97], v234 offset:7360
 ds_read_b64_tr_b16 v[98:99], v234 offset:8640
 s_waitcnt lgkmcnt(11)
 v_mfma_f32_32x32x16_bf16 v[48:63], v[108:111], v[112:115], v[48:63]
 ds_read_b64_tr_b16 v[100:101], v234 offset:7424
 ds_read_b64_tr_b16 v[102:103], v234 offset:8704
 s_waitcnt lgkmcnt(11)
 v_mfma_f32_32x32x16_bf16 v[64:79], v[80:83], v[112:115], v[64:79]
 ds_read_b128 v[120:123], v237 offset:2048
 ds_read_b64_tr_b16 v[104:105], v234 offset:12288
 ds_read_b64_tr_b16 v[106:107], v234 offset:13568
 s_waitcnt lgkmcnt(11)
 v_mfma_f32_32x32x16_bf16 v[0:15], v[84:87], v[116:119], v[0:15]
 ds_read_b64_tr_b16 v[108:109], v234 offset:12352
 ds_read_b64_tr_b16 v[110:111], v234 offset:13632
 s_waitcnt lgkmcnt(11)
 v_mfma_f32_32x32x16_bf16 v[16:31], v[88:91], v[116:119], v[16:31]
 ds_read_b64_tr_b16 v[80:81], v234 offset:12416
 ds_read_b64_tr_b16 v[82:83], v234 offset:13696
 s_waitcnt lgkmcnt(11)
 v_mfma_f32_32x32x16_bf16 v[32:47], v[92:95], v[116:119], v[32:47]
 ds_read_b64_tr_b16 v[84:85], v234 offset:12480
 ds_read_b64_tr_b16 v[86:87], v234 offset:13760
 s_waitcnt lgkmcnt(11)
 v_mfma_f32_32x32x16_bf16 v[48:63], v[96:99], v[116:119], v[48:63]
 ds_read_b64_tr_b16 v[88:89], v234 offset:12544
 ds_read_b64_tr_b16 v[90:91], v234 offset:13824
 s_waitcnt lgkmcnt(11)
 v_mfma_f32_32x32x16_bf16 v[64:79], v[100:103], v[116:119], v[64:79]
 ds_read_b128 v[124:127], v237 offset:3072
 ds_read_b64_tr_b16 v[92:93], v234 offset:17408
 ds_read_b64_tr_b16 v[94:95], v234 offset:18688
 s_waitcnt lgkmcnt(11)
 v_mfma_f32_32x32x16_bf16 v[0:15], v[104:107], v[120:123], v[0:15]
 ds_read_b64_tr_b16 v[96:97], v234 offset:17472
 ds_read_b64_tr_b16 v[98:99], v234 offset:18752
 s_waitcnt lgkmcnt(11)
 v_mfma_f32_32x32x16_bf16 v[16:31], v[108:111], v[120:123], v[16:31]
 ds_read_b64_tr_b16 v[100:101], v234 offset:17536
 ds_read_b64_tr_b16 v[102:103], v234 offset:18816
 s_waitcnt lgkmcnt(11)
 v_mfma_f32_32x32x16_bf16 v[32:47], v[80:83], v[120:123], v[32:47]
 ds_read_b64_tr_b16 v[104:105], v234 offset:17600
 ds_read_b64_tr_b16 v[106:107], v234 offset:18880
 s_waitcnt lgkmcnt(11)
 v_mfma_f32_32x32x16_bf16 v[48:63], v[84:87], v[120:123], v[48:63]
 ds_read_b64_tr_b16 v[108:109], v234 offset:17664
 ds_read_b64_tr_b16 v[110:111], v234 offset:18944
 s_waitcnt lgkmcnt(11)
 v_mfma_f32_32x32x16_bf16 v[64:79], v[88:91], v[120:123], v[64:79]
 ds_read_b128 v[112:115], v237 offset:8192
 ds_read_b64_tr_b16 v[80:81], v232 offset:40960
 ds_read_b64_tr_b16 v[82:83], v232 offset:42240
 s_waitcnt lgkmcnt(11)
 v_mfma_f32_32x32x16_bf16 v[0:15], v[92:95], v[124:127], v[0:15]
 ds_read_b64_tr_b16 v[84:85], v232 offset:41024
 ds_read_b64_tr_b16 v[86:87], v232 offset:42304
 s_waitcnt lgkmcnt(11)
 v_mfma_f32_32x32x16_bf16 v[16:31], v[96:99], v[124:127], v[16:31]
 ds_read_b64_tr_b16 v[88:89], v232 offset:41088
 ds_read_b64_tr_b16 v[90:91], v232 offset:42368
 s_waitcnt lgkmcnt(11)
 v_mfma_f32_32x32x16_bf16 v[32:47], v[100:103], v[124:127], v[32:47]
 ds_read_b64_tr_b16 v[92:93], v232 offset:41152
 ds_read_b64_tr_b16 v[94:95], v232 offset:42432
 s_waitcnt lgkmcnt(11)
 v_mfma_f32_32x32x16_bf16 v[48:63], v[104:107], v[124:127], v[48:63]
 ds_read_b64_tr_b16 v[96:97], v232 offset:41216
 ds_read_b64_tr_b16 v[98:99], v232 offset:42496
 s_waitcnt lgkmcnt(11)
 v_mfma_f32_32x32x16_bf16 v[64:79], v[108:111], v[124:127], v[64:79]
 ds_read_b128 v[116:119], v237 offset:9216
 ds_read_b64_tr_b16 v[100:101], v232 offset:46080
 ds_read_b64_tr_b16 v[102:103], v232 offset:47360
 s_waitcnt lgkmcnt(11)
 v_mfma_f32_32x32x16_bf16 v[0:15], v[80:83], v[112:115], v[0:15]
 ds_read_b64_tr_b16 v[104:105], v232 offset:46144
 ds_read_b64_tr_b16 v[106:107], v232 offset:47424
 s_waitcnt lgkmcnt(11)
 v_mfma_f32_32x32x16_bf16 v[16:31], v[84:87], v[112:115], v[16:31]
 ds_read_b64_tr_b16 v[108:109], v232 offset:46208
 ds_read_b64_tr_b16 v[110:111], v232 offset:47488
 s_waitcnt lgkmcnt(11)
 v_mfma_f32_32x32x16_bf16 v[32:47], v[88:91], v[112:115], v[32:47]
 ds_read_b64_tr_b16 v[80:81], v232 offset:46272
 ds_read_b64_tr_b16 v[82:83], v232 offset:47552
 s_waitcnt lgkmcnt(11)
 v_mfma_f32_32x32x16_bf16 v[48:63], v[92:95], v[112:115], v[48:63]
 ds_read_b64_tr_b16 v[84:85], v232 offset:46336
 ds_read_b64_tr_b16 v[86:87], v232 offset:47616
 s_waitcnt lgkmcnt(11)
 v_mfma_f32_32x32x16_bf16 v[64:79], v[96:99], v[112:115], v[64:79]
 ds_read_b128 v[120:123], v237 offset:14336
 ds_read_b64_tr_b16 v[88:89], v232 offset:24576
 ds_read_b64_tr_b16 v[90:91], v232 offset:25856
 s_waitcnt lgkmcnt(11)
 v_mfma_f32_32x32x16_bf16 v[0:15], v[100:103], v[116:119], v[0:15]
 ds_read_b64_tr_b16 v[92:93], v232 offset:24640
 ds_read_b64_tr_b16 v[94:95], v232 offset:25920
 s_waitcnt lgkmcnt(11)
 v_mfma_f32_32x32x16_bf16 v[16:31], v[104:107], v[116:119], v[16:31]
 ds_read_b64_tr_b16 v[96:97], v232 offset:24704
 ds_read_b64_tr_b16 v[98:99], v232 offset:25984
 s_waitcnt lgkmcnt(11)
 v_mfma_f32_32x32x16_bf16 v[32:47], v[108:111], v[116:119], v[32:47]
 ds_read_b64_tr_b16 v[100:101], v232 offset:24768
 ds_read_b64_tr_b16 v[102:103], v232 offset:26048
 s_waitcnt lgkmcnt(11)
 v_mfma_f32_32x32x16_bf16 v[48:63], v[80:83], v[116:119], v[48:63]
 ds_read_b64_tr_b16 v[104:105], v232 offset:24832
 ds_read_b64_tr_b16 v[106:107], v232 offset:26112
 s_waitcnt lgkmcnt(11)
 v_mfma_f32_32x32x16_bf16 v[64:79], v[84:87], v[116:119], v[64:79]
 ds_read_b128 v[124:127], v237 offset:15360
 ds_read_b64_tr_b16 v[108:109], v232 offset:29696
 ds_read_b64_tr_b16 v[110:111], v232 offset:30976
 s_barrier
 s_waitcnt lgkmcnt(11)
 v_mfma_f32_32x32x16_bf16 v[0:15], v[88:91], v[120:123], v[0:15]
 ds_read_b64_tr_b16 v[80:81], v232 offset:29760
 ds_read_b64_tr_b16 v[82:83], v232 offset:31040
 s_waitcnt lgkmcnt(11)
 v_mfma_f32_32x32x16_bf16 v[16:31], v[92:95], v[120:123], v[16:31]
 ds_read_b64_tr_b16 v[84:85], v232 offset:29824
 ds_read_b64_tr_b16 v[86:87], v232 offset:31104
 s_waitcnt lgkmcnt(11)
 v_mfma_f32_32x32x16_bf16 v[32:47], v[96:99], v[120:123], v[32:47]
 ds_read_b64_tr_b16 v[88:89], v232 offset:29888
 ds_read_b64_tr_b16 v[90:91], v232 offset:31168
 s_waitcnt lgkmcnt(11)
 v_mfma_f32_32x32x16_bf16 v[48:63], v[100:103], v[120:123], v[48:63]
 ds_read_b64_tr_b16 v[92:93], v232 offset:29952
 ds_read_b64_tr_b16 v[94:95], v232 offset:31232
 s_waitcnt lgkmcnt(11)
 v_mfma_f32_32x32x16_bf16 v[64:79], v[104:107], v[120:123], v[64:79]
 ds_read_b128 v[112:115], v238 offset:32768
 ds_read_b64_tr_b16 v[96:97], v233 offset:30720
 ds_read_b64_tr_b16 v[98:99], v233 offset:32000
 s_waitcnt lgkmcnt(11)
 v_mfma_f32_32x32x16_bf16 v[0:15], v[108:111], v[124:127], v[0:15]
 ds_read_b64_tr_b16 v[100:101], v233 offset:30784
 ds_read_b64_tr_b16 v[102:103], v233 offset:32064
 s_waitcnt lgkmcnt(11)
 v_mfma_f32_32x32x16_bf16 v[16:31], v[80:83], v[124:127], v[16:31]
 ds_read_b64_tr_b16 v[104:105], v233 offset:30848
 ds_read_b64_tr_b16 v[106:107], v233 offset:32128
 s_waitcnt lgkmcnt(11)
 v_mfma_f32_32x32x16_bf16 v[32:47], v[84:87], v[124:127], v[32:47]
 ds_read_b64_tr_b16 v[108:109], v233 offset:30912
 ds_read_b64_tr_b16 v[110:111], v233 offset:32192
 s_waitcnt lgkmcnt(11)
 v_mfma_f32_32x32x16_bf16 v[48:63], v[88:91], v[124:127], v[48:63]
 ds_read_b64_tr_b16 v[80:81], v233 offset:30976
 ds_read_b64_tr_b16 v[82:83], v233 offset:32256
 s_waitcnt lgkmcnt(11)
 v_mfma_f32_32x32x16_bf16 v[64:79], v[92:95], v[124:127], v[64:79]
 ds_read_b128 v[116:119], v238 offset:33792
 ds_read_b64_tr_b16 v[84:85], v233 offset:35840
 ds_read_b64_tr_b16 v[86:87], v233 offset:37120
 s_waitcnt lgkmcnt(11)
 v_mfma_f32_32x32x16_bf16 v[0:15], v[96:99], v[112:115], v[0:15]
 ds_read_b64_tr_b16 v[88:89], v233 offset:35904
 ds_read_b64_tr_b16 v[90:91], v233 offset:37184
 s_waitcnt lgkmcnt(11)
 v_mfma_f32_32x32x16_bf16 v[16:31], v[100:103], v[112:115], v[16:31]
 ds_read_b64_tr_b16 v[92:93], v233 offset:35968
 ds_read_b64_tr_b16 v[94:95], v233 offset:37248
 s_waitcnt lgkmcnt(11)
 v_mfma_f32_32x32x16_bf16 v[32:47], v[104:107], v[112:115], v[32:47]
 ds_read_b64_tr_b16 v[96:97], v233 offset:36032
 ds_read_b64_tr_b16 v[98:99], v233 offset:37312
 s_waitcnt lgkmcnt(11)
 v_mfma_f32_32x32x16_bf16 v[48:63], v[108:111], v[112:115], v[48:63]
 ds_read_b64_tr_b16 v[100:101], v233 offset:36096
 ds_read_b64_tr_b16 v[102:103], v233 offset:37376
 s_waitcnt lgkmcnt(11)
 v_mfma_f32_32x32x16_bf16 v[64:79], v[80:83], v[112:115], v[64:79]
 ds_read_b128 v[120:123], v236 offset:34816
 ds_read_b64_tr_b16 v[104:105], v234 offset:22528
 ds_read_b64_tr_b16 v[106:107], v234 offset:23808
 s_waitcnt lgkmcnt(11)
 v_mfma_f32_32x32x16_bf16 v[0:15], v[84:87], v[116:119], v[0:15]
 ds_read_b64_tr_b16 v[108:109], v234 offset:22592
 ds_read_b64_tr_b16 v[110:111], v234 offset:23872
 s_waitcnt lgkmcnt(11)
 v_mfma_f32_32x32x16_bf16 v[16:31], v[88:91], v[116:119], v[16:31]
 ds_read_b64_tr_b16 v[80:81], v234 offset:22656
 ds_read_b64_tr_b16 v[82:83], v234 offset:23936
 s_waitcnt lgkmcnt(11)
 v_mfma_f32_32x32x16_bf16 v[32:47], v[92:95], v[116:119], v[32:47]
 ds_read_b64_tr_b16 v[84:85], v234 offset:22720
 ds_read_b64_tr_b16 v[86:87], v234 offset:24000
 s_waitcnt lgkmcnt(11)
 v_mfma_f32_32x32x16_bf16 v[48:63], v[96:99], v[116:119], v[48:63]
 ds_read_b64_tr_b16 v[88:89], v234 offset:22784
 ds_read_b64_tr_b16 v[90:91], v234 offset:24064
 s_waitcnt lgkmcnt(11)
 v_mfma_f32_32x32x16_bf16 v[64:79], v[100:103], v[116:119], v[64:79]
 ds_read_b128 v[124:127], v236 offset:35840
 ds_read_b64_tr_b16 v[92:93], v234 offset:27648
 ds_read_b64_tr_b16 v[94:95], v234 offset:28928
 s_barrier
 s_waitcnt lgkmcnt(11)
 v_mfma_f32_32x32x16_bf16 v[0:15], v[104:107], v[120:123], v[0:15]
 ds_read_b64_tr_b16 v[96:97], v234 offset:27712
 ds_read_b64_tr_b16 v[98:99], v234 offset:28992
 s_waitcnt lgkmcnt(11)
 v_mfma_f32_32x32x16_bf16 v[16:31], v[108:111], v[120:123], v[16:31]
 ds_read_b64_tr_b16 v[100:101], v234 offset:27776
 ds_read_b64_tr_b16 v[102:103], v234 offset:29056
 s_waitcnt lgkmcnt(11)
 v_mfma_f32_32x32x16_bf16 v[32:47], v[80:83], v[120:123], v[32:47]
 ds_read_b64_tr_b16 v[104:105], v234 offset:27840
 ds_read_b64_tr_b16 v[106:107], v234 offset:29120
 s_waitcnt lgkmcnt(11)
 v_mfma_f32_32x32x16_bf16 v[48:63], v[84:87], v[120:123], v[48:63]
 ds_read_b64_tr_b16 v[108:109], v234 offset:27904
 ds_read_b64_tr_b16 v[110:111], v234 offset:29184
 s_waitcnt lgkmcnt(11)
 v_mfma_f32_32x32x16_bf16 v[64:79], v[88:91], v[120:123], v[64:79]
 ds_read_b128 v[112:115], v236 offset:51200
 ds_read_b64_tr_b16 v[80:81], v233 offset:53248
 ds_read_b64_tr_b16 v[82:83], v233 offset:54528
 s_waitcnt lgkmcnt(11)
 v_mfma_f32_32x32x16_bf16 v[0:15], v[92:95], v[124:127], v[0:15]
 ds_read_b64_tr_b16 v[84:85], v233 offset:53312
 ds_read_b64_tr_b16 v[86:87], v233 offset:54592
 s_waitcnt lgkmcnt(11)
 v_mfma_f32_32x32x16_bf16 v[16:31], v[96:99], v[124:127], v[16:31]
 ds_read_b64_tr_b16 v[88:89], v233 offset:53376
 ds_read_b64_tr_b16 v[90:91], v233 offset:54656
 s_waitcnt lgkmcnt(11)
 v_mfma_f32_32x32x16_bf16 v[32:47], v[100:103], v[124:127], v[32:47]
 ds_read_b64_tr_b16 v[92:93], v233 offset:53440
 ds_read_b64_tr_b16 v[94:95], v233 offset:54720
 s_waitcnt lgkmcnt(11)
 v_mfma_f32_32x32x16_bf16 v[48:63], v[104:107], v[124:127], v[48:63]
 ds_read_b64_tr_b16 v[96:97], v233 offset:53504
 ds_read_b64_tr_b16 v[98:99], v233 offset:54784
 s_waitcnt lgkmcnt(11)
 v_mfma_f32_32x32x16_bf16 v[64:79], v[108:111], v[124:127], v[64:79]
 ds_read_b128 v[116:119], v236 offset:52224
 ds_read_b64_tr_b16 v[100:101], v233 offset:58368
 ds_read_b64_tr_b16 v[102:103], v233 offset:59648
 s_waitcnt lgkmcnt(11)
 v_mfma_f32_32x32x16_bf16 v[0:15], v[80:83], v[112:115], v[0:15]
 ds_read_b64_tr_b16 v[104:105], v233 offset:58432
 ds_read_b64_tr_b16 v[106:107], v233 offset:59712
 s_waitcnt lgkmcnt(11)
 v_mfma_f32_32x32x16_bf16 v[16:31], v[84:87], v[112:115], v[16:31]
 ds_read_b64_tr_b16 v[108:109], v233 offset:58496
 ds_read_b64_tr_b16 v[110:111], v233 offset:59776
 s_waitcnt lgkmcnt(11)
 v_mfma_f32_32x32x16_bf16 v[32:47], v[88:91], v[112:115], v[32:47]
 ds_read_b64_tr_b16 v[80:81], v233 offset:58560
 ds_read_b64_tr_b16 v[82:83], v233 offset:59840
 s_waitcnt lgkmcnt(11)
 v_mfma_f32_32x32x16_bf16 v[48:63], v[92:95], v[112:115], v[48:63]
 ds_read_b64_tr_b16 v[84:85], v233 offset:58624
 ds_read_b64_tr_b16 v[86:87], v233 offset:59904
 s_waitcnt lgkmcnt(11)
 v_mfma_f32_32x32x16_bf16 v[64:79], v[96:99], v[112:115], v[64:79]
 ds_read_b128 v[120:123], v236 offset:57344
 ds_read_b64_tr_b16 v[88:89], v233 offset:20480
 ds_read_b64_tr_b16 v[90:91], v233 offset:21760
 s_waitcnt lgkmcnt(11)
 v_mfma_f32_32x32x16_bf16 v[0:15], v[100:103], v[116:119], v[0:15]
 ds_read_b64_tr_b16 v[92:93], v233 offset:20544
 ds_read_b64_tr_b16 v[94:95], v233 offset:21824
 s_waitcnt lgkmcnt(11)
 v_mfma_f32_32x32x16_bf16 v[16:31], v[104:107], v[116:119], v[16:31]
 ds_read_b64_tr_b16 v[96:97], v233 offset:20608
 ds_read_b64_tr_b16 v[98:99], v233 offset:21888
 s_waitcnt lgkmcnt(11)
 v_mfma_f32_32x32x16_bf16 v[32:47], v[108:111], v[116:119], v[32:47]
 ds_read_b64_tr_b16 v[100:101], v233 offset:20672
 ds_read_b64_tr_b16 v[102:103], v233 offset:21952
 s_waitcnt lgkmcnt(11)
 v_mfma_f32_32x32x16_bf16 v[48:63], v[80:83], v[116:119], v[48:63]
 ds_read_b64_tr_b16 v[104:105], v233 offset:20736
 ds_read_b64_tr_b16 v[106:107], v233 offset:22016
 s_waitcnt lgkmcnt(11)
 v_mfma_f32_32x32x16_bf16 v[64:79], v[84:87], v[116:119], v[64:79]
 ds_read_b128 v[124:127], v236 offset:58368
 ds_read_b64_tr_b16 v[108:109], v233 offset:25600
 ds_read_b64_tr_b16 v[110:111], v233 offset:26880
 s_barrier
 s_waitcnt lgkmcnt(11)
 v_mfma_f32_32x32x16_bf16 v[0:15], v[88:91], v[120:123], v[0:15]
 ds_read_b64_tr_b16 v[80:81], v233 offset:25664
 ds_read_b64_tr_b16 v[82:83], v233 offset:26944
 s_waitcnt lgkmcnt(11)
 v_mfma_f32_32x32x16_bf16 v[16:31], v[92:95], v[120:123], v[16:31]
 ds_read_b64_tr_b16 v[84:85], v233 offset:25728
 ds_read_b64_tr_b16 v[86:87], v233 offset:27008
 s_waitcnt lgkmcnt(11)
 v_mfma_f32_32x32x16_bf16 v[32:47], v[96:99], v[120:123], v[32:47]
 ds_read_b64_tr_b16 v[88:89], v233 offset:25792
 ds_read_b64_tr_b16 v[90:91], v233 offset:27072
 s_waitcnt lgkmcnt(11)
 v_mfma_f32_32x32x16_bf16 v[48:63], v[100:103], v[120:123], v[48:63]
 ds_read_b64_tr_b16 v[92:93], v233 offset:25856
 ds_read_b64_tr_b16 v[94:95], v233 offset:27136
 s_waitcnt lgkmcnt(11)
 v_mfma_f32_32x32x16_bf16 v[64:79], v[104:107], v[120:123], v[64:79]
 ds_read_b128 v[112:115], v237 offset:2048
 ds_read_b64_tr_b16 v[96:97], v233 offset:40960
 ds_read_b64_tr_b16 v[98:99], v233 offset:42240
 s_waitcnt lgkmcnt(11)
 v_mfma_f32_32x32x16_bf16 v[0:15], v[108:111], v[124:127], v[0:15]
 ds_read_b64_tr_b16 v[100:101], v233 offset:41024
 ds_read_b64_tr_b16 v[102:103], v233 offset:42304
 s_waitcnt lgkmcnt(11)
 v_mfma_f32_32x32x16_bf16 v[16:31], v[80:83], v[124:127], v[16:31]
 ds_read_b64_tr_b16 v[104:105], v233 offset:41088
 ds_read_b64_tr_b16 v[106:107], v233 offset:42368
 s_waitcnt lgkmcnt(11)
 v_mfma_f32_32x32x16_bf16 v[32:47], v[84:87], v[124:127], v[32:47]
 ds_read_b64_tr_b16 v[108:109], v233 offset:41152
 ds_read_b64_tr_b16 v[110:111], v233 offset:42432
 s_waitcnt lgkmcnt(11)
 v_mfma_f32_32x32x16_bf16 v[48:63], v[88:91], v[124:127], v[48:63]
 ds_read_b64_tr_b16 v[80:81], v233 offset:41216
 ds_read_b64_tr_b16 v[82:83], v233 offset:42496
 s_waitcnt lgkmcnt(11)
 v_mfma_f32_32x32x16_bf16 v[64:79], v[92:95], v[124:127], v[64:79]
 ds_read_b128 v[116:119], v237 offset:3072
 ds_read_b64_tr_b16 v[84:85], v233 offset:46080
 ds_read_b64_tr_b16 v[86:87], v233 offset:47360
 s_waitcnt lgkmcnt(11)
 v_mfma_f32_32x32x16_bf16 v[0:15], v[96:99], v[112:115], v[0:15]
 ds_read_b64_tr_b16 v[88:89], v233 offset:46144
 ds_read_b64_tr_b16 v[90:91], v233 offset:47424
 s_waitcnt lgkmcnt(11)
 v_mfma_f32_32x32x16_bf16 v[16:31], v[100:103], v[112:115], v[16:31]
 ds_read_b64_tr_b16 v[92:93], v233 offset:46208
 ds_read_b64_tr_b16 v[94:95], v233 offset:47488
 s_waitcnt lgkmcnt(11)
 v_mfma_f32_32x32x16_bf16 v[32:47], v[104:107], v[112:115], v[32:47]
 ds_read_b64_tr_b16 v[96:97], v233 offset:46272
 ds_read_b64_tr_b16 v[98:99], v233 offset:47552
 s_waitcnt lgkmcnt(11)
 v_mfma_f32_32x32x16_bf16 v[48:63], v[108:111], v[112:115], v[48:63]
 ds_read_b64_tr_b16 v[100:101], v233 offset:46336
 ds_read_b64_tr_b16 v[102:103], v233 offset:47616
 s_waitcnt lgkmcnt(11)
 v_mfma_f32_32x32x16_bf16 v[64:79], v[80:83], v[112:115], v[64:79]
 ds_read_b128 v[120:123], v237 offset:8192
 ds_read_b64_tr_b16 v[104:105], v234 offset:2048
 ds_read_b64_tr_b16 v[106:107], v234 offset:3328
 s_waitcnt lgkmcnt(11)
 v_mfma_f32_32x32x16_bf16 v[0:15], v[84:87], v[116:119], v[0:15]
 ds_read_b64_tr_b16 v[108:109], v234 offset:2112
 ds_read_b64_tr_b16 v[110:111], v234 offset:3392
 s_waitcnt lgkmcnt(11)
 v_mfma_f32_32x32x16_bf16 v[16:31], v[88:91], v[116:119], v[16:31]
 ds_read_b64_tr_b16 v[80:81], v234 offset:2176
 ds_read_b64_tr_b16 v[82:83], v234 offset:3456
 s_waitcnt lgkmcnt(11)
 v_mfma_f32_32x32x16_bf16 v[32:47], v[92:95], v[116:119], v[32:47]
 ds_read_b64_tr_b16 v[84:85], v234 offset:2240
 ds_read_b64_tr_b16 v[86:87], v234 offset:3520
 s_waitcnt lgkmcnt(11)
 v_mfma_f32_32x32x16_bf16 v[48:63], v[96:99], v[116:119], v[48:63]
 ds_read_b64_tr_b16 v[88:89], v234 offset:2304
 ds_read_b64_tr_b16 v[90:91], v234 offset:3584
 s_waitcnt lgkmcnt(11)
 v_mfma_f32_32x32x16_bf16 v[64:79], v[100:103], v[116:119], v[64:79]
 ds_read_b128 v[124:127], v237 offset:9216
 ds_read_b64_tr_b16 v[92:93], v234 offset:7168
 ds_read_b64_tr_b16 v[94:95], v234 offset:8448
 s_barrier
 s_waitcnt lgkmcnt(11)
 v_mfma_f32_32x32x16_bf16 v[0:15], v[104:107], v[120:123], v[0:15]
 ds_read_b64_tr_b16 v[96:97], v234 offset:7232
 ds_read_b64_tr_b16 v[98:99], v234 offset:8512
 s_waitcnt lgkmcnt(11)
 v_mfma_f32_32x32x16_bf16 v[16:31], v[108:111], v[120:123], v[16:31]
 ds_read_b64_tr_b16 v[100:101], v234 offset:7296
 ds_read_b64_tr_b16 v[102:103], v234 offset:8576
 s_waitcnt lgkmcnt(11)
 v_mfma_f32_32x32x16_bf16 v[32:47], v[80:83], v[120:123], v[32:47]
 ds_read_b64_tr_b16 v[104:105], v234 offset:7360
 ds_read_b64_tr_b16 v[106:107], v234 offset:8640
 s_waitcnt lgkmcnt(11)
 v_mfma_f32_32x32x16_bf16 v[48:63], v[84:87], v[120:123], v[48:63]
 ds_read_b64_tr_b16 v[108:109], v234 offset:7424
 ds_read_b64_tr_b16 v[110:111], v234 offset:8704
 s_waitcnt lgkmcnt(11)
 v_mfma_f32_32x32x16_bf16 v[64:79], v[88:91], v[120:123], v[64:79]
 ds_read_b128 v[112:115], v236 offset:0
 ds_read_b64_tr_b16 v[80:81], v234 offset:12288
 ds_read_b64_tr_b16 v[82:83], v234 offset:13568
 s_waitcnt lgkmcnt(11)
 v_mfma_f32_32x32x16_bf16 v[0:15], v[92:95], v[124:127], v[0:15]
 ds_read_b64_tr_b16 v[84:85], v234 offset:12352
 ds_read_b64_tr_b16 v[86:87], v234 offset:13632
 s_waitcnt lgkmcnt(11)
 v_mfma_f32_32x32x16_bf16 v[16:31], v[96:99], v[124:127], v[16:31]
 ds_read_b64_tr_b16 v[88:89], v234 offset:12416
 ds_read_b64_tr_b16 v[90:91], v234 offset:13696
 s_waitcnt lgkmcnt(11)
 v_mfma_f32_32x32x16_bf16 v[32:47], v[100:103], v[124:127], v[32:47]
 ds_read_b64_tr_b16 v[92:93], v234 offset:12480
 ds_read_b64_tr_b16 v[94:95], v234 offset:13760
 s_waitcnt lgkmcnt(11)
 v_mfma_f32_32x32x16_bf16 v[48:63], v[104:107], v[124:127], v[48:63]
 ds_read_b64_tr_b16 v[96:97], v234 offset:12544
 ds_read_b64_tr_b16 v[98:99], v234 offset:13824
 s_waitcnt lgkmcnt(11)
 v_mfma_f32_32x32x16_bf16 v[64:79], v[108:111], v[124:127], v[64:79]
 ds_read_b128 v[116:119], v236 offset:1024
 ds_read_b64_tr_b16 v[100:101], v234 offset:17408
 ds_read_b64_tr_b16 v[102:103], v234 offset:18688
 s_waitcnt lgkmcnt(11)
 v_mfma_f32_32x32x16_bf16 v[0:15], v[80:83], v[112:115], v[0:15]
 ds_read_b64_tr_b16 v[104:105], v234 offset:17472
 ds_read_b64_tr_b16 v[106:107], v234 offset:18752
 s_waitcnt lgkmcnt(11)
 v_mfma_f32_32x32x16_bf16 v[16:31], v[84:87], v[112:115], v[16:31]
 ds_read_b64_tr_b16 v[108:109], v234 offset:17536
 ds_read_b64_tr_b16 v[110:111], v234 offset:18816
 s_waitcnt lgkmcnt(11)
 v_mfma_f32_32x32x16_bf16 v[32:47], v[88:91], v[112:115], v[32:47]
 ds_read_b64_tr_b16 v[80:81], v234 offset:17600
 ds_read_b64_tr_b16 v[82:83], v234 offset:18880
 s_waitcnt lgkmcnt(11)
 v_mfma_f32_32x32x16_bf16 v[48:63], v[92:95], v[112:115], v[48:63]
 ds_read_b64_tr_b16 v[84:85], v234 offset:17664
 ds_read_b64_tr_b16 v[86:87], v234 offset:18944
 s_waitcnt lgkmcnt(11)
 v_mfma_f32_32x32x16_bf16 v[64:79], v[96:99], v[112:115], v[64:79]
 ds_read_b128 v[120:123], v236 offset:6144
 ds_read_b64_tr_b16 v[88:89], v232 offset:40960
 ds_read_b64_tr_b16 v[90:91], v232 offset:42240
 s_waitcnt lgkmcnt(11)
 v_mfma_f32_32x32x16_bf16 v[0:15], v[100:103], v[116:119], v[0:15]
 ds_read_b64_tr_b16 v[92:93], v232 offset:41024
 ds_read_b64_tr_b16 v[94:95], v232 offset:42304
 s_waitcnt lgkmcnt(11)
 v_mfma_f32_32x32x16_bf16 v[16:31], v[104:107], v[116:119], v[16:31]
 ds_read_b64_tr_b16 v[96:97], v232 offset:41088
 ds_read_b64_tr_b16 v[98:99], v232 offset:42368
 s_waitcnt lgkmcnt(11)
 v_mfma_f32_32x32x16_bf16 v[32:47], v[108:111], v[116:119], v[32:47]
 ds_read_b64_tr_b16 v[100:101], v232 offset:41152
 ds_read_b64_tr_b16 v[102:103], v232 offset:42432
 s_waitcnt lgkmcnt(11)
 v_mfma_f32_32x32x16_bf16 v[48:63], v[80:83], v[116:119], v[48:63]
 ds_read_b64_tr_b16 v[104:105], v232 offset:41216
 ds_read_b64_tr_b16 v[106:107], v232 offset:42496
 s_waitcnt lgkmcnt(11)
 v_mfma_f32_32x32x16_bf16 v[64:79], v[84:87], v[116:119], v[64:79]
 ds_read_b128 v[124:127], v236 offset:7168
 ds_read_b64_tr_b16 v[108:109], v232 offset:46080
 ds_read_b64_tr_b16 v[110:111], v232 offset:47360
 s_barrier
 s_waitcnt lgkmcnt(11)
 v_mfma_f32_32x32x16_bf16 v[0:15], v[88:91], v[120:123], v[0:15]
 ds_read_b64_tr_b16 v[80:81], v232 offset:46144
 ds_read_b64_tr_b16 v[82:83], v232 offset:47424
 s_waitcnt lgkmcnt(11)
 v_mfma_f32_32x32x16_bf16 v[16:31], v[92:95], v[120:123], v[16:31]
 ds_read_b64_tr_b16 v[84:85], v232 offset:46208
 ds_read_b64_tr_b16 v[86:87], v232 offset:47488
 s_waitcnt lgkmcnt(11)
 v_mfma_f32_32x32x16_bf16 v[32:47], v[96:99], v[120:123], v[32:47]
 ds_read_b64_tr_b16 v[88:89], v232 offset:46272
 ds_read_b64_tr_b16 v[90:91], v232 offset:47552
 s_waitcnt lgkmcnt(11)
 v_mfma_f32_32x32x16_bf16 v[48:63], v[100:103], v[120:123], v[48:63]
 ds_read_b64_tr_b16 v[92:93], v232 offset:46336
 ds_read_b64_tr_b16 v[94:95], v232 offset:47616
 s_waitcnt lgkmcnt(11)
 v_mfma_f32_32x32x16_bf16 v[64:79], v[104:107], v[120:123], v[64:79]
 ds_read_b128 v[112:115], v236 offset:12288
 ds_read_b64_tr_b16 v[96:97], v232 offset:24576
 ds_read_b64_tr_b16 v[98:99], v232 offset:25856
 s_waitcnt lgkmcnt(11)
 v_mfma_f32_32x32x16_bf16 v[0:15], v[108:111], v[124:127], v[0:15]
 ds_read_b64_tr_b16 v[100:101], v232 offset:24640
 ds_read_b64_tr_b16 v[102:103], v232 offset:25920
 s_waitcnt lgkmcnt(11)
 v_mfma_f32_32x32x16_bf16 v[16:31], v[80:83], v[124:127], v[16:31]
 ds_read_b64_tr_b16 v[104:105], v232 offset:24704
 ds_read_b64_tr_b16 v[106:107], v232 offset:25984
 s_waitcnt lgkmcnt(11)
 v_mfma_f32_32x32x16_bf16 v[32:47], v[84:87], v[124:127], v[32:47]
 ds_read_b64_tr_b16 v[108:109], v232 offset:24768
 ds_read_b64_tr_b16 v[110:111], v232 offset:26048
 s_waitcnt lgkmcnt(11)
 v_mfma_f32_32x32x16_bf16 v[48:63], v[88:91], v[124:127], v[48:63]
 ds_read_b64_tr_b16 v[80:81], v232 offset:24832
 ds_read_b64_tr_b16 v[82:83], v232 offset:26112
 s_waitcnt lgkmcnt(11)
 v_mfma_f32_32x32x16_bf16 v[64:79], v[92:95], v[124:127], v[64:79]
 ds_read_b128 v[116:119], v236 offset:13312
 ds_read_b64_tr_b16 v[84:85], v232 offset:29696
 ds_read_b64_tr_b16 v[86:87], v232 offset:30976
 s_waitcnt lgkmcnt(11)
 v_mfma_f32_32x32x16_bf16 v[0:15], v[96:99], v[112:115], v[0:15]
 ds_read_b64_tr_b16 v[88:89], v232 offset:29760
 ds_read_b64_tr_b16 v[90:91], v232 offset:31040
 s_waitcnt lgkmcnt(11)
 v_mfma_f32_32x32x16_bf16 v[16:31], v[100:103], v[112:115], v[16:31]
 ds_read_b64_tr_b16 v[92:93], v232 offset:29824
 ds_read_b64_tr_b16 v[94:95], v232 offset:31104
 s_waitcnt lgkmcnt(11)
 v_mfma_f32_32x32x16_bf16 v[32:47], v[104:107], v[112:115], v[32:47]
 ds_read_b64_tr_b16 v[96:97], v232 offset:29888
 ds_read_b64_tr_b16 v[98:99], v232 offset:31168
 s_waitcnt lgkmcnt(11)
 v_mfma_f32_32x32x16_bf16 v[48:63], v[108:111], v[112:115], v[48:63]
 ds_read_b64_tr_b16 v[100:101], v232 offset:29952
 ds_read_b64_tr_b16 v[102:103], v232 offset:31232
 s_waitcnt lgkmcnt(11)
 v_mfma_f32_32x32x16_bf16 v[64:79], v[80:83], v[112:115], v[64:79]
 ds_read_b128 v[120:123], v236 offset:18432
 ds_read_b64_tr_b16 v[104:105], v233 offset:30720
 ds_read_b64_tr_b16 v[106:107], v233 offset:32000
 s_waitcnt lgkmcnt(11)
 v_mfma_f32_32x32x16_bf16 v[0:15], v[84:87], v[116:119], v[0:15]
 ds_read_b64_tr_b16 v[108:109], v233 offset:30784
 ds_read_b64_tr_b16 v[110:111], v233 offset:32064
 s_waitcnt lgkmcnt(11)
 v_mfma_f32_32x32x16_bf16 v[16:31], v[88:91], v[116:119], v[16:31]
 ds_read_b64_tr_b16 v[80:81], v233 offset:30848
 ds_read_b64_tr_b16 v[82:83], v233 offset:32128
 s_waitcnt lgkmcnt(11)
 v_mfma_f32_32x32x16_bf16 v[32:47], v[92:95], v[116:119], v[32:47]
 ds_read_b64_tr_b16 v[84:85], v233 offset:30912
 ds_read_b64_tr_b16 v[86:87], v233 offset:32192
 s_waitcnt lgkmcnt(11)
 v_mfma_f32_32x32x16_bf16 v[48:63], v[96:99], v[116:119], v[48:63]
 ds_read_b64_tr_b16 v[88:89], v233 offset:30976
 ds_read_b64_tr_b16 v[90:91], v233 offset:32256
 s_waitcnt lgkmcnt(11)
 v_mfma_f32_32x32x16_bf16 v[64:79], v[100:103], v[116:119], v[64:79]
 ds_read_b128 v[124:127], v236 offset:19456
 ds_read_b64_tr_b16 v[92:93], v233 offset:35840
 ds_read_b64_tr_b16 v[94:95], v233 offset:37120
 s_barrier
 s_waitcnt lgkmcnt(11)
 v_mfma_f32_32x32x16_bf16 v[0:15], v[104:107], v[120:123], v[0:15]
 ds_read_b64_tr_b16 v[96:97], v233 offset:35904
 ds_read_b64_tr_b16 v[98:99], v233 offset:37184
 s_waitcnt lgkmcnt(11)
 v_mfma_f32_32x32x16_bf16 v[16:31], v[108:111], v[120:123], v[16:31]
 ds_read_b64_tr_b16 v[100:101], v233 offset:35968
 ds_read_b64_tr_b16 v[102:103], v233 offset:37248
 s_waitcnt lgkmcnt(11)
 v_mfma_f32_32x32x16_bf16 v[32:47], v[80:83], v[120:123], v[32:47]
 ds_read_b64_tr_b16 v[104:105], v233 offset:36032
 ds_read_b64_tr_b16 v[106:107], v233 offset:37312
 s_waitcnt lgkmcnt(11)
 v_mfma_f32_32x32x16_bf16 v[48:63], v[84:87], v[120:123], v[48:63]
 ds_read_b64_tr_b16 v[108:109], v233 offset:36096
 ds_read_b64_tr_b16 v[110:111], v233 offset:37376
 s_waitcnt lgkmcnt(11)
 v_mfma_f32_32x32x16_bf16 v[64:79], v[88:91], v[120:123], v[64:79]
 ds_read_b128 v[112:115], v238 offset:32768
 ds_read_b64_tr_b16 v[80:81], v233 offset:53248
 ds_read_b64_tr_b16 v[82:83], v233 offset:54528
 s_waitcnt lgkmcnt(11)
 v_mfma_f32_32x32x16_bf16 v[0:15], v[92:95], v[124:127], v[0:15]
 ds_read_b64_tr_b16 v[84:85], v233 offset:53312
 ds_read_b64_tr_b16 v[86:87], v233 offset:54592
 s_waitcnt lgkmcnt(11)
 v_mfma_f32_32x32x16_bf16 v[16:31], v[96:99], v[124:127], v[16:31]
 ds_read_b64_tr_b16 v[88:89], v233 offset:53376
 ds_read_b64_tr_b16 v[90:91], v233 offset:54656
 s_waitcnt lgkmcnt(11)
 v_mfma_f32_32x32x16_bf16 v[32:47], v[100:103], v[124:127], v[32:47]
 ds_read_b64_tr_b16 v[92:93], v233 offset:53440
 ds_read_b64_tr_b16 v[94:95], v233 offset:54720
 s_waitcnt lgkmcnt(11)
 v_mfma_f32_32x32x16_bf16 v[48:63], v[104:107], v[124:127], v[48:63]
 ds_read_b64_tr_b16 v[96:97], v233 offset:53504
 ds_read_b64_tr_b16 v[98:99], v233 offset:54784
 s_waitcnt lgkmcnt(11)
 v_mfma_f32_32x32x16_bf16 v[64:79], v[108:111], v[124:127], v[64:79]
 ds_read_b128 v[116:119], v238 offset:33792
 ds_read_b64_tr_b16 v[100:101], v233 offset:58368
 ds_read_b64_tr_b16 v[102:103], v233 offset:59648
 s_waitcnt lgkmcnt(11)
 v_mfma_f32_32x32x16_bf16 v[0:15], v[80:83], v[112:115], v[0:15]
 ds_read_b64_tr_b16 v[104:105], v233 offset:58432
 ds_read_b64_tr_b16 v[106:107], v233 offset:59712
 s_waitcnt lgkmcnt(11)
 v_mfma_f32_32x32x16_bf16 v[16:31], v[84:87], v[112:115], v[16:31]
 ds_read_b64_tr_b16 v[108:109], v233 offset:58496
 ds_read_b64_tr_b16 v[110:111], v233 offset:59776
 s_waitcnt lgkmcnt(11)
 v_mfma_f32_32x32x16_bf16 v[32:47], v[88:91], v[112:115], v[32:47]
 ds_read_b64_tr_b16 v[80:81], v233 offset:58560
 ds_read_b64_tr_b16 v[82:83], v233 offset:59840
 s_waitcnt lgkmcnt(11)
 v_mfma_f32_32x32x16_bf16 v[48:63], v[92:95], v[112:115], v[48:63]
 ds_read_b64_tr_b16 v[84:85], v233 offset:58624
 ds_read_b64_tr_b16 v[86:87], v233 offset:59904
 s_waitcnt lgkmcnt(11)
 v_mfma_f32_32x32x16_bf16 v[64:79], v[96:99], v[112:115], v[64:79]
 ds_read_b128 v[120:123], v236 offset:51200
 ds_read_b64_tr_b16 v[88:89], v234 offset:22528
 ds_read_b64_tr_b16 v[90:91], v234 offset:23808
 s_waitcnt lgkmcnt(11)
 v_mfma_f32_32x32x16_bf16 v[0:15], v[100:103], v[116:119], v[0:15]
 ds_read_b64_tr_b16 v[92:93], v234 offset:22592
 ds_read_b64_tr_b16 v[94:95], v234 offset:23872
 s_waitcnt lgkmcnt(11)
 v_mfma_f32_32x32x16_bf16 v[16:31], v[104:107], v[116:119], v[16:31]
 ds_read_b64_tr_b16 v[96:97], v234 offset:22656
 ds_read_b64_tr_b16 v[98:99], v234 offset:23936
 s_waitcnt lgkmcnt(11)
 v_mfma_f32_32x32x16_bf16 v[32:47], v[108:111], v[116:119], v[32:47]
 ds_read_b64_tr_b16 v[100:101], v234 offset:22720
 ds_read_b64_tr_b16 v[102:103], v234 offset:24000
 s_waitcnt lgkmcnt(11)
 v_mfma_f32_32x32x16_bf16 v[48:63], v[80:83], v[116:119], v[48:63]
 ds_read_b64_tr_b16 v[104:105], v234 offset:22784
 ds_read_b64_tr_b16 v[106:107], v234 offset:24064
 s_waitcnt lgkmcnt(11)
 v_mfma_f32_32x32x16_bf16 v[64:79], v[84:87], v[116:119], v[64:79]
 ds_read_b128 v[124:127], v236 offset:52224
 ds_read_b64_tr_b16 v[108:109], v234 offset:27648
 ds_read_b64_tr_b16 v[110:111], v234 offset:28928
 s_barrier
 s_waitcnt lgkmcnt(11)
 v_mfma_f32_32x32x16_bf16 v[0:15], v[88:91], v[120:123], v[0:15]
 ds_read_b64_tr_b16 v[80:81], v234 offset:27712
 ds_read_b64_tr_b16 v[82:83], v234 offset:28992
 s_waitcnt lgkmcnt(11)
 v_mfma_f32_32x32x16_bf16 v[16:31], v[92:95], v[120:123], v[16:31]
 ds_read_b64_tr_b16 v[84:85], v234 offset:27776
 ds_read_b64_tr_b16 v[86:87], v234 offset:29056
 s_waitcnt lgkmcnt(11)
 v_mfma_f32_32x32x16_bf16 v[32:47], v[96:99], v[120:123], v[32:47]
 ds_read_b64_tr_b16 v[88:89], v234 offset:27840
 ds_read_b64_tr_b16 v[90:91], v234 offset:29120
 s_waitcnt lgkmcnt(11)
 v_mfma_f32_32x32x16_bf16 v[48:63], v[100:103], v[120:123], v[48:63]
 ds_read_b64_tr_b16 v[92:93], v234 offset:27904
 ds_read_b64_tr_b16 v[94:95], v234 offset:29184
 s_waitcnt lgkmcnt(11)
 v_mfma_f32_32x32x16_bf16 v[64:79], v[104:107], v[120:123], v[64:79]
 ds_read_b128 v[112:115], v236 offset:57344
 ds_read_b64_tr_b16 v[96:97], v233 offset:20480
 ds_read_b64_tr_b16 v[98:99], v233 offset:21760
 s_waitcnt lgkmcnt(11)
 v_mfma_f32_32x32x16_bf16 v[0:15], v[108:111], v[124:127], v[0:15]
 ds_read_b64_tr_b16 v[100:101], v233 offset:20544
 ds_read_b64_tr_b16 v[102:103], v233 offset:21824
 s_waitcnt lgkmcnt(11)
 v_mfma_f32_32x32x16_bf16 v[16:31], v[80:83], v[124:127], v[16:31]
 ds_read_b64_tr_b16 v[104:105], v233 offset:20608
 ds_read_b64_tr_b16 v[106:107], v233 offset:21888
 s_waitcnt lgkmcnt(11)
 v_mfma_f32_32x32x16_bf16 v[32:47], v[84:87], v[124:127], v[32:47]
 ds_read_b64_tr_b16 v[108:109], v233 offset:20672
 ds_read_b64_tr_b16 v[110:111], v233 offset:21952
 s_waitcnt lgkmcnt(11)
 v_mfma_f32_32x32x16_bf16 v[48:63], v[88:91], v[124:127], v[48:63]
 ds_read_b64_tr_b16 v[80:81], v233 offset:20736
 ds_read_b64_tr_b16 v[82:83], v233 offset:22016
 s_waitcnt lgkmcnt(11)
 v_mfma_f32_32x32x16_bf16 v[64:79], v[92:95], v[124:127], v[64:79]
 ds_read_b128 v[116:119], v236 offset:58368
 ds_read_b64_tr_b16 v[84:85], v233 offset:25600
 ds_read_b64_tr_b16 v[86:87], v233 offset:26880
 s_waitcnt lgkmcnt(11)
 v_mfma_f32_32x32x16_bf16 v[0:15], v[96:99], v[112:115], v[0:15]
 ds_read_b64_tr_b16 v[88:89], v233 offset:25664
 ds_read_b64_tr_b16 v[90:91], v233 offset:26944
 s_waitcnt lgkmcnt(11)
 v_mfma_f32_32x32x16_bf16 v[16:31], v[100:103], v[112:115], v[16:31]
 ds_read_b64_tr_b16 v[92:93], v233 offset:25728
 ds_read_b64_tr_b16 v[94:95], v233 offset:27008
 s_waitcnt lgkmcnt(11)
 v_mfma_f32_32x32x16_bf16 v[32:47], v[104:107], v[112:115], v[32:47]
 ds_read_b64_tr_b16 v[96:97], v233 offset:25792
 ds_read_b64_tr_b16 v[98:99], v233 offset:27072
 s_waitcnt lgkmcnt(11)
 v_mfma_f32_32x32x16_bf16 v[48:63], v[108:111], v[112:115], v[48:63]
 ds_read_b64_tr_b16 v[100:101], v233 offset:25856
 ds_read_b64_tr_b16 v[102:103], v233 offset:27136
 s_waitcnt lgkmcnt(11)
 v_mfma_f32_32x32x16_bf16 v[64:79], v[80:83], v[112:115], v[64:79]
 ds_read_b128 v[120:123], v237 offset:2048
 ds_read_b64_tr_b16 v[104:105], v233 offset:40960
 ds_read_b64_tr_b16 v[106:107], v233 offset:42240
 s_waitcnt lgkmcnt(11)
 v_mfma_f32_32x32x16_bf16 v[0:15], v[84:87], v[116:119], v[0:15]
 ds_read_b64_tr_b16 v[108:109], v233 offset:41024
 ds_read_b64_tr_b16 v[110:111], v233 offset:42304
 s_waitcnt lgkmcnt(11)
 v_mfma_f32_32x32x16_bf16 v[16:31], v[88:91], v[116:119], v[16:31]
 ds_read_b64_tr_b16 v[80:81], v233 offset:41088
 ds_read_b64_tr_b16 v[82:83], v233 offset:42368
 s_waitcnt lgkmcnt(11)
 v_mfma_f32_32x32x16_bf16 v[32:47], v[92:95], v[116:119], v[32:47]
 ds_read_b64_tr_b16 v[84:85], v233 offset:41152
 ds_read_b64_tr_b16 v[86:87], v233 offset:42432
 s_waitcnt lgkmcnt(11)
 v_mfma_f32_32x32x16_bf16 v[48:63], v[96:99], v[116:119], v[48:63]
 ds_read_b64_tr_b16 v[88:89], v233 offset:41216
 ds_read_b64_tr_b16 v[90:91], v233 offset:42496
 s_waitcnt lgkmcnt(11)
 v_mfma_f32_32x32x16_bf16 v[64:79], v[100:103], v[116:119], v[64:79]
 ds_read_b128 v[124:127], v237 offset:3072
 ds_read_b64_tr_b16 v[92:93], v233 offset:46080
 ds_read_b64_tr_b16 v[94:95], v233 offset:47360
 s_barrier
 s_waitcnt lgkmcnt(11)
 v_mfma_f32_32x32x16_bf16 v[0:15], v[104:107], v[120:123], v[0:15]
 ds_read_b64_tr_b16 v[96:97], v233 offset:46144
 ds_read_b64_tr_b16 v[98:99], v233 offset:47424
 s_waitcnt lgkmcnt(11)
 v_mfma_f32_32x32x16_bf16 v[16:31], v[108:111], v[120:123], v[16:31]
 ds_read_b64_tr_b16 v[100:101], v233 offset:46208
 ds_read_b64_tr_b16 v[102:103], v233 offset:47488
 s_waitcnt lgkmcnt(11)
 v_mfma_f32_32x32x16_bf16 v[32:47], v[80:83], v[120:123], v[32:47]
 ds_read_b64_tr_b16 v[104:105], v233 offset:46272
 ds_read_b64_tr_b16 v[106:107], v233 offset:47552
 s_waitcnt lgkmcnt(11)
 v_mfma_f32_32x32x16_bf16 v[48:63], v[84:87], v[120:123], v[48:63]
 ds_read_b64_tr_b16 v[108:109], v233 offset:46336
 ds_read_b64_tr_b16 v[110:111], v233 offset:47616
 s_waitcnt lgkmcnt(11)
 v_mfma_f32_32x32x16_bf16 v[64:79], v[88:91], v[120:123], v[64:79]
 ds_read_b128 v[112:115], v237 offset:8192
 ds_read_b64_tr_b16 v[80:81], v234 offset:2048
 ds_read_b64_tr_b16 v[82:83], v234 offset:3328
 s_waitcnt lgkmcnt(11)
 v_mfma_f32_32x32x16_bf16 v[0:15], v[92:95], v[124:127], v[0:15]
 ds_read_b64_tr_b16 v[84:85], v234 offset:2112
 ds_read_b64_tr_b16 v[86:87], v234 offset:3392
 s_waitcnt lgkmcnt(11)
 v_mfma_f32_32x32x16_bf16 v[16:31], v[96:99], v[124:127], v[16:31]
 ds_read_b64_tr_b16 v[88:89], v234 offset:2176
 ds_read_b64_tr_b16 v[90:91], v234 offset:3456
 s_waitcnt lgkmcnt(11)
 v_mfma_f32_32x32x16_bf16 v[32:47], v[100:103], v[124:127], v[32:47]
 ds_read_b64_tr_b16 v[92:93], v234 offset:2240
 ds_read_b64_tr_b16 v[94:95], v234 offset:3520
 s_waitcnt lgkmcnt(11)
 v_mfma_f32_32x32x16_bf16 v[48:63], v[104:107], v[124:127], v[48:63]
 ds_read_b64_tr_b16 v[96:97], v234 offset:2304
 ds_read_b64_tr_b16 v[98:99], v234 offset:3584
 s_waitcnt lgkmcnt(11)
 v_mfma_f32_32x32x16_bf16 v[64:79], v[108:111], v[124:127], v[64:79]
 ds_read_b128 v[116:119], v237 offset:9216
 ds_read_b64_tr_b16 v[100:101], v234 offset:7168
 ds_read_b64_tr_b16 v[102:103], v234 offset:8448
 s_waitcnt lgkmcnt(11)
 v_mfma_f32_32x32x16_bf16 v[0:15], v[80:83], v[112:115], v[0:15]
 ds_read_b64_tr_b16 v[104:105], v234 offset:7232
 ds_read_b64_tr_b16 v[106:107], v234 offset:8512
 s_waitcnt lgkmcnt(11)
 v_mfma_f32_32x32x16_bf16 v[16:31], v[84:87], v[112:115], v[16:31]
 ds_read_b64_tr_b16 v[108:109], v234 offset:7296
 ds_read_b64_tr_b16 v[110:111], v234 offset:8576
 s_waitcnt lgkmcnt(11)
 v_mfma_f32_32x32x16_bf16 v[32:47], v[88:91], v[112:115], v[32:47]
 ds_read_b64_tr_b16 v[80:81], v234 offset:7360
 ds_read_b64_tr_b16 v[82:83], v234 offset:8640
 s_waitcnt lgkmcnt(11)
 v_mfma_f32_32x32x16_bf16 v[48:63], v[92:95], v[112:115], v[48:63]
 ds_read_b64_tr_b16 v[84:85], v234 offset:7424
 ds_read_b64_tr_b16 v[86:87], v234 offset:8704
 s_waitcnt lgkmcnt(11)
 v_mfma_f32_32x32x16_bf16 v[64:79], v[96:99], v[112:115], v[64:79]
 ds_read_b128 v[120:123], v237 offset:14336
 ds_read_b64_tr_b16 v[88:89], v234 offset:12288
 ds_read_b64_tr_b16 v[90:91], v234 offset:13568
 s_waitcnt lgkmcnt(11)
 v_mfma_f32_32x32x16_bf16 v[0:15], v[100:103], v[116:119], v[0:15]
 ds_read_b64_tr_b16 v[92:93], v234 offset:12352
 ds_read_b64_tr_b16 v[94:95], v234 offset:13632
 s_waitcnt lgkmcnt(11)
 v_mfma_f32_32x32x16_bf16 v[16:31], v[104:107], v[116:119], v[16:31]
 ds_read_b64_tr_b16 v[96:97], v234 offset:12416
 ds_read_b64_tr_b16 v[98:99], v234 offset:13696
 s_waitcnt lgkmcnt(11)
 v_mfma_f32_32x32x16_bf16 v[32:47], v[108:111], v[116:119], v[32:47]
 ds_read_b64_tr_b16 v[100:101], v234 offset:12480
 ds_read_b64_tr_b16 v[102:103], v234 offset:13760
 s_waitcnt lgkmcnt(11)
 v_mfma_f32_32x32x16_bf16 v[48:63], v[80:83], v[116:119], v[48:63]
 ds_read_b64_tr_b16 v[104:105], v234 offset:12544
 ds_read_b64_tr_b16 v[106:107], v234 offset:13824
 s_waitcnt lgkmcnt(11)
 v_mfma_f32_32x32x16_bf16 v[64:79], v[84:87], v[116:119], v[64:79]
 ds_read_b128 v[124:127], v237 offset:15360
 ds_read_b64_tr_b16 v[108:109], v234 offset:17408
 ds_read_b64_tr_b16 v[110:111], v234 offset:18688
 s_barrier
 s_waitcnt lgkmcnt(11)
 v_mfma_f32_32x32x16_bf16 v[0:15], v[88:91], v[120:123], v[0:15]
 ds_read_b64_tr_b16 v[80:81], v234 offset:17472
 ds_read_b64_tr_b16 v[82:83], v234 offset:18752
 s_waitcnt lgkmcnt(11)
 v_mfma_f32_32x32x16_bf16 v[16:31], v[92:95], v[120:123], v[16:31]
 ds_read_b64_tr_b16 v[84:85], v234 offset:17536
 ds_read_b64_tr_b16 v[86:87], v234 offset:18816
 s_waitcnt lgkmcnt(11)
 v_mfma_f32_32x32x16_bf16 v[32:47], v[96:99], v[120:123], v[32:47]
 ds_read_b64_tr_b16 v[88:89], v234 offset:17600
 ds_read_b64_tr_b16 v[90:91], v234 offset:18880
 s_waitcnt lgkmcnt(11)
 v_mfma_f32_32x32x16_bf16 v[48:63], v[100:103], v[120:123], v[48:63]
 ds_read_b64_tr_b16 v[92:93], v234 offset:17664
 ds_read_b64_tr_b16 v[94:95], v234 offset:18944
 s_waitcnt lgkmcnt(11)
 v_mfma_f32_32x32x16_bf16 v[64:79], v[104:107], v[120:123], v[64:79]
 ds_read_b128 v[112:115], v236 offset:34816
 ds_read_b64_tr_b16 v[96:97], v232 offset:40960
 ds_read_b64_tr_b16 v[98:99], v232 offset:42240
 s_waitcnt lgkmcnt(11)
 v_mfma_f32_32x32x16_bf16 v[0:15], v[108:111], v[124:127], v[0:15]
 ds_read_b64_tr_b16 v[100:101], v232 offset:41024
 ds_read_b64_tr_b16 v[102:103], v232 offset:42304
 s_waitcnt lgkmcnt(11)
 v_mfma_f32_32x32x16_bf16 v[16:31], v[80:83], v[124:127], v[16:31]
 ds_read_b64_tr_b16 v[104:105], v232 offset:41088
 ds_read_b64_tr_b16 v[106:107], v232 offset:42368
 s_waitcnt lgkmcnt(11)
 v_mfma_f32_32x32x16_bf16 v[32:47], v[84:87], v[124:127], v[32:47]
 ds_read_b64_tr_b16 v[108:109], v232 offset:41152
 ds_read_b64_tr_b16 v[110:111], v232 offset:42432
 s_waitcnt lgkmcnt(11)
 v_mfma_f32_32x32x16_bf16 v[48:63], v[88:91], v[124:127], v[48:63]
 ds_read_b64_tr_b16 v[80:81], v232 offset:41216
 ds_read_b64_tr_b16 v[82:83], v232 offset:42496
 s_waitcnt lgkmcnt(11)
 v_mfma_f32_32x32x16_bf16 v[64:79], v[92:95], v[124:127], v[64:79]
 ds_read_b128 v[116:119], v236 offset:35840
 ds_read_b64_tr_b16 v[84:85], v232 offset:46080
 ds_read_b64_tr_b16 v[86:87], v232 offset:47360
 s_waitcnt lgkmcnt(11)
 v_mfma_f32_32x32x16_bf16 v[0:15], v[96:99], v[112:115], v[0:15]
 ds_read_b64_tr_b16 v[88:89], v232 offset:46144
 ds_read_b64_tr_b16 v[90:91], v232 offset:47424
 s_waitcnt lgkmcnt(11)
 v_mfma_f32_32x32x16_bf16 v[16:31], v[100:103], v[112:115], v[16:31]
 ds_read_b64_tr_b16 v[92:93], v232 offset:46208
 ds_read_b64_tr_b16 v[94:95], v232 offset:47488
 s_waitcnt lgkmcnt(11)
 v_mfma_f32_32x32x16_bf16 v[32:47], v[104:107], v[112:115], v[32:47]
 ds_read_b64_tr_b16 v[96:97], v232 offset:46272
 ds_read_b64_tr_b16 v[98:99], v232 offset:47552
 s_waitcnt lgkmcnt(11)
 v_mfma_f32_32x32x16_bf16 v[48:63], v[108:111], v[112:115], v[48:63]
 ds_read_b64_tr_b16 v[100:101], v232 offset:46336
 ds_read_b64_tr_b16 v[102:103], v232 offset:47616
 s_waitcnt lgkmcnt(11)
 v_mfma_f32_32x32x16_bf16 v[64:79], v[80:83], v[112:115], v[64:79]
 ds_read_b128 v[120:123], v238 offset:32768
 ds_read_b64_tr_b16 v[104:105], v232 offset:24576
 ds_read_b64_tr_b16 v[106:107], v232 offset:25856
 s_waitcnt lgkmcnt(11)
 v_mfma_f32_32x32x16_bf16 v[0:15], v[84:87], v[116:119], v[0:15]
 ds_read_b64_tr_b16 v[108:109], v232 offset:24640
 ds_read_b64_tr_b16 v[110:111], v232 offset:25920
 s_waitcnt lgkmcnt(11)
 v_mfma_f32_32x32x16_bf16 v[16:31], v[88:91], v[116:119], v[16:31]
 ds_read_b64_tr_b16 v[80:81], v232 offset:24704
 ds_read_b64_tr_b16 v[82:83], v232 offset:25984
 s_waitcnt lgkmcnt(11)
 v_mfma_f32_32x32x16_bf16 v[32:47], v[92:95], v[116:119], v[32:47]
 ds_read_b64_tr_b16 v[84:85], v232 offset:24768
 ds_read_b64_tr_b16 v[86:87], v232 offset:26048
 s_waitcnt lgkmcnt(11)
 v_mfma_f32_32x32x16_bf16 v[48:63], v[96:99], v[116:119], v[48:63]
 ds_read_b64_tr_b16 v[88:89], v232 offset:24832
 ds_read_b64_tr_b16 v[90:91], v232 offset:26112
 s_waitcnt lgkmcnt(11)
 v_mfma_f32_32x32x16_bf16 v[64:79], v[100:103], v[116:119], v[64:79]
 ds_read_b128 v[124:127], v238 offset:33792
 ds_read_b64_tr_b16 v[92:93], v232 offset:29696
 ds_read_b64_tr_b16 v[94:95], v232 offset:30976
 s_barrier
 s_waitcnt lgkmcnt(11)
 v_mfma_f32_32x32x16_bf16 v[0:15], v[104:107], v[120:123], v[0:15]
 ds_read_b64_tr_b16 v[96:97], v232 offset:29760
 ds_read_b64_tr_b16 v[98:99], v232 offset:31040
 s_waitcnt lgkmcnt(11)
 v_mfma_f32_32x32x16_bf16 v[16:31], v[108:111], v[120:123], v[16:31]
 ds_read_b64_tr_b16 v[100:101], v232 offset:29824
 ds_read_b64_tr_b16 v[102:103], v232 offset:31104
 s_waitcnt lgkmcnt(11)
 v_mfma_f32_32x32x16_bf16 v[32:47], v[80:83], v[120:123], v[32:47]
 ds_read_b64_tr_b16 v[104:105], v232 offset:29888
 ds_read_b64_tr_b16 v[106:107], v232 offset:31168
 s_waitcnt lgkmcnt(11)
 v_mfma_f32_32x32x16_bf16 v[48:63], v[84:87], v[120:123], v[48:63]
 ds_read_b64_tr_b16 v[108:109], v232 offset:29952
 ds_read_b64_tr_b16 v[110:111], v232 offset:31232
 s_waitcnt lgkmcnt(11)
 v_mfma_f32_32x32x16_bf16 v[64:79], v[88:91], v[120:123], v[64:79]
 ds_read_b128 v[112:115], v236 offset:0
 ds_read_b64_tr_b16 v[80:81], v233 offset:53248
 ds_read_b64_tr_b16 v[82:83], v233 offset:54528
 s_waitcnt lgkmcnt(11)
 v_mfma_f32_32x32x16_bf16 v[0:15], v[92:95], v[124:127], v[0:15]
 ds_read_b64_tr_b16 v[84:85], v233 offset:53312
 ds_read_b64_tr_b16 v[86:87], v233 offset:54592
 s_waitcnt lgkmcnt(11)
 v_mfma_f32_32x32x16_bf16 v[16:31], v[96:99], v[124:127], v[16:31]
 ds_read_b64_tr_b16 v[88:89], v233 offset:53376
 ds_read_b64_tr_b16 v[90:91], v233 offset:54656
 s_waitcnt lgkmcnt(11)
 v_mfma_f32_32x32x16_bf16 v[32:47], v[100:103], v[124:127], v[32:47]
 ds_read_b64_tr_b16 v[92:93], v233 offset:53440
 ds_read_b64_tr_b16 v[94:95], v233 offset:54720
 s_waitcnt lgkmcnt(11)
 v_mfma_f32_32x32x16_bf16 v[48:63], v[104:107], v[124:127], v[48:63]
 ds_read_b64_tr_b16 v[96:97], v233 offset:53504
 ds_read_b64_tr_b16 v[98:99], v233 offset:54784
 s_waitcnt lgkmcnt(11)
 v_mfma_f32_32x32x16_bf16 v[64:79], v[108:111], v[124:127], v[64:79]
 ds_read_b128 v[116:119], v236 offset:1024
 ds_read_b64_tr_b16 v[100:101], v233 offset:58368
 ds_read_b64_tr_b16 v[102:103], v233 offset:59648
 s_waitcnt lgkmcnt(11)
 v_mfma_f32_32x32x16_bf16 v[0:15], v[80:83], v[112:115], v[0:15]
 ds_read_b64_tr_b16 v[104:105], v233 offset:58432
 ds_read_b64_tr_b16 v[106:107], v233 offset:59712
 s_waitcnt lgkmcnt(11)
 v_mfma_f32_32x32x16_bf16 v[16:31], v[84:87], v[112:115], v[16:31]
 ds_read_b64_tr_b16 v[108:109], v233 offset:58496
 ds_read_b64_tr_b16 v[110:111], v233 offset:59776
 s_waitcnt lgkmcnt(11)
 v_mfma_f32_32x32x16_bf16 v[32:47], v[88:91], v[112:115], v[32:47]
 ds_read_b64_tr_b16 v[80:81], v233 offset:58560
 ds_read_b64_tr_b16 v[82:83], v233 offset:59840
 s_waitcnt lgkmcnt(11)
 v_mfma_f32_32x32x16_bf16 v[48:63], v[92:95], v[112:115], v[48:63]
 ds_read_b64_tr_b16 v[84:85], v233 offset:58624
 ds_read_b64_tr_b16 v[86:87], v233 offset:59904
 s_waitcnt lgkmcnt(11)
 v_mfma_f32_32x32x16_bf16 v[64:79], v[96:99], v[112:115], v[64:79]
 ds_read_b128 v[120:123], v236 offset:6144
 ds_read_b64_tr_b16 v[88:89], v233 offset:30720
 ds_read_b64_tr_b16 v[90:91], v233 offset:32000
 s_waitcnt lgkmcnt(11)
 v_mfma_f32_32x32x16_bf16 v[0:15], v[100:103], v[116:119], v[0:15]
 ds_read_b64_tr_b16 v[92:93], v233 offset:30784
 ds_read_b64_tr_b16 v[94:95], v233 offset:32064
 s_waitcnt lgkmcnt(11)
 v_mfma_f32_32x32x16_bf16 v[16:31], v[104:107], v[116:119], v[16:31]
 ds_read_b64_tr_b16 v[96:97], v233 offset:30848
 ds_read_b64_tr_b16 v[98:99], v233 offset:32128
 s_waitcnt lgkmcnt(11)
 v_mfma_f32_32x32x16_bf16 v[32:47], v[108:111], v[116:119], v[32:47]
 ds_read_b64_tr_b16 v[100:101], v233 offset:30912
 ds_read_b64_tr_b16 v[102:103], v233 offset:32192
 s_waitcnt lgkmcnt(11)
 v_mfma_f32_32x32x16_bf16 v[48:63], v[80:83], v[116:119], v[48:63]
 ds_read_b64_tr_b16 v[104:105], v233 offset:30976
 ds_read_b64_tr_b16 v[106:107], v233 offset:32256
 s_waitcnt lgkmcnt(11)
 v_mfma_f32_32x32x16_bf16 v[64:79], v[84:87], v[116:119], v[64:79]
 ds_read_b128 v[124:127], v236 offset:7168
 ds_read_b64_tr_b16 v[108:109], v233 offset:35840
 ds_read_b64_tr_b16 v[110:111], v233 offset:37120
 s_barrier
 s_waitcnt lgkmcnt(11)
 v_mfma_f32_32x32x16_bf16 v[0:15], v[88:91], v[120:123], v[0:15]
 ds_read_b64_tr_b16 v[80:81], v233 offset:35904
 ds_read_b64_tr_b16 v[82:83], v233 offset:37184
 s_waitcnt lgkmcnt(11)
 v_mfma_f32_32x32x16_bf16 v[16:31], v[92:95], v[120:123], v[16:31]
 ds_read_b64_tr_b16 v[84:85], v233 offset:35968
 ds_read_b64_tr_b16 v[86:87], v233 offset:37248
 s_waitcnt lgkmcnt(11)
 v_mfma_f32_32x32x16_bf16 v[32:47], v[96:99], v[120:123], v[32:47]
 ds_read_b64_tr_b16 v[88:89], v233 offset:36032
 ds_read_b64_tr_b16 v[90:91], v233 offset:37312
 s_waitcnt lgkmcnt(11)
 v_mfma_f32_32x32x16_bf16 v[48:63], v[100:103], v[120:123], v[48:63]
 ds_read_b64_tr_b16 v[92:93], v233 offset:36096
 ds_read_b64_tr_b16 v[94:95], v233 offset:37376
 s_waitcnt lgkmcnt(11)
 v_mfma_f32_32x32x16_bf16 v[64:79], v[104:107], v[120:123], v[64:79]
 ds_read_b128 v[112:115], v236 offset:51200
 ds_read_b64_tr_b16 v[96:97], v234 offset:22528
 ds_read_b64_tr_b16 v[98:99], v234 offset:23808
 s_waitcnt lgkmcnt(11)
 v_mfma_f32_32x32x16_bf16 v[0:15], v[108:111], v[124:127], v[0:15]
 ds_read_b64_tr_b16 v[100:101], v234 offset:22592
 ds_read_b64_tr_b16 v[102:103], v234 offset:23872
 s_waitcnt lgkmcnt(11)
 v_mfma_f32_32x32x16_bf16 v[16:31], v[80:83], v[124:127], v[16:31]
 ds_read_b64_tr_b16 v[104:105], v234 offset:22656
 ds_read_b64_tr_b16 v[106:107], v234 offset:23936
 s_waitcnt lgkmcnt(11)
 v_mfma_f32_32x32x16_bf16 v[32:47], v[84:87], v[124:127], v[32:47]
 ds_read_b64_tr_b16 v[108:109], v234 offset:22720
 ds_read_b64_tr_b16 v[110:111], v234 offset:24000
 s_waitcnt lgkmcnt(11)
 v_mfma_f32_32x32x16_bf16 v[48:63], v[88:91], v[124:127], v[48:63]
 ds_read_b64_tr_b16 v[80:81], v234 offset:22784
 ds_read_b64_tr_b16 v[82:83], v234 offset:24064
 s_waitcnt lgkmcnt(11)
 v_mfma_f32_32x32x16_bf16 v[64:79], v[92:95], v[124:127], v[64:79]
 ds_read_b128 v[116:119], v236 offset:52224
 ds_read_b64_tr_b16 v[84:85], v234 offset:27648
 ds_read_b64_tr_b16 v[86:87], v234 offset:28928
 s_waitcnt lgkmcnt(11)
 v_mfma_f32_32x32x16_bf16 v[0:15], v[96:99], v[112:115], v[0:15]
 ds_read_b64_tr_b16 v[88:89], v234 offset:27712
 ds_read_b64_tr_b16 v[90:91], v234 offset:28992
 s_waitcnt lgkmcnt(11)
 v_mfma_f32_32x32x16_bf16 v[16:31], v[100:103], v[112:115], v[16:31]
 ds_read_b64_tr_b16 v[92:93], v234 offset:27776
 ds_read_b64_tr_b16 v[94:95], v234 offset:29056
 s_waitcnt lgkmcnt(11)
 v_mfma_f32_32x32x16_bf16 v[32:47], v[104:107], v[112:115], v[32:47]
 ds_read_b64_tr_b16 v[96:97], v234 offset:27840
 ds_read_b64_tr_b16 v[98:99], v234 offset:29120
 s_waitcnt lgkmcnt(11)
 v_mfma_f32_32x32x16_bf16 v[48:63], v[108:111], v[112:115], v[48:63]
 ds_read_b64_tr_b16 v[100:101], v234 offset:27904
 ds_read_b64_tr_b16 v[102:103], v234 offset:29184
 s_waitcnt lgkmcnt(11)
 v_mfma_f32_32x32x16_bf16 v[64:79], v[80:83], v[112:115], v[64:79]
 ds_read_b128 v[120:123], v236 offset:57344
 ds_read_b64_tr_b16 v[104:105], v233 offset:20480
 ds_read_b64_tr_b16 v[106:107], v233 offset:21760
 s_waitcnt lgkmcnt(11)
 v_mfma_f32_32x32x16_bf16 v[0:15], v[84:87], v[116:119], v[0:15]
 ds_read_b64_tr_b16 v[108:109], v233 offset:20544
 ds_read_b64_tr_b16 v[110:111], v233 offset:21824
 s_waitcnt lgkmcnt(11)
 v_mfma_f32_32x32x16_bf16 v[16:31], v[88:91], v[116:119], v[16:31]
 ds_read_b64_tr_b16 v[80:81], v233 offset:20608
 ds_read_b64_tr_b16 v[82:83], v233 offset:21888
 s_waitcnt lgkmcnt(11)
 v_mfma_f32_32x32x16_bf16 v[32:47], v[92:95], v[116:119], v[32:47]
 ds_read_b64_tr_b16 v[84:85], v233 offset:20672
 ds_read_b64_tr_b16 v[86:87], v233 offset:21952
 s_waitcnt lgkmcnt(11)
 v_mfma_f32_32x32x16_bf16 v[48:63], v[96:99], v[116:119], v[48:63]
 ds_read_b64_tr_b16 v[88:89], v233 offset:20736
 ds_read_b64_tr_b16 v[90:91], v233 offset:22016
 s_waitcnt lgkmcnt(11)
 v_mfma_f32_32x32x16_bf16 v[64:79], v[100:103], v[116:119], v[64:79]
 ds_read_b128 v[124:127], v236 offset:58368
 ds_read_b64_tr_b16 v[92:93], v233 offset:25600
 ds_read_b64_tr_b16 v[94:95], v233 offset:26880
 s_waitcnt lgkmcnt(11)
 v_mfma_f32_32x32x16_bf16 v[0:15], v[104:107], v[120:123], v[0:15]
 ds_read_b64_tr_b16 v[96:97], v233 offset:25664
 ds_read_b64_tr_b16 v[98:99], v233 offset:26944
 s_waitcnt lgkmcnt(11)
 v_mfma_f32_32x32x16_bf16 v[16:31], v[108:111], v[120:123], v[16:31]
 ds_read_b64_tr_b16 v[100:101], v233 offset:25728
 ds_read_b64_tr_b16 v[102:103], v233 offset:27008
 s_waitcnt lgkmcnt(11)
 v_mfma_f32_32x32x16_bf16 v[32:47], v[80:83], v[120:123], v[32:47]
 ds_read_b64_tr_b16 v[104:105], v233 offset:25792
 ds_read_b64_tr_b16 v[106:107], v233 offset:27072
 s_waitcnt lgkmcnt(11)
 v_mfma_f32_32x32x16_bf16 v[48:63], v[84:87], v[120:123], v[48:63]
 ds_read_b64_tr_b16 v[108:109], v233 offset:25856
 ds_read_b64_tr_b16 v[110:111], v233 offset:27136
 s_waitcnt lgkmcnt(11)
 v_mfma_f32_32x32x16_bf16 v[64:79], v[88:91], v[120:123], v[64:79]
 s_waitcnt lgkmcnt(8)
 v_mfma_f32_32x32x16_bf16 v[0:15], v[92:95], v[124:127], v[0:15]
 s_waitcnt lgkmcnt(6)
 v_mfma_f32_32x32x16_bf16 v[16:31], v[96:99], v[124:127], v[16:31]
 s_waitcnt lgkmcnt(4)
 v_mfma_f32_32x32x16_bf16 v[32:47], v[100:103], v[124:127], v[32:47]
 s_waitcnt lgkmcnt(2)
 v_mfma_f32_32x32x16_bf16 v[48:63], v[104:107], v[124:127], v[48:63]
 s_waitcnt lgkmcnt(0)
 v_mfma_f32_32x32x16_bf16 v[64:79], v[108:111], v[124:127], v[64:79]
 s_mul_i32 s49, s62, 10240
 s_add_u32 s57, s49, 4096
 s_add_u32 s58, s49, 8192
 s_nop 5
 v_cvt_pk_bf16_f32 v112, v0, v1
 v_cvt_pk_bf16_f32 v113, v2, v3
 v_cvt_pk_bf16_f32 v114, v4, v5
 v_cvt_pk_bf16_f32 v115, v6, v7
 buffer_store_dwordx4 v[112:115], v243, s[72:75], s49 offen offset:0 sc1
 v_cvt_pk_bf16_f32 v116, v8, v9
 v_cvt_pk_bf16_f32 v117, v10, v11
 v_cvt_pk_bf16_f32 v118, v12, v13
 v_cvt_pk_bf16_f32 v119, v14, v15
 buffer_store_dwordx4 v[116:119], v243, s[72:75], s49 offen offset:1024 sc1
 v_cvt_pk_bf16_f32 v120, v16, v17
 v_cvt_pk_bf16_f32 v121, v18, v19
 v_cvt_pk_bf16_f32 v122, v20, v21
 v_cvt_pk_bf16_f32 v123, v22, v23
 buffer_store_dwordx4 v[120:123], v243, s[72:75], s49 offen offset:2048 sc1
 v_cvt_pk_bf16_f32 v124, v24, v25
 v_cvt_pk_bf16_f32 v125, v26, v27
 v_cvt_pk_bf16_f32 v126, v28, v29
 v_cvt_pk_bf16_f32 v127, v30, v31
 buffer_store_dwordx4 v[124:127], v243, s[72:75], s49 offen offset:3072 sc1
 v_cvt_pk_bf16_f32 v128, v32, v33
 v_cvt_pk_bf16_f32 v129, v34, v35
 v_cvt_pk_bf16_f32 v130, v36, v37
 v_cvt_pk_bf16_f32 v131, v38, v39
 buffer_store_dwordx4 v[128:131], v243, s[72:75], s57 offen offset:0 sc1
 v_cvt_pk_bf16_f32 v132, v40, v41
 v_cvt_pk_bf16_f32 v133, v42, v43
 v_cvt_pk_bf16_f32 v134, v44, v45
 v_cvt_pk_bf16_f32 v135, v46, v47
 buffer_store_dwordx4 v[132:135], v243, s[72:75], s57 offen offset:1024 sc1
 v_cvt_pk_bf16_f32 v136, v48, v49
 v_cvt_pk_bf16_f32 v137, v50, v51
 v_cvt_pk_bf16_f32 v138, v52, v53
 v_cvt_pk_bf16_f32 v139, v54, v55
 buffer_store_dwordx4 v[136:139], v243, s[72:75], s57 offen offset:2048 sc1
 v_cvt_pk_bf16_f32 v140, v56, v57
 v_cvt_pk_bf16_f32 v141, v58, v59
 v_cvt_pk_bf16_f32 v142, v60, v61
 v_cvt_pk_bf16_f32 v143, v62, v63
 buffer_store_dwordx4 v[140:143], v243, s[72:75], s57 offen offset:3072 sc1
 v_cvt_pk_bf16_f32 v144, v64, v65
 v_cvt_pk_bf16_f32 v145, v66, v67
 v_cvt_pk_bf16_f32 v146, v68, v69
 v_cvt_pk_bf16_f32 v147, v70, v71
 buffer_store_dwordx4 v[144:147], v243, s[72:75], s58 offen offset:0 sc1
 v_cvt_pk_bf16_f32 v148, v72, v73
 v_cvt_pk_bf16_f32 v149, v74, v75
 v_cvt_pk_bf16_f32 v150, v76, v77
 v_cvt_pk_bf16_f32 v151, v78, v79
 buffer_store_dwordx4 v[148:151], v243, s[72:75], s58 offen offset:1024 sc1
 s_branch K_final
K_B:
 s_cmp_eq_u32 s62, 1
 s_cbranch_scc0 K_nopf
 s_getpc_b64 s[64:65]
K_pc:
 s_sub_u32 s64, s64, K_pc-concat_heads__gqa_block_cached__mha_block_cached__near_ridge_kernel
 s_subb_u32 s65, s65, 0
 s_and_b32 s65, s65, 0xffff
 s_mov_b32 s66, K_codeend-concat_heads__gqa_block_cached__mha_block_cached__near_ridge_kernel
 s_mov_b32 s67, 0x20000
 s_lshr_b32 s44, s2, 3
 s_lshl_b32 s44, s44, 7
 v_lshlrev_b32 v244, 12, v250
 buffer_load_dword v245, v244, s[64:67], s44 offen
K_nopf:
 s_add_u32 s95, s60, s63
 s_add_u32 s95, s95, s62
 s_lshr_b32 s78, s82, 2
 s_lshl_b32 s42, s78, 11
 s_add_u32 s42, s42, 41943040
 s_add_u32 s8, s16, s42
 s_addc_u32 s9, s17, 0
 s_and_b32 s9, s9, 0xffff
 s_mov_b32 s10, 67584
 s_mov_b32 s11, 0x20000
 v_and_b32 v246, 15, v250
 v_lshlrev_b32 v246, 7, v246
 v_lshrrev_b32 v247, 4, v250
 v_min_u32 v247, 2, v247
 v_lshlrev_b32 v247, 15, v247
 v_add_u32 v246, v246, v247
 s_lshl_b32 s44, s78, 4
 v_mov_b32 v248, s44
 s_cmp_eq_u32 s95, 0
 s_cbranch_scc0 K_nz
 buffer_load_dword v247, v246, s[8:11], 0 offen sc1
K_nz:
 s_barrier
 ds_read_b128 v[0:3], v236 offset:0
 ds_read_b128 v[4:7], v237 offset:0
 s_waitcnt lgkmcnt(0)
 s_barrier
 ds_read_b128 v[8:11], v238 offset:0
 ds_read_b128 v[12:15], v239 offset:0
 s_waitcnt lgkmcnt(0)
 s_barrier
 ds_read_b128 v[16:19], v236 offset:12288
 ds_read_b128 v[20:23], v237 offset:12288
 s_waitcnt lgkmcnt(0)
 s_barrier
 ds_read_b128 v[24:27], v238 offset:12288
 ds_read_b128 v[28:31], v239 offset:12288
 s_waitcnt lgkmcnt(0)
 s_barrier
 ds_read_b128 v[32:35], v236 offset:24576
 ds_read_b128 v[36:39], v237 offset:24576
 s_waitcnt lgkmcnt(0)
 s_barrier
 ds_read_b64_tr_b16 v[96:97], v232 offset:0
 ds_read_b64_tr_b16 v[98:99], v232 offset:1024
 ds_read_b64_tr_b16 v[100:101], v233 offset:0
 ds_read_b64_tr_b16 v[102:103], v233 offset:1024
 ds_read_b64_tr_b16 v[104:105], v234 offset:0
 ds_read_b64_tr_b16 v[106:107], v234 offset:1024
 ds_read_b64_tr_b16 v[108:109], v235 offset:0
 ds_read_b64_tr_b16 v[110:111], v235 offset:1024
 ds_read_b64_tr_b16 v[112:113], v232 offset:4096
 ds_read_b64_tr_b16 v[114:115], v232 offset:5120
 ds_read_b64_tr_b16 v[116:117], v233 offset:4096
 ds_read_b64_tr_b16 v[118:119], v233 offset:5120
 ds_read_b64_tr_b16 v[120:121], v234 offset:4096
 ds_read_b64_tr_b16 v[122:123], v234 offset:5120
 s_waitcnt lgkmcnt(12)
 v_mfma_f32_32x32x16_bf16 v[152:167], v[96:99], v[0:3], 0
 ds_read_b64_tr_b16 v[124:125], v235 offset:4096
 ds_read_b64_tr_b16 v[126:127], v235 offset:5120
 s_waitcnt lgkmcnt(12)
 v_mfma_f32_32x32x16_bf16 v[168:183], v[100:103], v[0:3], 0
 s_waitcnt lgkmcnt(10)
 v_mfma_f32_32x32x16_bf16 v[184:199], v[104:107], v[0:3], 0
 s_waitcnt lgkmcnt(8)
 v_mfma_f32_32x32x16_bf16 v[200:215], v[108:111], v[0:3], 0
 s_waitcnt lgkmcnt(6)
 v_mfma_f32_32x32x16_bf16 v[152:167], v[112:115], v[4:7], v[152:167]
 s_waitcnt lgkmcnt(4)
 v_mfma_f32_32x32x16_bf16 v[168:183], v[116:119], v[4:7], v[168:183]
 s_waitcnt lgkmcnt(2)
 v_mfma_f32_32x32x16_bf16 v[184:199], v[120:123], v[4:7], v[184:199]
 s_waitcnt lgkmcnt(0)
 v_mfma_f32_32x32x16_bf16 v[200:215], v[124:127], v[4:7], v[200:215]
 ds_read_b128 v[40:43], v238 offset:24576
 ds_read_b128 v[44:47], v239 offset:24576
 s_waitcnt lgkmcnt(0)
 s_cmp_eq_u32 s95, 0
 s_cbranch_scc0 K_na
 s_waitcnt vmcnt(0)
 s_mov_b32 s44, 0
K_pick:
 s_add_u32 s44, s44, 1
 v_cmp_eq_u32 vcc, s44, v247
 s_cbranch_vccnz K_pick
 v_mov_b32 v249, s44
 s_mov_b64 exec, 1
 global_store_dword v248, v249, s[76:77] sc1
 s_mov_b64 exec, -1
K_na:
 s_barrier
 ds_read_b128 v[48:51], v236 offset:0
 ds_read_b128 v[52:55], v237 offset:0
 s_waitcnt lgkmcnt(0)
 s_barrier
 ds_read_b64_tr_b16 v[96:97], v232 offset:24576
 ds_read_b64_tr_b16 v[98:99], v232 offset:25600
 ds_read_b64_tr_b16 v[100:101], v233 offset:24576
 ds_read_b64_tr_b16 v[102:103], v233 offset:25600
 ds_read_b64_tr_b16 v[104:105], v234 offset:24576
 ds_read_b64_tr_b16 v[106:107], v234 offset:25600
 ds_read_b64_tr_b16 v[108:109], v235 offset:24576
 ds_read_b64_tr_b16 v[110:111], v235 offset:25600
 ds_read_b64_tr_b16 v[112:113], v232 offset:28672
 ds_read_b64_tr_b16 v[114:115], v232 offset:29696
 ds_read_b64_tr_b16 v[116:117], v233 offset:28672
 ds_read_b64_tr_b16 v[118:119], v233 offset:29696
 ds_read_b64_tr_b16 v[120:121], v234 offset:28672
 ds_read_b64_tr_b16 v[122:123], v234 offset:29696
 s_waitcnt lgkmcnt(12)
 v_mfma_f32_32x32x16_bf16 v[152:167], v[96:99], v[8:11], v[152:167]
 ds_read_b64_tr_b16 v[124:125], v235 offset:28672
 ds_read_b64_tr_b16 v[126:127], v235 offset:29696
 s_waitcnt lgkmcnt(12)
 v_mfma_f32_32x32x16_bf16 v[168:183], v[100:103], v[8:11], v[168:183]
 s_waitcnt lgkmcnt(10)
 v_mfma_f32_32x32x16_bf16 v[184:199], v[104:107], v[8:11], v[184:199]
 s_waitcnt lgkmcnt(8)
 v_mfma_f32_32x32x16_bf16 v[200:215], v[108:111], v[8:11], v[200:215]
 s_waitcnt lgkmcnt(6)
 v_mfma_f32_32x32x16_bf16 v[152:167], v[112:115], v[12:15], v[152:167]
 s_waitcnt lgkmcnt(4)
 v_mfma_f32_32x32x16_bf16 v[168:183], v[116:119], v[12:15], v[168:183]
 s_waitcnt lgkmcnt(2)
 v_mfma_f32_32x32x16_bf16 v[184:199], v[120:123], v[12:15], v[184:199]
 s_waitcnt lgkmcnt(0)
 v_mfma_f32_32x32x16_bf16 v[200:215], v[124:127], v[12:15], v[200:215]
 ds_read_b128 v[56:59], v238 offset:0
 ds_read_b128 v[60:63], v239 offset:0
 s_waitcnt lgkmcnt(0)
 s_barrier
 ds_read_b128 v[64:67], v236 offset:12288
 ds_read_b128 v[68:71], v237 offset:12288
 s_waitcnt lgkmcnt(0)
 s_barrier
 ds_read_b64_tr_b16 v[96:97], v232 offset:0
 ds_read_b64_tr_b16 v[98:99], v232 offset:1024
 ds_read_b64_tr_b16 v[100:101], v233 offset:0
 ds_read_b64_tr_b16 v[102:103], v233 offset:1024
 ds_read_b64_tr_b16 v[104:105], v234 offset:0
 ds_read_b64_tr_b16 v[106:107], v234 offset:1024
 ds_read_b64_tr_b16 v[108:109], v235 offset:0
 ds_read_b64_tr_b16 v[110:111], v235 offset:1024
 ds_read_b64_tr_b16 v[112:113], v232 offset:4096
 ds_read_b64_tr_b16 v[114:115], v232 offset:5120
 ds_read_b64_tr_b16 v[116:117], v233 offset:4096
 ds_read_b64_tr_b16 v[118:119], v233 offset:5120
 ds_read_b64_tr_b16 v[120:121], v234 offset:4096
 ds_read_b64_tr_b16 v[122:123], v234 offset:5120
 s_waitcnt lgkmcnt(12)
 v_mfma_f32_32x32x16_bf16 v[152:167], v[96:99], v[16:19], v[152:167]
 ds_read_b64_tr_b16 v[124:125], v235 offset:4096
 ds_read_b64_tr_b16 v[126:127], v235 offset:5120
 s_waitcnt lgkmcnt(12)
 v_mfma_f32_32x32x16_bf16 v[168:183], v[100:103], v[16:19], v[168:183]
 s_waitcnt lgkmcnt(10)
 v_mfma_f32_32x32x16_bf16 v[184:199], v[104:107], v[16:19], v[184:199]
 s_waitcnt lgkmcnt(8)
 v_mfma_f32_32x32x16_bf16 v[200:215], v[108:111], v[16:19], v[200:215]
 s_waitcnt lgkmcnt(6)
 v_mfma_f32_32x32x16_bf16 v[152:167], v[112:115], v[20:23], v[152:167]
 s_waitcnt lgkmcnt(4)
 v_mfma_f32_32x32x16_bf16 v[168:183], v[116:119], v[20:23], v[168:183]
 s_waitcnt lgkmcnt(2)
 v_mfma_f32_32x32x16_bf16 v[184:199], v[120:123], v[20:23], v[184:199]
 s_waitcnt lgkmcnt(0)
 v_mfma_f32_32x32x16_bf16 v[200:215], v[124:127], v[20:23], v[200:215]
 ds_read_b128 v[72:75], v238 offset:12288
 ds_read_b128 v[76:79], v239 offset:12288
 s_waitcnt lgkmcnt(0)
 s_barrier
 ds_read_b128 v[80:83], v236 offset:24576
 ds_read_b128 v[84:87], v237 offset:24576
 s_waitcnt lgkmcnt(0)
 s_barrier
 ds_read_b64_tr_b16 v[96:97], v232 offset:24576
 ds_read_b64_tr_b16 v[98:99], v232 offset:25600
 ds_read_b64_tr_b16 v[100:101], v233 offset:24576
 ds_read_b64_tr_b16 v[102:103], v233 offset:25600
 ds_read_b64_tr_b16 v[104:105], v234 offset:24576
 ds_read_b64_tr_b16 v[106:107], v234 offset:25600
 ds_read_b64_tr_b16 v[108:109], v235 offset:24576
 ds_read_b64_tr_b16 v[110:111], v235 offset:25600
 ds_read_b64_tr_b16 v[112:113], v232 offset:28672
 ds_read_b64_tr_b16 v[114:115], v232 offset:29696
 ds_read_b64_tr_b16 v[116:117], v233 offset:28672
 ds_read_b64_tr_b16 v[118:119], v233 offset:29696
 ds_read_b64_tr_b16 v[120:121], v234 offset:28672
 ds_read_b64_tr_b16 v[122:123], v234 offset:29696
 s_waitcnt lgkmcnt(12)
 v_mfma_f32_32x32x16_bf16 v[152:167], v[96:99], v[24:27], v[152:167]
 ds_read_b64_tr_b16 v[124:125], v235 offset:28672
 ds_read_b64_tr_b16 v[126:127], v235 offset:29696
 s_waitcnt lgkmcnt(12)
 v_mfma_f32_32x32x16_bf16 v[168:183], v[100:103], v[24:27], v[168:183]
 s_waitcnt lgkmcnt(10)
 v_mfma_f32_32x32x16_bf16 v[184:199], v[104:107], v[24:27], v[184:199]
 s_waitcnt lgkmcnt(8)
 v_mfma_f32_32x32x16_bf16 v[200:215], v[108:111], v[24:27], v[200:215]
 s_waitcnt lgkmcnt(6)
 v_mfma_f32_32x32x16_bf16 v[152:167], v[112:115], v[28:31], v[152:167]
 s_waitcnt lgkmcnt(4)
 v_mfma_f32_32x32x16_bf16 v[168:183], v[116:119], v[28:31], v[168:183]
 s_waitcnt lgkmcnt(2)
 v_mfma_f32_32x32x16_bf16 v[184:199], v[120:123], v[28:31], v[184:199]
 s_waitcnt lgkmcnt(0)
 v_mfma_f32_32x32x16_bf16 v[200:215], v[124:127], v[28:31], v[200:215]
 ds_read_b128 v[88:91], v238 offset:24576
 ds_read_b128 v[92:95], v239 offset:24576
 s_waitcnt lgkmcnt(0)
 s_barrier
 ds_read_b128 v[128:131], v236 offset:0
 ds_read_b128 v[132:135], v237 offset:0
 s_waitcnt lgkmcnt(0)
 s_barrier
 ds_read_b64_tr_b16 v[96:97], v232 offset:0
 ds_read_b64_tr_b16 v[98:99], v232 offset:1024
 ds_read_b64_tr_b16 v[100:101], v233 offset:0
 ds_read_b64_tr_b16 v[102:103], v233 offset:1024
 ds_read_b64_tr_b16 v[104:105], v234 offset:0
 ds_read_b64_tr_b16 v[106:107], v234 offset:1024
 ds_read_b64_tr_b16 v[108:109], v235 offset:0
 ds_read_b64_tr_b16 v[110:111], v235 offset:1024
 ds_read_b64_tr_b16 v[112:113], v232 offset:4096
 ds_read_b64_tr_b16 v[114:115], v232 offset:5120
 ds_read_b64_tr_b16 v[116:117], v233 offset:4096
 ds_read_b64_tr_b16 v[118:119], v233 offset:5120
 ds_read_b64_tr_b16 v[120:121], v234 offset:4096
 ds_read_b64_tr_b16 v[122:123], v234 offset:5120
 s_waitcnt lgkmcnt(12)
 v_mfma_f32_32x32x16_bf16 v[152:167], v[96:99], v[32:35], v[152:167]
 ds_read_b64_tr_b16 v[124:125], v235 offset:4096
 ds_read_b64_tr_b16 v[126:127], v235 offset:5120
 s_waitcnt lgkmcnt(12)
 v_mfma_f32_32x32x16_bf16 v[168:183], v[100:103], v[32:35], v[168:183]
 s_waitcnt lgkmcnt(10)
 v_mfma_f32_32x32x16_bf16 v[184:199], v[104:107], v[32:35], v[184:199]
 s_waitcnt lgkmcnt(8)
 v_mfma_f32_32x32x16_bf16 v[200:215], v[108:111], v[32:35], v[200:215]
 s_waitcnt lgkmcnt(6)
 v_mfma_f32_32x32x16_bf16 v[152:167], v[112:115], v[36:39], v[152:167]
 s_waitcnt lgkmcnt(4)
 v_mfma_f32_32x32x16_bf16 v[168:183], v[116:119], v[36:39], v[168:183]
 s_waitcnt lgkmcnt(2)
 v_mfma_f32_32x32x16_bf16 v[184:199], v[120:123], v[36:39], v[184:199]
 s_waitcnt lgkmcnt(0)
 v_mfma_f32_32x32x16_bf16 v[200:215], v[124:127], v[36:39], v[200:215]
 ds_read_b128 v[136:139], v238 offset:0
 ds_read_b128 v[140:143], v239 offset:0
 s_waitcnt lgkmcnt(0)
 s_barrier
 ds_read_b128 v[144:147], v236 offset:12288
 ds_read_b128 v[148:151], v237 offset:12288
 s_waitcnt lgkmcnt(0)
 s_barrier
 ds_read_b64_tr_b16 v[96:97], v232 offset:24576
 ds_read_b64_tr_b16 v[98:99], v232 offset:25600
 ds_read_b64_tr_b16 v[100:101], v233 offset:24576
 ds_read_b64_tr_b16 v[102:103], v233 offset:25600
 ds_read_b64_tr_b16 v[104:105], v234 offset:24576
 ds_read_b64_tr_b16 v[106:107], v234 offset:25600
 ds_read_b64_tr_b16 v[108:109], v235 offset:24576
 ds_read_b64_tr_b16 v[110:111], v235 offset:25600
 ds_read_b64_tr_b16 v[112:113], v232 offset:28672
 ds_read_b64_tr_b16 v[114:115], v232 offset:29696
 ds_read_b64_tr_b16 v[116:117], v233 offset:28672
 ds_read_b64_tr_b16 v[118:119], v233 offset:29696
 ds_read_b64_tr_b16 v[120:121], v234 offset:28672
 ds_read_b64_tr_b16 v[122:123], v234 offset:29696
 s_waitcnt lgkmcnt(12)
 v_mfma_f32_32x32x16_bf16 v[152:167], v[96:99], v[40:43], v[152:167]
 ds_read_b64_tr_b16 v[124:125], v235 offset:28672
 ds_read_b64_tr_b16 v[126:127], v235 offset:29696
 s_waitcnt lgkmcnt(12)
 v_mfma_f32_32x32x16_bf16 v[168:183], v[100:103], v[40:43], v[168:183]
 s_waitcnt lgkmcnt(10)
 v_mfma_f32_32x32x16_bf16 v[184:199], v[104:107], v[40:43], v[184:199]
 s_waitcnt lgkmcnt(8)
 v_mfma_f32_32x32x16_bf16 v[200:215], v[108:111], v[40:43], v[200:215]
 s_waitcnt lgkmcnt(6)
 v_mfma_f32_32x32x16_bf16 v[152:167], v[112:115], v[44:47], v[152:167]
 s_waitcnt lgkmcnt(4)
 v_mfma_f32_32x32x16_bf16 v[168:183], v[116:119], v[44:47], v[168:183]
 s_waitcnt lgkmcnt(2)
 v_mfma_f32_32x32x16_bf16 v[184:199], v[120:123], v[44:47], v[184:199]
 s_waitcnt lgkmcnt(0)
 v_mfma_f32_32x32x16_bf16 v[200:215], v[124:127], v[44:47], v[200:215]
 ds_read_b128 v[216:219], v238 offset:12288
 ds_read_b128 v[220:223], v239 offset:12288
 s_waitcnt lgkmcnt(0)
 s_barrier
 ds_read_b128 v[224:227], v236 offset:24576
 ds_read_b128 v[228:231], v237 offset:24576
 s_waitcnt lgkmcnt(0)
 s_barrier
 ds_read_b64_tr_b16 v[96:97], v232 offset:0
 ds_read_b64_tr_b16 v[98:99], v232 offset:1024
 ds_read_b64_tr_b16 v[100:101], v233 offset:0
 ds_read_b64_tr_b16 v[102:103], v233 offset:1024
 ds_read_b64_tr_b16 v[104:105], v234 offset:0
 ds_read_b64_tr_b16 v[106:107], v234 offset:1024
 ds_read_b64_tr_b16 v[108:109], v235 offset:0
 ds_read_b64_tr_b16 v[110:111], v235 offset:1024
 ds_read_b64_tr_b16 v[112:113], v232 offset:4096
 ds_read_b64_tr_b16 v[114:115], v232 offset:5120
 ds_read_b64_tr_b16 v[116:117], v233 offset:4096
 ds_read_b64_tr_b16 v[118:119], v233 offset:5120
 ds_read_b64_tr_b16 v[120:121], v234 offset:4096
 ds_read_b64_tr_b16 v[122:123], v234 offset:5120
 s_waitcnt lgkmcnt(12)
 v_mfma_f32_32x32x16_bf16 v[152:167], v[96:99], v[48:51], v[152:167]
 ds_read_b64_tr_b16 v[124:125], v235 offset:4096
 ds_read_b64_tr_b16 v[126:127], v235 offset:5120
 s_waitcnt lgkmcnt(12)
 v_mfma_f32_32x32x16_bf16 v[168:183], v[100:103], v[48:51], v[168:183]
 s_waitcnt lgkmcnt(10)
 v_mfma_f32_32x32x16_bf16 v[184:199], v[104:107], v[48:51], v[184:199]
 s_waitcnt lgkmcnt(8)
 v_mfma_f32_32x32x16_bf16 v[200:215], v[108:111], v[48:51], v[200:215]
 s_waitcnt lgkmcnt(6)
 v_mfma_f32_32x32x16_bf16 v[152:167], v[112:115], v[52:55], v[152:167]
 s_waitcnt lgkmcnt(4)
 v_mfma_f32_32x32x16_bf16 v[168:183], v[116:119], v[52:55], v[168:183]
 s_waitcnt lgkmcnt(2)
 v_mfma_f32_32x32x16_bf16 v[184:199], v[120:123], v[52:55], v[184:199]
 s_waitcnt lgkmcnt(0)
 v_mfma_f32_32x32x16_bf16 v[200:215], v[124:127], v[52:55], v[200:215]
 ds_read_b128 v[0:3], v238 offset:24576
 ds_read_b128 v[4:7], v239 offset:24576
 s_waitcnt lgkmcnt(0)
 s_barrier
 ds_read_b128 v[8:11], v236 offset:0
 ds_read_b128 v[12:15], v237 offset:0
 s_waitcnt lgkmcnt(0)
 s_barrier
 ds_read_b64_tr_b16 v[96:97], v232 offset:24576
 ds_read_b64_tr_b16 v[98:99], v232 offset:25600
 ds_read_b64_tr_b16 v[100:101], v233 offset:24576
 ds_read_b64_tr_b16 v[102:103], v233 offset:25600
 ds_read_b64_tr_b16 v[104:105], v234 offset:24576
 ds_read_b64_tr_b16 v[106:107], v234 offset:25600
 ds_read_b64_tr_b16 v[108:109], v235 offset:24576
 ds_read_b64_tr_b16 v[110:111], v235 offset:25600
 ds_read_b64_tr_b16 v[112:113], v232 offset:28672
 ds_read_b64_tr_b16 v[114:115], v232 offset:29696
 ds_read_b64_tr_b16 v[116:117], v233 offset:28672
 ds_read_b64_tr_b16 v[118:119], v233 offset:29696
 ds_read_b64_tr_b16 v[120:121], v234 offset:28672
 ds_read_b64_tr_b16 v[122:123], v234 offset:29696
 s_waitcnt lgkmcnt(12)
 v_mfma_f32_32x32x16_bf16 v[152:167], v[96:99], v[56:59], v[152:167]
 ds_read_b64_tr_b16 v[124:125], v235 offset:28672
 ds_read_b64_tr_b16 v[126:127], v235 offset:29696
 s_waitcnt lgkmcnt(12)
 v_mfma_f32_32x32x16_bf16 v[168:183], v[100:103], v[56:59], v[168:183]
 s_waitcnt lgkmcnt(10)
 v_mfma_f32_32x32x16_bf16 v[184:199], v[104:107], v[56:59], v[184:199]
 s_waitcnt lgkmcnt(8)
 v_mfma_f32_32x32x16_bf16 v[200:215], v[108:111], v[56:59], v[200:215]
 s_waitcnt lgkmcnt(6)
 v_mfma_f32_32x32x16_bf16 v[152:167], v[112:115], v[60:63], v[152:167]
 s_waitcnt lgkmcnt(4)
 v_mfma_f32_32x32x16_bf16 v[168:183], v[116:119], v[60:63], v[168:183]
 s_waitcnt lgkmcnt(2)
 v_mfma_f32_32x32x16_bf16 v[184:199], v[120:123], v[60:63], v[184:199]
 s_waitcnt lgkmcnt(0)
 v_mfma_f32_32x32x16_bf16 v[200:215], v[124:127], v[60:63], v[200:215]
 ds_read_b128 v[16:19], v238 offset:0
 ds_read_b128 v[20:23], v239 offset:0
 s_waitcnt lgkmcnt(0)
 s_barrier
 s_barrier
 s_barrier
 ds_read_b64_tr_b16 v[96:97], v232 offset:0
 ds_read_b64_tr_b16 v[98:99], v232 offset:1024
 ds_read_b64_tr_b16 v[100:101], v233 offset:0
 ds_read_b64_tr_b16 v[102:103], v233 offset:1024
 ds_read_b64_tr_b16 v[104:105], v234 offset:0
 ds_read_b64_tr_b16 v[106:107], v234 offset:1024
 ds_read_b64_tr_b16 v[108:109], v235 offset:0
 ds_read_b64_tr_b16 v[110:111], v235 offset:1024
 ds_read_b64_tr_b16 v[112:113], v232 offset:4096
 ds_read_b64_tr_b16 v[114:115], v232 offset:5120
 ds_read_b64_tr_b16 v[116:117], v233 offset:4096
 ds_read_b64_tr_b16 v[118:119], v233 offset:5120
 ds_read_b64_tr_b16 v[120:121], v234 offset:4096
 ds_read_b64_tr_b16 v[122:123], v234 offset:5120
 s_waitcnt lgkmcnt(12)
 v_mfma_f32_32x32x16_bf16 v[152:167], v[96:99], v[64:67], v[152:167]
 ds_read_b64_tr_b16 v[124:125], v235 offset:4096
 ds_read_b64_tr_b16 v[126:127], v235 offset:5120
 s_waitcnt lgkmcnt(12)
 v_mfma_f32_32x32x16_bf16 v[168:183], v[100:103], v[64:67], v[168:183]
 s_waitcnt lgkmcnt(10)
 v_mfma_f32_32x32x16_bf16 v[184:199], v[104:107], v[64:67], v[184:199]
 s_waitcnt lgkmcnt(8)
 v_mfma_f32_32x32x16_bf16 v[200:215], v[108:111], v[64:67], v[200:215]
 s_waitcnt lgkmcnt(6)
 v_mfma_f32_32x32x16_bf16 v[152:167], v[112:115], v[68:71], v[152:167]
 s_waitcnt lgkmcnt(4)
 v_mfma_f32_32x32x16_bf16 v[168:183], v[116:119], v[68:71], v[168:183]
 s_waitcnt lgkmcnt(2)
 v_mfma_f32_32x32x16_bf16 v[184:199], v[120:123], v[68:71], v[184:199]
 s_waitcnt lgkmcnt(0)
 v_mfma_f32_32x32x16_bf16 v[200:215], v[124:127], v[68:71], v[200:215]
 s_barrier
 ds_read_b64_tr_b16 v[96:97], v232 offset:8192
 ds_read_b64_tr_b16 v[98:99], v232 offset:9216
 ds_read_b64_tr_b16 v[100:101], v233 offset:8192
 ds_read_b64_tr_b16 v[102:103], v233 offset:9216
 ds_read_b64_tr_b16 v[104:105], v234 offset:8192
 ds_read_b64_tr_b16 v[106:107], v234 offset:9216
 ds_read_b64_tr_b16 v[108:109], v235 offset:8192
 ds_read_b64_tr_b16 v[110:111], v235 offset:9216
 ds_read_b64_tr_b16 v[112:113], v232 offset:12288
 ds_read_b64_tr_b16 v[114:115], v232 offset:13312
 ds_read_b64_tr_b16 v[116:117], v233 offset:12288
 ds_read_b64_tr_b16 v[118:119], v233 offset:13312
 ds_read_b64_tr_b16 v[120:121], v234 offset:12288
 ds_read_b64_tr_b16 v[122:123], v234 offset:13312
 s_waitcnt lgkmcnt(12)
 v_mfma_f32_32x32x16_bf16 v[152:167], v[96:99], v[72:75], v[152:167]
 ds_read_b64_tr_b16 v[124:125], v235 offset:12288
 ds_read_b64_tr_b16 v[126:127], v235 offset:13312
 s_waitcnt lgkmcnt(12)
 v_mfma_f32_32x32x16_bf16 v[168:183], v[100:103], v[72:75], v[168:183]
 s_waitcnt lgkmcnt(10)
 v_mfma_f32_32x32x16_bf16 v[184:199], v[104:107], v[72:75], v[184:199]
 s_waitcnt lgkmcnt(8)
 v_mfma_f32_32x32x16_bf16 v[200:215], v[108:111], v[72:75], v[200:215]
 s_waitcnt lgkmcnt(6)
 v_mfma_f32_32x32x16_bf16 v[152:167], v[112:115], v[76:79], v[152:167]
 s_waitcnt lgkmcnt(4)
 v_mfma_f32_32x32x16_bf16 v[168:183], v[116:119], v[76:79], v[168:183]
 s_waitcnt lgkmcnt(2)
 v_mfma_f32_32x32x16_bf16 v[184:199], v[120:123], v[76:79], v[184:199]
 s_waitcnt lgkmcnt(0)
 v_mfma_f32_32x32x16_bf16 v[200:215], v[124:127], v[76:79], v[200:215]
 s_barrier
 ds_read_b64_tr_b16 v[96:97], v232 offset:16384
 ds_read_b64_tr_b16 v[98:99], v232 offset:17408
 ds_read_b64_tr_b16 v[100:101], v233 offset:16384
 ds_read_b64_tr_b16 v[102:103], v233 offset:17408
 ds_read_b64_tr_b16 v[104:105], v234 offset:16384
 ds_read_b64_tr_b16 v[106:107], v234 offset:17408
 ds_read_b64_tr_b16 v[108:109], v235 offset:16384
 ds_read_b64_tr_b16 v[110:111], v235 offset:17408
 ds_read_b64_tr_b16 v[112:113], v232 offset:20480
 ds_read_b64_tr_b16 v[114:115], v232 offset:21504
 ds_read_b64_tr_b16 v[116:117], v233 offset:20480
 ds_read_b64_tr_b16 v[118:119], v233 offset:21504
 ds_read_b64_tr_b16 v[120:121], v234 offset:20480
 ds_read_b64_tr_b16 v[122:123], v234 offset:21504
 s_waitcnt lgkmcnt(12)
 v_mfma_f32_32x32x16_bf16 v[152:167], v[96:99], v[80:83], v[152:167]
 ds_read_b64_tr_b16 v[124:125], v235 offset:20480
 ds_read_b64_tr_b16 v[126:127], v235 offset:21504
 s_waitcnt lgkmcnt(12)
 v_mfma_f32_32x32x16_bf16 v[168:183], v[100:103], v[80:83], v[168:183]
 s_waitcnt lgkmcnt(10)
 v_mfma_f32_32x32x16_bf16 v[184:199], v[104:107], v[80:83], v[184:199]
 s_waitcnt lgkmcnt(8)
 v_mfma_f32_32x32x16_bf16 v[200:215], v[108:111], v[80:83], v[200:215]
 s_waitcnt lgkmcnt(6)
 v_mfma_f32_32x32x16_bf16 v[152:167], v[112:115], v[84:87], v[152:167]
 s_waitcnt lgkmcnt(4)
 v_mfma_f32_32x32x16_bf16 v[168:183], v[116:119], v[84:87], v[168:183]
 s_waitcnt lgkmcnt(2)
 v_mfma_f32_32x32x16_bf16 v[184:199], v[120:123], v[84:87], v[184:199]
 s_waitcnt lgkmcnt(0)
 v_mfma_f32_32x32x16_bf16 v[200:215], v[124:127], v[84:87], v[200:215]
 s_barrier
 ds_read_b64_tr_b16 v[96:97], v232 offset:0
 ds_read_b64_tr_b16 v[98:99], v232 offset:1024
 ds_read_b64_tr_b16 v[100:101], v233 offset:0
 ds_read_b64_tr_b16 v[102:103], v233 offset:1024
 ds_read_b64_tr_b16 v[104:105], v234 offset:0
 ds_read_b64_tr_b16 v[106:107], v234 offset:1024
 ds_read_b64_tr_b16 v[108:109], v235 offset:0
 ds_read_b64_tr_b16 v[110:111], v235 offset:1024
 ds_read_b64_tr_b16 v[112:113], v232 offset:4096
 ds_read_b64_tr_b16 v[114:115], v232 offset:5120
 ds_read_b64_tr_b16 v[116:117], v233 offset:4096
 ds_read_b64_tr_b16 v[118:119], v233 offset:5120
 ds_read_b64_tr_b16 v[120:121], v234 offset:4096
 ds_read_b64_tr_b16 v[122:123], v234 offset:5120
 s_waitcnt lgkmcnt(12)
 v_mfma_f32_32x32x16_bf16 v[152:167], v[96:99], v[88:91], v[152:167]
 ds_read_b64_tr_b16 v[124:125], v235 offset:4096
 ds_read_b64_tr_b16 v[126:127], v235 offset:5120
 s_waitcnt lgkmcnt(12)
 v_mfma_f32_32x32x16_bf16 v[168:183], v[100:103], v[88:91], v[168:183]
 s_waitcnt lgkmcnt(10)
 v_mfma_f32_32x32x16_bf16 v[184:199], v[104:107], v[88:91], v[184:199]
 s_waitcnt lgkmcnt(8)
 v_mfma_f32_32x32x16_bf16 v[200:215], v[108:111], v[88:91], v[200:215]
 s_waitcnt lgkmcnt(6)
 v_mfma_f32_32x32x16_bf16 v[152:167], v[112:115], v[92:95], v[152:167]
 s_waitcnt lgkmcnt(4)
 v_mfma_f32_32x32x16_bf16 v[168:183], v[116:119], v[92:95], v[168:183]
 s_waitcnt lgkmcnt(2)
 v_mfma_f32_32x32x16_bf16 v[184:199], v[120:123], v[92:95], v[184:199]
 s_waitcnt lgkmcnt(0)
 v_mfma_f32_32x32x16_bf16 v[200:215], v[124:127], v[92:95], v[200:215]
 s_barrier
 ds_read_b64_tr_b16 v[96:97], v232 offset:8192
 ds_read_b64_tr_b16 v[98:99], v232 offset:9216
 ds_read_b64_tr_b16 v[100:101], v233 offset:8192
 ds_read_b64_tr_b16 v[102:103], v233 offset:9216
 ds_read_b64_tr_b16 v[104:105], v234 offset:8192
 ds_read_b64_tr_b16 v[106:107], v234 offset:9216
 ds_read_b64_tr_b16 v[108:109], v235 offset:8192
 ds_read_b64_tr_b16 v[110:111], v235 offset:9216
 ds_read_b64_tr_b16 v[112:113], v232 offset:12288
 ds_read_b64_tr_b16 v[114:115], v232 offset:13312
 ds_read_b64_tr_b16 v[116:117], v233 offset:12288
 ds_read_b64_tr_b16 v[118:119], v233 offset:13312
 ds_read_b64_tr_b16 v[120:121], v234 offset:12288
 ds_read_b64_tr_b16 v[122:123], v234 offset:13312
 s_waitcnt lgkmcnt(12)
 v_mfma_f32_32x32x16_bf16 v[152:167], v[96:99], v[128:131], v[152:167]
 ds_read_b64_tr_b16 v[124:125], v235 offset:12288
 ds_read_b64_tr_b16 v[126:127], v235 offset:13312
 s_waitcnt lgkmcnt(12)
 v_mfma_f32_32x32x16_bf16 v[168:183], v[100:103], v[128:131], v[168:183]
 s_waitcnt lgkmcnt(10)
 v_mfma_f32_32x32x16_bf16 v[184:199], v[104:107], v[128:131], v[184:199]
 s_waitcnt lgkmcnt(8)
 v_mfma_f32_32x32x16_bf16 v[200:215], v[108:111], v[128:131], v[200:215]
 s_waitcnt lgkmcnt(6)
 v_mfma_f32_32x32x16_bf16 v[152:167], v[112:115], v[132:135], v[152:167]
 s_waitcnt lgkmcnt(4)
 v_mfma_f32_32x32x16_bf16 v[168:183], v[116:119], v[132:135], v[168:183]
 s_waitcnt lgkmcnt(2)
 v_mfma_f32_32x32x16_bf16 v[184:199], v[120:123], v[132:135], v[184:199]
 s_waitcnt lgkmcnt(0)
 v_mfma_f32_32x32x16_bf16 v[200:215], v[124:127], v[132:135], v[200:215]
 s_barrier
 ds_read_b64_tr_b16 v[96:97], v232 offset:16384
 ds_read_b64_tr_b16 v[98:99], v232 offset:17408
 ds_read_b64_tr_b16 v[100:101], v233 offset:16384
 ds_read_b64_tr_b16 v[102:103], v233 offset:17408
 ds_read_b64_tr_b16 v[104:105], v234 offset:16384
 ds_read_b64_tr_b16 v[106:107], v234 offset:17408
 ds_read_b64_tr_b16 v[108:109], v235 offset:16384
 ds_read_b64_tr_b16 v[110:111], v235 offset:17408
 ds_read_b64_tr_b16 v[112:113], v232 offset:20480
 ds_read_b64_tr_b16 v[114:115], v232 offset:21504
 ds_read_b64_tr_b16 v[116:117], v233 offset:20480
 ds_read_b64_tr_b16 v[118:119], v233 offset:21504
 ds_read_b64_tr_b16 v[120:121], v234 offset:20480
 ds_read_b64_tr_b16 v[122:123], v234 offset:21504
 s_waitcnt lgkmcnt(12)
 v_mfma_f32_32x32x16_bf16 v[152:167], v[96:99], v[136:139], v[152:167]
 ds_read_b64_tr_b16 v[124:125], v235 offset:20480
 ds_read_b64_tr_b16 v[126:127], v235 offset:21504
 s_waitcnt lgkmcnt(12)
 v_mfma_f32_32x32x16_bf16 v[168:183], v[100:103], v[136:139], v[168:183]
 s_waitcnt lgkmcnt(10)
 v_mfma_f32_32x32x16_bf16 v[184:199], v[104:107], v[136:139], v[184:199]
 s_waitcnt lgkmcnt(8)
 v_mfma_f32_32x32x16_bf16 v[200:215], v[108:111], v[136:139], v[200:215]
 s_waitcnt lgkmcnt(6)
 v_mfma_f32_32x32x16_bf16 v[152:167], v[112:115], v[140:143], v[152:167]
 s_waitcnt lgkmcnt(4)
 v_mfma_f32_32x32x16_bf16 v[168:183], v[116:119], v[140:143], v[168:183]
 s_waitcnt lgkmcnt(2)
 v_mfma_f32_32x32x16_bf16 v[184:199], v[120:123], v[140:143], v[184:199]
 s_waitcnt lgkmcnt(0)
 v_mfma_f32_32x32x16_bf16 v[200:215], v[124:127], v[140:143], v[200:215]
 s_barrier
 ds_read_b64_tr_b16 v[96:97], v232 offset:0
 ds_read_b64_tr_b16 v[98:99], v232 offset:1024
 ds_read_b64_tr_b16 v[100:101], v233 offset:0
 ds_read_b64_tr_b16 v[102:103], v233 offset:1024
 ds_read_b64_tr_b16 v[104:105], v234 offset:0
 ds_read_b64_tr_b16 v[106:107], v234 offset:1024
 ds_read_b64_tr_b16 v[108:109], v235 offset:0
 ds_read_b64_tr_b16 v[110:111], v235 offset:1024
 ds_read_b64_tr_b16 v[112:113], v232 offset:4096
 ds_read_b64_tr_b16 v[114:115], v232 offset:5120
 ds_read_b64_tr_b16 v[116:117], v233 offset:4096
 ds_read_b64_tr_b16 v[118:119], v233 offset:5120
 ds_read_b64_tr_b16 v[120:121], v234 offset:4096
 ds_read_b64_tr_b16 v[122:123], v234 offset:5120
 s_waitcnt lgkmcnt(12)
 v_mfma_f32_32x32x16_bf16 v[152:167], v[96:99], v[144:147], v[152:167]
 ds_read_b64_tr_b16 v[124:125], v235 offset:4096
 ds_read_b64_tr_b16 v[126:127], v235 offset:5120
 s_waitcnt lgkmcnt(12)
 v_mfma_f32_32x32x16_bf16 v[168:183], v[100:103], v[144:147], v[168:183]
 s_waitcnt lgkmcnt(10)
 v_mfma_f32_32x32x16_bf16 v[184:199], v[104:107], v[144:147], v[184:199]
 s_waitcnt lgkmcnt(8)
 v_mfma_f32_32x32x16_bf16 v[200:215], v[108:111], v[144:147], v[200:215]
 s_waitcnt lgkmcnt(6)
 v_mfma_f32_32x32x16_bf16 v[152:167], v[112:115], v[148:151], v[152:167]
 s_waitcnt lgkmcnt(4)
 v_mfma_f32_32x32x16_bf16 v[168:183], v[116:119], v[148:151], v[168:183]
 s_waitcnt lgkmcnt(2)
 v_mfma_f32_32x32x16_bf16 v[184:199], v[120:123], v[148:151], v[184:199]
 s_waitcnt lgkmcnt(0)
 v_mfma_f32_32x32x16_bf16 v[200:215], v[124:127], v[148:151], v[200:215]
 s_barrier
 ds_read_b64_tr_b16 v[96:97], v232 offset:8192
 ds_read_b64_tr_b16 v[98:99], v232 offset:9216
 ds_read_b64_tr_b16 v[100:101], v233 offset:8192
 ds_read_b64_tr_b16 v[102:103], v233 offset:9216
 ds_read_b64_tr_b16 v[104:105], v234 offset:8192
 ds_read_b64_tr_b16 v[106:107], v234 offset:9216
 ds_read_b64_tr_b16 v[108:109], v235 offset:8192
 ds_read_b64_tr_b16 v[110:111], v235 offset:9216
 ds_read_b64_tr_b16 v[112:113], v232 offset:12288
 ds_read_b64_tr_b16 v[114:115], v232 offset:13312
 ds_read_b64_tr_b16 v[116:117], v233 offset:12288
 ds_read_b64_tr_b16 v[118:119], v233 offset:13312
 ds_read_b64_tr_b16 v[120:121], v234 offset:12288
 ds_read_b64_tr_b16 v[122:123], v234 offset:13312
 s_waitcnt lgkmcnt(12)
 v_mfma_f32_32x32x16_bf16 v[152:167], v[96:99], v[216:219], v[152:167]
 ds_read_b64_tr_b16 v[124:125], v235 offset:12288
 ds_read_b64_tr_b16 v[126:127], v235 offset:13312
 s_waitcnt lgkmcnt(12)
 v_mfma_f32_32x32x16_bf16 v[168:183], v[100:103], v[216:219], v[168:183]
 s_waitcnt lgkmcnt(10)
 v_mfma_f32_32x32x16_bf16 v[184:199], v[104:107], v[216:219], v[184:199]
 s_waitcnt lgkmcnt(8)
 v_mfma_f32_32x32x16_bf16 v[200:215], v[108:111], v[216:219], v[200:215]
 s_waitcnt lgkmcnt(6)
 v_mfma_f32_32x32x16_bf16 v[152:167], v[112:115], v[220:223], v[152:167]
 s_waitcnt lgkmcnt(4)
 v_mfma_f32_32x32x16_bf16 v[168:183], v[116:119], v[220:223], v[168:183]
 s_waitcnt lgkmcnt(2)
 v_mfma_f32_32x32x16_bf16 v[184:199], v[120:123], v[220:223], v[184:199]
 s_waitcnt lgkmcnt(0)
 v_mfma_f32_32x32x16_bf16 v[200:215], v[124:127], v[220:223], v[200:215]
 s_barrier
 ds_read_b64_tr_b16 v[96:97], v232 offset:16384
 ds_read_b64_tr_b16 v[98:99], v232 offset:17408
 ds_read_b64_tr_b16 v[100:101], v233 offset:16384
 ds_read_b64_tr_b16 v[102:103], v233 offset:17408
 ds_read_b64_tr_b16 v[104:105], v234 offset:16384
 ds_read_b64_tr_b16 v[106:107], v234 offset:17408
 ds_read_b64_tr_b16 v[108:109], v235 offset:16384
 ds_read_b64_tr_b16 v[110:111], v235 offset:17408
 ds_read_b64_tr_b16 v[112:113], v232 offset:20480
 ds_read_b64_tr_b16 v[114:115], v232 offset:21504
 ds_read_b64_tr_b16 v[116:117], v233 offset:20480
 ds_read_b64_tr_b16 v[118:119], v233 offset:21504
 ds_read_b64_tr_b16 v[120:121], v234 offset:20480
 ds_read_b64_tr_b16 v[122:123], v234 offset:21504
 s_waitcnt lgkmcnt(12)
 v_mfma_f32_32x32x16_bf16 v[152:167], v[96:99], v[224:227], v[152:167]
 ds_read_b64_tr_b16 v[124:125], v235 offset:20480
 ds_read_b64_tr_b16 v[126:127], v235 offset:21504
 s_waitcnt lgkmcnt(12)
 v_mfma_f32_32x32x16_bf16 v[168:183], v[100:103], v[224:227], v[168:183]
 s_waitcnt lgkmcnt(10)
 v_mfma_f32_32x32x16_bf16 v[184:199], v[104:107], v[224:227], v[184:199]
 s_waitcnt lgkmcnt(8)
 v_mfma_f32_32x32x16_bf16 v[200:215], v[108:111], v[224:227], v[200:215]
 s_waitcnt lgkmcnt(6)
 v_mfma_f32_32x32x16_bf16 v[152:167], v[112:115], v[228:231], v[152:167]
 s_waitcnt lgkmcnt(4)
 v_mfma_f32_32x32x16_bf16 v[168:183], v[116:119], v[228:231], v[168:183]
 s_waitcnt lgkmcnt(2)
 v_mfma_f32_32x32x16_bf16 v[184:199], v[120:123], v[228:231], v[184:199]
 s_waitcnt lgkmcnt(0)
 v_mfma_f32_32x32x16_bf16 v[200:215], v[124:127], v[228:231], v[200:215]
 s_barrier
 ds_read_b64_tr_b16 v[96:97], v232 offset:0
 ds_read_b64_tr_b16 v[98:99], v232 offset:1024
 ds_read_b64_tr_b16 v[100:101], v233 offset:0
 ds_read_b64_tr_b16 v[102:103], v233 offset:1024
 ds_read_b64_tr_b16 v[104:105], v234 offset:0
 ds_read_b64_tr_b16 v[106:107], v234 offset:1024
 ds_read_b64_tr_b16 v[108:109], v235 offset:0
 ds_read_b64_tr_b16 v[110:111], v235 offset:1024
 ds_read_b64_tr_b16 v[112:113], v232 offset:4096
 ds_read_b64_tr_b16 v[114:115], v232 offset:5120
 ds_read_b64_tr_b16 v[116:117], v233 offset:4096
 ds_read_b64_tr_b16 v[118:119], v233 offset:5120
 ds_read_b64_tr_b16 v[120:121], v234 offset:4096
 ds_read_b64_tr_b16 v[122:123], v234 offset:5120
 s_waitcnt lgkmcnt(12)
 v_mfma_f32_32x32x16_bf16 v[152:167], v[96:99], v[0:3], v[152:167]
 ds_read_b64_tr_b16 v[124:125], v235 offset:4096
 ds_read_b64_tr_b16 v[126:127], v235 offset:5120
 s_waitcnt lgkmcnt(12)
 v_mfma_f32_32x32x16_bf16 v[168:183], v[100:103], v[0:3], v[168:183]
 s_waitcnt lgkmcnt(10)
 v_mfma_f32_32x32x16_bf16 v[184:199], v[104:107], v[0:3], v[184:199]
 s_waitcnt lgkmcnt(8)
 v_mfma_f32_32x32x16_bf16 v[200:215], v[108:111], v[0:3], v[200:215]
 s_waitcnt lgkmcnt(6)
 v_mfma_f32_32x32x16_bf16 v[152:167], v[112:115], v[4:7], v[152:167]
 s_waitcnt lgkmcnt(4)
 v_mfma_f32_32x32x16_bf16 v[168:183], v[116:119], v[4:7], v[168:183]
 s_waitcnt lgkmcnt(2)
 v_mfma_f32_32x32x16_bf16 v[184:199], v[120:123], v[4:7], v[184:199]
 s_waitcnt lgkmcnt(0)
 v_mfma_f32_32x32x16_bf16 v[200:215], v[124:127], v[4:7], v[200:215]
 s_barrier
 ds_read_b64_tr_b16 v[96:97], v232 offset:8192
 ds_read_b64_tr_b16 v[98:99], v232 offset:9216
 ds_read_b64_tr_b16 v[100:101], v233 offset:8192
 ds_read_b64_tr_b16 v[102:103], v233 offset:9216
 ds_read_b64_tr_b16 v[104:105], v234 offset:8192
 ds_read_b64_tr_b16 v[106:107], v234 offset:9216
 ds_read_b64_tr_b16 v[108:109], v235 offset:8192
 ds_read_b64_tr_b16 v[110:111], v235 offset:9216
 ds_read_b64_tr_b16 v[112:113], v232 offset:12288
 ds_read_b64_tr_b16 v[114:115], v232 offset:13312
 ds_read_b64_tr_b16 v[116:117], v233 offset:12288
 ds_read_b64_tr_b16 v[118:119], v233 offset:13312
 ds_read_b64_tr_b16 v[120:121], v234 offset:12288
 ds_read_b64_tr_b16 v[122:123], v234 offset:13312
 s_waitcnt lgkmcnt(12)
 v_mfma_f32_32x32x16_bf16 v[152:167], v[96:99], v[8:11], v[152:167]
 ds_read_b64_tr_b16 v[124:125], v235 offset:12288
 ds_read_b64_tr_b16 v[126:127], v235 offset:13312
 s_waitcnt lgkmcnt(12)
 v_mfma_f32_32x32x16_bf16 v[168:183], v[100:103], v[8:11], v[168:183]
 s_waitcnt lgkmcnt(10)
 v_mfma_f32_32x32x16_bf16 v[184:199], v[104:107], v[8:11], v[184:199]
 s_waitcnt lgkmcnt(8)
 v_mfma_f32_32x32x16_bf16 v[200:215], v[108:111], v[8:11], v[200:215]
 s_waitcnt lgkmcnt(6)
 v_mfma_f32_32x32x16_bf16 v[152:167], v[112:115], v[12:15], v[152:167]
 s_waitcnt lgkmcnt(4)
 v_mfma_f32_32x32x16_bf16 v[168:183], v[116:119], v[12:15], v[168:183]
 s_waitcnt lgkmcnt(2)
 v_mfma_f32_32x32x16_bf16 v[184:199], v[120:123], v[12:15], v[184:199]
 s_waitcnt lgkmcnt(0)
 v_mfma_f32_32x32x16_bf16 v[200:215], v[124:127], v[12:15], v[200:215]
 s_barrier
 ds_read_b64_tr_b16 v[96:97], v232 offset:16384
 ds_read_b64_tr_b16 v[98:99], v232 offset:17408
 ds_read_b64_tr_b16 v[100:101], v233 offset:16384
 ds_read_b64_tr_b16 v[102:103], v233 offset:17408
 ds_read_b64_tr_b16 v[104:105], v234 offset:16384
 ds_read_b64_tr_b16 v[106:107], v234 offset:17408
 ds_read_b64_tr_b16 v[108:109], v235 offset:16384
 ds_read_b64_tr_b16 v[110:111], v235 offset:17408
 ds_read_b64_tr_b16 v[112:113], v232 offset:20480
 ds_read_b64_tr_b16 v[114:115], v232 offset:21504
 ds_read_b64_tr_b16 v[116:117], v233 offset:20480
 ds_read_b64_tr_b16 v[118:119], v233 offset:21504
 ds_read_b64_tr_b16 v[120:121], v234 offset:20480
 ds_read_b64_tr_b16 v[122:123], v234 offset:21504
 s_waitcnt lgkmcnt(12)
 v_mfma_f32_32x32x16_bf16 v[152:167], v[96:99], v[16:19], v[152:167]
 ds_read_b64_tr_b16 v[124:125], v235 offset:20480
 ds_read_b64_tr_b16 v[126:127], v235 offset:21504
 s_waitcnt lgkmcnt(12)
 v_mfma_f32_32x32x16_bf16 v[168:183], v[100:103], v[16:19], v[168:183]
 s_waitcnt lgkmcnt(10)
 v_mfma_f32_32x32x16_bf16 v[184:199], v[104:107], v[16:19], v[184:199]
 s_waitcnt lgkmcnt(8)
 v_mfma_f32_32x32x16_bf16 v[200:215], v[108:111], v[16:19], v[200:215]
 s_waitcnt lgkmcnt(6)
 v_mfma_f32_32x32x16_bf16 v[152:167], v[112:115], v[20:23], v[152:167]
 s_waitcnt lgkmcnt(4)
 v_mfma_f32_32x32x16_bf16 v[168:183], v[116:119], v[20:23], v[168:183]
 s_waitcnt lgkmcnt(2)
 v_mfma_f32_32x32x16_bf16 v[184:199], v[120:123], v[20:23], v[184:199]
 s_waitcnt lgkmcnt(0)
 v_mfma_f32_32x32x16_bf16 v[200:215], v[124:127], v[20:23], v[200:215]
 s_barrier
 v_and_b32 v244, 31, v250
 v_lshrrev_b32 v245, 5, v250
 v_and_b32 v246, 15, v244
 v_xor_b32 v245, v245, v246
 v_lshlrev_b32 v245, 4, v245
 v_lshl_add_u32 v216, v244, 8, v245
 v_xor_b32 v217, 32, v216
 v_xor_b32 v218, 64, v216
 v_xor_b32 v219, 96, v216
 v_xor_b32 v220, 128, v216
 v_xor_b32 v221, 160, v216
 v_xor_b32 v222, 192, v216
 v_xor_b32 v223, 224, v216
 v_bfe_u32 v244, v250, 2, 2
 v_lshrrev_b32 v245, 5, v250
 v_mul_u32_u24 v245, 4, v245
 v_add_u32 v245, v245, v244
 v_mul_u32_u24 v224, 256, v245
 v_lshlrev_b32 v244, 6, v244
 v_add_u32 v224, v224, v244
 v_bfe_u32 v244, v250, 4, 1
 v_lshlrev_b32 v244, 5, v244
 v_add_u32 v224, v224, v244
 v_and_b32 v244, 1, v250
 v_lshlrev_b32 v244, 4, v244
 v_add_u32 v224, v224, v244
 v_bfe_u32 v244, v250, 1, 1
 v_lshlrev_b32 v244, 3, v244
 v_add_u32 v224, v224, v244
 v_add_u32 v224, 49152, v224
 v_xor_b32 v225, 64, v224
 v_xor_b32 v226, 128, v224
 v_xor_b32 v227, 192, v224
 v_mov_b32 v228, 0
 v_mov_b32 v229, 0
 v_mul_f32 v152, s53, v152
 v_mul_f32 v153, s53, v153
 v_cvt_pk_bf16_f32 v64, v152, v153
 v_mul_f32 v154, s53, v154
 v_mul_f32 v155, s53, v155
 v_cvt_pk_bf16_f32 v65, v154, v155
 v_mul_f32 v156, s53, v156
 v_mul_f32 v157, s53, v157
 v_cvt_pk_bf16_f32 v66, v156, v157
 v_mul_f32 v158, s53, v158
 v_mul_f32 v159, s53, v159
 v_cvt_pk_bf16_f32 v67, v158, v159
 v_mul_f32 v160, s53, v160
 v_mul_f32 v161, s53, v161
 v_cvt_pk_bf16_f32 v68, v160, v161
 v_mul_f32 v162, s53, v162
 v_mul_f32 v163, s53, v163
 v_cvt_pk_bf16_f32 v69, v162, v163
 v_mul_f32 v164, s53, v164
 v_mul_f32 v165, s53, v165
 v_cvt_pk_bf16_f32 v70, v164, v165
 v_mul_f32 v166, s53, v166
 v_mul_f32 v167, s53, v167
 v_cvt_pk_bf16_f32 v71, v166, v167
 v_mul_f32 v168, s53, v168
 v_mul_f32 v169, s53, v169
 v_cvt_pk_bf16_f32 v72, v168, v169
 v_mul_f32 v170, s53, v170
 v_mul_f32 v171, s53, v171
 v_cvt_pk_bf16_f32 v73, v170, v171
 v_mul_f32 v172, s53, v172
 v_mul_f32 v173, s53, v173
 v_cvt_pk_bf16_f32 v74, v172, v173
 v_mul_f32 v174, s53, v174
 v_mul_f32 v175, s53, v175
 v_cvt_pk_bf16_f32 v75, v174, v175
 v_mul_f32 v176, s53, v176
 v_mul_f32 v177, s53, v177
 v_cvt_pk_bf16_f32 v76, v176, v177
 v_mul_f32 v178, s53, v178
 v_mul_f32 v179, s53, v179
 v_cvt_pk_bf16_f32 v77, v178, v179
 v_mul_f32 v180, s53, v180
 v_mul_f32 v181, s53, v181
 v_cvt_pk_bf16_f32 v78, v180, v181
 v_mul_f32 v182, s53, v182
 v_mul_f32 v183, s53, v183
 v_cvt_pk_bf16_f32 v79, v182, v183
 v_mul_f32 v184, s53, v184
 v_mul_f32 v185, s53, v185
 v_cvt_pk_bf16_f32 v80, v184, v185
 v_mul_f32 v186, s53, v186
 v_mul_f32 v187, s53, v187
 v_cvt_pk_bf16_f32 v81, v186, v187
 v_mul_f32 v188, s53, v188
 v_mul_f32 v189, s53, v189
 v_cvt_pk_bf16_f32 v82, v188, v189
 v_mul_f32 v190, s53, v190
 v_mul_f32 v191, s53, v191
 v_cvt_pk_bf16_f32 v83, v190, v191
 v_mul_f32 v192, s53, v192
 v_mul_f32 v193, s53, v193
 v_cvt_pk_bf16_f32 v84, v192, v193
 v_mul_f32 v194, s53, v194
 v_mul_f32 v195, s53, v195
 v_cvt_pk_bf16_f32 v85, v194, v195
 v_mul_f32 v196, s53, v196
 v_mul_f32 v197, s53, v197
 v_cvt_pk_bf16_f32 v86, v196, v197
 v_mul_f32 v198, s53, v198
 v_mul_f32 v199, s53, v199
 v_cvt_pk_bf16_f32 v87, v198, v199
 v_mul_f32 v200, s53, v200
 v_mul_f32 v201, s53, v201
 v_cvt_pk_bf16_f32 v88, v200, v201
 v_mul_f32 v202, s53, v202
 v_mul_f32 v203, s53, v203
 v_cvt_pk_bf16_f32 v89, v202, v203
 v_mul_f32 v204, s53, v204
 v_mul_f32 v205, s53, v205
 v_cvt_pk_bf16_f32 v90, v204, v205
 v_mul_f32 v206, s53, v206
 v_mul_f32 v207, s53, v207
 v_cvt_pk_bf16_f32 v91, v206, v207
 v_mul_f32 v208, s53, v208
 v_mul_f32 v209, s53, v209
 v_cvt_pk_bf16_f32 v92, v208, v209
 v_mul_f32 v210, s53, v210
 v_mul_f32 v211, s53, v211
 v_cvt_pk_bf16_f32 v93, v210, v211
 v_mul_f32 v212, s53, v212
 v_mul_f32 v213, s53, v213
 v_cvt_pk_bf16_f32 v94, v212, v213
 v_mul_f32 v214, s53, v214
 v_mul_f32 v215, s53, v215
 v_cvt_pk_bf16_f32 v95, v214, v215
 s_barrier
 s_barrier
 s_setprio 2
 ds_read_b128 v[96:99], v216 offset:24576
 ds_read_b128 v[100:103], v217 offset:24576
 ds_read_b128 v[104:107], v218 offset:24576
 ds_read_b128 v[108:111], v219 offset:24576
 ds_read_b128 v[112:115], v220 offset:24576
 ds_read_b128 v[116:119], v221 offset:24576
 ds_read_b128 v[120:123], v222 offset:24576
 ds_read_b128 v[124:127], v223 offset:24576
 s_waitcnt lgkmcnt(7)
 v_mfma_f32_32x32x16_bf16 v[128:143], v[96:99], v[64:67], 0
 s_waitcnt lgkmcnt(6)
 v_mfma_f32_32x32x16_bf16 v[128:143], v[100:103], v[68:71], v[128:143]
 s_waitcnt lgkmcnt(5)
 v_mfma_f32_32x32x16_bf16 v[128:143], v[104:107], v[72:75], v[128:143]
 s_waitcnt lgkmcnt(4)
 v_mfma_f32_32x32x16_bf16 v[128:143], v[108:111], v[76:79], v[128:143]
 s_waitcnt lgkmcnt(3)
 v_mfma_f32_32x32x16_bf16 v[128:143], v[112:115], v[80:83], v[128:143]
 s_waitcnt lgkmcnt(2)
 v_mfma_f32_32x32x16_bf16 v[128:143], v[116:119], v[84:87], v[128:143]
 s_waitcnt lgkmcnt(1)
 v_mfma_f32_32x32x16_bf16 v[128:143], v[120:123], v[88:91], v[128:143]
 s_waitcnt lgkmcnt(0)
 v_mfma_f32_32x32x16_bf16 v[128:143], v[124:127], v[92:95], v[128:143]
 ds_read_b128 v[152:155], v216 offset:32768
 ds_read_b128 v[156:159], v217 offset:32768
 ds_read_b128 v[160:163], v218 offset:32768
 ds_read_b128 v[164:167], v219 offset:32768
 ds_read_b128 v[168:171], v220 offset:32768
 ds_read_b128 v[172:175], v221 offset:32768
 ds_read_b128 v[176:179], v222 offset:32768
 ds_read_b128 v[180:183], v223 offset:32768
 s_nop 3
 v_max3_f32 v244, v128, v129, v130
 v_max3_f32 v245, v131, v132, v133
 v_max3_f32 v246, v134, v135, v136
 v_max3_f32 v247, v137, v138, v139
 v_max3_f32 v248, v140, v141, v142
 v_max3_f32 v244, v244, v245, v143
 v_max3_f32 v246, v246, v247, v248
 v_max_f32 v244, v244, v246
 v_mov_b32 v245, v244
 s_nop 1
 v_permlane32_swap_b32 v244, v245
 v_max_f32 v244, v244, v245
 v_sub_f32 v96, v128, v244
 v_sub_f32 v128, 0, v244
 v_sub_f32 v97, v129, v244
 v_sub_f32 v129, 0, v244
 v_sub_f32 v98, v130, v244
 v_sub_f32 v130, 0, v244
 v_sub_f32 v99, v131, v244
 v_sub_f32 v131, 0, v244
 v_sub_f32 v100, v132, v244
 v_sub_f32 v132, 0, v244
 v_sub_f32 v101, v133, v244
 v_sub_f32 v133, 0, v244
 v_sub_f32 v102, v134, v244
 v_sub_f32 v134, 0, v244
 v_sub_f32 v103, v135, v244
 v_sub_f32 v135, 0, v244
 v_sub_f32 v104, v136, v244
 v_sub_f32 v136, 0, v244
 v_sub_f32 v105, v137, v244
 v_sub_f32 v137, 0, v244
 v_sub_f32 v106, v138, v244
 v_sub_f32 v138, 0, v244
 v_sub_f32 v107, v139, v244
 v_sub_f32 v139, 0, v244
 v_sub_f32 v108, v140, v244
 v_sub_f32 v140, 0, v244
 v_sub_f32 v109, v141, v244
 v_sub_f32 v141, 0, v244
 v_sub_f32 v110, v142, v244
 v_sub_f32 v142, 0, v244
 v_sub_f32 v111, v143, v244
 v_sub_f32 v143, 0, v244
 v_exp_f32 v244, v96
 v_exp_f32 v245, v97
 v_exp_f32 v246, v98
 v_exp_f32 v247, v99
 v_add_f32 v230, v244, v245
 v_cvt_pk_bf16_f32 v144, v244, v245
 v_exp_f32 v248, v100
 v_add_f32 v231, v246, v247
 v_exp_f32 v249, v101
 v_cvt_pk_bf16_f32 v145, v246, v247
 v_exp_f32 v244, v102
 v_add_f32 v230, v230, v248
 v_exp_f32 v245, v103
 v_add_f32 v231, v231, v249
 v_cvt_pk_bf16_f32 v146, v248, v249
 v_exp_f32 v246, v104
 v_add_f32 v230, v230, v244
 v_exp_f32 v247, v105
 s_waitcnt lgkmcnt(0)
 s_barrier
 v_mfma_f32_32x32x16_bf16 v[112:127], v[152:155], v[64:67], v[128:143]
 ds_read_b64_tr_b16 v[184:185], v224 offset:24576
 ds_read_b64_tr_b16 v[186:187], v224 offset:26624
 v_add_f32 v231, v231, v245
 v_cvt_pk_bf16_f32 v147, v244, v245
 v_exp_f32 v248, v106
 v_mfma_f32_32x32x16_bf16 v[112:127], v[156:159], v[68:71], v[112:127]
 ds_read_b64_tr_b16 v[188:189], v225 offset:24576
 ds_read_b64_tr_b16 v[190:191], v225 offset:26624
 v_add_f32 v230, v230, v246
 v_exp_f32 v249, v107
 v_add_f32 v231, v231, v247
 v_mfma_f32_32x32x16_bf16 v[112:127], v[160:163], v[72:75], v[112:127]
 ds_read_b64_tr_b16 v[192:193], v226 offset:24576
 ds_read_b64_tr_b16 v[194:195], v226 offset:26624
 v_cvt_pk_bf16_f32 v148, v246, v247
 v_exp_f32 v244, v108
 v_add_f32 v230, v230, v248
 v_mfma_f32_32x32x16_bf16 v[112:127], v[164:167], v[76:79], v[112:127]
 ds_read_b64_tr_b16 v[196:197], v227 offset:24576
 ds_read_b64_tr_b16 v[198:199], v227 offset:26624
 v_exp_f32 v245, v109
 v_add_f32 v231, v231, v249
 v_cvt_pk_bf16_f32 v149, v248, v249
 v_mfma_f32_32x32x16_bf16 v[112:127], v[168:171], v[80:83], v[112:127]
 ds_read_b64_tr_b16 v[200:201], v224 offset:28672
 ds_read_b64_tr_b16 v[202:203], v224 offset:30720
 v_exp_f32 v246, v110
 v_add_f32 v230, v230, v244
 v_exp_f32 v247, v111
 v_mfma_f32_32x32x16_bf16 v[112:127], v[172:175], v[84:87], v[112:127]
 ds_read_b64_tr_b16 v[204:205], v225 offset:28672
 ds_read_b64_tr_b16 v[206:207], v225 offset:30720
 v_add_f32 v231, v231, v245
 v_cvt_pk_bf16_f32 v150, v244, v245
 v_add_f32 v230, v230, v246
 v_mfma_f32_32x32x16_bf16 v[112:127], v[176:179], v[88:91], v[112:127]
 ds_read_b64_tr_b16 v[208:209], v226 offset:28672
 ds_read_b64_tr_b16 v[210:211], v226 offset:30720
 v_add_f32 v231, v231, v247
 v_cvt_pk_bf16_f32 v151, v246, v247
 v_add_f32 v230, v230, v231
 v_mfma_f32_32x32x16_bf16 v[112:127], v[180:183], v[92:95], v[112:127]
 v_cmp_nge_f32 vcc, s54, v230
 s_waitcnt lgkmcnt(6)
 s_cbranch_vccnz K_rare_2001
K_back_2002:
 v_mfma_f32_32x32x16_bf16 v[0:15], v[184:187], v[144:147], 0
 ds_read_b64_tr_b16 v[212:213], v227 offset:28672
 ds_read_b64_tr_b16 v[214:215], v227 offset:30720
 v_add_f32 v228, v228, v230
 v_mfma_f32_32x32x16_bf16 v[16:31], v[188:191], v[144:147], 0
 ds_read_b128 v[152:155], v216 offset:40960
 ds_read_b128 v[156:159], v217 offset:40960
 v_mfma_f32_32x32x16_bf16 v[32:47], v[192:195], v[144:147], 0
 ds_read_b128 v[160:163], v218 offset:40960
 ds_read_b128 v[164:167], v219 offset:40960
 v_exp_f32 v244, v112
 v_exp_f32 v245, v113
 v_exp_f32 v246, v114
 v_mfma_f32_32x32x16_bf16 v[48:63], v[196:199], v[144:147], 0
 ds_read_b128 v[168:171], v220 offset:40960
 v_exp_f32 v247, v115
 v_add_f32 v230, v244, v245
 v_cvt_pk_bf16_f32 v232, v244, v245
 s_waitcnt lgkmcnt(5)
 v_mfma_f32_32x32x16_bf16 v[0:15], v[200:203], v[148:151], v[0:15]
 ds_read_b128 v[172:175], v221 offset:40960
 v_exp_f32 v248, v116
 v_add_f32 v231, v246, v247
 v_exp_f32 v249, v117
 v_mfma_f32_32x32x16_bf16 v[16:31], v[204:207], v[148:151], v[16:31]
 ds_read_b128 v[176:179], v222 offset:40960
 v_cvt_pk_bf16_f32 v233, v246, v247
 v_exp_f32 v244, v118
 v_add_f32 v230, v230, v248
 v_mfma_f32_32x32x16_bf16 v[32:47], v[208:211], v[148:151], v[32:47]
 ds_read_b128 v[180:183], v223 offset:40960
 v_exp_f32 v245, v119
 v_add_f32 v231, v231, v249
 v_cvt_pk_bf16_f32 v234, v248, v249
 v_mfma_f32_32x32x16_bf16 v[48:63], v[212:215], v[148:151], v[48:63]
 v_exp_f32 v246, v120
 v_add_f32 v230, v230, v244
 v_exp_f32 v247, v121
 s_waitcnt lgkmcnt(0)
 s_barrier
 v_mfma_f32_32x32x16_bf16 v[96:111], v[152:155], v[64:67], v[128:143]
 ds_read_b64_tr_b16 v[184:185], v224 offset:16384
 ds_read_b64_tr_b16 v[186:187], v224 offset:18432
 v_add_f32 v231, v231, v245
 v_cvt_pk_bf16_f32 v235, v244, v245
 v_exp_f32 v248, v122
 v_mfma_f32_32x32x16_bf16 v[96:111], v[156:159], v[68:71], v[96:111]
 ds_read_b64_tr_b16 v[188:189], v225 offset:16384
 ds_read_b64_tr_b16 v[190:191], v225 offset:18432
 v_add_f32 v230, v230, v246
 v_exp_f32 v249, v123
 v_add_f32 v231, v231, v247
 v_mfma_f32_32x32x16_bf16 v[96:111], v[160:163], v[72:75], v[96:111]
 ds_read_b64_tr_b16 v[192:193], v226 offset:16384
 ds_read_b64_tr_b16 v[194:195], v226 offset:18432
 v_cvt_pk_bf16_f32 v236, v246, v247
 v_exp_f32 v244, v124
 v_add_f32 v230, v230, v248
 v_mfma_f32_32x32x16_bf16 v[96:111], v[164:167], v[76:79], v[96:111]
 ds_read_b64_tr_b16 v[196:197], v227 offset:16384
 ds_read_b64_tr_b16 v[198:199], v227 offset:18432
 v_exp_f32 v245, v125
 v_add_f32 v231, v231, v249
 v_cvt_pk_bf16_f32 v237, v248, v249
 v_mfma_f32_32x32x16_bf16 v[96:111], v[168:171], v[80:83], v[96:111]
 ds_read_b64_tr_b16 v[200:201], v224 offset:20480
 ds_read_b64_tr_b16 v[202:203], v224 offset:22528
 v_exp_f32 v246, v126
 v_add_f32 v230, v230, v244
 v_exp_f32 v247, v127
 v_mfma_f32_32x32x16_bf16 v[96:111], v[172:175], v[84:87], v[96:111]
 ds_read_b64_tr_b16 v[204:205], v225 offset:20480
 ds_read_b64_tr_b16 v[206:207], v225 offset:22528
 v_add_f32 v231, v231, v245
 v_cvt_pk_bf16_f32 v238, v244, v245
 v_add_f32 v230, v230, v246
 v_mfma_f32_32x32x16_bf16 v[96:111], v[176:179], v[88:91], v[96:111]
 ds_read_b64_tr_b16 v[208:209], v226 offset:20480
 ds_read_b64_tr_b16 v[210:211], v226 offset:22528
 v_add_f32 v231, v231, v247
 v_cvt_pk_bf16_f32 v239, v246, v247
 v_add_f32 v230, v230, v231
 v_mfma_f32_32x32x16_bf16 v[96:111], v[180:183], v[92:95], v[96:111]
 v_cmp_nge_f32 vcc, s54, v230
 s_waitcnt lgkmcnt(6)
 s_cbranch_vccnz K_rare_2003
K_back_2004:
 v_mfma_f32_32x32x16_bf16 v[0:15], v[184:187], v[232:235], v[0:15]
 ds_read_b64_tr_b16 v[212:213], v227 offset:20480
 ds_read_b64_tr_b16 v[214:215], v227 offset:22528
 v_add_f32 v228, v228, v230
 v_mfma_f32_32x32x16_bf16 v[16:31], v[188:191], v[232:235], v[16:31]
 ds_read_b128 v[152:155], v216 offset:0
 ds_read_b128 v[156:159], v217 offset:0
 v_mfma_f32_32x32x16_bf16 v[32:47], v[192:195], v[232:235], v[32:47]
 ds_read_b128 v[160:163], v218 offset:0
 ds_read_b128 v[164:167], v219 offset:0
 v_exp_f32 v244, v96
 v_exp_f32 v245, v97
 v_exp_f32 v246, v98
 v_mfma_f32_32x32x16_bf16 v[48:63], v[196:199], v[232:235], v[48:63]
 ds_read_b128 v[168:171], v220 offset:0
 v_exp_f32 v247, v99
 v_add_f32 v230, v244, v245
 v_cvt_pk_bf16_f32 v144, v244, v245
 s_waitcnt lgkmcnt(5)
 v_mfma_f32_32x32x16_bf16 v[0:15], v[200:203], v[236:239], v[0:15]
 ds_read_b128 v[172:175], v221 offset:0
 v_exp_f32 v248, v100
 v_add_f32 v231, v246, v247
 v_exp_f32 v249, v101
 v_mfma_f32_32x32x16_bf16 v[16:31], v[204:207], v[236:239], v[16:31]
 ds_read_b128 v[176:179], v222 offset:0
 v_cvt_pk_bf16_f32 v145, v246, v247
 v_exp_f32 v244, v102
 v_add_f32 v230, v230, v248
 v_mfma_f32_32x32x16_bf16 v[32:47], v[208:211], v[236:239], v[32:47]
 ds_read_b128 v[180:183], v223 offset:0
 v_exp_f32 v245, v103
 v_add_f32 v231, v231, v249
 v_cvt_pk_bf16_f32 v146, v248, v249
 v_mfma_f32_32x32x16_bf16 v[48:63], v[212:215], v[236:239], v[48:63]
 v_exp_f32 v246, v104
 v_add_f32 v230, v230, v244
 v_exp_f32 v247, v105
 s_waitcnt lgkmcnt(0)
 s_barrier
 v_mfma_f32_32x32x16_bf16 v[112:127], v[152:155], v[64:67], v[128:143]
 ds_read_b64_tr_b16 v[184:185], v224 offset:32768
 ds_read_b64_tr_b16 v[186:187], v224 offset:34816
 v_add_f32 v231, v231, v245
 v_cvt_pk_bf16_f32 v147, v244, v245
 v_exp_f32 v248, v106
 v_mfma_f32_32x32x16_bf16 v[112:127], v[156:159], v[68:71], v[112:127]
 ds_read_b64_tr_b16 v[188:189], v225 offset:32768
 ds_read_b64_tr_b16 v[190:191], v225 offset:34816
 v_add_f32 v230, v230, v246
 v_exp_f32 v249, v107
 v_add_f32 v231, v231, v247
 v_mfma_f32_32x32x16_bf16 v[112:127], v[160:163], v[72:75], v[112:127]
 ds_read_b64_tr_b16 v[192:193], v226 offset:32768
 ds_read_b64_tr_b16 v[194:195], v226 offset:34816
 v_cvt_pk_bf16_f32 v148, v246, v247
 v_exp_f32 v244, v108
 v_add_f32 v230, v230, v248
 v_mfma_f32_32x32x16_bf16 v[112:127], v[164:167], v[76:79], v[112:127]
 ds_read_b64_tr_b16 v[196:197], v227 offset:32768
 ds_read_b64_tr_b16 v[198:199], v227 offset:34816
 v_exp_f32 v245, v109
 v_add_f32 v231, v231, v249
 v_cvt_pk_bf16_f32 v149, v248, v249
 v_mfma_f32_32x32x16_bf16 v[112:127], v[168:171], v[80:83], v[112:127]
 ds_read_b64_tr_b16 v[200:201], v224 offset:36864
 ds_read_b64_tr_b16 v[202:203], v224 offset:38912
 v_exp_f32 v246, v110
 v_add_f32 v230, v230, v244
 v_exp_f32 v247, v111
 v_mfma_f32_32x32x16_bf16 v[112:127], v[172:175], v[84:87], v[112:127]
 ds_read_b64_tr_b16 v[204:205], v225 offset:36864
 ds_read_b64_tr_b16 v[206:207], v225 offset:38912
 v_add_f32 v231, v231, v245
 v_cvt_pk_bf16_f32 v150, v244, v245
 v_add_f32 v230, v230, v246
 v_mfma_f32_32x32x16_bf16 v[112:127], v[176:179], v[88:91], v[112:127]
 ds_read_b64_tr_b16 v[208:209], v226 offset:36864
 ds_read_b64_tr_b16 v[210:211], v226 offset:38912
 v_add_f32 v231, v231, v247
 v_cvt_pk_bf16_f32 v151, v246, v247
 v_add_f32 v230, v230, v231
 v_mfma_f32_32x32x16_bf16 v[112:127], v[180:183], v[92:95], v[112:127]
 v_cmp_nge_f32 vcc, s54, v230
 s_waitcnt lgkmcnt(6)
 s_cbranch_vccnz K_rare_2005
K_back_2006:
 v_mfma_f32_32x32x16_bf16 v[0:15], v[184:187], v[144:147], v[0:15]
 ds_read_b64_tr_b16 v[212:213], v227 offset:36864
 ds_read_b64_tr_b16 v[214:215], v227 offset:38912
 v_add_f32 v228, v228, v230
 v_mfma_f32_32x32x16_bf16 v[16:31], v[188:191], v[144:147], v[16:31]
 ds_read_b128 v[152:155], v216 offset:8192
 ds_read_b128 v[156:159], v217 offset:8192
 v_mfma_f32_32x32x16_bf16 v[32:47], v[192:195], v[144:147], v[32:47]
 ds_read_b128 v[160:163], v218 offset:8192
 ds_read_b128 v[164:167], v219 offset:8192
 v_exp_f32 v244, v112
 v_exp_f32 v245, v113
 v_exp_f32 v246, v114
 v_mfma_f32_32x32x16_bf16 v[48:63], v[196:199], v[144:147], v[48:63]
 ds_read_b128 v[168:171], v220 offset:8192
 v_exp_f32 v247, v115
 v_add_f32 v230, v244, v245
 v_cvt_pk_bf16_f32 v232, v244, v245
 s_waitcnt lgkmcnt(5)
 v_mfma_f32_32x32x16_bf16 v[0:15], v[200:203], v[148:151], v[0:15]
 ds_read_b128 v[172:175], v221 offset:8192
 v_exp_f32 v248, v116
 v_add_f32 v231, v246, v247
 v_exp_f32 v249, v117
 v_mfma_f32_32x32x16_bf16 v[16:31], v[204:207], v[148:151], v[16:31]
 ds_read_b128 v[176:179], v222 offset:8192
 v_cvt_pk_bf16_f32 v233, v246, v247
 v_exp_f32 v244, v118
 v_add_f32 v230, v230, v248
 v_mfma_f32_32x32x16_bf16 v[32:47], v[208:211], v[148:151], v[32:47]
 ds_read_b128 v[180:183], v223 offset:8192
 v_exp_f32 v245, v119
 v_add_f32 v231, v231, v249
 v_cvt_pk_bf16_f32 v234, v248, v249
 v_mfma_f32_32x32x16_bf16 v[48:63], v[212:215], v[148:151], v[48:63]
 v_exp_f32 v246, v120
 v_add_f32 v230, v230, v244
 v_exp_f32 v247, v121
 s_waitcnt lgkmcnt(0)
 s_barrier
 v_mfma_f32_32x32x16_bf16 v[96:111], v[152:155], v[64:67], v[128:143]
 ds_read_b64_tr_b16 v[184:185], v224 offset:40960
 ds_read_b64_tr_b16 v[186:187], v224 offset:43008
 v_add_f32 v231, v231, v245
 v_cvt_pk_bf16_f32 v235, v244, v245
 v_exp_f32 v248, v122
 v_mfma_f32_32x32x16_bf16 v[96:111], v[156:159], v[68:71], v[96:111]
 ds_read_b64_tr_b16 v[188:189], v225 offset:40960
 ds_read_b64_tr_b16 v[190:191], v225 offset:43008
 v_add_f32 v230, v230, v246
 v_exp_f32 v249, v123
 v_add_f32 v231, v231, v247
 v_mfma_f32_32x32x16_bf16 v[96:111], v[160:163], v[72:75], v[96:111]
 ds_read_b64_tr_b16 v[192:193], v226 offset:40960
 ds_read_b64_tr_b16 v[194:195], v226 offset:43008
 v_cvt_pk_bf16_f32 v236, v246, v247
 v_exp_f32 v244, v124
 v_add_f32 v230, v230, v248
 v_mfma_f32_32x32x16_bf16 v[96:111], v[164:167], v[76:79], v[96:111]
 ds_read_b64_tr_b16 v[196:197], v227 offset:40960
 ds_read_b64_tr_b16 v[198:199], v227 offset:43008
 v_exp_f32 v245, v125
 v_add_f32 v231, v231, v249
 v_cvt_pk_bf16_f32 v237, v248, v249
 v_mfma_f32_32x32x16_bf16 v[96:111], v[168:171], v[80:83], v[96:111]
 ds_read_b64_tr_b16 v[200:201], v224 offset:45056
 ds_read_b64_tr_b16 v[202:203], v224 offset:47104
 v_exp_f32 v246, v126
 v_add_f32 v230, v230, v244
 v_exp_f32 v247, v127
 v_mfma_f32_32x32x16_bf16 v[96:111], v[172:175], v[84:87], v[96:111]
 ds_read_b64_tr_b16 v[204:205], v225 offset:45056
 ds_read_b64_tr_b16 v[206:207], v225 offset:47104
 v_add_f32 v231, v231, v245
 v_cvt_pk_bf16_f32 v238, v244, v245
 v_add_f32 v230, v230, v246
 v_mfma_f32_32x32x16_bf16 v[96:111], v[176:179], v[88:91], v[96:111]
 ds_read_b64_tr_b16 v[208:209], v226 offset:45056
 ds_read_b64_tr_b16 v[210:211], v226 offset:47104
 v_add_f32 v231, v231, v247
 v_cvt_pk_bf16_f32 v239, v246, v247
 v_add_f32 v230, v230, v231
 v_mfma_f32_32x32x16_bf16 v[96:111], v[180:183], v[92:95], v[96:111]
 v_cmp_nge_f32 vcc, s54, v230
 s_waitcnt lgkmcnt(6)
 s_cbranch_vccnz K_rare_2007
K_back_2008:
 v_mfma_f32_32x32x16_bf16 v[0:15], v[184:187], v[232:235], v[0:15]
 ds_read_b64_tr_b16 v[212:213], v227 offset:45056
 ds_read_b64_tr_b16 v[214:215], v227 offset:47104
 v_add_f32 v228, v228, v230
 v_mfma_f32_32x32x16_bf16 v[16:31], v[188:191], v[232:235], v[16:31]
 ds_read_b128 v[152:155], v216 offset:16384
 ds_read_b128 v[156:159], v217 offset:16384
 v_mfma_f32_32x32x16_bf16 v[32:47], v[192:195], v[232:235], v[32:47]
 ds_read_b128 v[160:163], v218 offset:16384
 ds_read_b128 v[164:167], v219 offset:16384
 v_exp_f32 v244, v96
 v_exp_f32 v245, v97
 v_exp_f32 v246, v98
 v_mfma_f32_32x32x16_bf16 v[48:63], v[196:199], v[232:235], v[48:63]
 ds_read_b128 v[168:171], v220 offset:16384
 v_exp_f32 v247, v99
 v_add_f32 v230, v244, v245
 v_cvt_pk_bf16_f32 v144, v244, v245
 s_waitcnt lgkmcnt(5)
 v_mfma_f32_32x32x16_bf16 v[0:15], v[200:203], v[236:239], v[0:15]
 ds_read_b128 v[172:175], v221 offset:16384
 v_exp_f32 v248, v100
 v_add_f32 v231, v246, v247
 v_exp_f32 v249, v101
 v_mfma_f32_32x32x16_bf16 v[16:31], v[204:207], v[236:239], v[16:31]
 ds_read_b128 v[176:179], v222 offset:16384
 v_cvt_pk_bf16_f32 v145, v246, v247
 v_exp_f32 v244, v102
 v_add_f32 v230, v230, v248
 v_mfma_f32_32x32x16_bf16 v[32:47], v[208:211], v[236:239], v[32:47]
 ds_read_b128 v[180:183], v223 offset:16384
 v_exp_f32 v245, v103
 v_add_f32 v231, v231, v249
 v_cvt_pk_bf16_f32 v146, v248, v249
 v_mfma_f32_32x32x16_bf16 v[48:63], v[212:215], v[236:239], v[48:63]
 v_exp_f32 v246, v104
 v_add_f32 v230, v230, v244
 v_exp_f32 v247, v105
 s_waitcnt lgkmcnt(0)
 s_barrier
 v_mfma_f32_32x32x16_bf16 v[112:127], v[152:155], v[64:67], v[128:143]
 ds_read_b64_tr_b16 v[184:185], v224 offset:49152
 ds_read_b64_tr_b16 v[186:187], v224 offset:51200
 v_add_f32 v231, v231, v245
 v_cvt_pk_bf16_f32 v147, v244, v245
 v_exp_f32 v248, v106
 v_mfma_f32_32x32x16_bf16 v[112:127], v[156:159], v[68:71], v[112:127]
 ds_read_b64_tr_b16 v[188:189], v225 offset:49152
 ds_read_b64_tr_b16 v[190:191], v225 offset:51200
 v_add_f32 v230, v230, v246
 v_exp_f32 v249, v107
 v_add_f32 v231, v231, v247
 v_mfma_f32_32x32x16_bf16 v[112:127], v[160:163], v[72:75], v[112:127]
 ds_read_b64_tr_b16 v[192:193], v226 offset:49152
 ds_read_b64_tr_b16 v[194:195], v226 offset:51200
 v_cvt_pk_bf16_f32 v148, v246, v247
 v_exp_f32 v244, v108
 v_add_f32 v230, v230, v248
 v_mfma_f32_32x32x16_bf16 v[112:127], v[164:167], v[76:79], v[112:127]
 ds_read_b64_tr_b16 v[196:197], v227 offset:49152
 ds_read_b64_tr_b16 v[198:199], v227 offset:51200
 v_exp_f32 v245, v109
 v_add_f32 v231, v231, v249
 v_cvt_pk_bf16_f32 v149, v248, v249
 v_mfma_f32_32x32x16_bf16 v[112:127], v[168:171], v[80:83], v[112:127]
 ds_read_b64_tr_b16 v[200:201], v224 offset:53248
 ds_read_b64_tr_b16 v[202:203], v224 offset:55296
 v_exp_f32 v246, v110
 v_add_f32 v230, v230, v244
 v_exp_f32 v247, v111
 v_mfma_f32_32x32x16_bf16 v[112:127], v[172:175], v[84:87], v[112:127]
 ds_read_b64_tr_b16 v[204:205], v225 offset:53248
 ds_read_b64_tr_b16 v[206:207], v225 offset:55296
 v_add_f32 v231, v231, v245
 v_cvt_pk_bf16_f32 v150, v244, v245
 v_add_f32 v230, v230, v246
 v_mfma_f32_32x32x16_bf16 v[112:127], v[176:179], v[88:91], v[112:127]
 ds_read_b64_tr_b16 v[208:209], v226 offset:53248
 ds_read_b64_tr_b16 v[210:211], v226 offset:55296
 v_add_f32 v231, v231, v247
 v_cvt_pk_bf16_f32 v151, v246, v247
 v_add_f32 v230, v230, v231
 v_mfma_f32_32x32x16_bf16 v[112:127], v[180:183], v[92:95], v[112:127]
 v_cmp_nge_f32 vcc, s54, v230
 s_waitcnt lgkmcnt(6)
 s_cbranch_vccnz K_rare_2009
K_back_2010:
 v_mfma_f32_32x32x16_bf16 v[0:15], v[184:187], v[144:147], v[0:15]
 ds_read_b64_tr_b16 v[212:213], v227 offset:53248
 ds_read_b64_tr_b16 v[214:215], v227 offset:55296
 v_add_f32 v228, v228, v230
 v_mfma_f32_32x32x16_bf16 v[16:31], v[188:191], v[144:147], v[16:31]
 ds_read_b128 v[152:155], v216 offset:49152
 ds_read_b128 v[156:159], v217 offset:49152
 v_mfma_f32_32x32x16_bf16 v[32:47], v[192:195], v[144:147], v[32:47]
 ds_read_b128 v[160:163], v218 offset:49152
 ds_read_b128 v[164:167], v219 offset:49152
 v_exp_f32 v244, v112
 v_exp_f32 v245, v113
 v_exp_f32 v246, v114
 v_mfma_f32_32x32x16_bf16 v[48:63], v[196:199], v[144:147], v[48:63]
 ds_read_b128 v[168:171], v220 offset:49152
 v_exp_f32 v247, v115
 v_add_f32 v230, v244, v245
 v_cvt_pk_bf16_f32 v232, v244, v245
 s_waitcnt lgkmcnt(5)
 v_mfma_f32_32x32x16_bf16 v[0:15], v[200:203], v[148:151], v[0:15]
 ds_read_b128 v[172:175], v221 offset:49152
 v_exp_f32 v248, v116
 v_add_f32 v231, v246, v247
 v_exp_f32 v249, v117
 v_mfma_f32_32x32x16_bf16 v[16:31], v[204:207], v[148:151], v[16:31]
 ds_read_b128 v[176:179], v222 offset:49152
 v_cvt_pk_bf16_f32 v233, v246, v247
 v_exp_f32 v244, v118
 v_add_f32 v230, v230, v248
 v_mfma_f32_32x32x16_bf16 v[32:47], v[208:211], v[148:151], v[32:47]
 ds_read_b128 v[180:183], v223 offset:49152
 v_exp_f32 v245, v119
 v_add_f32 v231, v231, v249
 v_cvt_pk_bf16_f32 v234, v248, v249
 v_mfma_f32_32x32x16_bf16 v[48:63], v[212:215], v[148:151], v[48:63]
 v_exp_f32 v246, v120
 v_add_f32 v230, v230, v244
 v_exp_f32 v247, v121
 s_waitcnt lgkmcnt(0)
 s_barrier
 v_mfma_f32_32x32x16_bf16 v[96:111], v[152:155], v[64:67], v[128:143]
 ds_read_b64_tr_b16 v[184:185], v224 offset:57344
 ds_read_b64_tr_b16 v[186:187], v224 offset:59392
 v_add_f32 v231, v231, v245
 v_cvt_pk_bf16_f32 v235, v244, v245
 v_exp_f32 v248, v122
 v_mfma_f32_32x32x16_bf16 v[96:111], v[156:159], v[68:71], v[96:111]
 ds_read_b64_tr_b16 v[188:189], v225 offset:57344
 ds_read_b64_tr_b16 v[190:191], v225 offset:59392
 v_add_f32 v230, v230, v246
 v_exp_f32 v249, v123
 v_add_f32 v231, v231, v247
 v_mfma_f32_32x32x16_bf16 v[96:111], v[160:163], v[72:75], v[96:111]
 ds_read_b64_tr_b16 v[192:193], v226 offset:57344
 ds_read_b64_tr_b16 v[194:195], v226 offset:59392
 v_cvt_pk_bf16_f32 v236, v246, v247
 v_exp_f32 v244, v124
 v_add_f32 v230, v230, v248
 v_mfma_f32_32x32x16_bf16 v[96:111], v[164:167], v[76:79], v[96:111]
 ds_read_b64_tr_b16 v[196:197], v227 offset:57344
 ds_read_b64_tr_b16 v[198:199], v227 offset:59392
 v_exp_f32 v245, v125
 v_add_f32 v231, v231, v249
 v_cvt_pk_bf16_f32 v237, v248, v249
 v_mfma_f32_32x32x16_bf16 v[96:111], v[168:171], v[80:83], v[96:111]
 ds_read_b64_tr_b16 v[200:201], v224 offset:61440
 ds_read_b64_tr_b16 v[202:203], v224 offset:63488
 v_exp_f32 v246, v126
 v_add_f32 v230, v230, v244
 v_exp_f32 v247, v127
 v_mfma_f32_32x32x16_bf16 v[96:111], v[172:175], v[84:87], v[96:111]
 ds_read_b64_tr_b16 v[204:205], v225 offset:61440
 ds_read_b64_tr_b16 v[206:207], v225 offset:63488
 v_add_f32 v231, v231, v245
 v_cvt_pk_bf16_f32 v238, v244, v245
 v_add_f32 v230, v230, v246
 v_mfma_f32_32x32x16_bf16 v[96:111], v[176:179], v[88:91], v[96:111]
 ds_read_b64_tr_b16 v[208:209], v226 offset:61440
 ds_read_b64_tr_b16 v[210:211], v226 offset:63488
 v_add_f32 v231, v231, v247
 v_cvt_pk_bf16_f32 v239, v246, v247
 v_add_f32 v230, v230, v231
 v_mfma_f32_32x32x16_bf16 v[96:111], v[180:183], v[92:95], v[96:111]
 v_cmp_nge_f32 vcc, s54, v230
 s_waitcnt lgkmcnt(6)
 s_cbranch_vccnz K_rare_2011
K_back_2012:
 v_mfma_f32_32x32x16_bf16 v[0:15], v[184:187], v[232:235], v[0:15]
 ds_read_b64_tr_b16 v[212:213], v227 offset:61440
 ds_read_b64_tr_b16 v[214:215], v227 offset:63488
 v_add_f32 v228, v228, v230
 v_mfma_f32_32x32x16_bf16 v[16:31], v[188:191], v[232:235], v[16:31]
 ds_read_b128 v[152:155], v216 offset:24576
 ds_read_b128 v[156:159], v217 offset:24576
 v_mfma_f32_32x32x16_bf16 v[32:47], v[192:195], v[232:235], v[32:47]
 ds_read_b128 v[160:163], v218 offset:24576
 ds_read_b128 v[164:167], v219 offset:24576
 v_exp_f32 v244, v96
 v_exp_f32 v245, v97
 v_exp_f32 v246, v98
 v_mfma_f32_32x32x16_bf16 v[48:63], v[196:199], v[232:235], v[48:63]
 ds_read_b128 v[168:171], v220 offset:24576
 v_exp_f32 v247, v99
 v_add_f32 v230, v244, v245
 v_cvt_pk_bf16_f32 v144, v244, v245
 s_waitcnt lgkmcnt(5)
 v_mfma_f32_32x32x16_bf16 v[0:15], v[200:203], v[236:239], v[0:15]
 ds_read_b128 v[172:175], v221 offset:24576
 v_exp_f32 v248, v100
 v_add_f32 v231, v246, v247
 v_exp_f32 v249, v101
 v_mfma_f32_32x32x16_bf16 v[16:31], v[204:207], v[236:239], v[16:31]
 ds_read_b128 v[176:179], v222 offset:24576
 v_cvt_pk_bf16_f32 v145, v246, v247
 v_exp_f32 v244, v102
 v_add_f32 v230, v230, v248
 v_mfma_f32_32x32x16_bf16 v[32:47], v[208:211], v[236:239], v[32:47]
 ds_read_b128 v[180:183], v223 offset:24576
 v_exp_f32 v245, v103
 v_add_f32 v231, v231, v249
 v_cvt_pk_bf16_f32 v146, v248, v249
 v_mfma_f32_32x32x16_bf16 v[48:63], v[212:215], v[236:239], v[48:63]
 v_exp_f32 v246, v104
 v_add_f32 v230, v230, v244
 v_exp_f32 v247, v105
 s_waitcnt lgkmcnt(0)
 s_barrier
 v_mfma_f32_32x32x16_bf16 v[112:127], v[152:155], v[64:67], v[128:143]
 ds_read_b64_tr_b16 v[184:185], v224 offset:24576
 ds_read_b64_tr_b16 v[186:187], v224 offset:26624
 v_add_f32 v231, v231, v245
 v_cvt_pk_bf16_f32 v147, v244, v245
 v_exp_f32 v248, v106
 v_mfma_f32_32x32x16_bf16 v[112:127], v[156:159], v[68:71], v[112:127]
 ds_read_b64_tr_b16 v[188:189], v225 offset:24576
 ds_read_b64_tr_b16 v[190:191], v225 offset:26624
 v_add_f32 v230, v230, v246
 v_exp_f32 v249, v107
 v_add_f32 v231, v231, v247
 v_mfma_f32_32x32x16_bf16 v[112:127], v[160:163], v[72:75], v[112:127]
 ds_read_b64_tr_b16 v[192:193], v226 offset:24576
 ds_read_b64_tr_b16 v[194:195], v226 offset:26624
 v_cvt_pk_bf16_f32 v148, v246, v247
 v_exp_f32 v244, v108
 v_add_f32 v230, v230, v248
 v_mfma_f32_32x32x16_bf16 v[112:127], v[164:167], v[76:79], v[112:127]
 ds_read_b64_tr_b16 v[196:197], v227 offset:24576
 ds_read_b64_tr_b16 v[198:199], v227 offset:26624
 v_exp_f32 v245, v109
 v_add_f32 v231, v231, v249
 v_cvt_pk_bf16_f32 v149, v248, v249
 v_mfma_f32_32x32x16_bf16 v[112:127], v[168:171], v[80:83], v[112:127]
 ds_read_b64_tr_b16 v[200:201], v224 offset:28672
 ds_read_b64_tr_b16 v[202:203], v224 offset:30720
 v_exp_f32 v246, v110
 v_add_f32 v230, v230, v244
 v_exp_f32 v247, v111
 v_mfma_f32_32x32x16_bf16 v[112:127], v[172:175], v[84:87], v[112:127]
 ds_read_b64_tr_b16 v[204:205], v225 offset:28672
 ds_read_b64_tr_b16 v[206:207], v225 offset:30720
 v_add_f32 v231, v231, v245
 v_cvt_pk_bf16_f32 v150, v244, v245
 v_add_f32 v230, v230, v246
 v_mfma_f32_32x32x16_bf16 v[112:127], v[176:179], v[88:91], v[112:127]
 ds_read_b64_tr_b16 v[208:209], v226 offset:28672
 ds_read_b64_tr_b16 v[210:211], v226 offset:30720
 v_add_f32 v231, v231, v247
 v_cvt_pk_bf16_f32 v151, v246, v247
 v_add_f32 v230, v230, v231
 v_mfma_f32_32x32x16_bf16 v[112:127], v[180:183], v[92:95], v[112:127]
 v_cmp_nge_f32 vcc, s54, v230
 s_waitcnt lgkmcnt(6)
 s_cbranch_vccnz K_rare_2013
K_back_2014:
 v_mfma_f32_32x32x16_bf16 v[0:15], v[184:187], v[144:147], v[0:15]
 ds_read_b64_tr_b16 v[212:213], v227 offset:28672
 ds_read_b64_tr_b16 v[214:215], v227 offset:30720
 v_add_f32 v228, v228, v230
 v_mfma_f32_32x32x16_bf16 v[16:31], v[188:191], v[144:147], v[16:31]
 ds_read_b128 v[152:155], v216 offset:0
 ds_read_b128 v[156:159], v217 offset:0
 v_mfma_f32_32x32x16_bf16 v[32:47], v[192:195], v[144:147], v[32:47]
 ds_read_b128 v[160:163], v218 offset:0
 ds_read_b128 v[164:167], v219 offset:0
 v_exp_f32 v244, v112
 v_exp_f32 v245, v113
 v_exp_f32 v246, v114
 v_mfma_f32_32x32x16_bf16 v[48:63], v[196:199], v[144:147], v[48:63]
 ds_read_b128 v[168:171], v220 offset:0
 v_exp_f32 v247, v115
 v_add_f32 v230, v244, v245
 v_cvt_pk_bf16_f32 v232, v244, v245
 s_waitcnt lgkmcnt(5)
 v_mfma_f32_32x32x16_bf16 v[0:15], v[200:203], v[148:151], v[0:15]
 ds_read_b128 v[172:175], v221 offset:0
 v_exp_f32 v248, v116
 v_add_f32 v231, v246, v247
 v_exp_f32 v249, v117
 v_mfma_f32_32x32x16_bf16 v[16:31], v[204:207], v[148:151], v[16:31]
 ds_read_b128 v[176:179], v222 offset:0
 v_cvt_pk_bf16_f32 v233, v246, v247
 v_exp_f32 v244, v118
 v_add_f32 v230, v230, v248
 v_mfma_f32_32x32x16_bf16 v[32:47], v[208:211], v[148:151], v[32:47]
 ds_read_b128 v[180:183], v223 offset:0
 v_exp_f32 v245, v119
 v_add_f32 v231, v231, v249
 v_cvt_pk_bf16_f32 v234, v248, v249
 v_mfma_f32_32x32x16_bf16 v[48:63], v[212:215], v[148:151], v[48:63]
 v_exp_f32 v246, v120
 v_add_f32 v230, v230, v244
 v_exp_f32 v247, v121
 s_waitcnt lgkmcnt(0)
 s_barrier
 v_mfma_f32_32x32x16_bf16 v[96:111], v[152:155], v[64:67], v[128:143]
 ds_read_b64_tr_b16 v[184:185], v224 offset:32768
 ds_read_b64_tr_b16 v[186:187], v224 offset:34816
 v_add_f32 v231, v231, v245
 v_cvt_pk_bf16_f32 v235, v244, v245
 v_exp_f32 v248, v122
 v_mfma_f32_32x32x16_bf16 v[96:111], v[156:159], v[68:71], v[96:111]
 ds_read_b64_tr_b16 v[188:189], v225 offset:32768
 ds_read_b64_tr_b16 v[190:191], v225 offset:34816
 v_add_f32 v230, v230, v246
 v_exp_f32 v249, v123
 v_add_f32 v231, v231, v247
 v_mfma_f32_32x32x16_bf16 v[96:111], v[160:163], v[72:75], v[96:111]
 ds_read_b64_tr_b16 v[192:193], v226 offset:32768
 ds_read_b64_tr_b16 v[194:195], v226 offset:34816
 v_cvt_pk_bf16_f32 v236, v246, v247
 v_exp_f32 v244, v124
 v_add_f32 v230, v230, v248
 v_mfma_f32_32x32x16_bf16 v[96:111], v[164:167], v[76:79], v[96:111]
 ds_read_b64_tr_b16 v[196:197], v227 offset:32768
 ds_read_b64_tr_b16 v[198:199], v227 offset:34816
 v_exp_f32 v245, v125
 v_add_f32 v231, v231, v249
 v_cvt_pk_bf16_f32 v237, v248, v249
 v_mfma_f32_32x32x16_bf16 v[96:111], v[168:171], v[80:83], v[96:111]
 ds_read_b64_tr_b16 v[200:201], v224 offset:36864
 ds_read_b64_tr_b16 v[202:203], v224 offset:38912
 v_exp_f32 v246, v126
 v_add_f32 v230, v230, v244
 v_exp_f32 v247, v127
 v_mfma_f32_32x32x16_bf16 v[96:111], v[172:175], v[84:87], v[96:111]
 ds_read_b64_tr_b16 v[204:205], v225 offset:36864
 ds_read_b64_tr_b16 v[206:207], v225 offset:38912
 v_add_f32 v231, v231, v245
 v_cvt_pk_bf16_f32 v238, v244, v245
 v_add_f32 v230, v230, v246
 v_mfma_f32_32x32x16_bf16 v[96:111], v[176:179], v[88:91], v[96:111]
 ds_read_b64_tr_b16 v[208:209], v226 offset:36864
 ds_read_b64_tr_b16 v[210:211], v226 offset:38912
 v_add_f32 v231, v231, v247
 v_cvt_pk_bf16_f32 v239, v246, v247
 v_add_f32 v230, v230, v231
 v_mfma_f32_32x32x16_bf16 v[96:111], v[180:183], v[92:95], v[96:111]
 v_cmp_nge_f32 vcc, s54, v230
 s_waitcnt lgkmcnt(6)
 s_cbranch_vccnz K_rare_2015
K_back_2016:
 v_mfma_f32_32x32x16_bf16 v[0:15], v[184:187], v[232:235], v[0:15]
 ds_read_b64_tr_b16 v[212:213], v227 offset:36864
 ds_read_b64_tr_b16 v[214:215], v227 offset:38912
 v_add_f32 v228, v228, v230
 v_mfma_f32_32x32x16_bf16 v[16:31], v[188:191], v[232:235], v[16:31]
 ds_read_b128 v[152:155], v216 offset:8192
 ds_read_b128 v[156:159], v217 offset:8192
 v_mfma_f32_32x32x16_bf16 v[32:47], v[192:195], v[232:235], v[32:47]
 ds_read_b128 v[160:163], v218 offset:8192
 ds_read_b128 v[164:167], v219 offset:8192
 v_exp_f32 v244, v96
 v_exp_f32 v245, v97
 v_exp_f32 v246, v98
 v_mfma_f32_32x32x16_bf16 v[48:63], v[196:199], v[232:235], v[48:63]
 ds_read_b128 v[168:171], v220 offset:8192
 v_exp_f32 v247, v99
 v_add_f32 v230, v244, v245
 v_cvt_pk_bf16_f32 v144, v244, v245
 s_waitcnt lgkmcnt(5)
 v_mfma_f32_32x32x16_bf16 v[0:15], v[200:203], v[236:239], v[0:15]
 ds_read_b128 v[172:175], v221 offset:8192
 v_exp_f32 v248, v100
 v_add_f32 v231, v246, v247
 v_exp_f32 v249, v101
 v_mfma_f32_32x32x16_bf16 v[16:31], v[204:207], v[236:239], v[16:31]
 ds_read_b128 v[176:179], v222 offset:8192
 v_cvt_pk_bf16_f32 v145, v246, v247
 v_exp_f32 v244, v102
 v_add_f32 v230, v230, v248
 v_mfma_f32_32x32x16_bf16 v[32:47], v[208:211], v[236:239], v[32:47]
 ds_read_b128 v[180:183], v223 offset:8192
 v_exp_f32 v245, v103
 v_add_f32 v231, v231, v249
 v_cvt_pk_bf16_f32 v146, v248, v249
 v_mfma_f32_32x32x16_bf16 v[48:63], v[212:215], v[236:239], v[48:63]
 v_exp_f32 v246, v104
 v_add_f32 v230, v230, v244
 v_exp_f32 v247, v105
 s_waitcnt lgkmcnt(0)
 s_barrier
 v_mfma_f32_32x32x16_bf16 v[112:127], v[152:155], v[64:67], v[128:143]
 ds_read_b64_tr_b16 v[184:185], v224 offset:40960
 ds_read_b64_tr_b16 v[186:187], v224 offset:43008
 v_add_f32 v231, v231, v245
 v_cvt_pk_bf16_f32 v147, v244, v245
 v_exp_f32 v248, v106
 v_mfma_f32_32x32x16_bf16 v[112:127], v[156:159], v[68:71], v[112:127]
 ds_read_b64_tr_b16 v[188:189], v225 offset:40960
 ds_read_b64_tr_b16 v[190:191], v225 offset:43008
 v_add_f32 v230, v230, v246
 v_exp_f32 v249, v107
 v_add_f32 v231, v231, v247
 v_mfma_f32_32x32x16_bf16 v[112:127], v[160:163], v[72:75], v[112:127]
 ds_read_b64_tr_b16 v[192:193], v226 offset:40960
 ds_read_b64_tr_b16 v[194:195], v226 offset:43008
 v_cvt_pk_bf16_f32 v148, v246, v247
 v_exp_f32 v244, v108
 v_add_f32 v230, v230, v248
 v_mfma_f32_32x32x16_bf16 v[112:127], v[164:167], v[76:79], v[112:127]
 ds_read_b64_tr_b16 v[196:197], v227 offset:40960
 ds_read_b64_tr_b16 v[198:199], v227 offset:43008
 v_exp_f32 v245, v109
 v_add_f32 v231, v231, v249
 v_cvt_pk_bf16_f32 v149, v248, v249
 v_mfma_f32_32x32x16_bf16 v[112:127], v[168:171], v[80:83], v[112:127]
 ds_read_b64_tr_b16 v[200:201], v224 offset:45056
 ds_read_b64_tr_b16 v[202:203], v224 offset:47104
 v_exp_f32 v246, v110
 v_add_f32 v230, v230, v244
 v_exp_f32 v247, v111
 v_mfma_f32_32x32x16_bf16 v[112:127], v[172:175], v[84:87], v[112:127]
 ds_read_b64_tr_b16 v[204:205], v225 offset:45056
 ds_read_b64_tr_b16 v[206:207], v225 offset:47104
 v_add_f32 v231, v231, v245
 v_cvt_pk_bf16_f32 v150, v244, v245
 v_add_f32 v230, v230, v246
 v_mfma_f32_32x32x16_bf16 v[112:127], v[176:179], v[88:91], v[112:127]
 ds_read_b64_tr_b16 v[208:209], v226 offset:45056
 ds_read_b64_tr_b16 v[210:211], v226 offset:47104
 v_add_f32 v231, v231, v247
 v_cvt_pk_bf16_f32 v151, v246, v247
 v_add_f32 v230, v230, v231
 v_mfma_f32_32x32x16_bf16 v[112:127], v[180:183], v[92:95], v[112:127]
 v_cmp_nge_f32 vcc, s54, v230
 s_waitcnt lgkmcnt(6)
 s_cbranch_vccnz K_rare_2017
K_back_2018:
 v_mfma_f32_32x32x16_bf16 v[0:15], v[184:187], v[144:147], v[0:15]
 ds_read_b64_tr_b16 v[212:213], v227 offset:45056
 ds_read_b64_tr_b16 v[214:215], v227 offset:47104
 v_add_f32 v228, v228, v230
 v_mfma_f32_32x32x16_bf16 v[16:31], v[188:191], v[144:147], v[16:31]
 ds_read_b128 v[152:155], v216 offset:16384
 ds_read_b128 v[156:159], v217 offset:16384
 v_mfma_f32_32x32x16_bf16 v[32:47], v[192:195], v[144:147], v[32:47]
 ds_read_b128 v[160:163], v218 offset:16384
 ds_read_b128 v[164:167], v219 offset:16384
 v_exp_f32 v244, v112
 v_exp_f32 v245, v113
 v_exp_f32 v246, v114
 v_mfma_f32_32x32x16_bf16 v[48:63], v[196:199], v[144:147], v[48:63]
 ds_read_b128 v[168:171], v220 offset:16384
 v_exp_f32 v247, v115
 v_add_f32 v230, v244, v245
 v_cvt_pk_bf16_f32 v232, v244, v245
 s_waitcnt lgkmcnt(5)
 v_mfma_f32_32x32x16_bf16 v[0:15], v[200:203], v[148:151], v[0:15]
 ds_read_b128 v[172:175], v221 offset:16384
 v_exp_f32 v248, v116
 v_add_f32 v231, v246, v247
 v_exp_f32 v249, v117
 v_mfma_f32_32x32x16_bf16 v[16:31], v[204:207], v[148:151], v[16:31]
 ds_read_b128 v[176:179], v222 offset:16384
 v_cvt_pk_bf16_f32 v233, v246, v247
 v_exp_f32 v244, v118
 v_add_f32 v230, v230, v248
 v_mfma_f32_32x32x16_bf16 v[32:47], v[208:211], v[148:151], v[32:47]
 ds_read_b128 v[180:183], v223 offset:16384
 v_exp_f32 v245, v119
 v_add_f32 v231, v231, v249
 v_cvt_pk_bf16_f32 v234, v248, v249
 v_mfma_f32_32x32x16_bf16 v[48:63], v[212:215], v[148:151], v[48:63]
 v_exp_f32 v246, v120
 v_add_f32 v230, v230, v244
 v_exp_f32 v247, v121
 s_waitcnt lgkmcnt(0)
 s_barrier
 v_mfma_f32_32x32x16_bf16 v[96:111], v[152:155], v[64:67], v[128:143]
 ds_read_b64_tr_b16 v[184:185], v224 offset:49152
 ds_read_b64_tr_b16 v[186:187], v224 offset:51200
 v_add_f32 v231, v231, v245
 v_cvt_pk_bf16_f32 v235, v244, v245
 v_exp_f32 v248, v122
 v_mfma_f32_32x32x16_bf16 v[96:111], v[156:159], v[68:71], v[96:111]
 ds_read_b64_tr_b16 v[188:189], v225 offset:49152
 ds_read_b64_tr_b16 v[190:191], v225 offset:51200
 v_add_f32 v230, v230, v246
 v_exp_f32 v249, v123
 v_add_f32 v231, v231, v247
 v_mfma_f32_32x32x16_bf16 v[96:111], v[160:163], v[72:75], v[96:111]
 ds_read_b64_tr_b16 v[192:193], v226 offset:49152
 ds_read_b64_tr_b16 v[194:195], v226 offset:51200
 v_cvt_pk_bf16_f32 v236, v246, v247
 v_exp_f32 v244, v124
 v_add_f32 v230, v230, v248
 v_mfma_f32_32x32x16_bf16 v[96:111], v[164:167], v[76:79], v[96:111]
 ds_read_b64_tr_b16 v[196:197], v227 offset:49152
 ds_read_b64_tr_b16 v[198:199], v227 offset:51200
 v_exp_f32 v245, v125
 v_add_f32 v231, v231, v249
 v_cvt_pk_bf16_f32 v237, v248, v249
 v_mfma_f32_32x32x16_bf16 v[96:111], v[168:171], v[80:83], v[96:111]
 ds_read_b64_tr_b16 v[200:201], v224 offset:53248
 ds_read_b64_tr_b16 v[202:203], v224 offset:55296
 v_exp_f32 v246, v126
 v_add_f32 v230, v230, v244
 v_exp_f32 v247, v127
 v_mfma_f32_32x32x16_bf16 v[96:111], v[172:175], v[84:87], v[96:111]
 ds_read_b64_tr_b16 v[204:205], v225 offset:53248
 ds_read_b64_tr_b16 v[206:207], v225 offset:55296
 v_add_f32 v231, v231, v245
 v_cvt_pk_bf16_f32 v238, v244, v245
 v_add_f32 v230, v230, v246
 v_mfma_f32_32x32x16_bf16 v[96:111], v[176:179], v[88:91], v[96:111]
 ds_read_b64_tr_b16 v[208:209], v226 offset:53248
 ds_read_b64_tr_b16 v[210:211], v226 offset:55296
 v_add_f32 v231, v231, v247
 v_cvt_pk_bf16_f32 v239, v246, v247
 v_add_f32 v230, v230, v231
 v_mfma_f32_32x32x16_bf16 v[96:111], v[180:183], v[92:95], v[96:111]
 v_cmp_nge_f32 vcc, s54, v230
 s_waitcnt lgkmcnt(6)
 s_cbranch_vccnz K_rare_2019
K_back_2020:
 v_mfma_f32_32x32x16_bf16 v[0:15], v[184:187], v[232:235], v[0:15]
 ds_read_b64_tr_b16 v[212:213], v227 offset:53248
 ds_read_b64_tr_b16 v[214:215], v227 offset:55296
 v_add_f32 v228, v228, v230
 v_mfma_f32_32x32x16_bf16 v[16:31], v[188:191], v[232:235], v[16:31]
 ds_read_b128 v[152:155], v216 offset:24576
 ds_read_b128 v[156:159], v217 offset:24576
 v_mfma_f32_32x32x16_bf16 v[32:47], v[192:195], v[232:235], v[32:47]
 ds_read_b128 v[160:163], v218 offset:24576
 ds_read_b128 v[164:167], v219 offset:24576
 v_exp_f32 v244, v96
 v_exp_f32 v245, v97
 v_exp_f32 v246, v98
 v_mfma_f32_32x32x16_bf16 v[48:63], v[196:199], v[232:235], v[48:63]
 ds_read_b128 v[168:171], v220 offset:24576
 v_exp_f32 v247, v99
 v_add_f32 v230, v244, v245
 v_cvt_pk_bf16_f32 v144, v244, v245
 s_waitcnt lgkmcnt(5)
 v_mfma_f32_32x32x16_bf16 v[0:15], v[200:203], v[236:239], v[0:15]
 ds_read_b128 v[172:175], v221 offset:24576
 v_exp_f32 v248, v100
 v_add_f32 v231, v246, v247
 v_exp_f32 v249, v101
 v_mfma_f32_32x32x16_bf16 v[16:31], v[204:207], v[236:239], v[16:31]
 ds_read_b128 v[176:179], v222 offset:24576
 v_cvt_pk_bf16_f32 v145, v246, v247
 v_exp_f32 v244, v102
 v_add_f32 v230, v230, v248
 v_mfma_f32_32x32x16_bf16 v[32:47], v[208:211], v[236:239], v[32:47]
 ds_read_b128 v[180:183], v223 offset:24576
 v_exp_f32 v245, v103
 v_add_f32 v231, v231, v249
 v_cvt_pk_bf16_f32 v146, v248, v249
 v_mfma_f32_32x32x16_bf16 v[48:63], v[212:215], v[236:239], v[48:63]
 v_exp_f32 v246, v104
 v_add_f32 v230, v230, v244
 v_exp_f32 v247, v105
 s_waitcnt lgkmcnt(0)
 s_barrier
 v_mfma_f32_32x32x16_bf16 v[112:127], v[152:155], v[64:67], v[128:143]
 ds_read_b64_tr_b16 v[184:185], v224 offset:57344
 ds_read_b64_tr_b16 v[186:187], v224 offset:59392
 v_add_f32 v231, v231, v245
 v_cvt_pk_bf16_f32 v147, v244, v245
 v_exp_f32 v248, v106
 v_mfma_f32_32x32x16_bf16 v[112:127], v[156:159], v[68:71], v[112:127]
 ds_read_b64_tr_b16 v[188:189], v225 offset:57344
 ds_read_b64_tr_b16 v[190:191], v225 offset:59392
 v_add_f32 v230, v230, v246
 v_exp_f32 v249, v107
 v_add_f32 v231, v231, v247
 v_mfma_f32_32x32x16_bf16 v[112:127], v[160:163], v[72:75], v[112:127]
 ds_read_b64_tr_b16 v[192:193], v226 offset:57344
 ds_read_b64_tr_b16 v[194:195], v226 offset:59392
 v_cvt_pk_bf16_f32 v148, v246, v247
 v_exp_f32 v244, v108
 v_add_f32 v230, v230, v248
 v_mfma_f32_32x32x16_bf16 v[112:127], v[164:167], v[76:79], v[112:127]
 ds_read_b64_tr_b16 v[196:197], v227 offset:57344
 ds_read_b64_tr_b16 v[198:199], v227 offset:59392
 v_exp_f32 v245, v109
 v_add_f32 v231, v231, v249
 v_cvt_pk_bf16_f32 v149, v248, v249
 v_mfma_f32_32x32x16_bf16 v[112:127], v[168:171], v[80:83], v[112:127]
 ds_read_b64_tr_b16 v[200:201], v224 offset:61440
 ds_read_b64_tr_b16 v[202:203], v224 offset:63488
 v_exp_f32 v246, v110
 v_add_f32 v230, v230, v244
 v_exp_f32 v247, v111
 v_mfma_f32_32x32x16_bf16 v[112:127], v[172:175], v[84:87], v[112:127]
 ds_read_b64_tr_b16 v[204:205], v225 offset:61440
 ds_read_b64_tr_b16 v[206:207], v225 offset:63488
 v_add_f32 v231, v231, v245
 v_cvt_pk_bf16_f32 v150, v244, v245
 v_add_f32 v230, v230, v246
 v_mfma_f32_32x32x16_bf16 v[112:127], v[176:179], v[88:91], v[112:127]
 ds_read_b64_tr_b16 v[208:209], v226 offset:61440
 ds_read_b64_tr_b16 v[210:211], v226 offset:63488
 v_add_f32 v231, v231, v247
 v_cvt_pk_bf16_f32 v151, v246, v247
 v_add_f32 v230, v230, v231
 v_mfma_f32_32x32x16_bf16 v[112:127], v[180:183], v[92:95], v[112:127]
 v_cmp_nge_f32 vcc, s54, v230
 s_waitcnt lgkmcnt(6)
 s_cbranch_vccnz K_rare_2021
K_back_2022:
 v_mfma_f32_32x32x16_bf16 v[0:15], v[184:187], v[144:147], v[0:15]
 ds_read_b64_tr_b16 v[212:213], v227 offset:61440
 ds_read_b64_tr_b16 v[214:215], v227 offset:63488
 v_add_f32 v228, v228, v230
 v_mfma_f32_32x32x16_bf16 v[16:31], v[188:191], v[144:147], v[16:31]
 ds_read_b128 v[152:155], v216 offset:0
 ds_read_b128 v[156:159], v217 offset:0
 v_mfma_f32_32x32x16_bf16 v[32:47], v[192:195], v[144:147], v[32:47]
 ds_read_b128 v[160:163], v218 offset:0
 ds_read_b128 v[164:167], v219 offset:0
 v_exp_f32 v244, v112
 v_exp_f32 v245, v113
 v_exp_f32 v246, v114
 v_mfma_f32_32x32x16_bf16 v[48:63], v[196:199], v[144:147], v[48:63]
 ds_read_b128 v[168:171], v220 offset:0
 v_exp_f32 v247, v115
 v_add_f32 v230, v244, v245
 v_cvt_pk_bf16_f32 v232, v244, v245
 s_waitcnt lgkmcnt(5)
 v_mfma_f32_32x32x16_bf16 v[0:15], v[200:203], v[148:151], v[0:15]
 ds_read_b128 v[172:175], v221 offset:0
 v_exp_f32 v248, v116
 v_add_f32 v231, v246, v247
 v_exp_f32 v249, v117
 v_mfma_f32_32x32x16_bf16 v[16:31], v[204:207], v[148:151], v[16:31]
 ds_read_b128 v[176:179], v222 offset:0
 v_cvt_pk_bf16_f32 v233, v246, v247
 v_exp_f32 v244, v118
 v_add_f32 v230, v230, v248
 v_mfma_f32_32x32x16_bf16 v[32:47], v[208:211], v[148:151], v[32:47]
 ds_read_b128 v[180:183], v223 offset:0
 v_exp_f32 v245, v119
 v_add_f32 v231, v231, v249
 v_cvt_pk_bf16_f32 v234, v248, v249
 v_mfma_f32_32x32x16_bf16 v[48:63], v[212:215], v[148:151], v[48:63]
 v_exp_f32 v246, v120
 v_add_f32 v230, v230, v244
 v_exp_f32 v247, v121
 s_waitcnt lgkmcnt(0)
 s_barrier
 v_mfma_f32_32x32x16_bf16 v[96:111], v[152:155], v[64:67], v[128:143]
 ds_read_b64_tr_b16 v[184:185], v224 offset:32768
 ds_read_b64_tr_b16 v[186:187], v224 offset:34816
 v_add_f32 v231, v231, v245
 v_cvt_pk_bf16_f32 v235, v244, v245
 v_exp_f32 v248, v122
 v_mfma_f32_32x32x16_bf16 v[96:111], v[156:159], v[68:71], v[96:111]
 ds_read_b64_tr_b16 v[188:189], v225 offset:32768
 ds_read_b64_tr_b16 v[190:191], v225 offset:34816
 v_add_f32 v230, v230, v246
 v_exp_f32 v249, v123
 v_add_f32 v231, v231, v247
 v_mfma_f32_32x32x16_bf16 v[96:111], v[160:163], v[72:75], v[96:111]
 ds_read_b64_tr_b16 v[192:193], v226 offset:32768
 ds_read_b64_tr_b16 v[194:195], v226 offset:34816
 v_cvt_pk_bf16_f32 v236, v246, v247
 v_exp_f32 v244, v124
 v_add_f32 v230, v230, v248
 v_mfma_f32_32x32x16_bf16 v[96:111], v[164:167], v[76:79], v[96:111]
 ds_read_b64_tr_b16 v[196:197], v227 offset:32768
 ds_read_b64_tr_b16 v[198:199], v227 offset:34816
 v_exp_f32 v245, v125
 v_add_f32 v231, v231, v249
 v_cvt_pk_bf16_f32 v237, v248, v249
 v_mfma_f32_32x32x16_bf16 v[96:111], v[168:171], v[80:83], v[96:111]
 ds_read_b64_tr_b16 v[200:201], v224 offset:36864
 ds_read_b64_tr_b16 v[202:203], v224 offset:38912
 v_exp_f32 v246, v126
 v_add_f32 v230, v230, v244
 v_exp_f32 v247, v127
 v_mfma_f32_32x32x16_bf16 v[96:111], v[172:175], v[84:87], v[96:111]
 ds_read_b64_tr_b16 v[204:205], v225 offset:36864
 ds_read_b64_tr_b16 v[206:207], v225 offset:38912
 v_add_f32 v231, v231, v245
 v_cvt_pk_bf16_f32 v238, v244, v245
 v_add_f32 v230, v230, v246
 v_mfma_f32_32x32x16_bf16 v[96:111], v[176:179], v[88:91], v[96:111]
 ds_read_b64_tr_b16 v[208:209], v226 offset:36864
 ds_read_b64_tr_b16 v[210:211], v226 offset:38912
 v_add_f32 v231, v231, v247
 v_cvt_pk_bf16_f32 v239, v246, v247
 v_add_f32 v230, v230, v231
 v_mfma_f32_32x32x16_bf16 v[96:111], v[180:183], v[92:95], v[96:111]
 v_cmp_nge_f32 vcc, s54, v230
 s_waitcnt lgkmcnt(6)
 s_cbranch_vccnz K_rare_2023
K_back_2024:
 v_mfma_f32_32x32x16_bf16 v[0:15], v[184:187], v[232:235], v[0:15]
 ds_read_b64_tr_b16 v[212:213], v227 offset:36864
 ds_read_b64_tr_b16 v[214:215], v227 offset:38912
 v_add_f32 v228, v228, v230
 v_mfma_f32_32x32x16_bf16 v[16:31], v[188:191], v[232:235], v[16:31]
 ds_read_b128 v[152:155], v216 offset:8192
 ds_read_b128 v[156:159], v217 offset:8192
 v_mfma_f32_32x32x16_bf16 v[32:47], v[192:195], v[232:235], v[32:47]
 ds_read_b128 v[160:163], v218 offset:8192
 ds_read_b128 v[164:167], v219 offset:8192
 v_exp_f32 v244, v96
 v_exp_f32 v245, v97
 v_exp_f32 v246, v98
 v_mfma_f32_32x32x16_bf16 v[48:63], v[196:199], v[232:235], v[48:63]
 ds_read_b128 v[168:171], v220 offset:8192
 v_exp_f32 v247, v99
 v_add_f32 v230, v244, v245
 v_cvt_pk_bf16_f32 v144, v244, v245
 s_waitcnt lgkmcnt(5)
 v_mfma_f32_32x32x16_bf16 v[0:15], v[200:203], v[236:239], v[0:15]
 ds_read_b128 v[172:175], v221 offset:8192
 v_exp_f32 v248, v100
 v_add_f32 v231, v246, v247
 v_exp_f32 v249, v101
 v_mfma_f32_32x32x16_bf16 v[16:31], v[204:207], v[236:239], v[16:31]
 ds_read_b128 v[176:179], v222 offset:8192
 v_cvt_pk_bf16_f32 v145, v246, v247
 v_exp_f32 v244, v102
 v_add_f32 v230, v230, v248
 v_mfma_f32_32x32x16_bf16 v[32:47], v[208:211], v[236:239], v[32:47]
 ds_read_b128 v[180:183], v223 offset:8192
 v_exp_f32 v245, v103
 v_add_f32 v231, v231, v249
 v_cvt_pk_bf16_f32 v146, v248, v249
 v_mfma_f32_32x32x16_bf16 v[48:63], v[212:215], v[236:239], v[48:63]
 v_exp_f32 v246, v104
 v_add_f32 v230, v230, v244
 v_exp_f32 v247, v105
 s_waitcnt lgkmcnt(0)
 s_barrier
 v_mfma_f32_32x32x16_bf16 v[112:127], v[152:155], v[64:67], v[128:143]
 ds_read_b64_tr_b16 v[184:185], v224 offset:40960
 ds_read_b64_tr_b16 v[186:187], v224 offset:43008
 v_add_f32 v231, v231, v245
 v_cvt_pk_bf16_f32 v147, v244, v245
 v_exp_f32 v248, v106
 v_mfma_f32_32x32x16_bf16 v[112:127], v[156:159], v[68:71], v[112:127]
 ds_read_b64_tr_b16 v[188:189], v225 offset:40960
 ds_read_b64_tr_b16 v[190:191], v225 offset:43008
 v_add_f32 v230, v230, v246
 v_exp_f32 v249, v107
 v_add_f32 v231, v231, v247
 v_mfma_f32_32x32x16_bf16 v[112:127], v[160:163], v[72:75], v[112:127]
 ds_read_b64_tr_b16 v[192:193], v226 offset:40960
 ds_read_b64_tr_b16 v[194:195], v226 offset:43008
 v_cvt_pk_bf16_f32 v148, v246, v247
 v_exp_f32 v244, v108
 v_add_f32 v230, v230, v248
 v_mfma_f32_32x32x16_bf16 v[112:127], v[164:167], v[76:79], v[112:127]
 ds_read_b64_tr_b16 v[196:197], v227 offset:40960
 ds_read_b64_tr_b16 v[198:199], v227 offset:43008
 v_exp_f32 v245, v109
 v_add_f32 v231, v231, v249
 v_cvt_pk_bf16_f32 v149, v248, v249
 v_mfma_f32_32x32x16_bf16 v[112:127], v[168:171], v[80:83], v[112:127]
 ds_read_b64_tr_b16 v[200:201], v224 offset:45056
 ds_read_b64_tr_b16 v[202:203], v224 offset:47104
 v_exp_f32 v246, v110
 v_add_f32 v230, v230, v244
 v_exp_f32 v247, v111
 v_mfma_f32_32x32x16_bf16 v[112:127], v[172:175], v[84:87], v[112:127]
 ds_read_b64_tr_b16 v[204:205], v225 offset:45056
 ds_read_b64_tr_b16 v[206:207], v225 offset:47104
 v_add_f32 v231, v231, v245
 v_cvt_pk_bf16_f32 v150, v244, v245
 v_add_f32 v230, v230, v246
 v_mfma_f32_32x32x16_bf16 v[112:127], v[176:179], v[88:91], v[112:127]
 ds_read_b64_tr_b16 v[208:209], v226 offset:45056
 ds_read_b64_tr_b16 v[210:211], v226 offset:47104
 v_add_f32 v231, v231, v247
 v_cvt_pk_bf16_f32 v151, v246, v247
 v_add_f32 v230, v230, v231
 v_mfma_f32_32x32x16_bf16 v[112:127], v[180:183], v[92:95], v[112:127]
 v_cmp_nge_f32 vcc, s54, v230
 s_waitcnt lgkmcnt(6)
 s_cbranch_vccnz K_rare_2025
K_back_2026:
 v_mfma_f32_32x32x16_bf16 v[0:15], v[184:187], v[144:147], v[0:15]
 ds_read_b64_tr_b16 v[212:213], v227 offset:45056
 ds_read_b64_tr_b16 v[214:215], v227 offset:47104
 v_add_f32 v228, v228, v230
 v_mfma_f32_32x32x16_bf16 v[16:31], v[188:191], v[144:147], v[16:31]
 ds_read_b128 v[152:155], v216 offset:16384
 ds_read_b128 v[156:159], v217 offset:16384
 v_mfma_f32_32x32x16_bf16 v[32:47], v[192:195], v[144:147], v[32:47]
 ds_read_b128 v[160:163], v218 offset:16384
 ds_read_b128 v[164:167], v219 offset:16384
 v_exp_f32 v244, v112
 v_exp_f32 v245, v113
 v_exp_f32 v246, v114
 v_mfma_f32_32x32x16_bf16 v[48:63], v[196:199], v[144:147], v[48:63]
 ds_read_b128 v[168:171], v220 offset:16384
 v_exp_f32 v247, v115
 v_add_f32 v230, v244, v245
 v_cvt_pk_bf16_f32 v232, v244, v245
 s_waitcnt lgkmcnt(5)
 v_mfma_f32_32x32x16_bf16 v[0:15], v[200:203], v[148:151], v[0:15]
 ds_read_b128 v[172:175], v221 offset:16384
 v_exp_f32 v248, v116
 v_add_f32 v231, v246, v247
 v_exp_f32 v249, v117
 v_mfma_f32_32x32x16_bf16 v[16:31], v[204:207], v[148:151], v[16:31]
 ds_read_b128 v[176:179], v222 offset:16384
 v_cvt_pk_bf16_f32 v233, v246, v247
 v_exp_f32 v244, v118
 v_add_f32 v230, v230, v248
 v_mfma_f32_32x32x16_bf16 v[32:47], v[208:211], v[148:151], v[32:47]
 ds_read_b128 v[180:183], v223 offset:16384
 v_exp_f32 v245, v119
 v_add_f32 v231, v231, v249
 v_cvt_pk_bf16_f32 v234, v248, v249
 v_mfma_f32_32x32x16_bf16 v[48:63], v[212:215], v[148:151], v[48:63]
 v_exp_f32 v246, v120
 v_add_f32 v230, v230, v244
 v_exp_f32 v247, v121
 s_waitcnt lgkmcnt(0)
 s_barrier
 v_mfma_f32_32x32x16_bf16 v[96:111], v[152:155], v[64:67], v[128:143]
 ds_read_b64_tr_b16 v[184:185], v224 offset:49152
 ds_read_b64_tr_b16 v[186:187], v224 offset:51200
 v_add_f32 v231, v231, v245
 v_cvt_pk_bf16_f32 v235, v244, v245
 v_exp_f32 v248, v122
 v_mfma_f32_32x32x16_bf16 v[96:111], v[156:159], v[68:71], v[96:111]
 ds_read_b64_tr_b16 v[188:189], v225 offset:49152
 ds_read_b64_tr_b16 v[190:191], v225 offset:51200
 v_add_f32 v230, v230, v246
 v_exp_f32 v249, v123
 v_add_f32 v231, v231, v247
 v_mfma_f32_32x32x16_bf16 v[96:111], v[160:163], v[72:75], v[96:111]
 ds_read_b64_tr_b16 v[192:193], v226 offset:49152
 ds_read_b64_tr_b16 v[194:195], v226 offset:51200
 v_cvt_pk_bf16_f32 v236, v246, v247
 v_exp_f32 v244, v124
 v_add_f32 v230, v230, v248
 v_mfma_f32_32x32x16_bf16 v[96:111], v[164:167], v[76:79], v[96:111]
 ds_read_b64_tr_b16 v[196:197], v227 offset:49152
 ds_read_b64_tr_b16 v[198:199], v227 offset:51200
 v_exp_f32 v245, v125
 v_add_f32 v231, v231, v249
 v_cvt_pk_bf16_f32 v237, v248, v249
 v_mfma_f32_32x32x16_bf16 v[96:111], v[168:171], v[80:83], v[96:111]
 ds_read_b64_tr_b16 v[200:201], v224 offset:53248
 ds_read_b64_tr_b16 v[202:203], v224 offset:55296
 v_exp_f32 v246, v126
 v_add_f32 v230, v230, v244
 v_exp_f32 v247, v127
 v_mfma_f32_32x32x16_bf16 v[96:111], v[172:175], v[84:87], v[96:111]
 ds_read_b64_tr_b16 v[204:205], v225 offset:53248
 ds_read_b64_tr_b16 v[206:207], v225 offset:55296
 v_add_f32 v231, v231, v245
 v_cvt_pk_bf16_f32 v238, v244, v245
 v_add_f32 v230, v230, v246
 v_mfma_f32_32x32x16_bf16 v[96:111], v[176:179], v[88:91], v[96:111]
 ds_read_b64_tr_b16 v[208:209], v226 offset:53248
 ds_read_b64_tr_b16 v[210:211], v226 offset:55296
 v_add_f32 v231, v231, v247
 v_cvt_pk_bf16_f32 v239, v246, v247
 v_add_f32 v230, v230, v231
 v_mfma_f32_32x32x16_bf16 v[96:111], v[180:183], v[92:95], v[96:111]
 v_cmp_nge_f32 vcc, s54, v230
 s_waitcnt lgkmcnt(6)
 s_cbranch_vccnz K_rare_2027
K_back_2028:
 v_mfma_f32_32x32x16_bf16 v[0:15], v[184:187], v[232:235], v[0:15]
 ds_read_b64_tr_b16 v[212:213], v227 offset:53248
 ds_read_b64_tr_b16 v[214:215], v227 offset:55296
 v_add_f32 v228, v228, v230
 v_mfma_f32_32x32x16_bf16 v[16:31], v[188:191], v[232:235], v[16:31]
 ds_read_b128 v[152:155], v216 offset:0
 ds_read_b128 v[156:159], v217 offset:0
 v_mfma_f32_32x32x16_bf16 v[32:47], v[192:195], v[232:235], v[32:47]
 ds_read_b128 v[160:163], v218 offset:0
 ds_read_b128 v[164:167], v219 offset:0
 v_exp_f32 v244, v96
 v_exp_f32 v245, v97
 v_exp_f32 v246, v98
 v_mfma_f32_32x32x16_bf16 v[48:63], v[196:199], v[232:235], v[48:63]
 ds_read_b128 v[168:171], v220 offset:0
 v_exp_f32 v247, v99
 v_add_f32 v230, v244, v245
 v_cvt_pk_bf16_f32 v144, v244, v245
 s_waitcnt lgkmcnt(5)
 v_mfma_f32_32x32x16_bf16 v[0:15], v[200:203], v[236:239], v[0:15]
 ds_read_b128 v[172:175], v221 offset:0
 v_exp_f32 v248, v100
 v_add_f32 v231, v246, v247
 v_exp_f32 v249, v101
 v_mfma_f32_32x32x16_bf16 v[16:31], v[204:207], v[236:239], v[16:31]
 ds_read_b128 v[176:179], v222 offset:0
 v_cvt_pk_bf16_f32 v145, v246, v247
 v_exp_f32 v244, v102
 v_add_f32 v230, v230, v248
 v_mfma_f32_32x32x16_bf16 v[32:47], v[208:211], v[236:239], v[32:47]
 ds_read_b128 v[180:183], v223 offset:0
 v_exp_f32 v245, v103
 v_add_f32 v231, v231, v249
 v_cvt_pk_bf16_f32 v146, v248, v249
 v_mfma_f32_32x32x16_bf16 v[48:63], v[212:215], v[236:239], v[48:63]
 v_exp_f32 v246, v104
 v_add_f32 v230, v230, v244
 v_exp_f32 v247, v105
 s_waitcnt lgkmcnt(0)
 s_barrier
 v_mfma_f32_32x32x16_bf16 v[112:127], v[152:155], v[64:67], v[128:143]
 ds_read_b64_tr_b16 v[184:185], v224 offset:57344
 ds_read_b64_tr_b16 v[186:187], v224 offset:59392
 v_add_f32 v231, v231, v245
 v_cvt_pk_bf16_f32 v147, v244, v245
 v_exp_f32 v248, v106
 v_mfma_f32_32x32x16_bf16 v[112:127], v[156:159], v[68:71], v[112:127]
 ds_read_b64_tr_b16 v[188:189], v225 offset:57344
 ds_read_b64_tr_b16 v[190:191], v225 offset:59392
 v_add_f32 v230, v230, v246
 v_exp_f32 v249, v107
 v_add_f32 v231, v231, v247
 v_mfma_f32_32x32x16_bf16 v[112:127], v[160:163], v[72:75], v[112:127]
 ds_read_b64_tr_b16 v[192:193], v226 offset:57344
 ds_read_b64_tr_b16 v[194:195], v226 offset:59392
 v_cvt_pk_bf16_f32 v148, v246, v247
 v_exp_f32 v244, v108
 v_add_f32 v230, v230, v248
 v_mfma_f32_32x32x16_bf16 v[112:127], v[164:167], v[76:79], v[112:127]
 ds_read_b64_tr_b16 v[196:197], v227 offset:57344
 ds_read_b64_tr_b16 v[198:199], v227 offset:59392
 v_exp_f32 v245, v109
 v_add_f32 v231, v231, v249
 v_cvt_pk_bf16_f32 v149, v248, v249
 v_mfma_f32_32x32x16_bf16 v[112:127], v[168:171], v[80:83], v[112:127]
 ds_read_b64_tr_b16 v[200:201], v224 offset:61440
 ds_read_b64_tr_b16 v[202:203], v224 offset:63488
 v_exp_f32 v246, v110
 v_add_f32 v230, v230, v244
 v_exp_f32 v247, v111
 v_mfma_f32_32x32x16_bf16 v[112:127], v[172:175], v[84:87], v[112:127]
 ds_read_b64_tr_b16 v[204:205], v225 offset:61440
 ds_read_b64_tr_b16 v[206:207], v225 offset:63488
 v_add_f32 v231, v231, v245
 v_cvt_pk_bf16_f32 v150, v244, v245
 v_add_f32 v230, v230, v246
 v_mfma_f32_32x32x16_bf16 v[112:127], v[176:179], v[88:91], v[112:127]
 ds_read_b64_tr_b16 v[208:209], v226 offset:61440
 ds_read_b64_tr_b16 v[210:211], v226 offset:63488
 v_add_f32 v231, v231, v247
 v_cvt_pk_bf16_f32 v151, v246, v247
 v_add_f32 v230, v230, v231
 v_mfma_f32_32x32x16_bf16 v[112:127], v[180:183], v[92:95], v[112:127]
 v_cmp_nge_f32 vcc, s54, v230
 s_waitcnt lgkmcnt(6)
 s_cbranch_vccnz K_rare_2029
K_back_2030:
 v_mfma_f32_32x32x16_bf16 v[0:15], v[184:187], v[144:147], v[0:15]
 ds_read_b64_tr_b16 v[212:213], v227 offset:61440
 ds_read_b64_tr_b16 v[214:215], v227 offset:63488
 v_add_f32 v228, v228, v230
 v_mfma_f32_32x32x16_bf16 v[16:31], v[188:191], v[144:147], v[16:31]
 s_nop 3
 v_mfma_f32_32x32x16_bf16 v[32:47], v[192:195], v[144:147], v[32:47]
 v_exp_f32 v244, v112
 v_exp_f32 v245, v113
 v_exp_f32 v246, v114
 v_mfma_f32_32x32x16_bf16 v[48:63], v[196:199], v[144:147], v[48:63]
 v_exp_f32 v247, v115
 v_add_f32 v230, v244, v245
 v_cvt_pk_bf16_f32 v232, v244, v245
 s_waitcnt lgkmcnt(0)
 v_mfma_f32_32x32x16_bf16 v[0:15], v[200:203], v[148:151], v[0:15]
 v_exp_f32 v248, v116
 v_add_f32 v231, v246, v247
 v_exp_f32 v249, v117
 v_mfma_f32_32x32x16_bf16 v[16:31], v[204:207], v[148:151], v[16:31]
 v_cvt_pk_bf16_f32 v233, v246, v247
 v_exp_f32 v244, v118
 v_add_f32 v230, v230, v248
 v_mfma_f32_32x32x16_bf16 v[32:47], v[208:211], v[148:151], v[32:47]
 v_exp_f32 v245, v119
 v_add_f32 v231, v231, v249
 v_cvt_pk_bf16_f32 v234, v248, v249
 v_mfma_f32_32x32x16_bf16 v[48:63], v[212:215], v[148:151], v[48:63]
 v_exp_f32 v246, v120
 v_add_f32 v230, v230, v244
 v_exp_f32 v247, v121
 s_barrier
 ds_read_b64_tr_b16 v[184:185], v224 offset:32768
 ds_read_b64_tr_b16 v[186:187], v224 offset:34816
 v_add_f32 v231, v231, v245
 v_cvt_pk_bf16_f32 v235, v244, v245
 v_exp_f32 v248, v122
 ds_read_b64_tr_b16 v[188:189], v225 offset:32768
 ds_read_b64_tr_b16 v[190:191], v225 offset:34816
 v_add_f32 v230, v230, v246
 v_exp_f32 v249, v123
 v_add_f32 v231, v231, v247
 ds_read_b64_tr_b16 v[192:193], v226 offset:32768
 ds_read_b64_tr_b16 v[194:195], v226 offset:34816
 v_cvt_pk_bf16_f32 v236, v246, v247
 v_exp_f32 v244, v124
 v_add_f32 v230, v230, v248
 ds_read_b64_tr_b16 v[196:197], v227 offset:32768
 ds_read_b64_tr_b16 v[198:199], v227 offset:34816
 v_exp_f32 v245, v125
 v_add_f32 v231, v231, v249
 v_cvt_pk_bf16_f32 v237, v248, v249
 ds_read_b64_tr_b16 v[200:201], v224 offset:36864
 ds_read_b64_tr_b16 v[202:203], v224 offset:38912
 v_exp_f32 v246, v126
 v_add_f32 v230, v230, v244
 v_exp_f32 v247, v127
 ds_read_b64_tr_b16 v[204:205], v225 offset:36864
 ds_read_b64_tr_b16 v[206:207], v225 offset:38912
 v_add_f32 v231, v231, v245
 v_cvt_pk_bf16_f32 v238, v244, v245
 v_add_f32 v230, v230, v246
 ds_read_b64_tr_b16 v[208:209], v226 offset:36864
 ds_read_b64_tr_b16 v[210:211], v226 offset:38912
 v_add_f32 v231, v231, v247
 v_cvt_pk_bf16_f32 v239, v246, v247
 v_add_f32 v230, v230, v231
 v_cmp_nge_f32 vcc, s54, v230
 s_waitcnt lgkmcnt(6)
 s_cbranch_vccnz K_rare_2031
K_back_2032:
 v_mfma_f32_32x32x16_bf16 v[0:15], v[184:187], v[232:235], v[0:15]
 ds_read_b64_tr_b16 v[212:213], v227 offset:36864
 ds_read_b64_tr_b16 v[214:215], v227 offset:38912
 v_add_f32 v228, v228, v230
 v_mfma_f32_32x32x16_bf16 v[16:31], v[188:191], v[232:235], v[16:31]
 v_mfma_f32_32x32x16_bf16 v[32:47], v[192:195], v[232:235], v[32:47]
 v_mfma_f32_32x32x16_bf16 v[48:63], v[196:199], v[232:235], v[48:63]
 s_waitcnt lgkmcnt(0)
 v_mfma_f32_32x32x16_bf16 v[0:15], v[200:203], v[236:239], v[0:15]
 v_mfma_f32_32x32x16_bf16 v[16:31], v[204:207], v[236:239], v[16:31]
 v_mfma_f32_32x32x16_bf16 v[32:47], v[208:211], v[236:239], v[32:47]
 v_mfma_f32_32x32x16_bf16 v[48:63], v[212:215], v[236:239], v[48:63]
 s_barrier
 s_lshl_b32 s49, s62, 11
 v_add_u32 v236, s49, v243
 s_nop 2
 s_nop 0
 s_nop 0
 v_mov_b32 v229, v228
 s_nop 1
 v_permlane32_swap_b32 v228, v229
 v_add_f32 v228, v228, v229
 v_rcp_f32 v228, v228
 s_nop 3
 v_mul_f32 v0, v0, v228
 v_mul_f32 v1, v1, v228
 v_mul_f32 v2, v2, v228
 v_mul_f32 v3, v3, v228
 v_mul_f32 v4, v4, v228
 v_mul_f32 v5, v5, v228
 v_mul_f32 v6, v6, v228
 v_mul_f32 v7, v7, v228
 v_cvt_pk_bf16_f32 v152, v0, v1
 v_cvt_pk_bf16_f32 v153, v2, v3
 v_cvt_pk_bf16_f32 v154, v4, v5
 v_cvt_pk_bf16_f32 v155, v6, v7
 buffer_store_dwordx4 v[152:155], v243, s[36:39], s55 offen offset:0 sc1
 ds_write_b128 v236, v[152:155] offset:0
 v_mul_f32 v8, v8, v228
 v_mul_f32 v9, v9, v228
 v_mul_f32 v10, v10, v228
 v_mul_f32 v11, v11, v228
 v_mul_f32 v12, v12, v228
 v_mul_f32 v13, v13, v228
 v_mul_f32 v14, v14, v228
 v_mul_f32 v15, v15, v228
 v_cvt_pk_bf16_f32 v156, v8, v9
 v_cvt_pk_bf16_f32 v157, v10, v11
 v_cvt_pk_bf16_f32 v158, v12, v13
 v_cvt_pk_bf16_f32 v159, v14, v15
 buffer_store_dwordx4 v[156:159], v243, s[36:39], s55 offen offset:1024 sc1
 ds_write_b128 v236, v[156:159] offset:1024
 v_mul_f32 v16, v16, v228
 v_mul_f32 v17, v17, v228
 v_mul_f32 v18, v18, v228
 v_mul_f32 v19, v19, v228
 v_mul_f32 v20, v20, v228
 v_mul_f32 v21, v21, v228
 v_mul_f32 v22, v22, v228
 v_mul_f32 v23, v23, v228
 v_cvt_pk_bf16_f32 v160, v16, v17
 v_cvt_pk_bf16_f32 v161, v18, v19
 v_cvt_pk_bf16_f32 v162, v20, v21
 v_cvt_pk_bf16_f32 v163, v22, v23
 buffer_store_dwordx4 v[160:163], v243, s[36:39], s55 offen offset:2048 sc1
 ds_write_b128 v236, v[160:163] offset:6144
 v_mul_f32 v24, v24, v228
 v_mul_f32 v25, v25, v228
 v_mul_f32 v26, v26, v228
 v_mul_f32 v27, v27, v228
 v_mul_f32 v28, v28, v228
 v_mul_f32 v29, v29, v228
 v_mul_f32 v30, v30, v228
 v_mul_f32 v31, v31, v228
 v_cvt_pk_bf16_f32 v164, v24, v25
 v_cvt_pk_bf16_f32 v165, v26, v27
 v_cvt_pk_bf16_f32 v166, v28, v29
 v_cvt_pk_bf16_f32 v167, v30, v31
 buffer_store_dwordx4 v[164:167], v243, s[36:39], s55 offen offset:3072 sc1
 ds_write_b128 v236, v[164:167] offset:7168
 v_mul_f32 v32, v32, v228
 v_mul_f32 v33, v33, v228
 v_mul_f32 v34, v34, v228
 v_mul_f32 v35, v35, v228
 v_mul_f32 v36, v36, v228
 v_mul_f32 v37, v37, v228
 v_mul_f32 v38, v38, v228
 v_mul_f32 v39, v39, v228
 v_cvt_pk_bf16_f32 v168, v32, v33
 v_cvt_pk_bf16_f32 v169, v34, v35
 v_cvt_pk_bf16_f32 v170, v36, v37
 v_cvt_pk_bf16_f32 v171, v38, v39
 buffer_store_dwordx4 v[168:171], v243, s[36:39], s56 offen offset:0 sc1
 ds_write_b128 v236, v[168:171] offset:12288
 v_mul_f32 v40, v40, v228
 v_mul_f32 v41, v41, v228
 v_mul_f32 v42, v42, v228
 v_mul_f32 v43, v43, v228
 v_mul_f32 v44, v44, v228
 v_mul_f32 v45, v45, v228
 v_mul_f32 v46, v46, v228
 v_mul_f32 v47, v47, v228
 v_cvt_pk_bf16_f32 v172, v40, v41
 v_cvt_pk_bf16_f32 v173, v42, v43
 v_cvt_pk_bf16_f32 v174, v44, v45
 v_cvt_pk_bf16_f32 v175, v46, v47
 buffer_store_dwordx4 v[172:175], v243, s[36:39], s56 offen offset:1024 sc1
 ds_write_b128 v236, v[172:175] offset:13312
 v_mul_f32 v48, v48, v228
 v_mul_f32 v49, v49, v228
 v_mul_f32 v50, v50, v228
 v_mul_f32 v51, v51, v228
 v_mul_f32 v52, v52, v228
 v_mul_f32 v53, v53, v228
 v_mul_f32 v54, v54, v228
 v_mul_f32 v55, v55, v228
 v_cvt_pk_bf16_f32 v176, v48, v49
 v_cvt_pk_bf16_f32 v177, v50, v51
 v_cvt_pk_bf16_f32 v178, v52, v53
 v_cvt_pk_bf16_f32 v179, v54, v55
 buffer_store_dwordx4 v[176:179], v243, s[36:39], s56 offen offset:2048 sc1
 ds_write_b128 v236, v[176:179] offset:18432
 v_mul_f32 v56, v56, v228
 v_mul_f32 v57, v57, v228
 v_mul_f32 v58, v58, v228
 v_mul_f32 v59, v59, v228
 v_mul_f32 v60, v60, v228
 v_mul_f32 v61, v61, v228
 v_mul_f32 v62, v62, v228
 v_mul_f32 v63, v63, v228
 v_cvt_pk_bf16_f32 v180, v56, v57
 v_cvt_pk_bf16_f32 v181, v58, v59
 v_cvt_pk_bf16_f32 v182, v60, v61
 v_cvt_pk_bf16_f32 v183, v62, v63
 buffer_store_dwordx4 v[180:183], v243, s[36:39], s56 offen offset:3072 sc1
 ds_write_b128 v236, v[180:183] offset:19456
 s_waitcnt lgkmcnt(0)
 s_barrier
 s_waitcnt vmcnt(0)
 s_barrier
 s_barrier
 s_barrier
 s_barrier
 s_barrier
 s_barrier
 s_barrier
 s_barrier
 s_barrier
 s_barrier
K_final:
 v_lshrrev_b32 v1, 3, v250
 v_and_b32 v2, 7, v250
 v_lshrrev_b32 v3, 1, v1
 v_lshlrev_b32 v3, 10, v3
 v_and_b32 v4, 1, v1
 v_lshlrev_b32 v4, 9, v4
 v_add_u32 v3, v3, v4
 v_lshl_add_u32 v3, v2, 4, v3
 s_lshl_b32 s59, s60, 7
 v_add_u32 v3, s59, v3
 v_add_u32 v4, 4096, v3
 v_mul_u32_u24 v5, 2560, v2
 v_lshl_add_u32 v5, v1, 4, v5
 s_mul_i32 s49, s62, 10240
 s_mul_i32 s57, s61, 5120
 s_add_u32 s49, s49, s57
 s_add_u32 s52, s49, 0
 s_add_u32 s53, s49, 30720
 s_add_u32 s54, s49, 61440
 s_add_u32 s55, s49, 92160
 s_waitcnt vmcnt(0)
 s_barrier
 s_barrier
 buffer_load_dwordx4 v[8:11], v3, s[96:99], s52 offen sc1
 buffer_load_dwordx4 v[12:15], v3, s[96:99], s53 offen sc1
 buffer_load_dwordx4 v[16:19], v3, s[96:99], s54 offen sc1
 buffer_load_dwordx4 v[20:23], v3, s[96:99], s55 offen sc1
 s_mov_b64 exec, 0xffff
 buffer_load_dwordx4 v[24:27], v4, s[96:99], s52 offen sc1
 buffer_load_dwordx4 v[28:31], v4, s[96:99], s53 offen sc1
 buffer_load_dwordx4 v[32:35], v4, s[96:99], s54 offen sc1
 buffer_load_dwordx4 v[36:39], v4, s[96:99], s55 offen sc1
 s_mov_b64 exec, -1
 s_waitcnt vmcnt(7)
 v_lshlrev_b32 v40, 16, v8
 v_and_b32 v41, 0xffff0000, v8
 v_lshlrev_b32 v42, 16, v9
 v_and_b32 v43, 0xffff0000, v9
 v_lshlrev_b32 v44, 16, v10
 v_and_b32 v45, 0xffff0000, v10
 v_lshlrev_b32 v46, 16, v11
 v_and_b32 v47, 0xffff0000, v11
 s_waitcnt vmcnt(6)
 v_lshlrev_b32 v6, 16, v12
 v_and_b32 v7, 0xffff0000, v12
 v_add_f32 v40, v40, v6
 v_add_f32 v41, v41, v7
 v_lshlrev_b32 v6, 16, v13
 v_and_b32 v7, 0xffff0000, v13
 v_add_f32 v42, v42, v6
 v_add_f32 v43, v43, v7
 v_lshlrev_b32 v6, 16, v14
 v_and_b32 v7, 0xffff0000, v14
 v_add_f32 v44, v44, v6
 v_add_f32 v45, v45, v7
 v_lshlrev_b32 v6, 16, v15
 v_and_b32 v7, 0xffff0000, v15
 v_add_f32 v46, v46, v6
 v_add_f32 v47, v47, v7
 s_waitcnt vmcnt(5)
 v_lshlrev_b32 v6, 16, v16
 v_and_b32 v7, 0xffff0000, v16
 v_add_f32 v40, v40, v6
 v_add_f32 v41, v41, v7
 v_lshlrev_b32 v6, 16, v17
 v_and_b32 v7, 0xffff0000, v17
 v_add_f32 v42, v42, v6
 v_add_f32 v43, v43, v7
 v_lshlrev_b32 v6, 16, v18
 v_and_b32 v7, 0xffff0000, v18
 v_add_f32 v44, v44, v6
 v_add_f32 v45, v45, v7
 v_lshlrev_b32 v6, 16, v19
 v_and_b32 v7, 0xffff0000, v19
 v_add_f32 v46, v46, v6
 v_add_f32 v47, v47, v7
 s_waitcnt vmcnt(4)
 v_lshlrev_b32 v6, 16, v20
 v_and_b32 v7, 0xffff0000, v20
 v_add_f32 v40, v40, v6
 v_add_f32 v41, v41, v7
 v_lshlrev_b32 v6, 16, v21
 v_and_b32 v7, 0xffff0000, v21
 v_add_f32 v42, v42, v6
 v_add_f32 v43, v43, v7
 v_lshlrev_b32 v6, 16, v22
 v_and_b32 v7, 0xffff0000, v22
 v_add_f32 v44, v44, v6
 v_add_f32 v45, v45, v7
 v_lshlrev_b32 v6, 16, v23
 v_and_b32 v7, 0xffff0000, v23
 v_add_f32 v46, v46, v6
 v_add_f32 v47, v47, v7
 v_cvt_pk_bf16_f32 v56, v40, v41
 v_cvt_pk_bf16_f32 v57, v42, v43
 v_cvt_pk_bf16_f32 v58, v44, v45
 v_cvt_pk_bf16_f32 v59, v46, v47
 buffer_store_dwordx4 v[56:59], v5, s[12:15], s100 offen offset:0
 s_waitcnt vmcnt(4)
 v_lshlrev_b32 v48, 16, v24
 v_and_b32 v49, 0xffff0000, v24
 v_lshlrev_b32 v50, 16, v25
 v_and_b32 v51, 0xffff0000, v25
 v_lshlrev_b32 v52, 16, v26
 v_and_b32 v53, 0xffff0000, v26
 v_lshlrev_b32 v54, 16, v27
 v_and_b32 v55, 0xffff0000, v27
 s_waitcnt vmcnt(3)
 v_lshlrev_b32 v6, 16, v28
 v_and_b32 v7, 0xffff0000, v28
 v_add_f32 v48, v48, v6
 v_add_f32 v49, v49, v7
 v_lshlrev_b32 v6, 16, v29
 v_and_b32 v7, 0xffff0000, v29
 v_add_f32 v50, v50, v6
 v_add_f32 v51, v51, v7
 v_lshlrev_b32 v6, 16, v30
 v_and_b32 v7, 0xffff0000, v30
 v_add_f32 v52, v52, v6
 v_add_f32 v53, v53, v7
 v_lshlrev_b32 v6, 16, v31
 v_and_b32 v7, 0xffff0000, v31
 v_add_f32 v54, v54, v6
 v_add_f32 v55, v55, v7
 s_waitcnt vmcnt(2)
 v_lshlrev_b32 v6, 16, v32
 v_and_b32 v7, 0xffff0000, v32
 v_add_f32 v48, v48, v6
 v_add_f32 v49, v49, v7
 v_lshlrev_b32 v6, 16, v33
 v_and_b32 v7, 0xffff0000, v33
 v_add_f32 v50, v50, v6
 v_add_f32 v51, v51, v7
 v_lshlrev_b32 v6, 16, v34
 v_and_b32 v7, 0xffff0000, v34
 v_add_f32 v52, v52, v6
 v_add_f32 v53, v53, v7
 v_lshlrev_b32 v6, 16, v35
 v_and_b32 v7, 0xffff0000, v35
 v_add_f32 v54, v54, v6
 v_add_f32 v55, v55, v7
 s_waitcnt vmcnt(1)
 v_lshlrev_b32 v6, 16, v36
 v_and_b32 v7, 0xffff0000, v36
 v_add_f32 v48, v48, v6
 v_add_f32 v49, v49, v7
 v_lshlrev_b32 v6, 16, v37
 v_and_b32 v7, 0xffff0000, v37
 v_add_f32 v50, v50, v6
 v_add_f32 v51, v51, v7
 v_lshlrev_b32 v6, 16, v38
 v_and_b32 v7, 0xffff0000, v38
 v_add_f32 v52, v52, v6
 v_add_f32 v53, v53, v7
 v_lshlrev_b32 v6, 16, v39
 v_and_b32 v7, 0xffff0000, v39
 v_add_f32 v54, v54, v6
 v_add_f32 v55, v55, v7
 v_cvt_pk_bf16_f32 v60, v48, v49
 v_cvt_pk_bf16_f32 v61, v50, v51
 v_cvt_pk_bf16_f32 v62, v52, v53
 v_cvt_pk_bf16_f32 v63, v54, v55
 s_mov_b64 exec, 0xffff
 buffer_store_dwordx4 v[60:63], v5, s[12:15], s100 offen offset:128
 s_mov_b64 exec, -1
 s_endpgm
K_codeend:
K_rare_1:
 v_max3_f32 v244, v96, v97, v98
 v_max3_f32 v245, v99, v100, v101
 v_max3_f32 v246, v102, v103, v104
 v_max3_f32 v247, v105, v106, v107
 v_max3_f32 v248, v108, v109, v110
 v_max3_f32 v244, v244, v245, v111
 v_max3_f32 v246, v246, v247, v248
 v_max_f32 v244, v244, v246
 v_mov_b32 v245, v244
 s_nop 1
 v_permlane32_swap_b32 v244, v245
 v_max_f32 v244, v244, v245
 v_max_f32 v229, 0, v244
 v_sub_f32 v231, 0, v229
 v_exp_f32 v231, v231
 s_nop 4
 v_sub_f32 v96, v96, v229
 v_sub_f32 v97, v97, v229
 v_sub_f32 v98, v98, v229
 v_sub_f32 v99, v99, v229
 v_sub_f32 v100, v100, v229
 v_sub_f32 v101, v101, v229
 v_sub_f32 v102, v102, v229
 v_sub_f32 v103, v103, v229
 v_sub_f32 v104, v104, v229
 v_sub_f32 v105, v105, v229
 v_sub_f32 v106, v106, v229
 v_sub_f32 v107, v107, v229
 v_sub_f32 v108, v108, v229
 v_sub_f32 v109, v109, v229
 v_sub_f32 v110, v110, v229
 v_sub_f32 v111, v111, v229
 v_sub_f32 v128, v128, v229
 v_sub_f32 v129, v129, v229
 v_sub_f32 v130, v130, v229
 v_sub_f32 v131, v131, v229
 v_sub_f32 v132, v132, v229
 v_sub_f32 v133, v133, v229
 v_sub_f32 v134, v134, v229
 v_sub_f32 v135, v135, v229
 v_sub_f32 v136, v136, v229
 v_sub_f32 v137, v137, v229
 v_sub_f32 v138, v138, v229
 v_sub_f32 v139, v139, v229
 v_sub_f32 v140, v140, v229
 v_sub_f32 v141, v141, v229
 v_sub_f32 v142, v142, v229
 v_sub_f32 v143, v143, v229
 v_sub_f32 v112, v112, v229
 v_sub_f32 v113, v113, v229
 v_sub_f32 v114, v114, v229
 v_sub_f32 v115, v115, v229
 v_sub_f32 v116, v116, v229
 v_sub_f32 v117, v117, v229
 v_sub_f32 v118, v118, v229
 v_sub_f32 v119, v119, v229
 v_sub_f32 v120, v120, v229
 v_sub_f32 v121, v121, v229
 v_sub_f32 v122, v122, v229
 v_sub_f32 v123, v123, v229
 v_sub_f32 v124, v124, v229
 v_sub_f32 v125, v125, v229
 v_sub_f32 v126, v126, v229
 v_sub_f32 v127, v127, v229
 v_mul_f32 v228, v228, v231
 v_exp_f32 v244, v96
 v_exp_f32 v245, v97
 v_exp_f32 v246, v98
 v_exp_f32 v247, v99
 v_add_f32 v230, v244, v245
 v_cvt_pk_bf16_f32 v144, v244, v245
 v_exp_f32 v248, v100
 v_add_f32 v231, v246, v247
 v_exp_f32 v249, v101
 v_cvt_pk_bf16_f32 v145, v246, v247
 v_exp_f32 v244, v102
 v_add_f32 v230, v230, v248
 v_exp_f32 v245, v103
 v_add_f32 v231, v231, v249
 v_cvt_pk_bf16_f32 v146, v248, v249
 v_exp_f32 v246, v104
 v_add_f32 v230, v230, v244
 v_exp_f32 v247, v105
 v_add_f32 v231, v231, v245
 v_cvt_pk_bf16_f32 v147, v244, v245
 v_exp_f32 v248, v106
 v_add_f32 v230, v230, v246
 v_exp_f32 v249, v107
 v_add_f32 v231, v231, v247
 v_cvt_pk_bf16_f32 v148, v246, v247
 v_exp_f32 v244, v108
 v_add_f32 v230, v230, v248
 v_exp_f32 v245, v109
 v_add_f32 v231, v231, v249
 v_cvt_pk_bf16_f32 v149, v248, v249
 v_exp_f32 v246, v110
 v_add_f32 v230, v230, v244
 v_exp_f32 v247, v111
 v_add_f32 v231, v231, v245
 v_cvt_pk_bf16_f32 v150, v244, v245
 v_add_f32 v230, v230, v246
 v_add_f32 v231, v231, v247
 v_cvt_pk_bf16_f32 v151, v246, v247
 v_add_f32 v230, v230, v231
 s_nop 1
 s_branch K_back_2
K_rare_3:
 v_max3_f32 v244, v112, v113, v114
 v_max3_f32 v245, v115, v116, v117
 v_max3_f32 v246, v118, v119, v120
 v_max3_f32 v247, v121, v122, v123
 v_max3_f32 v248, v124, v125, v126
 v_max3_f32 v244, v244, v245, v127
 v_max3_f32 v246, v246, v247, v248
 v_max_f32 v244, v244, v246
 v_mov_b32 v245, v244
 s_nop 1
 v_permlane32_swap_b32 v244, v245
 v_max_f32 v244, v244, v245
 v_max_f32 v229, 0, v244
 v_sub_f32 v231, 0, v229
 v_exp_f32 v231, v231
 s_nop 4
 v_sub_f32 v112, v112, v229
 v_sub_f32 v113, v113, v229
 v_sub_f32 v114, v114, v229
 v_sub_f32 v115, v115, v229
 v_sub_f32 v116, v116, v229
 v_sub_f32 v117, v117, v229
 v_sub_f32 v118, v118, v229
 v_sub_f32 v119, v119, v229
 v_sub_f32 v120, v120, v229
 v_sub_f32 v121, v121, v229
 v_sub_f32 v122, v122, v229
 v_sub_f32 v123, v123, v229
 v_sub_f32 v124, v124, v229
 v_sub_f32 v125, v125, v229
 v_sub_f32 v126, v126, v229
 v_sub_f32 v127, v127, v229
 v_sub_f32 v128, v128, v229
 v_sub_f32 v129, v129, v229
 v_sub_f32 v130, v130, v229
 v_sub_f32 v131, v131, v229
 v_sub_f32 v132, v132, v229
 v_sub_f32 v133, v133, v229
 v_sub_f32 v134, v134, v229
 v_sub_f32 v135, v135, v229
 v_sub_f32 v136, v136, v229
 v_sub_f32 v137, v137, v229
 v_sub_f32 v138, v138, v229
 v_sub_f32 v139, v139, v229
 v_sub_f32 v140, v140, v229
 v_sub_f32 v141, v141, v229
 v_sub_f32 v142, v142, v229
 v_sub_f32 v143, v143, v229
 v_sub_f32 v96, v96, v229
 v_sub_f32 v97, v97, v229
 v_sub_f32 v98, v98, v229
 v_sub_f32 v99, v99, v229
 v_sub_f32 v100, v100, v229
 v_sub_f32 v101, v101, v229
 v_sub_f32 v102, v102, v229
 v_sub_f32 v103, v103, v229
 v_sub_f32 v104, v104, v229
 v_sub_f32 v105, v105, v229
 v_sub_f32 v106, v106, v229
 v_sub_f32 v107, v107, v229
 v_sub_f32 v108, v108, v229
 v_sub_f32 v109, v109, v229
 v_sub_f32 v110, v110, v229
 v_sub_f32 v111, v111, v229
 v_mul_f32 v228, v228, v231
 v_mul_f32 v0, v0, v231
 v_mul_f32 v1, v1, v231
 v_mul_f32 v2, v2, v231
 v_mul_f32 v3, v3, v231
 v_mul_f32 v4, v4, v231
 v_mul_f32 v5, v5, v231
 v_mul_f32 v6, v6, v231
 v_mul_f32 v7, v7, v231
 v_mul_f32 v8, v8, v231
 v_mul_f32 v9, v9, v231
 v_mul_f32 v10, v10, v231
 v_mul_f32 v11, v11, v231
 v_mul_f32 v12, v12, v231
 v_mul_f32 v13, v13, v231
 v_mul_f32 v14, v14, v231
 v_mul_f32 v15, v15, v231
 v_mul_f32 v16, v16, v231
 v_mul_f32 v17, v17, v231
 v_mul_f32 v18, v18, v231
 v_mul_f32 v19, v19, v231
 v_mul_f32 v20, v20, v231
 v_mul_f32 v21, v21, v231
 v_mul_f32 v22, v22, v231
 v_mul_f32 v23, v23, v231
 v_mul_f32 v24, v24, v231
 v_mul_f32 v25, v25, v231
 v_mul_f32 v26, v26, v231
 v_mul_f32 v27, v27, v231
 v_mul_f32 v28, v28, v231
 v_mul_f32 v29, v29, v231
 v_mul_f32 v30, v30, v231
 v_mul_f32 v31, v31, v231
 v_mul_f32 v32, v32, v231
 v_mul_f32 v33, v33, v231
 v_mul_f32 v34, v34, v231
 v_mul_f32 v35, v35, v231
 v_mul_f32 v36, v36, v231
 v_mul_f32 v37, v37, v231
 v_mul_f32 v38, v38, v231
 v_mul_f32 v39, v39, v231
 v_mul_f32 v40, v40, v231
 v_mul_f32 v41, v41, v231
 v_mul_f32 v42, v42, v231
 v_mul_f32 v43, v43, v231
 v_mul_f32 v44, v44, v231
 v_mul_f32 v45, v45, v231
 v_mul_f32 v46, v46, v231
 v_mul_f32 v47, v47, v231
 v_mul_f32 v48, v48, v231
 v_mul_f32 v49, v49, v231
 v_mul_f32 v50, v50, v231
 v_mul_f32 v51, v51, v231
 v_mul_f32 v52, v52, v231
 v_mul_f32 v53, v53, v231
 v_mul_f32 v54, v54, v231
 v_mul_f32 v55, v55, v231
 v_mul_f32 v56, v56, v231
 v_mul_f32 v57, v57, v231
 v_mul_f32 v58, v58, v231
 v_mul_f32 v59, v59, v231
 v_mul_f32 v60, v60, v231
 v_mul_f32 v61, v61, v231
 v_mul_f32 v62, v62, v231
 v_mul_f32 v63, v63, v231
 v_exp_f32 v244, v112
 v_exp_f32 v245, v113
 v_exp_f32 v246, v114
 v_exp_f32 v247, v115
 v_add_f32 v230, v244, v245
 v_cvt_pk_bf16_f32 v232, v244, v245
 v_exp_f32 v248, v116
 v_add_f32 v231, v246, v247
 v_exp_f32 v249, v117
 v_cvt_pk_bf16_f32 v233, v246, v247
 v_exp_f32 v244, v118
 v_add_f32 v230, v230, v248
 v_exp_f32 v245, v119
 v_add_f32 v231, v231, v249
 v_cvt_pk_bf16_f32 v234, v248, v249
 v_exp_f32 v246, v120
 v_add_f32 v230, v230, v244
 v_exp_f32 v247, v121
 v_add_f32 v231, v231, v245
 v_cvt_pk_bf16_f32 v235, v244, v245
 v_exp_f32 v248, v122
 v_add_f32 v230, v230, v246
 v_exp_f32 v249, v123
 v_add_f32 v231, v231, v247
 v_cvt_pk_bf16_f32 v236, v246, v247
 v_exp_f32 v244, v124
 v_add_f32 v230, v230, v248
 v_exp_f32 v245, v125
 v_add_f32 v231, v231, v249
 v_cvt_pk_bf16_f32 v237, v248, v249
 v_exp_f32 v246, v126
 v_add_f32 v230, v230, v244
 v_exp_f32 v247, v127
 v_add_f32 v231, v231, v245
 v_cvt_pk_bf16_f32 v238, v244, v245
 v_add_f32 v230, v230, v246
 v_add_f32 v231, v231, v247
 v_cvt_pk_bf16_f32 v239, v246, v247
 v_add_f32 v230, v230, v231
 s_nop 1
 s_branch K_back_4
K_rare_5:
 v_max3_f32 v244, v96, v97, v98
 v_max3_f32 v245, v99, v100, v101
 v_max3_f32 v246, v102, v103, v104
 v_max3_f32 v247, v105, v106, v107
 v_max3_f32 v248, v108, v109, v110
 v_max3_f32 v244, v244, v245, v111
 v_max3_f32 v246, v246, v247, v248
 v_max_f32 v244, v244, v246
 v_mov_b32 v245, v244
 s_nop 1
 v_permlane32_swap_b32 v244, v245
 v_max_f32 v244, v244, v245
 v_max_f32 v229, 0, v244
 v_sub_f32 v231, 0, v229
 v_exp_f32 v231, v231
 s_nop 4
 v_sub_f32 v96, v96, v229
 v_sub_f32 v97, v97, v229
 v_sub_f32 v98, v98, v229
 v_sub_f32 v99, v99, v229
 v_sub_f32 v100, v100, v229
 v_sub_f32 v101, v101, v229
 v_sub_f32 v102, v102, v229
 v_sub_f32 v103, v103, v229
 v_sub_f32 v104, v104, v229
 v_sub_f32 v105, v105, v229
 v_sub_f32 v106, v106, v229
 v_sub_f32 v107, v107, v229
 v_sub_f32 v108, v108, v229
 v_sub_f32 v109, v109, v229
 v_sub_f32 v110, v110, v229
 v_sub_f32 v111, v111, v229
 v_sub_f32 v128, v128, v229
 v_sub_f32 v129, v129, v229
 v_sub_f32 v130, v130, v229
 v_sub_f32 v131, v131, v229
 v_sub_f32 v132, v132, v229
 v_sub_f32 v133, v133, v229
 v_sub_f32 v134, v134, v229
 v_sub_f32 v135, v135, v229
 v_sub_f32 v136, v136, v229
 v_sub_f32 v137, v137, v229
 v_sub_f32 v138, v138, v229
 v_sub_f32 v139, v139, v229
 v_sub_f32 v140, v140, v229
 v_sub_f32 v141, v141, v229
 v_sub_f32 v142, v142, v229
 v_sub_f32 v143, v143, v229
 v_sub_f32 v112, v112, v229
 v_sub_f32 v113, v113, v229
 v_sub_f32 v114, v114, v229
 v_sub_f32 v115, v115, v229
 v_sub_f32 v116, v116, v229
 v_sub_f32 v117, v117, v229
 v_sub_f32 v118, v118, v229
 v_sub_f32 v119, v119, v229
 v_sub_f32 v120, v120, v229
 v_sub_f32 v121, v121, v229
 v_sub_f32 v122, v122, v229
 v_sub_f32 v123, v123, v229
 v_sub_f32 v124, v124, v229
 v_sub_f32 v125, v125, v229
 v_sub_f32 v126, v126, v229
 v_sub_f32 v127, v127, v229
 v_mul_f32 v228, v228, v231
 v_mul_f32 v0, v0, v231
 v_mul_f32 v1, v1, v231
 v_mul_f32 v2, v2, v231
 v_mul_f32 v3, v3, v231
 v_mul_f32 v4, v4, v231
 v_mul_f32 v5, v5, v231
 v_mul_f32 v6, v6, v231
 v_mul_f32 v7, v7, v231
 v_mul_f32 v8, v8, v231
 v_mul_f32 v9, v9, v231
 v_mul_f32 v10, v10, v231
 v_mul_f32 v11, v11, v231
 v_mul_f32 v12, v12, v231
 v_mul_f32 v13, v13, v231
 v_mul_f32 v14, v14, v231
 v_mul_f32 v15, v15, v231
 v_mul_f32 v16, v16, v231
 v_mul_f32 v17, v17, v231
 v_mul_f32 v18, v18, v231
 v_mul_f32 v19, v19, v231
 v_mul_f32 v20, v20, v231
 v_mul_f32 v21, v21, v231
 v_mul_f32 v22, v22, v231
 v_mul_f32 v23, v23, v231
 v_mul_f32 v24, v24, v231
 v_mul_f32 v25, v25, v231
 v_mul_f32 v26, v26, v231
 v_mul_f32 v27, v27, v231
 v_mul_f32 v28, v28, v231
 v_mul_f32 v29, v29, v231
 v_mul_f32 v30, v30, v231
 v_mul_f32 v31, v31, v231
 v_mul_f32 v32, v32, v231
 v_mul_f32 v33, v33, v231
 v_mul_f32 v34, v34, v231
 v_mul_f32 v35, v35, v231
 v_mul_f32 v36, v36, v231
 v_mul_f32 v37, v37, v231
 v_mul_f32 v38, v38, v231
 v_mul_f32 v39, v39, v231
 v_mul_f32 v40, v40, v231
 v_mul_f32 v41, v41, v231
 v_mul_f32 v42, v42, v231
 v_mul_f32 v43, v43, v231
 v_mul_f32 v44, v44, v231
 v_mul_f32 v45, v45, v231
 v_mul_f32 v46, v46, v231
 v_mul_f32 v47, v47, v231
 v_mul_f32 v48, v48, v231
 v_mul_f32 v49, v49, v231
 v_mul_f32 v50, v50, v231
 v_mul_f32 v51, v51, v231
 v_mul_f32 v52, v52, v231
 v_mul_f32 v53, v53, v231
 v_mul_f32 v54, v54, v231
 v_mul_f32 v55, v55, v231
 v_mul_f32 v56, v56, v231
 v_mul_f32 v57, v57, v231
 v_mul_f32 v58, v58, v231
 v_mul_f32 v59, v59, v231
 v_mul_f32 v60, v60, v231
 v_mul_f32 v61, v61, v231
 v_mul_f32 v62, v62, v231
 v_mul_f32 v63, v63, v231
 v_exp_f32 v244, v96
 v_exp_f32 v245, v97
 v_exp_f32 v246, v98
 v_exp_f32 v247, v99
 v_add_f32 v230, v244, v245
 v_cvt_pk_bf16_f32 v144, v244, v245
 v_exp_f32 v248, v100
 v_add_f32 v231, v246, v247
 v_exp_f32 v249, v101
 v_cvt_pk_bf16_f32 v145, v246, v247
 v_exp_f32 v244, v102
 v_add_f32 v230, v230, v248
 v_exp_f32 v245, v103
 v_add_f32 v231, v231, v249
 v_cvt_pk_bf16_f32 v146, v248, v249
 v_exp_f32 v246, v104
 v_add_f32 v230, v230, v244
 v_exp_f32 v247, v105
 v_add_f32 v231, v231, v245
 v_cvt_pk_bf16_f32 v147, v244, v245
 v_exp_f32 v248, v106
 v_add_f32 v230, v230, v246
 v_exp_f32 v249, v107
 v_add_f32 v231, v231, v247
 v_cvt_pk_bf16_f32 v148, v246, v247
 v_exp_f32 v244, v108
 v_add_f32 v230, v230, v248
 v_exp_f32 v245, v109
 v_add_f32 v231, v231, v249
 v_cvt_pk_bf16_f32 v149, v248, v249
 v_exp_f32 v246, v110
 v_add_f32 v230, v230, v244
 v_exp_f32 v247, v111
 v_add_f32 v231, v231, v245
 v_cvt_pk_bf16_f32 v150, v244, v245
 v_add_f32 v230, v230, v246
 v_add_f32 v231, v231, v247
 v_cvt_pk_bf16_f32 v151, v246, v247
 v_add_f32 v230, v230, v231
 s_nop 1
 s_branch K_back_6
K_rare_7:
 v_max3_f32 v244, v112, v113, v114
 v_max3_f32 v245, v115, v116, v117
 v_max3_f32 v246, v118, v119, v120
 v_max3_f32 v247, v121, v122, v123
 v_max3_f32 v248, v124, v125, v126
 v_max3_f32 v244, v244, v245, v127
 v_max3_f32 v246, v246, v247, v248
 v_max_f32 v244, v244, v246
 v_mov_b32 v245, v244
 s_nop 1
 v_permlane32_swap_b32 v244, v245
 v_max_f32 v244, v244, v245
 v_max_f32 v229, 0, v244
 v_sub_f32 v231, 0, v229
 v_exp_f32 v231, v231
 s_nop 4
 v_sub_f32 v112, v112, v229
 v_sub_f32 v113, v113, v229
 v_sub_f32 v114, v114, v229
 v_sub_f32 v115, v115, v229
 v_sub_f32 v116, v116, v229
 v_sub_f32 v117, v117, v229
 v_sub_f32 v118, v118, v229
 v_sub_f32 v119, v119, v229
 v_sub_f32 v120, v120, v229
 v_sub_f32 v121, v121, v229
 v_sub_f32 v122, v122, v229
 v_sub_f32 v123, v123, v229
 v_sub_f32 v124, v124, v229
 v_sub_f32 v125, v125, v229
 v_sub_f32 v126, v126, v229
 v_sub_f32 v127, v127, v229
 v_sub_f32 v128, v128, v229
 v_sub_f32 v129, v129, v229
 v_sub_f32 v130, v130, v229
 v_sub_f32 v131, v131, v229
 v_sub_f32 v132, v132, v229
 v_sub_f32 v133, v133, v229
 v_sub_f32 v134, v134, v229
 v_sub_f32 v135, v135, v229
 v_sub_f32 v136, v136, v229
 v_sub_f32 v137, v137, v229
 v_sub_f32 v138, v138, v229
 v_sub_f32 v139, v139, v229
 v_sub_f32 v140, v140, v229
 v_sub_f32 v141, v141, v229
 v_sub_f32 v142, v142, v229
 v_sub_f32 v143, v143, v229
 v_sub_f32 v96, v96, v229
 v_sub_f32 v97, v97, v229
 v_sub_f32 v98, v98, v229
 v_sub_f32 v99, v99, v229
 v_sub_f32 v100, v100, v229
 v_sub_f32 v101, v101, v229
 v_sub_f32 v102, v102, v229
 v_sub_f32 v103, v103, v229
 v_sub_f32 v104, v104, v229
 v_sub_f32 v105, v105, v229
 v_sub_f32 v106, v106, v229
 v_sub_f32 v107, v107, v229
 v_sub_f32 v108, v108, v229
 v_sub_f32 v109, v109, v229
 v_sub_f32 v110, v110, v229
 v_sub_f32 v111, v111, v229
 v_mul_f32 v228, v228, v231
 v_mul_f32 v0, v0, v231
 v_mul_f32 v1, v1, v231
 v_mul_f32 v2, v2, v231
 v_mul_f32 v3, v3, v231
 v_mul_f32 v4, v4, v231
 v_mul_f32 v5, v5, v231
 v_mul_f32 v6, v6, v231
 v_mul_f32 v7, v7, v231
 v_mul_f32 v8, v8, v231
 v_mul_f32 v9, v9, v231
 v_mul_f32 v10, v10, v231
 v_mul_f32 v11, v11, v231
 v_mul_f32 v12, v12, v231
 v_mul_f32 v13, v13, v231
 v_mul_f32 v14, v14, v231
 v_mul_f32 v15, v15, v231
 v_mul_f32 v16, v16, v231
 v_mul_f32 v17, v17, v231
 v_mul_f32 v18, v18, v231
 v_mul_f32 v19, v19, v231
 v_mul_f32 v20, v20, v231
 v_mul_f32 v21, v21, v231
 v_mul_f32 v22, v22, v231
 v_mul_f32 v23, v23, v231
 v_mul_f32 v24, v24, v231
 v_mul_f32 v25, v25, v231
 v_mul_f32 v26, v26, v231
 v_mul_f32 v27, v27, v231
 v_mul_f32 v28, v28, v231
 v_mul_f32 v29, v29, v231
 v_mul_f32 v30, v30, v231
 v_mul_f32 v31, v31, v231
 v_mul_f32 v32, v32, v231
 v_mul_f32 v33, v33, v231
 v_mul_f32 v34, v34, v231
 v_mul_f32 v35, v35, v231
 v_mul_f32 v36, v36, v231
 v_mul_f32 v37, v37, v231
 v_mul_f32 v38, v38, v231
 v_mul_f32 v39, v39, v231
 v_mul_f32 v40, v40, v231
 v_mul_f32 v41, v41, v231
 v_mul_f32 v42, v42, v231
 v_mul_f32 v43, v43, v231
 v_mul_f32 v44, v44, v231
 v_mul_f32 v45, v45, v231
 v_mul_f32 v46, v46, v231
 v_mul_f32 v47, v47, v231
 v_mul_f32 v48, v48, v231
 v_mul_f32 v49, v49, v231
 v_mul_f32 v50, v50, v231
 v_mul_f32 v51, v51, v231
 v_mul_f32 v52, v52, v231
 v_mul_f32 v53, v53, v231
 v_mul_f32 v54, v54, v231
 v_mul_f32 v55, v55, v231
 v_mul_f32 v56, v56, v231
 v_mul_f32 v57, v57, v231
 v_mul_f32 v58, v58, v231
 v_mul_f32 v59, v59, v231
 v_mul_f32 v60, v60, v231
 v_mul_f32 v61, v61, v231
 v_mul_f32 v62, v62, v231
 v_mul_f32 v63, v63, v231
 v_exp_f32 v244, v112
 v_exp_f32 v245, v113
 v_exp_f32 v246, v114
 v_exp_f32 v247, v115
 v_add_f32 v230, v244, v245
 v_cvt_pk_bf16_f32 v232, v244, v245
 v_exp_f32 v248, v116
 v_add_f32 v231, v246, v247
 v_exp_f32 v249, v117
 v_cvt_pk_bf16_f32 v233, v246, v247
 v_exp_f32 v244, v118
 v_add_f32 v230, v230, v248
 v_exp_f32 v245, v119
 v_add_f32 v231, v231, v249
 v_cvt_pk_bf16_f32 v234, v248, v249
 v_exp_f32 v246, v120
 v_add_f32 v230, v230, v244
 v_exp_f32 v247, v121
 v_add_f32 v231, v231, v245
 v_cvt_pk_bf16_f32 v235, v244, v245
 v_exp_f32 v248, v122
 v_add_f32 v230, v230, v246
 v_exp_f32 v249, v123
 v_add_f32 v231, v231, v247
 v_cvt_pk_bf16_f32 v236, v246, v247
 v_exp_f32 v244, v124
 v_add_f32 v230, v230, v248
 v_exp_f32 v245, v125
 v_add_f32 v231, v231, v249
 v_cvt_pk_bf16_f32 v237, v248, v249
 v_exp_f32 v246, v126
 v_add_f32 v230, v230, v244
 v_exp_f32 v247, v127
 v_add_f32 v231, v231, v245
 v_cvt_pk_bf16_f32 v238, v244, v245
 v_add_f32 v230, v230, v246
 v_add_f32 v231, v231, v247
 v_cvt_pk_bf16_f32 v239, v246, v247
 v_add_f32 v230, v230, v231
 s_nop 1
 s_branch K_back_8
K_rare_9:
 v_max3_f32 v244, v96, v97, v98
 v_max3_f32 v245, v99, v100, v101
 v_max3_f32 v246, v102, v103, v104
 v_max3_f32 v247, v105, v106, v107
 v_max3_f32 v248, v108, v109, v110
 v_max3_f32 v244, v244, v245, v111
 v_max3_f32 v246, v246, v247, v248
 v_max_f32 v244, v244, v246
 v_mov_b32 v245, v244
 s_nop 1
 v_permlane32_swap_b32 v244, v245
 v_max_f32 v244, v244, v245
 v_max_f32 v229, 0, v244
 v_sub_f32 v231, 0, v229
 v_exp_f32 v231, v231
 s_nop 4
 v_sub_f32 v96, v96, v229
 v_sub_f32 v97, v97, v229
 v_sub_f32 v98, v98, v229
 v_sub_f32 v99, v99, v229
 v_sub_f32 v100, v100, v229
 v_sub_f32 v101, v101, v229
 v_sub_f32 v102, v102, v229
 v_sub_f32 v103, v103, v229
 v_sub_f32 v104, v104, v229
 v_sub_f32 v105, v105, v229
 v_sub_f32 v106, v106, v229
 v_sub_f32 v107, v107, v229
 v_sub_f32 v108, v108, v229
 v_sub_f32 v109, v109, v229
 v_sub_f32 v110, v110, v229
 v_sub_f32 v111, v111, v229
 v_sub_f32 v128, v128, v229
 v_sub_f32 v129, v129, v229
 v_sub_f32 v130, v130, v229
 v_sub_f32 v131, v131, v229
 v_sub_f32 v132, v132, v229
 v_sub_f32 v133, v133, v229
 v_sub_f32 v134, v134, v229
 v_sub_f32 v135, v135, v229
 v_sub_f32 v136, v136, v229
 v_sub_f32 v137, v137, v229
 v_sub_f32 v138, v138, v229
 v_sub_f32 v139, v139, v229
 v_sub_f32 v140, v140, v229
 v_sub_f32 v141, v141, v229
 v_sub_f32 v142, v142, v229
 v_sub_f32 v143, v143, v229
 v_sub_f32 v112, v112, v229
 v_sub_f32 v113, v113, v229
 v_sub_f32 v114, v114, v229
 v_sub_f32 v115, v115, v229
 v_sub_f32 v116, v116, v229
 v_sub_f32 v117, v117, v229
 v_sub_f32 v118, v118, v229
 v_sub_f32 v119, v119, v229
 v_sub_f32 v120, v120, v229
 v_sub_f32 v121, v121, v229
 v_sub_f32 v122, v122, v229
 v_sub_f32 v123, v123, v229
 v_sub_f32 v124, v124, v229
 v_sub_f32 v125, v125, v229
 v_sub_f32 v126, v126, v229
 v_sub_f32 v127, v127, v229
 v_mul_f32 v228, v228, v231
 v_mul_f32 v0, v0, v231
 v_mul_f32 v1, v1, v231
 v_mul_f32 v2, v2, v231
 v_mul_f32 v3, v3, v231
 v_mul_f32 v4, v4, v231
 v_mul_f32 v5, v5, v231
 v_mul_f32 v6, v6, v231
 v_mul_f32 v7, v7, v231
 v_mul_f32 v8, v8, v231
 v_mul_f32 v9, v9, v231
 v_mul_f32 v10, v10, v231
 v_mul_f32 v11, v11, v231
 v_mul_f32 v12, v12, v231
 v_mul_f32 v13, v13, v231
 v_mul_f32 v14, v14, v231
 v_mul_f32 v15, v15, v231
 v_mul_f32 v16, v16, v231
 v_mul_f32 v17, v17, v231
 v_mul_f32 v18, v18, v231
 v_mul_f32 v19, v19, v231
 v_mul_f32 v20, v20, v231
 v_mul_f32 v21, v21, v231
 v_mul_f32 v22, v22, v231
 v_mul_f32 v23, v23, v231
 v_mul_f32 v24, v24, v231
 v_mul_f32 v25, v25, v231
 v_mul_f32 v26, v26, v231
 v_mul_f32 v27, v27, v231
 v_mul_f32 v28, v28, v231
 v_mul_f32 v29, v29, v231
 v_mul_f32 v30, v30, v231
 v_mul_f32 v31, v31, v231
 v_mul_f32 v32, v32, v231
 v_mul_f32 v33, v33, v231
 v_mul_f32 v34, v34, v231
 v_mul_f32 v35, v35, v231
 v_mul_f32 v36, v36, v231
 v_mul_f32 v37, v37, v231
 v_mul_f32 v38, v38, v231
 v_mul_f32 v39, v39, v231
 v_mul_f32 v40, v40, v231
 v_mul_f32 v41, v41, v231
 v_mul_f32 v42, v42, v231
 v_mul_f32 v43, v43, v231
 v_mul_f32 v44, v44, v231
 v_mul_f32 v45, v45, v231
 v_mul_f32 v46, v46, v231
 v_mul_f32 v47, v47, v231
 v_mul_f32 v48, v48, v231
 v_mul_f32 v49, v49, v231
 v_mul_f32 v50, v50, v231
 v_mul_f32 v51, v51, v231
 v_mul_f32 v52, v52, v231
 v_mul_f32 v53, v53, v231
 v_mul_f32 v54, v54, v231
 v_mul_f32 v55, v55, v231
 v_mul_f32 v56, v56, v231
 v_mul_f32 v57, v57, v231
 v_mul_f32 v58, v58, v231
 v_mul_f32 v59, v59, v231
 v_mul_f32 v60, v60, v231
 v_mul_f32 v61, v61, v231
 v_mul_f32 v62, v62, v231
 v_mul_f32 v63, v63, v231
 v_exp_f32 v244, v96
 v_exp_f32 v245, v97
 v_exp_f32 v246, v98
 v_exp_f32 v247, v99
 v_add_f32 v230, v244, v245
 v_cvt_pk_bf16_f32 v144, v244, v245
 v_exp_f32 v248, v100
 v_add_f32 v231, v246, v247
 v_exp_f32 v249, v101
 v_cvt_pk_bf16_f32 v145, v246, v247
 v_exp_f32 v244, v102
 v_add_f32 v230, v230, v248
 v_exp_f32 v245, v103
 v_add_f32 v231, v231, v249
 v_cvt_pk_bf16_f32 v146, v248, v249
 v_exp_f32 v246, v104
 v_add_f32 v230, v230, v244
 v_exp_f32 v247, v105
 v_add_f32 v231, v231, v245
 v_cvt_pk_bf16_f32 v147, v244, v245
 v_exp_f32 v248, v106
 v_add_f32 v230, v230, v246
 v_exp_f32 v249, v107
 v_add_f32 v231, v231, v247
 v_cvt_pk_bf16_f32 v148, v246, v247
 v_exp_f32 v244, v108
 v_add_f32 v230, v230, v248
 v_exp_f32 v245, v109
 v_add_f32 v231, v231, v249
 v_cvt_pk_bf16_f32 v149, v248, v249
 v_exp_f32 v246, v110
 v_add_f32 v230, v230, v244
 v_exp_f32 v247, v111
 v_add_f32 v231, v231, v245
 v_cvt_pk_bf16_f32 v150, v244, v245
 v_add_f32 v230, v230, v246
 v_add_f32 v231, v231, v247
 v_cvt_pk_bf16_f32 v151, v246, v247
 v_add_f32 v230, v230, v231
 s_nop 1
 s_branch K_back_10
K_rare_11:
 v_max3_f32 v244, v112, v113, v114
 v_max3_f32 v245, v115, v116, v117
 v_max3_f32 v246, v118, v119, v120
 v_max3_f32 v247, v121, v122, v123
 v_max3_f32 v248, v124, v125, v126
 v_max3_f32 v244, v244, v245, v127
 v_max3_f32 v246, v246, v247, v248
 v_max_f32 v244, v244, v246
 v_mov_b32 v245, v244
 s_nop 1
 v_permlane32_swap_b32 v244, v245
 v_max_f32 v244, v244, v245
 v_max_f32 v229, 0, v244
 v_sub_f32 v231, 0, v229
 v_exp_f32 v231, v231
 s_nop 4
 v_sub_f32 v112, v112, v229
 v_sub_f32 v113, v113, v229
 v_sub_f32 v114, v114, v229
 v_sub_f32 v115, v115, v229
 v_sub_f32 v116, v116, v229
 v_sub_f32 v117, v117, v229
 v_sub_f32 v118, v118, v229
 v_sub_f32 v119, v119, v229
 v_sub_f32 v120, v120, v229
 v_sub_f32 v121, v121, v229
 v_sub_f32 v122, v122, v229
 v_sub_f32 v123, v123, v229
 v_sub_f32 v124, v124, v229
 v_sub_f32 v125, v125, v229
 v_sub_f32 v126, v126, v229
 v_sub_f32 v127, v127, v229
 v_sub_f32 v128, v128, v229
 v_sub_f32 v129, v129, v229
 v_sub_f32 v130, v130, v229
 v_sub_f32 v131, v131, v229
 v_sub_f32 v132, v132, v229
 v_sub_f32 v133, v133, v229
 v_sub_f32 v134, v134, v229
 v_sub_f32 v135, v135, v229
 v_sub_f32 v136, v136, v229
 v_sub_f32 v137, v137, v229
 v_sub_f32 v138, v138, v229
 v_sub_f32 v139, v139, v229
 v_sub_f32 v140, v140, v229
 v_sub_f32 v141, v141, v229
 v_sub_f32 v142, v142, v229
 v_sub_f32 v143, v143, v229
 v_sub_f32 v96, v96, v229
 v_sub_f32 v97, v97, v229
 v_sub_f32 v98, v98, v229
 v_sub_f32 v99, v99, v229
 v_sub_f32 v100, v100, v229
 v_sub_f32 v101, v101, v229
 v_sub_f32 v102, v102, v229
 v_sub_f32 v103, v103, v229
 v_sub_f32 v104, v104, v229
 v_sub_f32 v105, v105, v229
 v_sub_f32 v106, v106, v229
 v_sub_f32 v107, v107, v229
 v_sub_f32 v108, v108, v229
 v_sub_f32 v109, v109, v229
 v_sub_f32 v110, v110, v229
 v_sub_f32 v111, v111, v229
 v_mul_f32 v228, v228, v231
 v_mul_f32 v0, v0, v231
 v_mul_f32 v1, v1, v231
 v_mul_f32 v2, v2, v231
 v_mul_f32 v3, v3, v231
 v_mul_f32 v4, v4, v231
 v_mul_f32 v5, v5, v231
 v_mul_f32 v6, v6, v231
 v_mul_f32 v7, v7, v231
 v_mul_f32 v8, v8, v231
 v_mul_f32 v9, v9, v231
 v_mul_f32 v10, v10, v231
 v_mul_f32 v11, v11, v231
 v_mul_f32 v12, v12, v231
 v_mul_f32 v13, v13, v231
 v_mul_f32 v14, v14, v231
 v_mul_f32 v15, v15, v231
 v_mul_f32 v16, v16, v231
 v_mul_f32 v17, v17, v231
 v_mul_f32 v18, v18, v231
 v_mul_f32 v19, v19, v231
 v_mul_f32 v20, v20, v231
 v_mul_f32 v21, v21, v231
 v_mul_f32 v22, v22, v231
 v_mul_f32 v23, v23, v231
 v_mul_f32 v24, v24, v231
 v_mul_f32 v25, v25, v231
 v_mul_f32 v26, v26, v231
 v_mul_f32 v27, v27, v231
 v_mul_f32 v28, v28, v231
 v_mul_f32 v29, v29, v231
 v_mul_f32 v30, v30, v231
 v_mul_f32 v31, v31, v231
 v_mul_f32 v32, v32, v231
 v_mul_f32 v33, v33, v231
 v_mul_f32 v34, v34, v231
 v_mul_f32 v35, v35, v231
 v_mul_f32 v36, v36, v231
 v_mul_f32 v37, v37, v231
 v_mul_f32 v38, v38, v231
 v_mul_f32 v39, v39, v231
 v_mul_f32 v40, v40, v231
 v_mul_f32 v41, v41, v231
 v_mul_f32 v42, v42, v231
 v_mul_f32 v43, v43, v231
 v_mul_f32 v44, v44, v231
 v_mul_f32 v45, v45, v231
 v_mul_f32 v46, v46, v231
 v_mul_f32 v47, v47, v231
 v_mul_f32 v48, v48, v231
 v_mul_f32 v49, v49, v231
 v_mul_f32 v50, v50, v231
 v_mul_f32 v51, v51, v231
 v_mul_f32 v52, v52, v231
 v_mul_f32 v53, v53, v231
 v_mul_f32 v54, v54, v231
 v_mul_f32 v55, v55, v231
 v_mul_f32 v56, v56, v231
 v_mul_f32 v57, v57, v231
 v_mul_f32 v58, v58, v231
 v_mul_f32 v59, v59, v231
 v_mul_f32 v60, v60, v231
 v_mul_f32 v61, v61, v231
 v_mul_f32 v62, v62, v231
 v_mul_f32 v63, v63, v231
 v_exp_f32 v244, v112
 v_exp_f32 v245, v113
 v_exp_f32 v246, v114
 v_exp_f32 v247, v115
 v_add_f32 v230, v244, v245
 v_cvt_pk_bf16_f32 v232, v244, v245
 v_exp_f32 v248, v116
 v_add_f32 v231, v246, v247
 v_exp_f32 v249, v117
 v_cvt_pk_bf16_f32 v233, v246, v247
 v_exp_f32 v244, v118
 v_add_f32 v230, v230, v248
 v_exp_f32 v245, v119
 v_add_f32 v231, v231, v249
 v_cvt_pk_bf16_f32 v234, v248, v249
 v_exp_f32 v246, v120
 v_add_f32 v230, v230, v244
 v_exp_f32 v247, v121
 v_add_f32 v231, v231, v245
 v_cvt_pk_bf16_f32 v235, v244, v245
 v_exp_f32 v248, v122
 v_add_f32 v230, v230, v246
 v_exp_f32 v249, v123
 v_add_f32 v231, v231, v247
 v_cvt_pk_bf16_f32 v236, v246, v247
 v_exp_f32 v244, v124
 v_add_f32 v230, v230, v248
 v_exp_f32 v245, v125
 v_add_f32 v231, v231, v249
 v_cvt_pk_bf16_f32 v237, v248, v249
 v_exp_f32 v246, v126
 v_add_f32 v230, v230, v244
 v_exp_f32 v247, v127
 v_add_f32 v231, v231, v245
 v_cvt_pk_bf16_f32 v238, v244, v245
 v_add_f32 v230, v230, v246
 v_add_f32 v231, v231, v247
 v_cvt_pk_bf16_f32 v239, v246, v247
 v_add_f32 v230, v230, v231
 s_nop 1
 s_branch K_back_12
K_rare_13:
 v_max3_f32 v244, v96, v97, v98
 v_max3_f32 v245, v99, v100, v101
 v_max3_f32 v246, v102, v103, v104
 v_max3_f32 v247, v105, v106, v107
 v_max3_f32 v248, v108, v109, v110
 v_max3_f32 v244, v244, v245, v111
 v_max3_f32 v246, v246, v247, v248
 v_max_f32 v244, v244, v246
 v_mov_b32 v245, v244
 s_nop 1
 v_permlane32_swap_b32 v244, v245
 v_max_f32 v244, v244, v245
 v_max_f32 v229, 0, v244
 v_sub_f32 v231, 0, v229
 v_exp_f32 v231, v231
 s_nop 4
 v_sub_f32 v96, v96, v229
 v_sub_f32 v97, v97, v229
 v_sub_f32 v98, v98, v229
 v_sub_f32 v99, v99, v229
 v_sub_f32 v100, v100, v229
 v_sub_f32 v101, v101, v229
 v_sub_f32 v102, v102, v229
 v_sub_f32 v103, v103, v229
 v_sub_f32 v104, v104, v229
 v_sub_f32 v105, v105, v229
 v_sub_f32 v106, v106, v229
 v_sub_f32 v107, v107, v229
 v_sub_f32 v108, v108, v229
 v_sub_f32 v109, v109, v229
 v_sub_f32 v110, v110, v229
 v_sub_f32 v111, v111, v229
 v_sub_f32 v128, v128, v229
 v_sub_f32 v129, v129, v229
 v_sub_f32 v130, v130, v229
 v_sub_f32 v131, v131, v229
 v_sub_f32 v132, v132, v229
 v_sub_f32 v133, v133, v229
 v_sub_f32 v134, v134, v229
 v_sub_f32 v135, v135, v229
 v_sub_f32 v136, v136, v229
 v_sub_f32 v137, v137, v229
 v_sub_f32 v138, v138, v229
 v_sub_f32 v139, v139, v229
 v_sub_f32 v140, v140, v229
 v_sub_f32 v141, v141, v229
 v_sub_f32 v142, v142, v229
 v_sub_f32 v143, v143, v229
 v_sub_f32 v112, v112, v229
 v_sub_f32 v113, v113, v229
 v_sub_f32 v114, v114, v229
 v_sub_f32 v115, v115, v229
 v_sub_f32 v116, v116, v229
 v_sub_f32 v117, v117, v229
 v_sub_f32 v118, v118, v229
 v_sub_f32 v119, v119, v229
 v_sub_f32 v120, v120, v229
 v_sub_f32 v121, v121, v229
 v_sub_f32 v122, v122, v229
 v_sub_f32 v123, v123, v229
 v_sub_f32 v124, v124, v229
 v_sub_f32 v125, v125, v229
 v_sub_f32 v126, v126, v229
 v_sub_f32 v127, v127, v229
 v_mul_f32 v228, v228, v231
 v_mul_f32 v0, v0, v231
 v_mul_f32 v1, v1, v231
 v_mul_f32 v2, v2, v231
 v_mul_f32 v3, v3, v231
 v_mul_f32 v4, v4, v231
 v_mul_f32 v5, v5, v231
 v_mul_f32 v6, v6, v231
 v_mul_f32 v7, v7, v231
 v_mul_f32 v8, v8, v231
 v_mul_f32 v9, v9, v231
 v_mul_f32 v10, v10, v231
 v_mul_f32 v11, v11, v231
 v_mul_f32 v12, v12, v231
 v_mul_f32 v13, v13, v231
 v_mul_f32 v14, v14, v231
 v_mul_f32 v15, v15, v231
 v_mul_f32 v16, v16, v231
 v_mul_f32 v17, v17, v231
 v_mul_f32 v18, v18, v231
 v_mul_f32 v19, v19, v231
 v_mul_f32 v20, v20, v231
 v_mul_f32 v21, v21, v231
 v_mul_f32 v22, v22, v231
 v_mul_f32 v23, v23, v231
 v_mul_f32 v24, v24, v231
 v_mul_f32 v25, v25, v231
 v_mul_f32 v26, v26, v231
 v_mul_f32 v27, v27, v231
 v_mul_f32 v28, v28, v231
 v_mul_f32 v29, v29, v231
 v_mul_f32 v30, v30, v231
 v_mul_f32 v31, v31, v231
 v_mul_f32 v32, v32, v231
 v_mul_f32 v33, v33, v231
 v_mul_f32 v34, v34, v231
 v_mul_f32 v35, v35, v231
 v_mul_f32 v36, v36, v231
 v_mul_f32 v37, v37, v231
 v_mul_f32 v38, v38, v231
 v_mul_f32 v39, v39, v231
 v_mul_f32 v40, v40, v231
 v_mul_f32 v41, v41, v231
 v_mul_f32 v42, v42, v231
 v_mul_f32 v43, v43, v231
 v_mul_f32 v44, v44, v231
 v_mul_f32 v45, v45, v231
 v_mul_f32 v46, v46, v231
 v_mul_f32 v47, v47, v231
 v_mul_f32 v48, v48, v231
 v_mul_f32 v49, v49, v231
 v_mul_f32 v50, v50, v231
 v_mul_f32 v51, v51, v231
 v_mul_f32 v52, v52, v231
 v_mul_f32 v53, v53, v231
 v_mul_f32 v54, v54, v231
 v_mul_f32 v55, v55, v231
 v_mul_f32 v56, v56, v231
 v_mul_f32 v57, v57, v231
 v_mul_f32 v58, v58, v231
 v_mul_f32 v59, v59, v231
 v_mul_f32 v60, v60, v231
 v_mul_f32 v61, v61, v231
 v_mul_f32 v62, v62, v231
 v_mul_f32 v63, v63, v231
 v_exp_f32 v244, v96
 v_exp_f32 v245, v97
 v_exp_f32 v246, v98
 v_exp_f32 v247, v99
 v_add_f32 v230, v244, v245
 v_cvt_pk_bf16_f32 v144, v244, v245
 v_exp_f32 v248, v100
 v_add_f32 v231, v246, v247
 v_exp_f32 v249, v101
 v_cvt_pk_bf16_f32 v145, v246, v247
 v_exp_f32 v244, v102
 v_add_f32 v230, v230, v248
 v_exp_f32 v245, v103
 v_add_f32 v231, v231, v249
 v_cvt_pk_bf16_f32 v146, v248, v249
 v_exp_f32 v246, v104
 v_add_f32 v230, v230, v244
 v_exp_f32 v247, v105
 v_add_f32 v231, v231, v245
 v_cvt_pk_bf16_f32 v147, v244, v245
 v_exp_f32 v248, v106
 v_add_f32 v230, v230, v246
 v_exp_f32 v249, v107
 v_add_f32 v231, v231, v247
 v_cvt_pk_bf16_f32 v148, v246, v247
 v_exp_f32 v244, v108
 v_add_f32 v230, v230, v248
 v_exp_f32 v245, v109
 v_add_f32 v231, v231, v249
 v_cvt_pk_bf16_f32 v149, v248, v249
 v_exp_f32 v246, v110
 v_add_f32 v230, v230, v244
 v_exp_f32 v247, v111
 v_add_f32 v231, v231, v245
 v_cvt_pk_bf16_f32 v150, v244, v245
 v_add_f32 v230, v230, v246
 v_add_f32 v231, v231, v247
 v_cvt_pk_bf16_f32 v151, v246, v247
 v_add_f32 v230, v230, v231
 s_nop 1
 s_branch K_back_14
K_rare_15:
 v_max3_f32 v244, v112, v113, v114
 v_max3_f32 v245, v115, v116, v117
 v_max3_f32 v246, v118, v119, v120
 v_max3_f32 v247, v121, v122, v123
 v_max3_f32 v248, v124, v125, v126
 v_max3_f32 v244, v244, v245, v127
 v_max3_f32 v246, v246, v247, v248
 v_max_f32 v244, v244, v246
 v_mov_b32 v245, v244
 s_nop 1
 v_permlane32_swap_b32 v244, v245
 v_max_f32 v244, v244, v245
 v_max_f32 v229, 0, v244
 v_sub_f32 v231, 0, v229
 v_exp_f32 v231, v231
 s_nop 4
 v_sub_f32 v112, v112, v229
 v_sub_f32 v113, v113, v229
 v_sub_f32 v114, v114, v229
 v_sub_f32 v115, v115, v229
 v_sub_f32 v116, v116, v229
 v_sub_f32 v117, v117, v229
 v_sub_f32 v118, v118, v229
 v_sub_f32 v119, v119, v229
 v_sub_f32 v120, v120, v229
 v_sub_f32 v121, v121, v229
 v_sub_f32 v122, v122, v229
 v_sub_f32 v123, v123, v229
 v_sub_f32 v124, v124, v229
 v_sub_f32 v125, v125, v229
 v_sub_f32 v126, v126, v229
 v_sub_f32 v127, v127, v229
 v_sub_f32 v128, v128, v229
 v_sub_f32 v129, v129, v229
 v_sub_f32 v130, v130, v229
 v_sub_f32 v131, v131, v229
 v_sub_f32 v132, v132, v229
 v_sub_f32 v133, v133, v229
 v_sub_f32 v134, v134, v229
 v_sub_f32 v135, v135, v229
 v_sub_f32 v136, v136, v229
 v_sub_f32 v137, v137, v229
 v_sub_f32 v138, v138, v229
 v_sub_f32 v139, v139, v229
 v_sub_f32 v140, v140, v229
 v_sub_f32 v141, v141, v229
 v_sub_f32 v142, v142, v229
 v_sub_f32 v143, v143, v229
 v_sub_f32 v96, v96, v229
 v_sub_f32 v97, v97, v229
 v_sub_f32 v98, v98, v229
 v_sub_f32 v99, v99, v229
 v_sub_f32 v100, v100, v229
 v_sub_f32 v101, v101, v229
 v_sub_f32 v102, v102, v229
 v_sub_f32 v103, v103, v229
 v_sub_f32 v104, v104, v229
 v_sub_f32 v105, v105, v229
 v_sub_f32 v106, v106, v229
 v_sub_f32 v107, v107, v229
 v_sub_f32 v108, v108, v229
 v_sub_f32 v109, v109, v229
 v_sub_f32 v110, v110, v229
 v_sub_f32 v111, v111, v229
 v_mul_f32 v228, v228, v231
 v_mul_f32 v0, v0, v231
 v_mul_f32 v1, v1, v231
 v_mul_f32 v2, v2, v231
 v_mul_f32 v3, v3, v231
 v_mul_f32 v4, v4, v231
 v_mul_f32 v5, v5, v231
 v_mul_f32 v6, v6, v231
 v_mul_f32 v7, v7, v231
 v_mul_f32 v8, v8, v231
 v_mul_f32 v9, v9, v231
 v_mul_f32 v10, v10, v231
 v_mul_f32 v11, v11, v231
 v_mul_f32 v12, v12, v231
 v_mul_f32 v13, v13, v231
 v_mul_f32 v14, v14, v231
 v_mul_f32 v15, v15, v231
 v_mul_f32 v16, v16, v231
 v_mul_f32 v17, v17, v231
 v_mul_f32 v18, v18, v231
 v_mul_f32 v19, v19, v231
 v_mul_f32 v20, v20, v231
 v_mul_f32 v21, v21, v231
 v_mul_f32 v22, v22, v231
 v_mul_f32 v23, v23, v231
 v_mul_f32 v24, v24, v231
 v_mul_f32 v25, v25, v231
 v_mul_f32 v26, v26, v231
 v_mul_f32 v27, v27, v231
 v_mul_f32 v28, v28, v231
 v_mul_f32 v29, v29, v231
 v_mul_f32 v30, v30, v231
 v_mul_f32 v31, v31, v231
 v_mul_f32 v32, v32, v231
 v_mul_f32 v33, v33, v231
 v_mul_f32 v34, v34, v231
 v_mul_f32 v35, v35, v231
 v_mul_f32 v36, v36, v231
 v_mul_f32 v37, v37, v231
 v_mul_f32 v38, v38, v231
 v_mul_f32 v39, v39, v231
 v_mul_f32 v40, v40, v231
 v_mul_f32 v41, v41, v231
 v_mul_f32 v42, v42, v231
 v_mul_f32 v43, v43, v231
 v_mul_f32 v44, v44, v231
 v_mul_f32 v45, v45, v231
 v_mul_f32 v46, v46, v231
 v_mul_f32 v47, v47, v231
 v_mul_f32 v48, v48, v231
 v_mul_f32 v49, v49, v231
 v_mul_f32 v50, v50, v231
 v_mul_f32 v51, v51, v231
 v_mul_f32 v52, v52, v231
 v_mul_f32 v53, v53, v231
 v_mul_f32 v54, v54, v231
 v_mul_f32 v55, v55, v231
 v_mul_f32 v56, v56, v231
 v_mul_f32 v57, v57, v231
 v_mul_f32 v58, v58, v231
 v_mul_f32 v59, v59, v231
 v_mul_f32 v60, v60, v231
 v_mul_f32 v61, v61, v231
 v_mul_f32 v62, v62, v231
 v_mul_f32 v63, v63, v231
 v_exp_f32 v244, v112
 v_exp_f32 v245, v113
 v_exp_f32 v246, v114
 v_exp_f32 v247, v115
 v_add_f32 v230, v244, v245
 v_cvt_pk_bf16_f32 v232, v244, v245
 v_exp_f32 v248, v116
 v_add_f32 v231, v246, v247
 v_exp_f32 v249, v117
 v_cvt_pk_bf16_f32 v233, v246, v247
 v_exp_f32 v244, v118
 v_add_f32 v230, v230, v248
 v_exp_f32 v245, v119
 v_add_f32 v231, v231, v249
 v_cvt_pk_bf16_f32 v234, v248, v249
 v_exp_f32 v246, v120
 v_add_f32 v230, v230, v244
 v_exp_f32 v247, v121
 v_add_f32 v231, v231, v245
 v_cvt_pk_bf16_f32 v235, v244, v245
 v_exp_f32 v248, v122
 v_add_f32 v230, v230, v246
 v_exp_f32 v249, v123
 v_add_f32 v231, v231, v247
 v_cvt_pk_bf16_f32 v236, v246, v247
 v_exp_f32 v244, v124
 v_add_f32 v230, v230, v248
 v_exp_f32 v245, v125
 v_add_f32 v231, v231, v249
 v_cvt_pk_bf16_f32 v237, v248, v249
 v_exp_f32 v246, v126
 v_add_f32 v230, v230, v244
 v_exp_f32 v247, v127
 v_add_f32 v231, v231, v245
 v_cvt_pk_bf16_f32 v238, v244, v245
 v_add_f32 v230, v230, v246
 v_add_f32 v231, v231, v247
 v_cvt_pk_bf16_f32 v239, v246, v247
 v_add_f32 v230, v230, v231
 s_nop 1
 s_branch K_back_16
K_rare_17:
 v_max3_f32 v244, v96, v97, v98
 v_max3_f32 v245, v99, v100, v101
 v_max3_f32 v246, v102, v103, v104
 v_max3_f32 v247, v105, v106, v107
 v_max3_f32 v248, v108, v109, v110
 v_max3_f32 v244, v244, v245, v111
 v_max3_f32 v246, v246, v247, v248
 v_max_f32 v244, v244, v246
 v_mov_b32 v245, v244
 s_nop 1
 v_permlane32_swap_b32 v244, v245
 v_max_f32 v244, v244, v245
 v_max_f32 v229, 0, v244
 v_sub_f32 v231, 0, v229
 v_exp_f32 v231, v231
 s_nop 4
 v_sub_f32 v96, v96, v229
 v_sub_f32 v97, v97, v229
 v_sub_f32 v98, v98, v229
 v_sub_f32 v99, v99, v229
 v_sub_f32 v100, v100, v229
 v_sub_f32 v101, v101, v229
 v_sub_f32 v102, v102, v229
 v_sub_f32 v103, v103, v229
 v_sub_f32 v104, v104, v229
 v_sub_f32 v105, v105, v229
 v_sub_f32 v106, v106, v229
 v_sub_f32 v107, v107, v229
 v_sub_f32 v108, v108, v229
 v_sub_f32 v109, v109, v229
 v_sub_f32 v110, v110, v229
 v_sub_f32 v111, v111, v229
 v_sub_f32 v128, v128, v229
 v_sub_f32 v129, v129, v229
 v_sub_f32 v130, v130, v229
 v_sub_f32 v131, v131, v229
 v_sub_f32 v132, v132, v229
 v_sub_f32 v133, v133, v229
 v_sub_f32 v134, v134, v229
 v_sub_f32 v135, v135, v229
 v_sub_f32 v136, v136, v229
 v_sub_f32 v137, v137, v229
 v_sub_f32 v138, v138, v229
 v_sub_f32 v139, v139, v229
 v_sub_f32 v140, v140, v229
 v_sub_f32 v141, v141, v229
 v_sub_f32 v142, v142, v229
 v_sub_f32 v143, v143, v229
 v_sub_f32 v112, v112, v229
 v_sub_f32 v113, v113, v229
 v_sub_f32 v114, v114, v229
 v_sub_f32 v115, v115, v229
 v_sub_f32 v116, v116, v229
 v_sub_f32 v117, v117, v229
 v_sub_f32 v118, v118, v229
 v_sub_f32 v119, v119, v229
 v_sub_f32 v120, v120, v229
 v_sub_f32 v121, v121, v229
 v_sub_f32 v122, v122, v229
 v_sub_f32 v123, v123, v229
 v_sub_f32 v124, v124, v229
 v_sub_f32 v125, v125, v229
 v_sub_f32 v126, v126, v229
 v_sub_f32 v127, v127, v229
 v_mul_f32 v228, v228, v231
 v_mul_f32 v0, v0, v231
 v_mul_f32 v1, v1, v231
 v_mul_f32 v2, v2, v231
 v_mul_f32 v3, v3, v231
 v_mul_f32 v4, v4, v231
 v_mul_f32 v5, v5, v231
 v_mul_f32 v6, v6, v231
 v_mul_f32 v7, v7, v231
 v_mul_f32 v8, v8, v231
 v_mul_f32 v9, v9, v231
 v_mul_f32 v10, v10, v231
 v_mul_f32 v11, v11, v231
 v_mul_f32 v12, v12, v231
 v_mul_f32 v13, v13, v231
 v_mul_f32 v14, v14, v231
 v_mul_f32 v15, v15, v231
 v_mul_f32 v16, v16, v231
 v_mul_f32 v17, v17, v231
 v_mul_f32 v18, v18, v231
 v_mul_f32 v19, v19, v231
 v_mul_f32 v20, v20, v231
 v_mul_f32 v21, v21, v231
 v_mul_f32 v22, v22, v231
 v_mul_f32 v23, v23, v231
 v_mul_f32 v24, v24, v231
 v_mul_f32 v25, v25, v231
 v_mul_f32 v26, v26, v231
 v_mul_f32 v27, v27, v231
 v_mul_f32 v28, v28, v231
 v_mul_f32 v29, v29, v231
 v_mul_f32 v30, v30, v231
 v_mul_f32 v31, v31, v231
 v_mul_f32 v32, v32, v231
 v_mul_f32 v33, v33, v231
 v_mul_f32 v34, v34, v231
 v_mul_f32 v35, v35, v231
 v_mul_f32 v36, v36, v231
 v_mul_f32 v37, v37, v231
 v_mul_f32 v38, v38, v231
 v_mul_f32 v39, v39, v231
 v_mul_f32 v40, v40, v231
 v_mul_f32 v41, v41, v231
 v_mul_f32 v42, v42, v231
 v_mul_f32 v43, v43, v231
 v_mul_f32 v44, v44, v231
 v_mul_f32 v45, v45, v231
 v_mul_f32 v46, v46, v231
 v_mul_f32 v47, v47, v231
 v_mul_f32 v48, v48, v231
 v_mul_f32 v49, v49, v231
 v_mul_f32 v50, v50, v231
 v_mul_f32 v51, v51, v231
 v_mul_f32 v52, v52, v231
 v_mul_f32 v53, v53, v231
 v_mul_f32 v54, v54, v231
 v_mul_f32 v55, v55, v231
 v_mul_f32 v56, v56, v231
 v_mul_f32 v57, v57, v231
 v_mul_f32 v58, v58, v231
 v_mul_f32 v59, v59, v231
 v_mul_f32 v60, v60, v231
 v_mul_f32 v61, v61, v231
 v_mul_f32 v62, v62, v231
 v_mul_f32 v63, v63, v231
 v_exp_f32 v244, v96
 v_exp_f32 v245, v97
 v_exp_f32 v246, v98
 v_exp_f32 v247, v99
 v_add_f32 v230, v244, v245
 v_cvt_pk_bf16_f32 v144, v244, v245
 v_exp_f32 v248, v100
 v_add_f32 v231, v246, v247
 v_exp_f32 v249, v101
 v_cvt_pk_bf16_f32 v145, v246, v247
 v_exp_f32 v244, v102
 v_add_f32 v230, v230, v248
 v_exp_f32 v245, v103
 v_add_f32 v231, v231, v249
 v_cvt_pk_bf16_f32 v146, v248, v249
 v_exp_f32 v246, v104
 v_add_f32 v230, v230, v244
 v_exp_f32 v247, v105
 v_add_f32 v231, v231, v245
 v_cvt_pk_bf16_f32 v147, v244, v245
 v_exp_f32 v248, v106
 v_add_f32 v230, v230, v246
 v_exp_f32 v249, v107
 v_add_f32 v231, v231, v247
 v_cvt_pk_bf16_f32 v148, v246, v247
 v_exp_f32 v244, v108
 v_add_f32 v230, v230, v248
 v_exp_f32 v245, v109
 v_add_f32 v231, v231, v249
 v_cvt_pk_bf16_f32 v149, v248, v249
 v_exp_f32 v246, v110
 v_add_f32 v230, v230, v244
 v_exp_f32 v247, v111
 v_add_f32 v231, v231, v245
 v_cvt_pk_bf16_f32 v150, v244, v245
 v_add_f32 v230, v230, v246
 v_add_f32 v231, v231, v247
 v_cvt_pk_bf16_f32 v151, v246, v247
 v_add_f32 v230, v230, v231
 s_nop 1
 s_branch K_back_18
K_rare_19:
 v_max3_f32 v244, v112, v113, v114
 v_max3_f32 v245, v115, v116, v117
 v_max3_f32 v246, v118, v119, v120
 v_max3_f32 v247, v121, v122, v123
 v_max3_f32 v248, v124, v125, v126
 v_max3_f32 v244, v244, v245, v127
 v_max3_f32 v246, v246, v247, v248
 v_max_f32 v244, v244, v246
 v_mov_b32 v245, v244
 s_nop 1
 v_permlane32_swap_b32 v244, v245
 v_max_f32 v244, v244, v245
 v_max_f32 v229, 0, v244
 v_sub_f32 v231, 0, v229
 v_exp_f32 v231, v231
 s_nop 4
 v_sub_f32 v112, v112, v229
 v_sub_f32 v113, v113, v229
 v_sub_f32 v114, v114, v229
 v_sub_f32 v115, v115, v229
 v_sub_f32 v116, v116, v229
 v_sub_f32 v117, v117, v229
 v_sub_f32 v118, v118, v229
 v_sub_f32 v119, v119, v229
 v_sub_f32 v120, v120, v229
 v_sub_f32 v121, v121, v229
 v_sub_f32 v122, v122, v229
 v_sub_f32 v123, v123, v229
 v_sub_f32 v124, v124, v229
 v_sub_f32 v125, v125, v229
 v_sub_f32 v126, v126, v229
 v_sub_f32 v127, v127, v229
 v_sub_f32 v128, v128, v229
 v_sub_f32 v129, v129, v229
 v_sub_f32 v130, v130, v229
 v_sub_f32 v131, v131, v229
 v_sub_f32 v132, v132, v229
 v_sub_f32 v133, v133, v229
 v_sub_f32 v134, v134, v229
 v_sub_f32 v135, v135, v229
 v_sub_f32 v136, v136, v229
 v_sub_f32 v137, v137, v229
 v_sub_f32 v138, v138, v229
 v_sub_f32 v139, v139, v229
 v_sub_f32 v140, v140, v229
 v_sub_f32 v141, v141, v229
 v_sub_f32 v142, v142, v229
 v_sub_f32 v143, v143, v229
 v_sub_f32 v96, v96, v229
 v_sub_f32 v97, v97, v229
 v_sub_f32 v98, v98, v229
 v_sub_f32 v99, v99, v229
 v_sub_f32 v100, v100, v229
 v_sub_f32 v101, v101, v229
 v_sub_f32 v102, v102, v229
 v_sub_f32 v103, v103, v229
 v_sub_f32 v104, v104, v229
 v_sub_f32 v105, v105, v229
 v_sub_f32 v106, v106, v229
 v_sub_f32 v107, v107, v229
 v_sub_f32 v108, v108, v229
 v_sub_f32 v109, v109, v229
 v_sub_f32 v110, v110, v229
 v_sub_f32 v111, v111, v229
 v_mul_f32 v228, v228, v231
 v_mul_f32 v0, v0, v231
 v_mul_f32 v1, v1, v231
 v_mul_f32 v2, v2, v231
 v_mul_f32 v3, v3, v231
 v_mul_f32 v4, v4, v231
 v_mul_f32 v5, v5, v231
 v_mul_f32 v6, v6, v231
 v_mul_f32 v7, v7, v231
 v_mul_f32 v8, v8, v231
 v_mul_f32 v9, v9, v231
 v_mul_f32 v10, v10, v231
 v_mul_f32 v11, v11, v231
 v_mul_f32 v12, v12, v231
 v_mul_f32 v13, v13, v231
 v_mul_f32 v14, v14, v231
 v_mul_f32 v15, v15, v231
 v_mul_f32 v16, v16, v231
 v_mul_f32 v17, v17, v231
 v_mul_f32 v18, v18, v231
 v_mul_f32 v19, v19, v231
 v_mul_f32 v20, v20, v231
 v_mul_f32 v21, v21, v231
 v_mul_f32 v22, v22, v231
 v_mul_f32 v23, v23, v231
 v_mul_f32 v24, v24, v231
 v_mul_f32 v25, v25, v231
 v_mul_f32 v26, v26, v231
 v_mul_f32 v27, v27, v231
 v_mul_f32 v28, v28, v231
 v_mul_f32 v29, v29, v231
 v_mul_f32 v30, v30, v231
 v_mul_f32 v31, v31, v231
 v_mul_f32 v32, v32, v231
 v_mul_f32 v33, v33, v231
 v_mul_f32 v34, v34, v231
 v_mul_f32 v35, v35, v231
 v_mul_f32 v36, v36, v231
 v_mul_f32 v37, v37, v231
 v_mul_f32 v38, v38, v231
 v_mul_f32 v39, v39, v231
 v_mul_f32 v40, v40, v231
 v_mul_f32 v41, v41, v231
 v_mul_f32 v42, v42, v231
 v_mul_f32 v43, v43, v231
 v_mul_f32 v44, v44, v231
 v_mul_f32 v45, v45, v231
 v_mul_f32 v46, v46, v231
 v_mul_f32 v47, v47, v231
 v_mul_f32 v48, v48, v231
 v_mul_f32 v49, v49, v231
 v_mul_f32 v50, v50, v231
 v_mul_f32 v51, v51, v231
 v_mul_f32 v52, v52, v231
 v_mul_f32 v53, v53, v231
 v_mul_f32 v54, v54, v231
 v_mul_f32 v55, v55, v231
 v_mul_f32 v56, v56, v231
 v_mul_f32 v57, v57, v231
 v_mul_f32 v58, v58, v231
 v_mul_f32 v59, v59, v231
 v_mul_f32 v60, v60, v231
 v_mul_f32 v61, v61, v231
 v_mul_f32 v62, v62, v231
 v_mul_f32 v63, v63, v231
 v_exp_f32 v244, v112
 v_exp_f32 v245, v113
 v_exp_f32 v246, v114
 v_exp_f32 v247, v115
 v_add_f32 v230, v244, v245
 v_cvt_pk_bf16_f32 v232, v244, v245
 v_exp_f32 v248, v116
 v_add_f32 v231, v246, v247
 v_exp_f32 v249, v117
 v_cvt_pk_bf16_f32 v233, v246, v247
 v_exp_f32 v244, v118
 v_add_f32 v230, v230, v248
 v_exp_f32 v245, v119
 v_add_f32 v231, v231, v249
 v_cvt_pk_bf16_f32 v234, v248, v249
 v_exp_f32 v246, v120
 v_add_f32 v230, v230, v244
 v_exp_f32 v247, v121
 v_add_f32 v231, v231, v245
 v_cvt_pk_bf16_f32 v235, v244, v245
 v_exp_f32 v248, v122
 v_add_f32 v230, v230, v246
 v_exp_f32 v249, v123
 v_add_f32 v231, v231, v247
 v_cvt_pk_bf16_f32 v236, v246, v247
 v_exp_f32 v244, v124
 v_add_f32 v230, v230, v248
 v_exp_f32 v245, v125
 v_add_f32 v231, v231, v249
 v_cvt_pk_bf16_f32 v237, v248, v249
 v_exp_f32 v246, v126
 v_add_f32 v230, v230, v244
 v_exp_f32 v247, v127
 v_add_f32 v231, v231, v245
 v_cvt_pk_bf16_f32 v238, v244, v245
 v_add_f32 v230, v230, v246
 v_add_f32 v231, v231, v247
 v_cvt_pk_bf16_f32 v239, v246, v247
 v_add_f32 v230, v230, v231
 s_nop 1
 s_branch K_back_20
K_rare_21:
 v_max3_f32 v244, v96, v97, v98
 v_max3_f32 v245, v99, v100, v101
 v_max3_f32 v246, v102, v103, v104
 v_max3_f32 v247, v105, v106, v107
 v_max3_f32 v248, v108, v109, v110
 v_max3_f32 v244, v244, v245, v111
 v_max3_f32 v246, v246, v247, v248
 v_max_f32 v244, v244, v246
 v_mov_b32 v245, v244
 s_nop 1
 v_permlane32_swap_b32 v244, v245
 v_max_f32 v244, v244, v245
 v_max_f32 v229, 0, v244
 v_sub_f32 v231, 0, v229
 v_exp_f32 v231, v231
 s_nop 4
 v_sub_f32 v96, v96, v229
 v_sub_f32 v97, v97, v229
 v_sub_f32 v98, v98, v229
 v_sub_f32 v99, v99, v229
 v_sub_f32 v100, v100, v229
 v_sub_f32 v101, v101, v229
 v_sub_f32 v102, v102, v229
 v_sub_f32 v103, v103, v229
 v_sub_f32 v104, v104, v229
 v_sub_f32 v105, v105, v229
 v_sub_f32 v106, v106, v229
 v_sub_f32 v107, v107, v229
 v_sub_f32 v108, v108, v229
 v_sub_f32 v109, v109, v229
 v_sub_f32 v110, v110, v229
 v_sub_f32 v111, v111, v229
 v_sub_f32 v128, v128, v229
 v_sub_f32 v129, v129, v229
 v_sub_f32 v130, v130, v229
 v_sub_f32 v131, v131, v229
 v_sub_f32 v132, v132, v229
 v_sub_f32 v133, v133, v229
 v_sub_f32 v134, v134, v229
 v_sub_f32 v135, v135, v229
 v_sub_f32 v136, v136, v229
 v_sub_f32 v137, v137, v229
 v_sub_f32 v138, v138, v229
 v_sub_f32 v139, v139, v229
 v_sub_f32 v140, v140, v229
 v_sub_f32 v141, v141, v229
 v_sub_f32 v142, v142, v229
 v_sub_f32 v143, v143, v229
 v_sub_f32 v112, v112, v229
 v_sub_f32 v113, v113, v229
 v_sub_f32 v114, v114, v229
 v_sub_f32 v115, v115, v229
 v_sub_f32 v116, v116, v229
 v_sub_f32 v117, v117, v229
 v_sub_f32 v118, v118, v229
 v_sub_f32 v119, v119, v229
 v_sub_f32 v120, v120, v229
 v_sub_f32 v121, v121, v229
 v_sub_f32 v122, v122, v229
 v_sub_f32 v123, v123, v229
 v_sub_f32 v124, v124, v229
 v_sub_f32 v125, v125, v229
 v_sub_f32 v126, v126, v229
 v_sub_f32 v127, v127, v229
 v_mul_f32 v228, v228, v231
 v_mul_f32 v0, v0, v231
 v_mul_f32 v1, v1, v231
 v_mul_f32 v2, v2, v231
 v_mul_f32 v3, v3, v231
 v_mul_f32 v4, v4, v231
 v_mul_f32 v5, v5, v231
 v_mul_f32 v6, v6, v231
 v_mul_f32 v7, v7, v231
 v_mul_f32 v8, v8, v231
 v_mul_f32 v9, v9, v231
 v_mul_f32 v10, v10, v231
 v_mul_f32 v11, v11, v231
 v_mul_f32 v12, v12, v231
 v_mul_f32 v13, v13, v231
 v_mul_f32 v14, v14, v231
 v_mul_f32 v15, v15, v231
 v_mul_f32 v16, v16, v231
 v_mul_f32 v17, v17, v231
 v_mul_f32 v18, v18, v231
 v_mul_f32 v19, v19, v231
 v_mul_f32 v20, v20, v231
 v_mul_f32 v21, v21, v231
 v_mul_f32 v22, v22, v231
 v_mul_f32 v23, v23, v231
 v_mul_f32 v24, v24, v231
 v_mul_f32 v25, v25, v231
 v_mul_f32 v26, v26, v231
 v_mul_f32 v27, v27, v231
 v_mul_f32 v28, v28, v231
 v_mul_f32 v29, v29, v231
 v_mul_f32 v30, v30, v231
 v_mul_f32 v31, v31, v231
 v_mul_f32 v32, v32, v231
 v_mul_f32 v33, v33, v231
 v_mul_f32 v34, v34, v231
 v_mul_f32 v35, v35, v231
 v_mul_f32 v36, v36, v231
 v_mul_f32 v37, v37, v231
 v_mul_f32 v38, v38, v231
 v_mul_f32 v39, v39, v231
 v_mul_f32 v40, v40, v231
 v_mul_f32 v41, v41, v231
 v_mul_f32 v42, v42, v231
 v_mul_f32 v43, v43, v231
 v_mul_f32 v44, v44, v231
 v_mul_f32 v45, v45, v231
 v_mul_f32 v46, v46, v231
 v_mul_f32 v47, v47, v231
 v_mul_f32 v48, v48, v231
 v_mul_f32 v49, v49, v231
 v_mul_f32 v50, v50, v231
 v_mul_f32 v51, v51, v231
 v_mul_f32 v52, v52, v231
 v_mul_f32 v53, v53, v231
 v_mul_f32 v54, v54, v231
 v_mul_f32 v55, v55, v231
 v_mul_f32 v56, v56, v231
 v_mul_f32 v57, v57, v231
 v_mul_f32 v58, v58, v231
 v_mul_f32 v59, v59, v231
 v_mul_f32 v60, v60, v231
 v_mul_f32 v61, v61, v231
 v_mul_f32 v62, v62, v231
 v_mul_f32 v63, v63, v231
 v_exp_f32 v244, v96
 v_exp_f32 v245, v97
 v_exp_f32 v246, v98
 v_exp_f32 v247, v99
 v_add_f32 v230, v244, v245
 v_cvt_pk_bf16_f32 v144, v244, v245
 v_exp_f32 v248, v100
 v_add_f32 v231, v246, v247
 v_exp_f32 v249, v101
 v_cvt_pk_bf16_f32 v145, v246, v247
 v_exp_f32 v244, v102
 v_add_f32 v230, v230, v248
 v_exp_f32 v245, v103
 v_add_f32 v231, v231, v249
 v_cvt_pk_bf16_f32 v146, v248, v249
 v_exp_f32 v246, v104
 v_add_f32 v230, v230, v244
 v_exp_f32 v247, v105
 v_add_f32 v231, v231, v245
 v_cvt_pk_bf16_f32 v147, v244, v245
 v_exp_f32 v248, v106
 v_add_f32 v230, v230, v246
 v_exp_f32 v249, v107
 v_add_f32 v231, v231, v247
 v_cvt_pk_bf16_f32 v148, v246, v247
 v_exp_f32 v244, v108
 v_add_f32 v230, v230, v248
 v_exp_f32 v245, v109
 v_add_f32 v231, v231, v249
 v_cvt_pk_bf16_f32 v149, v248, v249
 v_exp_f32 v246, v110
 v_add_f32 v230, v230, v244
 v_exp_f32 v247, v111
 v_add_f32 v231, v231, v245
 v_cvt_pk_bf16_f32 v150, v244, v245
 v_add_f32 v230, v230, v246
 v_add_f32 v231, v231, v247
 v_cvt_pk_bf16_f32 v151, v246, v247
 v_add_f32 v230, v230, v231
 s_nop 1
 s_branch K_back_22
K_rare_23:
 v_max3_f32 v244, v112, v113, v114
 v_max3_f32 v245, v115, v116, v117
 v_max3_f32 v246, v118, v119, v120
 v_max3_f32 v247, v121, v122, v123
 v_max3_f32 v248, v124, v125, v126
 v_max3_f32 v244, v244, v245, v127
 v_max3_f32 v246, v246, v247, v248
 v_max_f32 v244, v244, v246
 v_mov_b32 v245, v244
 s_nop 1
 v_permlane32_swap_b32 v244, v245
 v_max_f32 v244, v244, v245
 v_max_f32 v229, 0, v244
 v_sub_f32 v231, 0, v229
 v_exp_f32 v231, v231
 s_nop 4
 v_sub_f32 v112, v112, v229
 v_sub_f32 v113, v113, v229
 v_sub_f32 v114, v114, v229
 v_sub_f32 v115, v115, v229
 v_sub_f32 v116, v116, v229
 v_sub_f32 v117, v117, v229
 v_sub_f32 v118, v118, v229
 v_sub_f32 v119, v119, v229
 v_sub_f32 v120, v120, v229
 v_sub_f32 v121, v121, v229
 v_sub_f32 v122, v122, v229
 v_sub_f32 v123, v123, v229
 v_sub_f32 v124, v124, v229
 v_sub_f32 v125, v125, v229
 v_sub_f32 v126, v126, v229
 v_sub_f32 v127, v127, v229
 v_sub_f32 v128, v128, v229
 v_sub_f32 v129, v129, v229
 v_sub_f32 v130, v130, v229
 v_sub_f32 v131, v131, v229
 v_sub_f32 v132, v132, v229
 v_sub_f32 v133, v133, v229
 v_sub_f32 v134, v134, v229
 v_sub_f32 v135, v135, v229
 v_sub_f32 v136, v136, v229
 v_sub_f32 v137, v137, v229
 v_sub_f32 v138, v138, v229
 v_sub_f32 v139, v139, v229
 v_sub_f32 v140, v140, v229
 v_sub_f32 v141, v141, v229
 v_sub_f32 v142, v142, v229
 v_sub_f32 v143, v143, v229
 v_sub_f32 v96, v96, v229
 v_sub_f32 v97, v97, v229
 v_sub_f32 v98, v98, v229
 v_sub_f32 v99, v99, v229
 v_sub_f32 v100, v100, v229
 v_sub_f32 v101, v101, v229
 v_sub_f32 v102, v102, v229
 v_sub_f32 v103, v103, v229
 v_sub_f32 v104, v104, v229
 v_sub_f32 v105, v105, v229
 v_sub_f32 v106, v106, v229
 v_sub_f32 v107, v107, v229
 v_sub_f32 v108, v108, v229
 v_sub_f32 v109, v109, v229
 v_sub_f32 v110, v110, v229
 v_sub_f32 v111, v111, v229
 v_mul_f32 v228, v228, v231
 v_mul_f32 v0, v0, v231
 v_mul_f32 v1, v1, v231
 v_mul_f32 v2, v2, v231
 v_mul_f32 v3, v3, v231
 v_mul_f32 v4, v4, v231
 v_mul_f32 v5, v5, v231
 v_mul_f32 v6, v6, v231
 v_mul_f32 v7, v7, v231
 v_mul_f32 v8, v8, v231
 v_mul_f32 v9, v9, v231
 v_mul_f32 v10, v10, v231
 v_mul_f32 v11, v11, v231
 v_mul_f32 v12, v12, v231
 v_mul_f32 v13, v13, v231
 v_mul_f32 v14, v14, v231
 v_mul_f32 v15, v15, v231
 v_mul_f32 v16, v16, v231
 v_mul_f32 v17, v17, v231
 v_mul_f32 v18, v18, v231
 v_mul_f32 v19, v19, v231
 v_mul_f32 v20, v20, v231
 v_mul_f32 v21, v21, v231
 v_mul_f32 v22, v22, v231
 v_mul_f32 v23, v23, v231
 v_mul_f32 v24, v24, v231
 v_mul_f32 v25, v25, v231
 v_mul_f32 v26, v26, v231
 v_mul_f32 v27, v27, v231
 v_mul_f32 v28, v28, v231
 v_mul_f32 v29, v29, v231
 v_mul_f32 v30, v30, v231
 v_mul_f32 v31, v31, v231
 v_mul_f32 v32, v32, v231
 v_mul_f32 v33, v33, v231
 v_mul_f32 v34, v34, v231
 v_mul_f32 v35, v35, v231
 v_mul_f32 v36, v36, v231
 v_mul_f32 v37, v37, v231
 v_mul_f32 v38, v38, v231
 v_mul_f32 v39, v39, v231
 v_mul_f32 v40, v40, v231
 v_mul_f32 v41, v41, v231
 v_mul_f32 v42, v42, v231
 v_mul_f32 v43, v43, v231
 v_mul_f32 v44, v44, v231
 v_mul_f32 v45, v45, v231
 v_mul_f32 v46, v46, v231
 v_mul_f32 v47, v47, v231
 v_mul_f32 v48, v48, v231
 v_mul_f32 v49, v49, v231
 v_mul_f32 v50, v50, v231
 v_mul_f32 v51, v51, v231
 v_mul_f32 v52, v52, v231
 v_mul_f32 v53, v53, v231
 v_mul_f32 v54, v54, v231
 v_mul_f32 v55, v55, v231
 v_mul_f32 v56, v56, v231
 v_mul_f32 v57, v57, v231
 v_mul_f32 v58, v58, v231
 v_mul_f32 v59, v59, v231
 v_mul_f32 v60, v60, v231
 v_mul_f32 v61, v61, v231
 v_mul_f32 v62, v62, v231
 v_mul_f32 v63, v63, v231
 v_exp_f32 v244, v112
 v_exp_f32 v245, v113
 v_exp_f32 v246, v114
 v_exp_f32 v247, v115
 v_add_f32 v230, v244, v245
 v_cvt_pk_bf16_f32 v232, v244, v245
 v_exp_f32 v248, v116
 v_add_f32 v231, v246, v247
 v_exp_f32 v249, v117
 v_cvt_pk_bf16_f32 v233, v246, v247
 v_exp_f32 v244, v118
 v_add_f32 v230, v230, v248
 v_exp_f32 v245, v119
 v_add_f32 v231, v231, v249
 v_cvt_pk_bf16_f32 v234, v248, v249
 v_exp_f32 v246, v120
 v_add_f32 v230, v230, v244
 v_exp_f32 v247, v121
 v_add_f32 v231, v231, v245
 v_cvt_pk_bf16_f32 v235, v244, v245
 v_exp_f32 v248, v122
 v_add_f32 v230, v230, v246
 v_exp_f32 v249, v123
 v_add_f32 v231, v231, v247
 v_cvt_pk_bf16_f32 v236, v246, v247
 v_exp_f32 v244, v124
 v_add_f32 v230, v230, v248
 v_exp_f32 v245, v125
 v_add_f32 v231, v231, v249
 v_cvt_pk_bf16_f32 v237, v248, v249
 v_exp_f32 v246, v126
 v_add_f32 v230, v230, v244
 v_exp_f32 v247, v127
 v_add_f32 v231, v231, v245
 v_cvt_pk_bf16_f32 v238, v244, v245
 v_add_f32 v230, v230, v246
 v_add_f32 v231, v231, v247
 v_cvt_pk_bf16_f32 v239, v246, v247
 v_add_f32 v230, v230, v231
 s_nop 1
 s_branch K_back_24
K_rare_25:
 v_max3_f32 v244, v96, v97, v98
 v_max3_f32 v245, v99, v100, v101
 v_max3_f32 v246, v102, v103, v104
 v_max3_f32 v247, v105, v106, v107
 v_max3_f32 v248, v108, v109, v110
 v_max3_f32 v244, v244, v245, v111
 v_max3_f32 v246, v246, v247, v248
 v_max_f32 v244, v244, v246
 v_mov_b32 v245, v244
 s_nop 1
 v_permlane32_swap_b32 v244, v245
 v_max_f32 v244, v244, v245
 v_max_f32 v229, 0, v244
 v_sub_f32 v231, 0, v229
 v_exp_f32 v231, v231
 s_nop 4
 v_sub_f32 v96, v96, v229
 v_sub_f32 v97, v97, v229
 v_sub_f32 v98, v98, v229
 v_sub_f32 v99, v99, v229
 v_sub_f32 v100, v100, v229
 v_sub_f32 v101, v101, v229
 v_sub_f32 v102, v102, v229
 v_sub_f32 v103, v103, v229
 v_sub_f32 v104, v104, v229
 v_sub_f32 v105, v105, v229
 v_sub_f32 v106, v106, v229
 v_sub_f32 v107, v107, v229
 v_sub_f32 v108, v108, v229
 v_sub_f32 v109, v109, v229
 v_sub_f32 v110, v110, v229
 v_sub_f32 v111, v111, v229
 v_sub_f32 v128, v128, v229
 v_sub_f32 v129, v129, v229
 v_sub_f32 v130, v130, v229
 v_sub_f32 v131, v131, v229
 v_sub_f32 v132, v132, v229
 v_sub_f32 v133, v133, v229
 v_sub_f32 v134, v134, v229
 v_sub_f32 v135, v135, v229
 v_sub_f32 v136, v136, v229
 v_sub_f32 v137, v137, v229
 v_sub_f32 v138, v138, v229
 v_sub_f32 v139, v139, v229
 v_sub_f32 v140, v140, v229
 v_sub_f32 v141, v141, v229
 v_sub_f32 v142, v142, v229
 v_sub_f32 v143, v143, v229
 v_sub_f32 v112, v112, v229
 v_sub_f32 v113, v113, v229
 v_sub_f32 v114, v114, v229
 v_sub_f32 v115, v115, v229
 v_sub_f32 v116, v116, v229
 v_sub_f32 v117, v117, v229
 v_sub_f32 v118, v118, v229
 v_sub_f32 v119, v119, v229
 v_sub_f32 v120, v120, v229
 v_sub_f32 v121, v121, v229
 v_sub_f32 v122, v122, v229
 v_sub_f32 v123, v123, v229
 v_sub_f32 v124, v124, v229
 v_sub_f32 v125, v125, v229
 v_sub_f32 v126, v126, v229
 v_sub_f32 v127, v127, v229
 v_mul_f32 v228, v228, v231
 v_mul_f32 v0, v0, v231
 v_mul_f32 v1, v1, v231
 v_mul_f32 v2, v2, v231
 v_mul_f32 v3, v3, v231
 v_mul_f32 v4, v4, v231
 v_mul_f32 v5, v5, v231
 v_mul_f32 v6, v6, v231
 v_mul_f32 v7, v7, v231
 v_mul_f32 v8, v8, v231
 v_mul_f32 v9, v9, v231
 v_mul_f32 v10, v10, v231
 v_mul_f32 v11, v11, v231
 v_mul_f32 v12, v12, v231
 v_mul_f32 v13, v13, v231
 v_mul_f32 v14, v14, v231
 v_mul_f32 v15, v15, v231
 v_mul_f32 v16, v16, v231
 v_mul_f32 v17, v17, v231
 v_mul_f32 v18, v18, v231
 v_mul_f32 v19, v19, v231
 v_mul_f32 v20, v20, v231
 v_mul_f32 v21, v21, v231
 v_mul_f32 v22, v22, v231
 v_mul_f32 v23, v23, v231
 v_mul_f32 v24, v24, v231
 v_mul_f32 v25, v25, v231
 v_mul_f32 v26, v26, v231
 v_mul_f32 v27, v27, v231
 v_mul_f32 v28, v28, v231
 v_mul_f32 v29, v29, v231
 v_mul_f32 v30, v30, v231
 v_mul_f32 v31, v31, v231
 v_mul_f32 v32, v32, v231
 v_mul_f32 v33, v33, v231
 v_mul_f32 v34, v34, v231
 v_mul_f32 v35, v35, v231
 v_mul_f32 v36, v36, v231
 v_mul_f32 v37, v37, v231
 v_mul_f32 v38, v38, v231
 v_mul_f32 v39, v39, v231
 v_mul_f32 v40, v40, v231
 v_mul_f32 v41, v41, v231
 v_mul_f32 v42, v42, v231
 v_mul_f32 v43, v43, v231
 v_mul_f32 v44, v44, v231
 v_mul_f32 v45, v45, v231
 v_mul_f32 v46, v46, v231
 v_mul_f32 v47, v47, v231
 v_mul_f32 v48, v48, v231
 v_mul_f32 v49, v49, v231
 v_mul_f32 v50, v50, v231
 v_mul_f32 v51, v51, v231
 v_mul_f32 v52, v52, v231
 v_mul_f32 v53, v53, v231
 v_mul_f32 v54, v54, v231
 v_mul_f32 v55, v55, v231
 v_mul_f32 v56, v56, v231
 v_mul_f32 v57, v57, v231
 v_mul_f32 v58, v58, v231
 v_mul_f32 v59, v59, v231
 v_mul_f32 v60, v60, v231
 v_mul_f32 v61, v61, v231
 v_mul_f32 v62, v62, v231
 v_mul_f32 v63, v63, v231
 v_exp_f32 v244, v96
 v_exp_f32 v245, v97
 v_exp_f32 v246, v98
 v_exp_f32 v247, v99
 v_add_f32 v230, v244, v245
 v_cvt_pk_bf16_f32 v144, v244, v245
 v_exp_f32 v248, v100
 v_add_f32 v231, v246, v247
 v_exp_f32 v249, v101
 v_cvt_pk_bf16_f32 v145, v246, v247
 v_exp_f32 v244, v102
 v_add_f32 v230, v230, v248
 v_exp_f32 v245, v103
 v_add_f32 v231, v231, v249
 v_cvt_pk_bf16_f32 v146, v248, v249
 v_exp_f32 v246, v104
 v_add_f32 v230, v230, v244
 v_exp_f32 v247, v105
 v_add_f32 v231, v231, v245
 v_cvt_pk_bf16_f32 v147, v244, v245
 v_exp_f32 v248, v106
 v_add_f32 v230, v230, v246
 v_exp_f32 v249, v107
 v_add_f32 v231, v231, v247
 v_cvt_pk_bf16_f32 v148, v246, v247
 v_exp_f32 v244, v108
 v_add_f32 v230, v230, v248
 v_exp_f32 v245, v109
 v_add_f32 v231, v231, v249
 v_cvt_pk_bf16_f32 v149, v248, v249
 v_exp_f32 v246, v110
 v_add_f32 v230, v230, v244
 v_exp_f32 v247, v111
 v_add_f32 v231, v231, v245
 v_cvt_pk_bf16_f32 v150, v244, v245
 v_add_f32 v230, v230, v246
 v_add_f32 v231, v231, v247
 v_cvt_pk_bf16_f32 v151, v246, v247
 v_add_f32 v230, v230, v231
 s_nop 1
 s_branch K_back_26
K_rare_27:
 v_max3_f32 v244, v112, v113, v114
 v_max3_f32 v245, v115, v116, v117
 v_max3_f32 v246, v118, v119, v120
 v_max3_f32 v247, v121, v122, v123
 v_max3_f32 v248, v124, v125, v126
 v_max3_f32 v244, v244, v245, v127
 v_max3_f32 v246, v246, v247, v248
 v_max_f32 v244, v244, v246
 v_mov_b32 v245, v244
 s_nop 1
 v_permlane32_swap_b32 v244, v245
 v_max_f32 v244, v244, v245
 v_max_f32 v229, 0, v244
 v_sub_f32 v231, 0, v229
 v_exp_f32 v231, v231
 s_nop 4
 v_sub_f32 v112, v112, v229
 v_sub_f32 v113, v113, v229
 v_sub_f32 v114, v114, v229
 v_sub_f32 v115, v115, v229
 v_sub_f32 v116, v116, v229
 v_sub_f32 v117, v117, v229
 v_sub_f32 v118, v118, v229
 v_sub_f32 v119, v119, v229
 v_sub_f32 v120, v120, v229
 v_sub_f32 v121, v121, v229
 v_sub_f32 v122, v122, v229
 v_sub_f32 v123, v123, v229
 v_sub_f32 v124, v124, v229
 v_sub_f32 v125, v125, v229
 v_sub_f32 v126, v126, v229
 v_sub_f32 v127, v127, v229
 v_sub_f32 v128, v128, v229
 v_sub_f32 v129, v129, v229
 v_sub_f32 v130, v130, v229
 v_sub_f32 v131, v131, v229
 v_sub_f32 v132, v132, v229
 v_sub_f32 v133, v133, v229
 v_sub_f32 v134, v134, v229
 v_sub_f32 v135, v135, v229
 v_sub_f32 v136, v136, v229
 v_sub_f32 v137, v137, v229
 v_sub_f32 v138, v138, v229
 v_sub_f32 v139, v139, v229
 v_sub_f32 v140, v140, v229
 v_sub_f32 v141, v141, v229
 v_sub_f32 v142, v142, v229
 v_sub_f32 v143, v143, v229
 v_sub_f32 v96, v96, v229
 v_sub_f32 v97, v97, v229
 v_sub_f32 v98, v98, v229
 v_sub_f32 v99, v99, v229
 v_sub_f32 v100, v100, v229
 v_sub_f32 v101, v101, v229
 v_sub_f32 v102, v102, v229
 v_sub_f32 v103, v103, v229
 v_sub_f32 v104, v104, v229
 v_sub_f32 v105, v105, v229
 v_sub_f32 v106, v106, v229
 v_sub_f32 v107, v107, v229
 v_sub_f32 v108, v108, v229
 v_sub_f32 v109, v109, v229
 v_sub_f32 v110, v110, v229
 v_sub_f32 v111, v111, v229
 v_mul_f32 v228, v228, v231
 v_mul_f32 v0, v0, v231
 v_mul_f32 v1, v1, v231
 v_mul_f32 v2, v2, v231
 v_mul_f32 v3, v3, v231
 v_mul_f32 v4, v4, v231
 v_mul_f32 v5, v5, v231
 v_mul_f32 v6, v6, v231
 v_mul_f32 v7, v7, v231
 v_mul_f32 v8, v8, v231
 v_mul_f32 v9, v9, v231
 v_mul_f32 v10, v10, v231
 v_mul_f32 v11, v11, v231
 v_mul_f32 v12, v12, v231
 v_mul_f32 v13, v13, v231
 v_mul_f32 v14, v14, v231
 v_mul_f32 v15, v15, v231
 v_mul_f32 v16, v16, v231
 v_mul_f32 v17, v17, v231
 v_mul_f32 v18, v18, v231
 v_mul_f32 v19, v19, v231
 v_mul_f32 v20, v20, v231
 v_mul_f32 v21, v21, v231
 v_mul_f32 v22, v22, v231
 v_mul_f32 v23, v23, v231
 v_mul_f32 v24, v24, v231
 v_mul_f32 v25, v25, v231
 v_mul_f32 v26, v26, v231
 v_mul_f32 v27, v27, v231
 v_mul_f32 v28, v28, v231
 v_mul_f32 v29, v29, v231
 v_mul_f32 v30, v30, v231
 v_mul_f32 v31, v31, v231
 v_mul_f32 v32, v32, v231
 v_mul_f32 v33, v33, v231
 v_mul_f32 v34, v34, v231
 v_mul_f32 v35, v35, v231
 v_mul_f32 v36, v36, v231
 v_mul_f32 v37, v37, v231
 v_mul_f32 v38, v38, v231
 v_mul_f32 v39, v39, v231
 v_mul_f32 v40, v40, v231
 v_mul_f32 v41, v41, v231
 v_mul_f32 v42, v42, v231
 v_mul_f32 v43, v43, v231
 v_mul_f32 v44, v44, v231
 v_mul_f32 v45, v45, v231
 v_mul_f32 v46, v46, v231
 v_mul_f32 v47, v47, v231
 v_mul_f32 v48, v48, v231
 v_mul_f32 v49, v49, v231
 v_mul_f32 v50, v50, v231
 v_mul_f32 v51, v51, v231
 v_mul_f32 v52, v52, v231
 v_mul_f32 v53, v53, v231
 v_mul_f32 v54, v54, v231
 v_mul_f32 v55, v55, v231
 v_mul_f32 v56, v56, v231
 v_mul_f32 v57, v57, v231
 v_mul_f32 v58, v58, v231
 v_mul_f32 v59, v59, v231
 v_mul_f32 v60, v60, v231
 v_mul_f32 v61, v61, v231
 v_mul_f32 v62, v62, v231
 v_mul_f32 v63, v63, v231
 v_exp_f32 v244, v112
 v_exp_f32 v245, v113
 v_exp_f32 v246, v114
 v_exp_f32 v247, v115
 v_add_f32 v230, v244, v245
 v_cvt_pk_bf16_f32 v232, v244, v245
 v_exp_f32 v248, v116
 v_add_f32 v231, v246, v247
 v_exp_f32 v249, v117
 v_cvt_pk_bf16_f32 v233, v246, v247
 v_exp_f32 v244, v118
 v_add_f32 v230, v230, v248
 v_exp_f32 v245, v119
 v_add_f32 v231, v231, v249
 v_cvt_pk_bf16_f32 v234, v248, v249
 v_exp_f32 v246, v120
 v_add_f32 v230, v230, v244
 v_exp_f32 v247, v121
 v_add_f32 v231, v231, v245
 v_cvt_pk_bf16_f32 v235, v244, v245
 v_exp_f32 v248, v122
 v_add_f32 v230, v230, v246
 v_exp_f32 v249, v123
 v_add_f32 v231, v231, v247
 v_cvt_pk_bf16_f32 v236, v246, v247
 v_exp_f32 v244, v124
 v_add_f32 v230, v230, v248
 v_exp_f32 v245, v125
 v_add_f32 v231, v231, v249
 v_cvt_pk_bf16_f32 v237, v248, v249
 v_exp_f32 v246, v126
 v_add_f32 v230, v230, v244
 v_exp_f32 v247, v127
 v_add_f32 v231, v231, v245
 v_cvt_pk_bf16_f32 v238, v244, v245
 v_add_f32 v230, v230, v246
 v_add_f32 v231, v231, v247
 v_cvt_pk_bf16_f32 v239, v246, v247
 v_add_f32 v230, v230, v231
 s_nop 1
 s_branch K_back_28
K_rare_29:
 v_max3_f32 v244, v96, v97, v98
 v_max3_f32 v245, v99, v100, v101
 v_max3_f32 v246, v102, v103, v104
 v_max3_f32 v247, v105, v106, v107
 v_max3_f32 v248, v108, v109, v110
 v_max3_f32 v244, v244, v245, v111
 v_max3_f32 v246, v246, v247, v248
 v_max_f32 v244, v244, v246
 v_mov_b32 v245, v244
 s_nop 1
 v_permlane32_swap_b32 v244, v245
 v_max_f32 v244, v244, v245
 v_max_f32 v229, 0, v244
 v_sub_f32 v231, 0, v229
 v_exp_f32 v231, v231
 s_nop 4
 v_sub_f32 v96, v96, v229
 v_sub_f32 v97, v97, v229
 v_sub_f32 v98, v98, v229
 v_sub_f32 v99, v99, v229
 v_sub_f32 v100, v100, v229
 v_sub_f32 v101, v101, v229
 v_sub_f32 v102, v102, v229
 v_sub_f32 v103, v103, v229
 v_sub_f32 v104, v104, v229
 v_sub_f32 v105, v105, v229
 v_sub_f32 v106, v106, v229
 v_sub_f32 v107, v107, v229
 v_sub_f32 v108, v108, v229
 v_sub_f32 v109, v109, v229
 v_sub_f32 v110, v110, v229
 v_sub_f32 v111, v111, v229
 v_sub_f32 v128, v128, v229
 v_sub_f32 v129, v129, v229
 v_sub_f32 v130, v130, v229
 v_sub_f32 v131, v131, v229
 v_sub_f32 v132, v132, v229
 v_sub_f32 v133, v133, v229
 v_sub_f32 v134, v134, v229
 v_sub_f32 v135, v135, v229
 v_sub_f32 v136, v136, v229
 v_sub_f32 v137, v137, v229
 v_sub_f32 v138, v138, v229
 v_sub_f32 v139, v139, v229
 v_sub_f32 v140, v140, v229
 v_sub_f32 v141, v141, v229
 v_sub_f32 v142, v142, v229
 v_sub_f32 v143, v143, v229
 v_sub_f32 v112, v112, v229
 v_sub_f32 v113, v113, v229
 v_sub_f32 v114, v114, v229
 v_sub_f32 v115, v115, v229
 v_sub_f32 v116, v116, v229
 v_sub_f32 v117, v117, v229
 v_sub_f32 v118, v118, v229
 v_sub_f32 v119, v119, v229
 v_sub_f32 v120, v120, v229
 v_sub_f32 v121, v121, v229
 v_sub_f32 v122, v122, v229
 v_sub_f32 v123, v123, v229
 v_sub_f32 v124, v124, v229
 v_sub_f32 v125, v125, v229
 v_sub_f32 v126, v126, v229
 v_sub_f32 v127, v127, v229
 v_mul_f32 v228, v228, v231
 v_mul_f32 v0, v0, v231
 v_mul_f32 v1, v1, v231
 v_mul_f32 v2, v2, v231
 v_mul_f32 v3, v3, v231
 v_mul_f32 v4, v4, v231
 v_mul_f32 v5, v5, v231
 v_mul_f32 v6, v6, v231
 v_mul_f32 v7, v7, v231
 v_mul_f32 v8, v8, v231
 v_mul_f32 v9, v9, v231
 v_mul_f32 v10, v10, v231
 v_mul_f32 v11, v11, v231
 v_mul_f32 v12, v12, v231
 v_mul_f32 v13, v13, v231
 v_mul_f32 v14, v14, v231
 v_mul_f32 v15, v15, v231
 v_mul_f32 v16, v16, v231
 v_mul_f32 v17, v17, v231
 v_mul_f32 v18, v18, v231
 v_mul_f32 v19, v19, v231
 v_mul_f32 v20, v20, v231
 v_mul_f32 v21, v21, v231
 v_mul_f32 v22, v22, v231
 v_mul_f32 v23, v23, v231
 v_mul_f32 v24, v24, v231
 v_mul_f32 v25, v25, v231
 v_mul_f32 v26, v26, v231
 v_mul_f32 v27, v27, v231
 v_mul_f32 v28, v28, v231
 v_mul_f32 v29, v29, v231
 v_mul_f32 v30, v30, v231
 v_mul_f32 v31, v31, v231
 v_mul_f32 v32, v32, v231
 v_mul_f32 v33, v33, v231
 v_mul_f32 v34, v34, v231
 v_mul_f32 v35, v35, v231
 v_mul_f32 v36, v36, v231
 v_mul_f32 v37, v37, v231
 v_mul_f32 v38, v38, v231
 v_mul_f32 v39, v39, v231
 v_mul_f32 v40, v40, v231
 v_mul_f32 v41, v41, v231
 v_mul_f32 v42, v42, v231
 v_mul_f32 v43, v43, v231
 v_mul_f32 v44, v44, v231
 v_mul_f32 v45, v45, v231
 v_mul_f32 v46, v46, v231
 v_mul_f32 v47, v47, v231
 v_mul_f32 v48, v48, v231
 v_mul_f32 v49, v49, v231
 v_mul_f32 v50, v50, v231
 v_mul_f32 v51, v51, v231
 v_mul_f32 v52, v52, v231
 v_mul_f32 v53, v53, v231
 v_mul_f32 v54, v54, v231
 v_mul_f32 v55, v55, v231
 v_mul_f32 v56, v56, v231
 v_mul_f32 v57, v57, v231
 v_mul_f32 v58, v58, v231
 v_mul_f32 v59, v59, v231
 v_mul_f32 v60, v60, v231
 v_mul_f32 v61, v61, v231
 v_mul_f32 v62, v62, v231
 v_mul_f32 v63, v63, v231
 v_exp_f32 v244, v96
 v_exp_f32 v245, v97
 v_exp_f32 v246, v98
 v_exp_f32 v247, v99
 v_add_f32 v230, v244, v245
 v_cvt_pk_bf16_f32 v144, v244, v245
 v_exp_f32 v248, v100
 v_add_f32 v231, v246, v247
 v_exp_f32 v249, v101
 v_cvt_pk_bf16_f32 v145, v246, v247
 v_exp_f32 v244, v102
 v_add_f32 v230, v230, v248
 v_exp_f32 v245, v103
 v_add_f32 v231, v231, v249
 v_cvt_pk_bf16_f32 v146, v248, v249
 v_exp_f32 v246, v104
 v_add_f32 v230, v230, v244
 v_exp_f32 v247, v105
 v_add_f32 v231, v231, v245
 v_cvt_pk_bf16_f32 v147, v244, v245
 v_exp_f32 v248, v106
 v_add_f32 v230, v230, v246
 v_exp_f32 v249, v107
 v_add_f32 v231, v231, v247
 v_cvt_pk_bf16_f32 v148, v246, v247
 v_exp_f32 v244, v108
 v_add_f32 v230, v230, v248
 v_exp_f32 v245, v109
 v_add_f32 v231, v231, v249
 v_cvt_pk_bf16_f32 v149, v248, v249
 v_exp_f32 v246, v110
 v_add_f32 v230, v230, v244
 v_exp_f32 v247, v111
 v_add_f32 v231, v231, v245
 v_cvt_pk_bf16_f32 v150, v244, v245
 v_add_f32 v230, v230, v246
 v_add_f32 v231, v231, v247
 v_cvt_pk_bf16_f32 v151, v246, v247
 v_add_f32 v230, v230, v231
 s_nop 1
 s_branch K_back_30
K_rare_31:
 v_max3_f32 v244, v112, v113, v114
 v_max3_f32 v245, v115, v116, v117
 v_max3_f32 v246, v118, v119, v120
 v_max3_f32 v247, v121, v122, v123
 v_max3_f32 v248, v124, v125, v126
 v_max3_f32 v244, v244, v245, v127
 v_max3_f32 v246, v246, v247, v248
 v_max_f32 v244, v244, v246
 v_mov_b32 v245, v244
 s_nop 1
 v_permlane32_swap_b32 v244, v245
 v_max_f32 v244, v244, v245
 v_max_f32 v229, 0, v244
 v_sub_f32 v231, 0, v229
 v_exp_f32 v231, v231
 s_nop 4
 v_sub_f32 v112, v112, v229
 v_sub_f32 v113, v113, v229
 v_sub_f32 v114, v114, v229
 v_sub_f32 v115, v115, v229
 v_sub_f32 v116, v116, v229
 v_sub_f32 v117, v117, v229
 v_sub_f32 v118, v118, v229
 v_sub_f32 v119, v119, v229
 v_sub_f32 v120, v120, v229
 v_sub_f32 v121, v121, v229
 v_sub_f32 v122, v122, v229
 v_sub_f32 v123, v123, v229
 v_sub_f32 v124, v124, v229
 v_sub_f32 v125, v125, v229
 v_sub_f32 v126, v126, v229
 v_sub_f32 v127, v127, v229
 v_sub_f32 v128, v128, v229
 v_sub_f32 v129, v129, v229
 v_sub_f32 v130, v130, v229
 v_sub_f32 v131, v131, v229
 v_sub_f32 v132, v132, v229
 v_sub_f32 v133, v133, v229
 v_sub_f32 v134, v134, v229
 v_sub_f32 v135, v135, v229
 v_sub_f32 v136, v136, v229
 v_sub_f32 v137, v137, v229
 v_sub_f32 v138, v138, v229
 v_sub_f32 v139, v139, v229
 v_sub_f32 v140, v140, v229
 v_sub_f32 v141, v141, v229
 v_sub_f32 v142, v142, v229
 v_sub_f32 v143, v143, v229
 v_mul_f32 v228, v228, v231
 v_mul_f32 v0, v0, v231
 v_mul_f32 v1, v1, v231
 v_mul_f32 v2, v2, v231
 v_mul_f32 v3, v3, v231
 v_mul_f32 v4, v4, v231
 v_mul_f32 v5, v5, v231
 v_mul_f32 v6, v6, v231
 v_mul_f32 v7, v7, v231
 v_mul_f32 v8, v8, v231
 v_mul_f32 v9, v9, v231
 v_mul_f32 v10, v10, v231
 v_mul_f32 v11, v11, v231
 v_mul_f32 v12, v12, v231
 v_mul_f32 v13, v13, v231
 v_mul_f32 v14, v14, v231
 v_mul_f32 v15, v15, v231
 v_mul_f32 v16, v16, v231
 v_mul_f32 v17, v17, v231
 v_mul_f32 v18, v18, v231
 v_mul_f32 v19, v19, v231
 v_mul_f32 v20, v20, v231
 v_mul_f32 v21, v21, v231
 v_mul_f32 v22, v22, v231
 v_mul_f32 v23, v23, v231
 v_mul_f32 v24, v24, v231
 v_mul_f32 v25, v25, v231
 v_mul_f32 v26, v26, v231
 v_mul_f32 v27, v27, v231
 v_mul_f32 v28, v28, v231
 v_mul_f32 v29, v29, v231
 v_mul_f32 v30, v30, v231
 v_mul_f32 v31, v31, v231
 v_mul_f32 v32, v32, v231
 v_mul_f32 v33, v33, v231
 v_mul_f32 v34, v34, v231
 v_mul_f32 v35, v35, v231
 v_mul_f32 v36, v36, v231
 v_mul_f32 v37, v37, v231
 v_mul_f32 v38, v38, v231
 v_mul_f32 v39, v39, v231
 v_mul_f32 v40, v40, v231
 v_mul_f32 v41, v41, v231
 v_mul_f32 v42, v42, v231
 v_mul_f32 v43, v43, v231
 v_mul_f32 v44, v44, v231
 v_mul_f32 v45, v45, v231
 v_mul_f32 v46, v46, v231
 v_mul_f32 v47, v47, v231
 v_mul_f32 v48, v48, v231
 v_mul_f32 v49, v49, v231
 v_mul_f32 v50, v50, v231
 v_mul_f32 v51, v51, v231
 v_mul_f32 v52, v52, v231
 v_mul_f32 v53, v53, v231
 v_mul_f32 v54, v54, v231
 v_mul_f32 v55, v55, v231
 v_mul_f32 v56, v56, v231
 v_mul_f32 v57, v57, v231
 v_mul_f32 v58, v58, v231
 v_mul_f32 v59, v59, v231
 v_mul_f32 v60, v60, v231
 v_mul_f32 v61, v61, v231
 v_mul_f32 v62, v62, v231
 v_mul_f32 v63, v63, v231
 v_exp_f32 v244, v112
 v_exp_f32 v245, v113
 v_exp_f32 v246, v114
 v_exp_f32 v247, v115
 v_add_f32 v230, v244, v245
 v_cvt_pk_bf16_f32 v232, v244, v245
 v_exp_f32 v248, v116
 v_add_f32 v231, v246, v247
 v_exp_f32 v249, v117
 v_cvt_pk_bf16_f32 v233, v246, v247
 v_exp_f32 v244, v118
 v_add_f32 v230, v230, v248
 v_exp_f32 v245, v119
 v_add_f32 v231, v231, v249
 v_cvt_pk_bf16_f32 v234, v248, v249
 v_exp_f32 v246, v120
 v_add_f32 v230, v230, v244
 v_exp_f32 v247, v121
 v_add_f32 v231, v231, v245
 v_cvt_pk_bf16_f32 v235, v244, v245
 v_exp_f32 v248, v122
 v_add_f32 v230, v230, v246
 v_exp_f32 v249, v123
 v_add_f32 v231, v231, v247
 v_cvt_pk_bf16_f32 v236, v246, v247
 v_exp_f32 v244, v124
 v_add_f32 v230, v230, v248
 v_exp_f32 v245, v125
 v_add_f32 v231, v231, v249
 v_cvt_pk_bf16_f32 v237, v248, v249
 v_exp_f32 v246, v126
 v_add_f32 v230, v230, v244
 v_exp_f32 v247, v127
 v_add_f32 v231, v231, v245
 v_cvt_pk_bf16_f32 v238, v244, v245
 v_add_f32 v230, v230, v246
 v_add_f32 v231, v231, v247
 v_cvt_pk_bf16_f32 v239, v246, v247
 v_add_f32 v230, v230, v231
 s_nop 1
 s_branch K_back_32
K_rare_2001:
 v_max3_f32 v244, v96, v97, v98
 v_max3_f32 v245, v99, v100, v101
 v_max3_f32 v246, v102, v103, v104
 v_max3_f32 v247, v105, v106, v107
 v_max3_f32 v248, v108, v109, v110
 v_max3_f32 v244, v244, v245, v111
 v_max3_f32 v246, v246, v247, v248
 v_max_f32 v244, v244, v246
 v_mov_b32 v245, v244
 s_nop 1
 v_permlane32_swap_b32 v244, v245
 v_max_f32 v244, v244, v245
 v_max_f32 v229, 0, v244
 v_sub_f32 v231, 0, v229
 v_exp_f32 v231, v231
 s_nop 4
 v_sub_f32 v96, v96, v229
 v_sub_f32 v97, v97, v229
 v_sub_f32 v98, v98, v229
 v_sub_f32 v99, v99, v229
 v_sub_f32 v100, v100, v229
 v_sub_f32 v101, v101, v229
 v_sub_f32 v102, v102, v229
 v_sub_f32 v103, v103, v229
 v_sub_f32 v104, v104, v229
 v_sub_f32 v105, v105, v229
 v_sub_f32 v106, v106, v229
 v_sub_f32 v107, v107, v229
 v_sub_f32 v108, v108, v229
 v_sub_f32 v109, v109, v229
 v_sub_f32 v110, v110, v229
 v_sub_f32 v111, v111, v229
 v_sub_f32 v128, v128, v229
 v_sub_f32 v129, v129, v229
 v_sub_f32 v130, v130, v229
 v_sub_f32 v131, v131, v229
 v_sub_f32 v132, v132, v229
 v_sub_f32 v133, v133, v229
 v_sub_f32 v134, v134, v229
 v_sub_f32 v135, v135, v229
 v_sub_f32 v136, v136, v229
 v_sub_f32 v137, v137, v229
 v_sub_f32 v138, v138, v229
 v_sub_f32 v139, v139, v229
 v_sub_f32 v140, v140, v229
 v_sub_f32 v141, v141, v229
 v_sub_f32 v142, v142, v229
 v_sub_f32 v143, v143, v229
 v_sub_f32 v112, v112, v229
 v_sub_f32 v113, v113, v229
 v_sub_f32 v114, v114, v229
 v_sub_f32 v115, v115, v229
 v_sub_f32 v116, v116, v229
 v_sub_f32 v117, v117, v229
 v_sub_f32 v118, v118, v229
 v_sub_f32 v119, v119, v229
 v_sub_f32 v120, v120, v229
 v_sub_f32 v121, v121, v229
 v_sub_f32 v122, v122, v229
 v_sub_f32 v123, v123, v229
 v_sub_f32 v124, v124, v229
 v_sub_f32 v125, v125, v229
 v_sub_f32 v126, v126, v229
 v_sub_f32 v127, v127, v229
 v_mul_f32 v228, v228, v231
 v_exp_f32 v244, v96
 v_exp_f32 v245, v97
 v_exp_f32 v246, v98
 v_exp_f32 v247, v99
 v_add_f32 v230, v244, v245
 v_cvt_pk_bf16_f32 v144, v244, v245
 v_exp_f32 v248, v100
 v_add_f32 v231, v246, v247
 v_exp_f32 v249, v101
 v_cvt_pk_bf16_f32 v145, v246, v247
 v_exp_f32 v244, v102
 v_add_f32 v230, v230, v248
 v_exp_f32 v245, v103
 v_add_f32 v231, v231, v249
 v_cvt_pk_bf16_f32 v146, v248, v249
 v_exp_f32 v246, v104
 v_add_f32 v230, v230, v244
 v_exp_f32 v247, v105
 v_add_f32 v231, v231, v245
 v_cvt_pk_bf16_f32 v147, v244, v245
 v_exp_f32 v248, v106
 v_add_f32 v230, v230, v246
 v_exp_f32 v249, v107
 v_add_f32 v231, v231, v247
 v_cvt_pk_bf16_f32 v148, v246, v247
 v_exp_f32 v244, v108
 v_add_f32 v230, v230, v248
 v_exp_f32 v245, v109
 v_add_f32 v231, v231, v249
 v_cvt_pk_bf16_f32 v149, v248, v249
 v_exp_f32 v246, v110
 v_add_f32 v230, v230, v244
 v_exp_f32 v247, v111
 v_add_f32 v231, v231, v245
 v_cvt_pk_bf16_f32 v150, v244, v245
 v_add_f32 v230, v230, v246
 v_add_f32 v231, v231, v247
 v_cvt_pk_bf16_f32 v151, v246, v247
 v_add_f32 v230, v230, v231
 s_nop 1
 s_branch K_back_2002
K_rare_2003:
 v_max3_f32 v244, v112, v113, v114
 v_max3_f32 v245, v115, v116, v117
 v_max3_f32 v246, v118, v119, v120
 v_max3_f32 v247, v121, v122, v123
 v_max3_f32 v248, v124, v125, v126
 v_max3_f32 v244, v244, v245, v127
 v_max3_f32 v246, v246, v247, v248
 v_max_f32 v244, v244, v246
 v_mov_b32 v245, v244
 s_nop 1
 v_permlane32_swap_b32 v244, v245
 v_max_f32 v244, v244, v245
 v_max_f32 v229, 0, v244
 v_sub_f32 v231, 0, v229
 v_exp_f32 v231, v231
 s_nop 4
 v_sub_f32 v112, v112, v229
 v_sub_f32 v113, v113, v229
 v_sub_f32 v114, v114, v229
 v_sub_f32 v115, v115, v229
 v_sub_f32 v116, v116, v229
 v_sub_f32 v117, v117, v229
 v_sub_f32 v118, v118, v229
 v_sub_f32 v119, v119, v229
 v_sub_f32 v120, v120, v229
 v_sub_f32 v121, v121, v229
 v_sub_f32 v122, v122, v229
 v_sub_f32 v123, v123, v229
 v_sub_f32 v124, v124, v229
 v_sub_f32 v125, v125, v229
 v_sub_f32 v126, v126, v229
 v_sub_f32 v127, v127, v229
 v_sub_f32 v128, v128, v229
 v_sub_f32 v129, v129, v229
 v_sub_f32 v130, v130, v229
 v_sub_f32 v131, v131, v229
 v_sub_f32 v132, v132, v229
 v_sub_f32 v133, v133, v229
 v_sub_f32 v134, v134, v229
 v_sub_f32 v135, v135, v229
 v_sub_f32 v136, v136, v229
 v_sub_f32 v137, v137, v229
 v_sub_f32 v138, v138, v229
 v_sub_f32 v139, v139, v229
 v_sub_f32 v140, v140, v229
 v_sub_f32 v141, v141, v229
 v_sub_f32 v142, v142, v229
 v_sub_f32 v143, v143, v229
 v_sub_f32 v96, v96, v229
 v_sub_f32 v97, v97, v229
 v_sub_f32 v98, v98, v229
 v_sub_f32 v99, v99, v229
 v_sub_f32 v100, v100, v229
 v_sub_f32 v101, v101, v229
 v_sub_f32 v102, v102, v229
 v_sub_f32 v103, v103, v229
 v_sub_f32 v104, v104, v229
 v_sub_f32 v105, v105, v229
 v_sub_f32 v106, v106, v229
 v_sub_f32 v107, v107, v229
 v_sub_f32 v108, v108, v229
 v_sub_f32 v109, v109, v229
 v_sub_f32 v110, v110, v229
 v_sub_f32 v111, v111, v229
 v_mul_f32 v228, v228, v231
 v_mul_f32 v0, v0, v231
 v_mul_f32 v1, v1, v231
 v_mul_f32 v2, v2, v231
 v_mul_f32 v3, v3, v231
 v_mul_f32 v4, v4, v231
 v_mul_f32 v5, v5, v231
 v_mul_f32 v6, v6, v231
 v_mul_f32 v7, v7, v231
 v_mul_f32 v8, v8, v231
 v_mul_f32 v9, v9, v231
 v_mul_f32 v10, v10, v231
 v_mul_f32 v11, v11, v231
 v_mul_f32 v12, v12, v231
 v_mul_f32 v13, v13, v231
 v_mul_f32 v14, v14, v231
 v_mul_f32 v15, v15, v231
 v_mul_f32 v16, v16, v231
 v_mul_f32 v17, v17, v231
 v_mul_f32 v18, v18, v231
 v_mul_f32 v19, v19, v231
 v_mul_f32 v20, v20, v231
 v_mul_f32 v21, v21, v231
 v_mul_f32 v22, v22, v231
 v_mul_f32 v23, v23, v231
 v_mul_f32 v24, v24, v231
 v_mul_f32 v25, v25, v231
 v_mul_f32 v26, v26, v231
 v_mul_f32 v27, v27, v231
 v_mul_f32 v28, v28, v231
 v_mul_f32 v29, v29, v231
 v_mul_f32 v30, v30, v231
 v_mul_f32 v31, v31, v231
 v_mul_f32 v32, v32, v231
 v_mul_f32 v33, v33, v231
 v_mul_f32 v34, v34, v231
 v_mul_f32 v35, v35, v231
 v_mul_f32 v36, v36, v231
 v_mul_f32 v37, v37, v231
 v_mul_f32 v38, v38, v231
 v_mul_f32 v39, v39, v231
 v_mul_f32 v40, v40, v231
 v_mul_f32 v41, v41, v231
 v_mul_f32 v42, v42, v231
 v_mul_f32 v43, v43, v231
 v_mul_f32 v44, v44, v231
 v_mul_f32 v45, v45, v231
 v_mul_f32 v46, v46, v231
 v_mul_f32 v47, v47, v231
 v_mul_f32 v48, v48, v231
 v_mul_f32 v49, v49, v231
 v_mul_f32 v50, v50, v231
 v_mul_f32 v51, v51, v231
 v_mul_f32 v52, v52, v231
 v_mul_f32 v53, v53, v231
 v_mul_f32 v54, v54, v231
 v_mul_f32 v55, v55, v231
 v_mul_f32 v56, v56, v231
 v_mul_f32 v57, v57, v231
 v_mul_f32 v58, v58, v231
 v_mul_f32 v59, v59, v231
 v_mul_f32 v60, v60, v231
 v_mul_f32 v61, v61, v231
 v_mul_f32 v62, v62, v231
 v_mul_f32 v63, v63, v231
 v_exp_f32 v244, v112
 v_exp_f32 v245, v113
 v_exp_f32 v246, v114
 v_exp_f32 v247, v115
 v_add_f32 v230, v244, v245
 v_cvt_pk_bf16_f32 v232, v244, v245
 v_exp_f32 v248, v116
 v_add_f32 v231, v246, v247
 v_exp_f32 v249, v117
 v_cvt_pk_bf16_f32 v233, v246, v247
 v_exp_f32 v244, v118
 v_add_f32 v230, v230, v248
 v_exp_f32 v245, v119
 v_add_f32 v231, v231, v249
 v_cvt_pk_bf16_f32 v234, v248, v249
 v_exp_f32 v246, v120
 v_add_f32 v230, v230, v244
 v_exp_f32 v247, v121
 v_add_f32 v231, v231, v245
 v_cvt_pk_bf16_f32 v235, v244, v245
 v_exp_f32 v248, v122
 v_add_f32 v230, v230, v246
 v_exp_f32 v249, v123
 v_add_f32 v231, v231, v247
 v_cvt_pk_bf16_f32 v236, v246, v247
 v_exp_f32 v244, v124
 v_add_f32 v230, v230, v248
 v_exp_f32 v245, v125
 v_add_f32 v231, v231, v249
 v_cvt_pk_bf16_f32 v237, v248, v249
 v_exp_f32 v246, v126
 v_add_f32 v230, v230, v244
 v_exp_f32 v247, v127
 v_add_f32 v231, v231, v245
 v_cvt_pk_bf16_f32 v238, v244, v245
 v_add_f32 v230, v230, v246
 v_add_f32 v231, v231, v247
 v_cvt_pk_bf16_f32 v239, v246, v247
 v_add_f32 v230, v230, v231
 s_nop 1
 s_branch K_back_2004
K_rare_2005:
 v_max3_f32 v244, v96, v97, v98
 v_max3_f32 v245, v99, v100, v101
 v_max3_f32 v246, v102, v103, v104
 v_max3_f32 v247, v105, v106, v107
 v_max3_f32 v248, v108, v109, v110
 v_max3_f32 v244, v244, v245, v111
 v_max3_f32 v246, v246, v247, v248
 v_max_f32 v244, v244, v246
 v_mov_b32 v245, v244
 s_nop 1
 v_permlane32_swap_b32 v244, v245
 v_max_f32 v244, v244, v245
 v_max_f32 v229, 0, v244
 v_sub_f32 v231, 0, v229
 v_exp_f32 v231, v231
 s_nop 4
 v_sub_f32 v96, v96, v229
 v_sub_f32 v97, v97, v229
 v_sub_f32 v98, v98, v229
 v_sub_f32 v99, v99, v229
 v_sub_f32 v100, v100, v229
 v_sub_f32 v101, v101, v229
 v_sub_f32 v102, v102, v229
 v_sub_f32 v103, v103, v229
 v_sub_f32 v104, v104, v229
 v_sub_f32 v105, v105, v229
 v_sub_f32 v106, v106, v229
 v_sub_f32 v107, v107, v229
 v_sub_f32 v108, v108, v229
 v_sub_f32 v109, v109, v229
 v_sub_f32 v110, v110, v229
 v_sub_f32 v111, v111, v229
 v_sub_f32 v128, v128, v229
 v_sub_f32 v129, v129, v229
 v_sub_f32 v130, v130, v229
 v_sub_f32 v131, v131, v229
 v_sub_f32 v132, v132, v229
 v_sub_f32 v133, v133, v229
 v_sub_f32 v134, v134, v229
 v_sub_f32 v135, v135, v229
 v_sub_f32 v136, v136, v229
 v_sub_f32 v137, v137, v229
 v_sub_f32 v138, v138, v229
 v_sub_f32 v139, v139, v229
 v_sub_f32 v140, v140, v229
 v_sub_f32 v141, v141, v229
 v_sub_f32 v142, v142, v229
 v_sub_f32 v143, v143, v229
 v_sub_f32 v112, v112, v229
 v_sub_f32 v113, v113, v229
 v_sub_f32 v114, v114, v229
 v_sub_f32 v115, v115, v229
 v_sub_f32 v116, v116, v229
 v_sub_f32 v117, v117, v229
 v_sub_f32 v118, v118, v229
 v_sub_f32 v119, v119, v229
 v_sub_f32 v120, v120, v229
 v_sub_f32 v121, v121, v229
 v_sub_f32 v122, v122, v229
 v_sub_f32 v123, v123, v229
 v_sub_f32 v124, v124, v229
 v_sub_f32 v125, v125, v229
 v_sub_f32 v126, v126, v229
 v_sub_f32 v127, v127, v229
 v_mul_f32 v228, v228, v231
 v_mul_f32 v0, v0, v231
 v_mul_f32 v1, v1, v231
 v_mul_f32 v2, v2, v231
 v_mul_f32 v3, v3, v231
 v_mul_f32 v4, v4, v231
 v_mul_f32 v5, v5, v231
 v_mul_f32 v6, v6, v231
 v_mul_f32 v7, v7, v231
 v_mul_f32 v8, v8, v231
 v_mul_f32 v9, v9, v231
 v_mul_f32 v10, v10, v231
 v_mul_f32 v11, v11, v231
 v_mul_f32 v12, v12, v231
 v_mul_f32 v13, v13, v231
 v_mul_f32 v14, v14, v231
 v_mul_f32 v15, v15, v231
 v_mul_f32 v16, v16, v231
 v_mul_f32 v17, v17, v231
 v_mul_f32 v18, v18, v231
 v_mul_f32 v19, v19, v231
 v_mul_f32 v20, v20, v231
 v_mul_f32 v21, v21, v231
 v_mul_f32 v22, v22, v231
 v_mul_f32 v23, v23, v231
 v_mul_f32 v24, v24, v231
 v_mul_f32 v25, v25, v231
 v_mul_f32 v26, v26, v231
 v_mul_f32 v27, v27, v231
 v_mul_f32 v28, v28, v231
 v_mul_f32 v29, v29, v231
 v_mul_f32 v30, v30, v231
 v_mul_f32 v31, v31, v231
 v_mul_f32 v32, v32, v231
 v_mul_f32 v33, v33, v231
 v_mul_f32 v34, v34, v231
 v_mul_f32 v35, v35, v231
 v_mul_f32 v36, v36, v231
 v_mul_f32 v37, v37, v231
 v_mul_f32 v38, v38, v231
 v_mul_f32 v39, v39, v231
 v_mul_f32 v40, v40, v231
 v_mul_f32 v41, v41, v231
 v_mul_f32 v42, v42, v231
 v_mul_f32 v43, v43, v231
 v_mul_f32 v44, v44, v231
 v_mul_f32 v45, v45, v231
 v_mul_f32 v46, v46, v231
 v_mul_f32 v47, v47, v231
 v_mul_f32 v48, v48, v231
 v_mul_f32 v49, v49, v231
 v_mul_f32 v50, v50, v231
 v_mul_f32 v51, v51, v231
 v_mul_f32 v52, v52, v231
 v_mul_f32 v53, v53, v231
 v_mul_f32 v54, v54, v231
 v_mul_f32 v55, v55, v231
 v_mul_f32 v56, v56, v231
 v_mul_f32 v57, v57, v231
 v_mul_f32 v58, v58, v231
 v_mul_f32 v59, v59, v231
 v_mul_f32 v60, v60, v231
 v_mul_f32 v61, v61, v231
 v_mul_f32 v62, v62, v231
 v_mul_f32 v63, v63, v231
 v_exp_f32 v244, v96
 v_exp_f32 v245, v97
 v_exp_f32 v246, v98
 v_exp_f32 v247, v99
 v_add_f32 v230, v244, v245
 v_cvt_pk_bf16_f32 v144, v244, v245
 v_exp_f32 v248, v100
 v_add_f32 v231, v246, v247
 v_exp_f32 v249, v101
 v_cvt_pk_bf16_f32 v145, v246, v247
 v_exp_f32 v244, v102
 v_add_f32 v230, v230, v248
 v_exp_f32 v245, v103
 v_add_f32 v231, v231, v249
 v_cvt_pk_bf16_f32 v146, v248, v249
 v_exp_f32 v246, v104
 v_add_f32 v230, v230, v244
 v_exp_f32 v247, v105
 v_add_f32 v231, v231, v245
 v_cvt_pk_bf16_f32 v147, v244, v245
 v_exp_f32 v248, v106
 v_add_f32 v230, v230, v246
 v_exp_f32 v249, v107
 v_add_f32 v231, v231, v247
 v_cvt_pk_bf16_f32 v148, v246, v247
 v_exp_f32 v244, v108
 v_add_f32 v230, v230, v248
 v_exp_f32 v245, v109
 v_add_f32 v231, v231, v249
 v_cvt_pk_bf16_f32 v149, v248, v249
 v_exp_f32 v246, v110
 v_add_f32 v230, v230, v244
 v_exp_f32 v247, v111
 v_add_f32 v231, v231, v245
 v_cvt_pk_bf16_f32 v150, v244, v245
 v_add_f32 v230, v230, v246
 v_add_f32 v231, v231, v247
 v_cvt_pk_bf16_f32 v151, v246, v247
 v_add_f32 v230, v230, v231
 s_nop 1
 s_branch K_back_2006
K_rare_2007:
 v_max3_f32 v244, v112, v113, v114
 v_max3_f32 v245, v115, v116, v117
 v_max3_f32 v246, v118, v119, v120
 v_max3_f32 v247, v121, v122, v123
 v_max3_f32 v248, v124, v125, v126
 v_max3_f32 v244, v244, v245, v127
 v_max3_f32 v246, v246, v247, v248
 v_max_f32 v244, v244, v246
 v_mov_b32 v245, v244
 s_nop 1
 v_permlane32_swap_b32 v244, v245
 v_max_f32 v244, v244, v245
 v_max_f32 v229, 0, v244
 v_sub_f32 v231, 0, v229
 v_exp_f32 v231, v231
 s_nop 4
 v_sub_f32 v112, v112, v229
 v_sub_f32 v113, v113, v229
 v_sub_f32 v114, v114, v229
 v_sub_f32 v115, v115, v229
 v_sub_f32 v116, v116, v229
 v_sub_f32 v117, v117, v229
 v_sub_f32 v118, v118, v229
 v_sub_f32 v119, v119, v229
 v_sub_f32 v120, v120, v229
 v_sub_f32 v121, v121, v229
 v_sub_f32 v122, v122, v229
 v_sub_f32 v123, v123, v229
 v_sub_f32 v124, v124, v229
 v_sub_f32 v125, v125, v229
 v_sub_f32 v126, v126, v229
 v_sub_f32 v127, v127, v229
 v_sub_f32 v128, v128, v229
 v_sub_f32 v129, v129, v229
 v_sub_f32 v130, v130, v229
 v_sub_f32 v131, v131, v229
 v_sub_f32 v132, v132, v229
 v_sub_f32 v133, v133, v229
 v_sub_f32 v134, v134, v229
 v_sub_f32 v135, v135, v229
 v_sub_f32 v136, v136, v229
 v_sub_f32 v137, v137, v229
 v_sub_f32 v138, v138, v229
 v_sub_f32 v139, v139, v229
 v_sub_f32 v140, v140, v229
 v_sub_f32 v141, v141, v229
 v_sub_f32 v142, v142, v229
 v_sub_f32 v143, v143, v229
 v_sub_f32 v96, v96, v229
 v_sub_f32 v97, v97, v229
 v_sub_f32 v98, v98, v229
 v_sub_f32 v99, v99, v229
 v_sub_f32 v100, v100, v229
 v_sub_f32 v101, v101, v229
 v_sub_f32 v102, v102, v229
 v_sub_f32 v103, v103, v229
 v_sub_f32 v104, v104, v229
 v_sub_f32 v105, v105, v229
 v_sub_f32 v106, v106, v229
 v_sub_f32 v107, v107, v229
 v_sub_f32 v108, v108, v229
 v_sub_f32 v109, v109, v229
 v_sub_f32 v110, v110, v229
 v_sub_f32 v111, v111, v229
 v_mul_f32 v228, v228, v231
 v_mul_f32 v0, v0, v231
 v_mul_f32 v1, v1, v231
 v_mul_f32 v2, v2, v231
 v_mul_f32 v3, v3, v231
 v_mul_f32 v4, v4, v231
 v_mul_f32 v5, v5, v231
 v_mul_f32 v6, v6, v231
 v_mul_f32 v7, v7, v231
 v_mul_f32 v8, v8, v231
 v_mul_f32 v9, v9, v231
 v_mul_f32 v10, v10, v231
 v_mul_f32 v11, v11, v231
 v_mul_f32 v12, v12, v231
 v_mul_f32 v13, v13, v231
 v_mul_f32 v14, v14, v231
 v_mul_f32 v15, v15, v231
 v_mul_f32 v16, v16, v231
 v_mul_f32 v17, v17, v231
 v_mul_f32 v18, v18, v231
 v_mul_f32 v19, v19, v231
 v_mul_f32 v20, v20, v231
 v_mul_f32 v21, v21, v231
 v_mul_f32 v22, v22, v231
 v_mul_f32 v23, v23, v231
 v_mul_f32 v24, v24, v231
 v_mul_f32 v25, v25, v231
 v_mul_f32 v26, v26, v231
 v_mul_f32 v27, v27, v231
 v_mul_f32 v28, v28, v231
 v_mul_f32 v29, v29, v231
 v_mul_f32 v30, v30, v231
 v_mul_f32 v31, v31, v231
 v_mul_f32 v32, v32, v231
 v_mul_f32 v33, v33, v231
 v_mul_f32 v34, v34, v231
 v_mul_f32 v35, v35, v231
 v_mul_f32 v36, v36, v231
 v_mul_f32 v37, v37, v231
 v_mul_f32 v38, v38, v231
 v_mul_f32 v39, v39, v231
 v_mul_f32 v40, v40, v231
 v_mul_f32 v41, v41, v231
 v_mul_f32 v42, v42, v231
 v_mul_f32 v43, v43, v231
 v_mul_f32 v44, v44, v231
 v_mul_f32 v45, v45, v231
 v_mul_f32 v46, v46, v231
 v_mul_f32 v47, v47, v231
 v_mul_f32 v48, v48, v231
 v_mul_f32 v49, v49, v231
 v_mul_f32 v50, v50, v231
 v_mul_f32 v51, v51, v231
 v_mul_f32 v52, v52, v231
 v_mul_f32 v53, v53, v231
 v_mul_f32 v54, v54, v231
 v_mul_f32 v55, v55, v231
 v_mul_f32 v56, v56, v231
 v_mul_f32 v57, v57, v231
 v_mul_f32 v58, v58, v231
 v_mul_f32 v59, v59, v231
 v_mul_f32 v60, v60, v231
 v_mul_f32 v61, v61, v231
 v_mul_f32 v62, v62, v231
 v_mul_f32 v63, v63, v231
 v_exp_f32 v244, v112
 v_exp_f32 v245, v113
 v_exp_f32 v246, v114
 v_exp_f32 v247, v115
 v_add_f32 v230, v244, v245
 v_cvt_pk_bf16_f32 v232, v244, v245
 v_exp_f32 v248, v116
 v_add_f32 v231, v246, v247
 v_exp_f32 v249, v117
 v_cvt_pk_bf16_f32 v233, v246, v247
 v_exp_f32 v244, v118
 v_add_f32 v230, v230, v248
 v_exp_f32 v245, v119
 v_add_f32 v231, v231, v249
 v_cvt_pk_bf16_f32 v234, v248, v249
 v_exp_f32 v246, v120
 v_add_f32 v230, v230, v244
 v_exp_f32 v247, v121
 v_add_f32 v231, v231, v245
 v_cvt_pk_bf16_f32 v235, v244, v245
 v_exp_f32 v248, v122
 v_add_f32 v230, v230, v246
 v_exp_f32 v249, v123
 v_add_f32 v231, v231, v247
 v_cvt_pk_bf16_f32 v236, v246, v247
 v_exp_f32 v244, v124
 v_add_f32 v230, v230, v248
 v_exp_f32 v245, v125
 v_add_f32 v231, v231, v249
 v_cvt_pk_bf16_f32 v237, v248, v249
 v_exp_f32 v246, v126
 v_add_f32 v230, v230, v244
 v_exp_f32 v247, v127
 v_add_f32 v231, v231, v245
 v_cvt_pk_bf16_f32 v238, v244, v245
 v_add_f32 v230, v230, v246
 v_add_f32 v231, v231, v247
 v_cvt_pk_bf16_f32 v239, v246, v247
 v_add_f32 v230, v230, v231
 s_nop 1
 s_branch K_back_2008
K_rare_2009:
 v_max3_f32 v244, v96, v97, v98
 v_max3_f32 v245, v99, v100, v101
 v_max3_f32 v246, v102, v103, v104
 v_max3_f32 v247, v105, v106, v107
 v_max3_f32 v248, v108, v109, v110
 v_max3_f32 v244, v244, v245, v111
 v_max3_f32 v246, v246, v247, v248
 v_max_f32 v244, v244, v246
 v_mov_b32 v245, v244
 s_nop 1
 v_permlane32_swap_b32 v244, v245
 v_max_f32 v244, v244, v245
 v_max_f32 v229, 0, v244
 v_sub_f32 v231, 0, v229
 v_exp_f32 v231, v231
 s_nop 4
 v_sub_f32 v96, v96, v229
 v_sub_f32 v97, v97, v229
 v_sub_f32 v98, v98, v229
 v_sub_f32 v99, v99, v229
 v_sub_f32 v100, v100, v229
 v_sub_f32 v101, v101, v229
 v_sub_f32 v102, v102, v229
 v_sub_f32 v103, v103, v229
 v_sub_f32 v104, v104, v229
 v_sub_f32 v105, v105, v229
 v_sub_f32 v106, v106, v229
 v_sub_f32 v107, v107, v229
 v_sub_f32 v108, v108, v229
 v_sub_f32 v109, v109, v229
 v_sub_f32 v110, v110, v229
 v_sub_f32 v111, v111, v229
 v_sub_f32 v128, v128, v229
 v_sub_f32 v129, v129, v229
 v_sub_f32 v130, v130, v229
 v_sub_f32 v131, v131, v229
 v_sub_f32 v132, v132, v229
 v_sub_f32 v133, v133, v229
 v_sub_f32 v134, v134, v229
 v_sub_f32 v135, v135, v229
 v_sub_f32 v136, v136, v229
 v_sub_f32 v137, v137, v229
 v_sub_f32 v138, v138, v229
 v_sub_f32 v139, v139, v229
 v_sub_f32 v140, v140, v229
 v_sub_f32 v141, v141, v229
 v_sub_f32 v142, v142, v229
 v_sub_f32 v143, v143, v229
 v_sub_f32 v112, v112, v229
 v_sub_f32 v113, v113, v229
 v_sub_f32 v114, v114, v229
 v_sub_f32 v115, v115, v229
 v_sub_f32 v116, v116, v229
 v_sub_f32 v117, v117, v229
 v_sub_f32 v118, v118, v229
 v_sub_f32 v119, v119, v229
 v_sub_f32 v120, v120, v229
 v_sub_f32 v121, v121, v229
 v_sub_f32 v122, v122, v229
 v_sub_f32 v123, v123, v229
 v_sub_f32 v124, v124, v229
 v_sub_f32 v125, v125, v229
 v_sub_f32 v126, v126, v229
 v_sub_f32 v127, v127, v229
 v_mul_f32 v228, v228, v231
 v_mul_f32 v0, v0, v231
 v_mul_f32 v1, v1, v231
 v_mul_f32 v2, v2, v231
 v_mul_f32 v3, v3, v231
 v_mul_f32 v4, v4, v231
 v_mul_f32 v5, v5, v231
 v_mul_f32 v6, v6, v231
 v_mul_f32 v7, v7, v231
 v_mul_f32 v8, v8, v231
 v_mul_f32 v9, v9, v231
 v_mul_f32 v10, v10, v231
 v_mul_f32 v11, v11, v231
 v_mul_f32 v12, v12, v231
 v_mul_f32 v13, v13, v231
 v_mul_f32 v14, v14, v231
 v_mul_f32 v15, v15, v231
 v_mul_f32 v16, v16, v231
 v_mul_f32 v17, v17, v231
 v_mul_f32 v18, v18, v231
 v_mul_f32 v19, v19, v231
 v_mul_f32 v20, v20, v231
 v_mul_f32 v21, v21, v231
 v_mul_f32 v22, v22, v231
 v_mul_f32 v23, v23, v231
 v_mul_f32 v24, v24, v231
 v_mul_f32 v25, v25, v231
 v_mul_f32 v26, v26, v231
 v_mul_f32 v27, v27, v231
 v_mul_f32 v28, v28, v231
 v_mul_f32 v29, v29, v231
 v_mul_f32 v30, v30, v231
 v_mul_f32 v31, v31, v231
 v_mul_f32 v32, v32, v231
 v_mul_f32 v33, v33, v231
 v_mul_f32 v34, v34, v231
 v_mul_f32 v35, v35, v231
 v_mul_f32 v36, v36, v231
 v_mul_f32 v37, v37, v231
 v_mul_f32 v38, v38, v231
 v_mul_f32 v39, v39, v231
 v_mul_f32 v40, v40, v231
 v_mul_f32 v41, v41, v231
 v_mul_f32 v42, v42, v231
 v_mul_f32 v43, v43, v231
 v_mul_f32 v44, v44, v231
 v_mul_f32 v45, v45, v231
 v_mul_f32 v46, v46, v231
 v_mul_f32 v47, v47, v231
 v_mul_f32 v48, v48, v231
 v_mul_f32 v49, v49, v231
 v_mul_f32 v50, v50, v231
 v_mul_f32 v51, v51, v231
 v_mul_f32 v52, v52, v231
 v_mul_f32 v53, v53, v231
 v_mul_f32 v54, v54, v231
 v_mul_f32 v55, v55, v231
 v_mul_f32 v56, v56, v231
 v_mul_f32 v57, v57, v231
 v_mul_f32 v58, v58, v231
 v_mul_f32 v59, v59, v231
 v_mul_f32 v60, v60, v231
 v_mul_f32 v61, v61, v231
 v_mul_f32 v62, v62, v231
 v_mul_f32 v63, v63, v231
 v_exp_f32 v244, v96
 v_exp_f32 v245, v97
 v_exp_f32 v246, v98
 v_exp_f32 v247, v99
 v_add_f32 v230, v244, v245
 v_cvt_pk_bf16_f32 v144, v244, v245
 v_exp_f32 v248, v100
 v_add_f32 v231, v246, v247
 v_exp_f32 v249, v101
 v_cvt_pk_bf16_f32 v145, v246, v247
 v_exp_f32 v244, v102
 v_add_f32 v230, v230, v248
 v_exp_f32 v245, v103
 v_add_f32 v231, v231, v249
 v_cvt_pk_bf16_f32 v146, v248, v249
 v_exp_f32 v246, v104
 v_add_f32 v230, v230, v244
 v_exp_f32 v247, v105
 v_add_f32 v231, v231, v245
 v_cvt_pk_bf16_f32 v147, v244, v245
 v_exp_f32 v248, v106
 v_add_f32 v230, v230, v246
 v_exp_f32 v249, v107
 v_add_f32 v231, v231, v247
 v_cvt_pk_bf16_f32 v148, v246, v247
 v_exp_f32 v244, v108
 v_add_f32 v230, v230, v248
 v_exp_f32 v245, v109
 v_add_f32 v231, v231, v249
 v_cvt_pk_bf16_f32 v149, v248, v249
 v_exp_f32 v246, v110
 v_add_f32 v230, v230, v244
 v_exp_f32 v247, v111
 v_add_f32 v231, v231, v245
 v_cvt_pk_bf16_f32 v150, v244, v245
 v_add_f32 v230, v230, v246
 v_add_f32 v231, v231, v247
 v_cvt_pk_bf16_f32 v151, v246, v247
 v_add_f32 v230, v230, v231
 s_nop 1
 s_branch K_back_2010
K_rare_2011:
 v_max3_f32 v244, v112, v113, v114
 v_max3_f32 v245, v115, v116, v117
 v_max3_f32 v246, v118, v119, v120
 v_max3_f32 v247, v121, v122, v123
 v_max3_f32 v248, v124, v125, v126
 v_max3_f32 v244, v244, v245, v127
 v_max3_f32 v246, v246, v247, v248
 v_max_f32 v244, v244, v246
 v_mov_b32 v245, v244
 s_nop 1
 v_permlane32_swap_b32 v244, v245
 v_max_f32 v244, v244, v245
 v_max_f32 v229, 0, v244
 v_sub_f32 v231, 0, v229
 v_exp_f32 v231, v231
 s_nop 4
 v_sub_f32 v112, v112, v229
 v_sub_f32 v113, v113, v229
 v_sub_f32 v114, v114, v229
 v_sub_f32 v115, v115, v229
 v_sub_f32 v116, v116, v229
 v_sub_f32 v117, v117, v229
 v_sub_f32 v118, v118, v229
 v_sub_f32 v119, v119, v229
 v_sub_f32 v120, v120, v229
 v_sub_f32 v121, v121, v229
 v_sub_f32 v122, v122, v229
 v_sub_f32 v123, v123, v229
 v_sub_f32 v124, v124, v229
 v_sub_f32 v125, v125, v229
 v_sub_f32 v126, v126, v229
 v_sub_f32 v127, v127, v229
 v_sub_f32 v128, v128, v229
 v_sub_f32 v129, v129, v229
 v_sub_f32 v130, v130, v229
 v_sub_f32 v131, v131, v229
 v_sub_f32 v132, v132, v229
 v_sub_f32 v133, v133, v229
 v_sub_f32 v134, v134, v229
 v_sub_f32 v135, v135, v229
 v_sub_f32 v136, v136, v229
 v_sub_f32 v137, v137, v229
 v_sub_f32 v138, v138, v229
 v_sub_f32 v139, v139, v229
 v_sub_f32 v140, v140, v229
 v_sub_f32 v141, v141, v229
 v_sub_f32 v142, v142, v229
 v_sub_f32 v143, v143, v229
 v_sub_f32 v96, v96, v229
 v_sub_f32 v97, v97, v229
 v_sub_f32 v98, v98, v229
 v_sub_f32 v99, v99, v229
 v_sub_f32 v100, v100, v229
 v_sub_f32 v101, v101, v229
 v_sub_f32 v102, v102, v229
 v_sub_f32 v103, v103, v229
 v_sub_f32 v104, v104, v229
 v_sub_f32 v105, v105, v229
 v_sub_f32 v106, v106, v229
 v_sub_f32 v107, v107, v229
 v_sub_f32 v108, v108, v229
 v_sub_f32 v109, v109, v229
 v_sub_f32 v110, v110, v229
 v_sub_f32 v111, v111, v229
 v_mul_f32 v228, v228, v231
 v_mul_f32 v0, v0, v231
 v_mul_f32 v1, v1, v231
 v_mul_f32 v2, v2, v231
 v_mul_f32 v3, v3, v231
 v_mul_f32 v4, v4, v231
 v_mul_f32 v5, v5, v231
 v_mul_f32 v6, v6, v231
 v_mul_f32 v7, v7, v231
 v_mul_f32 v8, v8, v231
 v_mul_f32 v9, v9, v231
 v_mul_f32 v10, v10, v231
 v_mul_f32 v11, v11, v231
 v_mul_f32 v12, v12, v231
 v_mul_f32 v13, v13, v231
 v_mul_f32 v14, v14, v231
 v_mul_f32 v15, v15, v231
 v_mul_f32 v16, v16, v231
 v_mul_f32 v17, v17, v231
 v_mul_f32 v18, v18, v231
 v_mul_f32 v19, v19, v231
 v_mul_f32 v20, v20, v231
 v_mul_f32 v21, v21, v231
 v_mul_f32 v22, v22, v231
 v_mul_f32 v23, v23, v231
 v_mul_f32 v24, v24, v231
 v_mul_f32 v25, v25, v231
 v_mul_f32 v26, v26, v231
 v_mul_f32 v27, v27, v231
 v_mul_f32 v28, v28, v231
 v_mul_f32 v29, v29, v231
 v_mul_f32 v30, v30, v231
 v_mul_f32 v31, v31, v231
 v_mul_f32 v32, v32, v231
 v_mul_f32 v33, v33, v231
 v_mul_f32 v34, v34, v231
 v_mul_f32 v35, v35, v231
 v_mul_f32 v36, v36, v231
 v_mul_f32 v37, v37, v231
 v_mul_f32 v38, v38, v231
 v_mul_f32 v39, v39, v231
 v_mul_f32 v40, v40, v231
 v_mul_f32 v41, v41, v231
 v_mul_f32 v42, v42, v231
 v_mul_f32 v43, v43, v231
 v_mul_f32 v44, v44, v231
 v_mul_f32 v45, v45, v231
 v_mul_f32 v46, v46, v231
 v_mul_f32 v47, v47, v231
 v_mul_f32 v48, v48, v231
 v_mul_f32 v49, v49, v231
 v_mul_f32 v50, v50, v231
 v_mul_f32 v51, v51, v231
 v_mul_f32 v52, v52, v231
 v_mul_f32 v53, v53, v231
 v_mul_f32 v54, v54, v231
 v_mul_f32 v55, v55, v231
 v_mul_f32 v56, v56, v231
 v_mul_f32 v57, v57, v231
 v_mul_f32 v58, v58, v231
 v_mul_f32 v59, v59, v231
 v_mul_f32 v60, v60, v231
 v_mul_f32 v61, v61, v231
 v_mul_f32 v62, v62, v231
 v_mul_f32 v63, v63, v231
 v_exp_f32 v244, v112
 v_exp_f32 v245, v113
 v_exp_f32 v246, v114
 v_exp_f32 v247, v115
 v_add_f32 v230, v244, v245
 v_cvt_pk_bf16_f32 v232, v244, v245
 v_exp_f32 v248, v116
 v_add_f32 v231, v246, v247
 v_exp_f32 v249, v117
 v_cvt_pk_bf16_f32 v233, v246, v247
 v_exp_f32 v244, v118
 v_add_f32 v230, v230, v248
 v_exp_f32 v245, v119
 v_add_f32 v231, v231, v249
 v_cvt_pk_bf16_f32 v234, v248, v249
 v_exp_f32 v246, v120
 v_add_f32 v230, v230, v244
 v_exp_f32 v247, v121
 v_add_f32 v231, v231, v245
 v_cvt_pk_bf16_f32 v235, v244, v245
 v_exp_f32 v248, v122
 v_add_f32 v230, v230, v246
 v_exp_f32 v249, v123
 v_add_f32 v231, v231, v247
 v_cvt_pk_bf16_f32 v236, v246, v247
 v_exp_f32 v244, v124
 v_add_f32 v230, v230, v248
 v_exp_f32 v245, v125
 v_add_f32 v231, v231, v249
 v_cvt_pk_bf16_f32 v237, v248, v249
 v_exp_f32 v246, v126
 v_add_f32 v230, v230, v244
 v_exp_f32 v247, v127
 v_add_f32 v231, v231, v245
 v_cvt_pk_bf16_f32 v238, v244, v245
 v_add_f32 v230, v230, v246
 v_add_f32 v231, v231, v247
 v_cvt_pk_bf16_f32 v239, v246, v247
 v_add_f32 v230, v230, v231
 s_nop 1
 s_branch K_back_2012
K_rare_2013:
 v_max3_f32 v244, v96, v97, v98
 v_max3_f32 v245, v99, v100, v101
 v_max3_f32 v246, v102, v103, v104
 v_max3_f32 v247, v105, v106, v107
 v_max3_f32 v248, v108, v109, v110
 v_max3_f32 v244, v244, v245, v111
 v_max3_f32 v246, v246, v247, v248
 v_max_f32 v244, v244, v246
 v_mov_b32 v245, v244
 s_nop 1
 v_permlane32_swap_b32 v244, v245
 v_max_f32 v244, v244, v245
 v_max_f32 v229, 0, v244
 v_sub_f32 v231, 0, v229
 v_exp_f32 v231, v231
 s_nop 4
 v_sub_f32 v96, v96, v229
 v_sub_f32 v97, v97, v229
 v_sub_f32 v98, v98, v229
 v_sub_f32 v99, v99, v229
 v_sub_f32 v100, v100, v229
 v_sub_f32 v101, v101, v229
 v_sub_f32 v102, v102, v229
 v_sub_f32 v103, v103, v229
 v_sub_f32 v104, v104, v229
 v_sub_f32 v105, v105, v229
 v_sub_f32 v106, v106, v229
 v_sub_f32 v107, v107, v229
 v_sub_f32 v108, v108, v229
 v_sub_f32 v109, v109, v229
 v_sub_f32 v110, v110, v229
 v_sub_f32 v111, v111, v229
 v_sub_f32 v128, v128, v229
 v_sub_f32 v129, v129, v229
 v_sub_f32 v130, v130, v229
 v_sub_f32 v131, v131, v229
 v_sub_f32 v132, v132, v229
 v_sub_f32 v133, v133, v229
 v_sub_f32 v134, v134, v229
 v_sub_f32 v135, v135, v229
 v_sub_f32 v136, v136, v229
 v_sub_f32 v137, v137, v229
 v_sub_f32 v138, v138, v229
 v_sub_f32 v139, v139, v229
 v_sub_f32 v140, v140, v229
 v_sub_f32 v141, v141, v229
 v_sub_f32 v142, v142, v229
 v_sub_f32 v143, v143, v229
 v_sub_f32 v112, v112, v229
 v_sub_f32 v113, v113, v229
 v_sub_f32 v114, v114, v229
 v_sub_f32 v115, v115, v229
 v_sub_f32 v116, v116, v229
 v_sub_f32 v117, v117, v229
 v_sub_f32 v118, v118, v229
 v_sub_f32 v119, v119, v229
 v_sub_f32 v120, v120, v229
 v_sub_f32 v121, v121, v229
 v_sub_f32 v122, v122, v229
 v_sub_f32 v123, v123, v229
 v_sub_f32 v124, v124, v229
 v_sub_f32 v125, v125, v229
 v_sub_f32 v126, v126, v229
 v_sub_f32 v127, v127, v229
 v_mul_f32 v228, v228, v231
 v_mul_f32 v0, v0, v231
 v_mul_f32 v1, v1, v231
 v_mul_f32 v2, v2, v231
 v_mul_f32 v3, v3, v231
 v_mul_f32 v4, v4, v231
 v_mul_f32 v5, v5, v231
 v_mul_f32 v6, v6, v231
 v_mul_f32 v7, v7, v231
 v_mul_f32 v8, v8, v231
 v_mul_f32 v9, v9, v231
 v_mul_f32 v10, v10, v231
 v_mul_f32 v11, v11, v231
 v_mul_f32 v12, v12, v231
 v_mul_f32 v13, v13, v231
 v_mul_f32 v14, v14, v231
 v_mul_f32 v15, v15, v231
 v_mul_f32 v16, v16, v231
 v_mul_f32 v17, v17, v231
 v_mul_f32 v18, v18, v231
 v_mul_f32 v19, v19, v231
 v_mul_f32 v20, v20, v231
 v_mul_f32 v21, v21, v231
 v_mul_f32 v22, v22, v231
 v_mul_f32 v23, v23, v231
 v_mul_f32 v24, v24, v231
 v_mul_f32 v25, v25, v231
 v_mul_f32 v26, v26, v231
 v_mul_f32 v27, v27, v231
 v_mul_f32 v28, v28, v231
 v_mul_f32 v29, v29, v231
 v_mul_f32 v30, v30, v231
 v_mul_f32 v31, v31, v231
 v_mul_f32 v32, v32, v231
 v_mul_f32 v33, v33, v231
 v_mul_f32 v34, v34, v231
 v_mul_f32 v35, v35, v231
 v_mul_f32 v36, v36, v231
 v_mul_f32 v37, v37, v231
 v_mul_f32 v38, v38, v231
 v_mul_f32 v39, v39, v231
 v_mul_f32 v40, v40, v231
 v_mul_f32 v41, v41, v231
 v_mul_f32 v42, v42, v231
 v_mul_f32 v43, v43, v231
 v_mul_f32 v44, v44, v231
 v_mul_f32 v45, v45, v231
 v_mul_f32 v46, v46, v231
 v_mul_f32 v47, v47, v231
 v_mul_f32 v48, v48, v231
 v_mul_f32 v49, v49, v231
 v_mul_f32 v50, v50, v231
 v_mul_f32 v51, v51, v231
 v_mul_f32 v52, v52, v231
 v_mul_f32 v53, v53, v231
 v_mul_f32 v54, v54, v231
 v_mul_f32 v55, v55, v231
 v_mul_f32 v56, v56, v231
 v_mul_f32 v57, v57, v231
 v_mul_f32 v58, v58, v231
 v_mul_f32 v59, v59, v231
 v_mul_f32 v60, v60, v231
 v_mul_f32 v61, v61, v231
 v_mul_f32 v62, v62, v231
 v_mul_f32 v63, v63, v231
 v_exp_f32 v244, v96
 v_exp_f32 v245, v97
 v_exp_f32 v246, v98
 v_exp_f32 v247, v99
 v_add_f32 v230, v244, v245
 v_cvt_pk_bf16_f32 v144, v244, v245
 v_exp_f32 v248, v100
 v_add_f32 v231, v246, v247
 v_exp_f32 v249, v101
 v_cvt_pk_bf16_f32 v145, v246, v247
 v_exp_f32 v244, v102
 v_add_f32 v230, v230, v248
 v_exp_f32 v245, v103
 v_add_f32 v231, v231, v249
 v_cvt_pk_bf16_f32 v146, v248, v249
 v_exp_f32 v246, v104
 v_add_f32 v230, v230, v244
 v_exp_f32 v247, v105
 v_add_f32 v231, v231, v245
 v_cvt_pk_bf16_f32 v147, v244, v245
 v_exp_f32 v248, v106
 v_add_f32 v230, v230, v246
 v_exp_f32 v249, v107
 v_add_f32 v231, v231, v247
 v_cvt_pk_bf16_f32 v148, v246, v247
 v_exp_f32 v244, v108
 v_add_f32 v230, v230, v248
 v_exp_f32 v245, v109
 v_add_f32 v231, v231, v249
 v_cvt_pk_bf16_f32 v149, v248, v249
 v_exp_f32 v246, v110
 v_add_f32 v230, v230, v244
 v_exp_f32 v247, v111
 v_add_f32 v231, v231, v245
 v_cvt_pk_bf16_f32 v150, v244, v245
 v_add_f32 v230, v230, v246
 v_add_f32 v231, v231, v247
 v_cvt_pk_bf16_f32 v151, v246, v247
 v_add_f32 v230, v230, v231
 s_nop 1
 s_branch K_back_2014
K_rare_2015:
 v_max3_f32 v244, v112, v113, v114
 v_max3_f32 v245, v115, v116, v117
 v_max3_f32 v246, v118, v119, v120
 v_max3_f32 v247, v121, v122, v123
 v_max3_f32 v248, v124, v125, v126
 v_max3_f32 v244, v244, v245, v127
 v_max3_f32 v246, v246, v247, v248
 v_max_f32 v244, v244, v246
 v_mov_b32 v245, v244
 s_nop 1
 v_permlane32_swap_b32 v244, v245
 v_max_f32 v244, v244, v245
 v_max_f32 v229, 0, v244
 v_sub_f32 v231, 0, v229
 v_exp_f32 v231, v231
 s_nop 4
 v_sub_f32 v112, v112, v229
 v_sub_f32 v113, v113, v229
 v_sub_f32 v114, v114, v229
 v_sub_f32 v115, v115, v229
 v_sub_f32 v116, v116, v229
 v_sub_f32 v117, v117, v229
 v_sub_f32 v118, v118, v229
 v_sub_f32 v119, v119, v229
 v_sub_f32 v120, v120, v229
 v_sub_f32 v121, v121, v229
 v_sub_f32 v122, v122, v229
 v_sub_f32 v123, v123, v229
 v_sub_f32 v124, v124, v229
 v_sub_f32 v125, v125, v229
 v_sub_f32 v126, v126, v229
 v_sub_f32 v127, v127, v229
 v_sub_f32 v128, v128, v229
 v_sub_f32 v129, v129, v229
 v_sub_f32 v130, v130, v229
 v_sub_f32 v131, v131, v229
 v_sub_f32 v132, v132, v229
 v_sub_f32 v133, v133, v229
 v_sub_f32 v134, v134, v229
 v_sub_f32 v135, v135, v229
 v_sub_f32 v136, v136, v229
 v_sub_f32 v137, v137, v229
 v_sub_f32 v138, v138, v229
 v_sub_f32 v139, v139, v229
 v_sub_f32 v140, v140, v229
 v_sub_f32 v141, v141, v229
 v_sub_f32 v142, v142, v229
 v_sub_f32 v143, v143, v229
 v_sub_f32 v96, v96, v229
 v_sub_f32 v97, v97, v229
 v_sub_f32 v98, v98, v229
 v_sub_f32 v99, v99, v229
 v_sub_f32 v100, v100, v229
 v_sub_f32 v101, v101, v229
 v_sub_f32 v102, v102, v229
 v_sub_f32 v103, v103, v229
 v_sub_f32 v104, v104, v229
 v_sub_f32 v105, v105, v229
 v_sub_f32 v106, v106, v229
 v_sub_f32 v107, v107, v229
 v_sub_f32 v108, v108, v229
 v_sub_f32 v109, v109, v229
 v_sub_f32 v110, v110, v229
 v_sub_f32 v111, v111, v229
 v_mul_f32 v228, v228, v231
 v_mul_f32 v0, v0, v231
 v_mul_f32 v1, v1, v231
 v_mul_f32 v2, v2, v231
 v_mul_f32 v3, v3, v231
 v_mul_f32 v4, v4, v231
 v_mul_f32 v5, v5, v231
 v_mul_f32 v6, v6, v231
 v_mul_f32 v7, v7, v231
 v_mul_f32 v8, v8, v231
 v_mul_f32 v9, v9, v231
 v_mul_f32 v10, v10, v231
 v_mul_f32 v11, v11, v231
 v_mul_f32 v12, v12, v231
 v_mul_f32 v13, v13, v231
 v_mul_f32 v14, v14, v231
 v_mul_f32 v15, v15, v231
 v_mul_f32 v16, v16, v231
 v_mul_f32 v17, v17, v231
 v_mul_f32 v18, v18, v231
 v_mul_f32 v19, v19, v231
 v_mul_f32 v20, v20, v231
 v_mul_f32 v21, v21, v231
 v_mul_f32 v22, v22, v231
 v_mul_f32 v23, v23, v231
 v_mul_f32 v24, v24, v231
 v_mul_f32 v25, v25, v231
 v_mul_f32 v26, v26, v231
 v_mul_f32 v27, v27, v231
 v_mul_f32 v28, v28, v231
 v_mul_f32 v29, v29, v231
 v_mul_f32 v30, v30, v231
 v_mul_f32 v31, v31, v231
 v_mul_f32 v32, v32, v231
 v_mul_f32 v33, v33, v231
 v_mul_f32 v34, v34, v231
 v_mul_f32 v35, v35, v231
 v_mul_f32 v36, v36, v231
 v_mul_f32 v37, v37, v231
 v_mul_f32 v38, v38, v231
 v_mul_f32 v39, v39, v231
 v_mul_f32 v40, v40, v231
 v_mul_f32 v41, v41, v231
 v_mul_f32 v42, v42, v231
 v_mul_f32 v43, v43, v231
 v_mul_f32 v44, v44, v231
 v_mul_f32 v45, v45, v231
 v_mul_f32 v46, v46, v231
 v_mul_f32 v47, v47, v231
 v_mul_f32 v48, v48, v231
 v_mul_f32 v49, v49, v231
 v_mul_f32 v50, v50, v231
 v_mul_f32 v51, v51, v231
 v_mul_f32 v52, v52, v231
 v_mul_f32 v53, v53, v231
 v_mul_f32 v54, v54, v231
 v_mul_f32 v55, v55, v231
 v_mul_f32 v56, v56, v231
 v_mul_f32 v57, v57, v231
 v_mul_f32 v58, v58, v231
 v_mul_f32 v59, v59, v231
 v_mul_f32 v60, v60, v231
 v_mul_f32 v61, v61, v231
 v_mul_f32 v62, v62, v231
 v_mul_f32 v63, v63, v231
 v_exp_f32 v244, v112
 v_exp_f32 v245, v113
 v_exp_f32 v246, v114
 v_exp_f32 v247, v115
 v_add_f32 v230, v244, v245
 v_cvt_pk_bf16_f32 v232, v244, v245
 v_exp_f32 v248, v116
 v_add_f32 v231, v246, v247
 v_exp_f32 v249, v117
 v_cvt_pk_bf16_f32 v233, v246, v247
 v_exp_f32 v244, v118
 v_add_f32 v230, v230, v248
 v_exp_f32 v245, v119
 v_add_f32 v231, v231, v249
 v_cvt_pk_bf16_f32 v234, v248, v249
 v_exp_f32 v246, v120
 v_add_f32 v230, v230, v244
 v_exp_f32 v247, v121
 v_add_f32 v231, v231, v245
 v_cvt_pk_bf16_f32 v235, v244, v245
 v_exp_f32 v248, v122
 v_add_f32 v230, v230, v246
 v_exp_f32 v249, v123
 v_add_f32 v231, v231, v247
 v_cvt_pk_bf16_f32 v236, v246, v247
 v_exp_f32 v244, v124
 v_add_f32 v230, v230, v248
 v_exp_f32 v245, v125
 v_add_f32 v231, v231, v249
 v_cvt_pk_bf16_f32 v237, v248, v249
 v_exp_f32 v246, v126
 v_add_f32 v230, v230, v244
 v_exp_f32 v247, v127
 v_add_f32 v231, v231, v245
 v_cvt_pk_bf16_f32 v238, v244, v245
 v_add_f32 v230, v230, v246
 v_add_f32 v231, v231, v247
 v_cvt_pk_bf16_f32 v239, v246, v247
 v_add_f32 v230, v230, v231
 s_nop 1
 s_branch K_back_2016
K_rare_2017:
 v_max3_f32 v244, v96, v97, v98
 v_max3_f32 v245, v99, v100, v101
 v_max3_f32 v246, v102, v103, v104
 v_max3_f32 v247, v105, v106, v107
 v_max3_f32 v248, v108, v109, v110
 v_max3_f32 v244, v244, v245, v111
 v_max3_f32 v246, v246, v247, v248
 v_max_f32 v244, v244, v246
 v_mov_b32 v245, v244
 s_nop 1
 v_permlane32_swap_b32 v244, v245
 v_max_f32 v244, v244, v245
 v_max_f32 v229, 0, v244
 v_sub_f32 v231, 0, v229
 v_exp_f32 v231, v231
 s_nop 4
 v_sub_f32 v96, v96, v229
 v_sub_f32 v97, v97, v229
 v_sub_f32 v98, v98, v229
 v_sub_f32 v99, v99, v229
 v_sub_f32 v100, v100, v229
 v_sub_f32 v101, v101, v229
 v_sub_f32 v102, v102, v229
 v_sub_f32 v103, v103, v229
 v_sub_f32 v104, v104, v229
 v_sub_f32 v105, v105, v229
 v_sub_f32 v106, v106, v229
 v_sub_f32 v107, v107, v229
 v_sub_f32 v108, v108, v229
 v_sub_f32 v109, v109, v229
 v_sub_f32 v110, v110, v229
 v_sub_f32 v111, v111, v229
 v_sub_f32 v128, v128, v229
 v_sub_f32 v129, v129, v229
 v_sub_f32 v130, v130, v229
 v_sub_f32 v131, v131, v229
 v_sub_f32 v132, v132, v229
 v_sub_f32 v133, v133, v229
 v_sub_f32 v134, v134, v229
 v_sub_f32 v135, v135, v229
 v_sub_f32 v136, v136, v229
 v_sub_f32 v137, v137, v229
 v_sub_f32 v138, v138, v229
 v_sub_f32 v139, v139, v229
 v_sub_f32 v140, v140, v229
 v_sub_f32 v141, v141, v229
 v_sub_f32 v142, v142, v229
 v_sub_f32 v143, v143, v229
 v_sub_f32 v112, v112, v229
 v_sub_f32 v113, v113, v229
 v_sub_f32 v114, v114, v229
 v_sub_f32 v115, v115, v229
 v_sub_f32 v116, v116, v229
 v_sub_f32 v117, v117, v229
 v_sub_f32 v118, v118, v229
 v_sub_f32 v119, v119, v229
 v_sub_f32 v120, v120, v229
 v_sub_f32 v121, v121, v229
 v_sub_f32 v122, v122, v229
 v_sub_f32 v123, v123, v229
 v_sub_f32 v124, v124, v229
 v_sub_f32 v125, v125, v229
 v_sub_f32 v126, v126, v229
 v_sub_f32 v127, v127, v229
 v_mul_f32 v228, v228, v231
 v_mul_f32 v0, v0, v231
 v_mul_f32 v1, v1, v231
 v_mul_f32 v2, v2, v231
 v_mul_f32 v3, v3, v231
 v_mul_f32 v4, v4, v231
 v_mul_f32 v5, v5, v231
 v_mul_f32 v6, v6, v231
 v_mul_f32 v7, v7, v231
 v_mul_f32 v8, v8, v231
 v_mul_f32 v9, v9, v231
 v_mul_f32 v10, v10, v231
 v_mul_f32 v11, v11, v231
 v_mul_f32 v12, v12, v231
 v_mul_f32 v13, v13, v231
 v_mul_f32 v14, v14, v231
 v_mul_f32 v15, v15, v231
 v_mul_f32 v16, v16, v231
 v_mul_f32 v17, v17, v231
 v_mul_f32 v18, v18, v231
 v_mul_f32 v19, v19, v231
 v_mul_f32 v20, v20, v231
 v_mul_f32 v21, v21, v231
 v_mul_f32 v22, v22, v231
 v_mul_f32 v23, v23, v231
 v_mul_f32 v24, v24, v231
 v_mul_f32 v25, v25, v231
 v_mul_f32 v26, v26, v231
 v_mul_f32 v27, v27, v231
 v_mul_f32 v28, v28, v231
 v_mul_f32 v29, v29, v231
 v_mul_f32 v30, v30, v231
 v_mul_f32 v31, v31, v231
 v_mul_f32 v32, v32, v231
 v_mul_f32 v33, v33, v231
 v_mul_f32 v34, v34, v231
 v_mul_f32 v35, v35, v231
 v_mul_f32 v36, v36, v231
 v_mul_f32 v37, v37, v231
 v_mul_f32 v38, v38, v231
 v_mul_f32 v39, v39, v231
 v_mul_f32 v40, v40, v231
 v_mul_f32 v41, v41, v231
 v_mul_f32 v42, v42, v231
 v_mul_f32 v43, v43, v231
 v_mul_f32 v44, v44, v231
 v_mul_f32 v45, v45, v231
 v_mul_f32 v46, v46, v231
 v_mul_f32 v47, v47, v231
 v_mul_f32 v48, v48, v231
 v_mul_f32 v49, v49, v231
 v_mul_f32 v50, v50, v231
 v_mul_f32 v51, v51, v231
 v_mul_f32 v52, v52, v231
 v_mul_f32 v53, v53, v231
 v_mul_f32 v54, v54, v231
 v_mul_f32 v55, v55, v231
 v_mul_f32 v56, v56, v231
 v_mul_f32 v57, v57, v231
 v_mul_f32 v58, v58, v231
 v_mul_f32 v59, v59, v231
 v_mul_f32 v60, v60, v231
 v_mul_f32 v61, v61, v231
 v_mul_f32 v62, v62, v231
 v_mul_f32 v63, v63, v231
 v_exp_f32 v244, v96
 v_exp_f32 v245, v97
 v_exp_f32 v246, v98
 v_exp_f32 v247, v99
 v_add_f32 v230, v244, v245
 v_cvt_pk_bf16_f32 v144, v244, v245
 v_exp_f32 v248, v100
 v_add_f32 v231, v246, v247
 v_exp_f32 v249, v101
 v_cvt_pk_bf16_f32 v145, v246, v247
 v_exp_f32 v244, v102
 v_add_f32 v230, v230, v248
 v_exp_f32 v245, v103
 v_add_f32 v231, v231, v249
 v_cvt_pk_bf16_f32 v146, v248, v249
 v_exp_f32 v246, v104
 v_add_f32 v230, v230, v244
 v_exp_f32 v247, v105
 v_add_f32 v231, v231, v245
 v_cvt_pk_bf16_f32 v147, v244, v245
 v_exp_f32 v248, v106
 v_add_f32 v230, v230, v246
 v_exp_f32 v249, v107
 v_add_f32 v231, v231, v247
 v_cvt_pk_bf16_f32 v148, v246, v247
 v_exp_f32 v244, v108
 v_add_f32 v230, v230, v248
 v_exp_f32 v245, v109
 v_add_f32 v231, v231, v249
 v_cvt_pk_bf16_f32 v149, v248, v249
 v_exp_f32 v246, v110
 v_add_f32 v230, v230, v244
 v_exp_f32 v247, v111
 v_add_f32 v231, v231, v245
 v_cvt_pk_bf16_f32 v150, v244, v245
 v_add_f32 v230, v230, v246
 v_add_f32 v231, v231, v247
 v_cvt_pk_bf16_f32 v151, v246, v247
 v_add_f32 v230, v230, v231
 s_nop 1
 s_branch K_back_2018
K_rare_2019:
 v_max3_f32 v244, v112, v113, v114
 v_max3_f32 v245, v115, v116, v117
 v_max3_f32 v246, v118, v119, v120
 v_max3_f32 v247, v121, v122, v123
 v_max3_f32 v248, v124, v125, v126
 v_max3_f32 v244, v244, v245, v127
 v_max3_f32 v246, v246, v247, v248
 v_max_f32 v244, v244, v246
 v_mov_b32 v245, v244
 s_nop 1
 v_permlane32_swap_b32 v244, v245
 v_max_f32 v244, v244, v245
 v_max_f32 v229, 0, v244
 v_sub_f32 v231, 0, v229
 v_exp_f32 v231, v231
 s_nop 4
 v_sub_f32 v112, v112, v229
 v_sub_f32 v113, v113, v229
 v_sub_f32 v114, v114, v229
 v_sub_f32 v115, v115, v229
 v_sub_f32 v116, v116, v229
 v_sub_f32 v117, v117, v229
 v_sub_f32 v118, v118, v229
 v_sub_f32 v119, v119, v229
 v_sub_f32 v120, v120, v229
 v_sub_f32 v121, v121, v229
 v_sub_f32 v122, v122, v229
 v_sub_f32 v123, v123, v229
 v_sub_f32 v124, v124, v229
 v_sub_f32 v125, v125, v229
 v_sub_f32 v126, v126, v229
 v_sub_f32 v127, v127, v229
 v_sub_f32 v128, v128, v229
 v_sub_f32 v129, v129, v229
 v_sub_f32 v130, v130, v229
 v_sub_f32 v131, v131, v229
 v_sub_f32 v132, v132, v229
 v_sub_f32 v133, v133, v229
 v_sub_f32 v134, v134, v229
 v_sub_f32 v135, v135, v229
 v_sub_f32 v136, v136, v229
 v_sub_f32 v137, v137, v229
 v_sub_f32 v138, v138, v229
 v_sub_f32 v139, v139, v229
 v_sub_f32 v140, v140, v229
 v_sub_f32 v141, v141, v229
 v_sub_f32 v142, v142, v229
 v_sub_f32 v143, v143, v229
 v_sub_f32 v96, v96, v229
 v_sub_f32 v97, v97, v229
 v_sub_f32 v98, v98, v229
 v_sub_f32 v99, v99, v229
 v_sub_f32 v100, v100, v229
 v_sub_f32 v101, v101, v229
 v_sub_f32 v102, v102, v229
 v_sub_f32 v103, v103, v229
 v_sub_f32 v104, v104, v229
 v_sub_f32 v105, v105, v229
 v_sub_f32 v106, v106, v229
 v_sub_f32 v107, v107, v229
 v_sub_f32 v108, v108, v229
 v_sub_f32 v109, v109, v229
 v_sub_f32 v110, v110, v229
 v_sub_f32 v111, v111, v229
 v_mul_f32 v228, v228, v231
 v_mul_f32 v0, v0, v231
 v_mul_f32 v1, v1, v231
 v_mul_f32 v2, v2, v231
 v_mul_f32 v3, v3, v231
 v_mul_f32 v4, v4, v231
 v_mul_f32 v5, v5, v231
 v_mul_f32 v6, v6, v231
 v_mul_f32 v7, v7, v231
 v_mul_f32 v8, v8, v231
 v_mul_f32 v9, v9, v231
 v_mul_f32 v10, v10, v231
 v_mul_f32 v11, v11, v231
 v_mul_f32 v12, v12, v231
 v_mul_f32 v13, v13, v231
 v_mul_f32 v14, v14, v231
 v_mul_f32 v15, v15, v231
 v_mul_f32 v16, v16, v231
 v_mul_f32 v17, v17, v231
 v_mul_f32 v18, v18, v231
 v_mul_f32 v19, v19, v231
 v_mul_f32 v20, v20, v231
 v_mul_f32 v21, v21, v231
 v_mul_f32 v22, v22, v231
 v_mul_f32 v23, v23, v231
 v_mul_f32 v24, v24, v231
 v_mul_f32 v25, v25, v231
 v_mul_f32 v26, v26, v231
 v_mul_f32 v27, v27, v231
 v_mul_f32 v28, v28, v231
 v_mul_f32 v29, v29, v231
 v_mul_f32 v30, v30, v231
 v_mul_f32 v31, v31, v231
 v_mul_f32 v32, v32, v231
 v_mul_f32 v33, v33, v231
 v_mul_f32 v34, v34, v231
 v_mul_f32 v35, v35, v231
 v_mul_f32 v36, v36, v231
 v_mul_f32 v37, v37, v231
 v_mul_f32 v38, v38, v231
 v_mul_f32 v39, v39, v231
 v_mul_f32 v40, v40, v231
 v_mul_f32 v41, v41, v231
 v_mul_f32 v42, v42, v231
 v_mul_f32 v43, v43, v231
 v_mul_f32 v44, v44, v231
 v_mul_f32 v45, v45, v231
 v_mul_f32 v46, v46, v231
 v_mul_f32 v47, v47, v231
 v_mul_f32 v48, v48, v231
 v_mul_f32 v49, v49, v231
 v_mul_f32 v50, v50, v231
 v_mul_f32 v51, v51, v231
 v_mul_f32 v52, v52, v231
 v_mul_f32 v53, v53, v231
 v_mul_f32 v54, v54, v231
 v_mul_f32 v55, v55, v231
 v_mul_f32 v56, v56, v231
 v_mul_f32 v57, v57, v231
 v_mul_f32 v58, v58, v231
 v_mul_f32 v59, v59, v231
 v_mul_f32 v60, v60, v231
 v_mul_f32 v61, v61, v231
 v_mul_f32 v62, v62, v231
 v_mul_f32 v63, v63, v231
 v_exp_f32 v244, v112
 v_exp_f32 v245, v113
 v_exp_f32 v246, v114
 v_exp_f32 v247, v115
 v_add_f32 v230, v244, v245
 v_cvt_pk_bf16_f32 v232, v244, v245
 v_exp_f32 v248, v116
 v_add_f32 v231, v246, v247
 v_exp_f32 v249, v117
 v_cvt_pk_bf16_f32 v233, v246, v247
 v_exp_f32 v244, v118
 v_add_f32 v230, v230, v248
 v_exp_f32 v245, v119
 v_add_f32 v231, v231, v249
 v_cvt_pk_bf16_f32 v234, v248, v249
 v_exp_f32 v246, v120
 v_add_f32 v230, v230, v244
 v_exp_f32 v247, v121
 v_add_f32 v231, v231, v245
 v_cvt_pk_bf16_f32 v235, v244, v245
 v_exp_f32 v248, v122
 v_add_f32 v230, v230, v246
 v_exp_f32 v249, v123
 v_add_f32 v231, v231, v247
 v_cvt_pk_bf16_f32 v236, v246, v247
 v_exp_f32 v244, v124
 v_add_f32 v230, v230, v248
 v_exp_f32 v245, v125
 v_add_f32 v231, v231, v249
 v_cvt_pk_bf16_f32 v237, v248, v249
 v_exp_f32 v246, v126
 v_add_f32 v230, v230, v244
 v_exp_f32 v247, v127
 v_add_f32 v231, v231, v245
 v_cvt_pk_bf16_f32 v238, v244, v245
 v_add_f32 v230, v230, v246
 v_add_f32 v231, v231, v247
 v_cvt_pk_bf16_f32 v239, v246, v247
 v_add_f32 v230, v230, v231
 s_nop 1
 s_branch K_back_2020
K_rare_2021:
 v_max3_f32 v244, v96, v97, v98
 v_max3_f32 v245, v99, v100, v101
 v_max3_f32 v246, v102, v103, v104
 v_max3_f32 v247, v105, v106, v107
 v_max3_f32 v248, v108, v109, v110
 v_max3_f32 v244, v244, v245, v111
 v_max3_f32 v246, v246, v247, v248
 v_max_f32 v244, v244, v246
 v_mov_b32 v245, v244
 s_nop 1
 v_permlane32_swap_b32 v244, v245
 v_max_f32 v244, v244, v245
 v_max_f32 v229, 0, v244
 v_sub_f32 v231, 0, v229
 v_exp_f32 v231, v231
 s_nop 4
 v_sub_f32 v96, v96, v229
 v_sub_f32 v97, v97, v229
 v_sub_f32 v98, v98, v229
 v_sub_f32 v99, v99, v229
 v_sub_f32 v100, v100, v229
 v_sub_f32 v101, v101, v229
 v_sub_f32 v102, v102, v229
 v_sub_f32 v103, v103, v229
 v_sub_f32 v104, v104, v229
 v_sub_f32 v105, v105, v229
 v_sub_f32 v106, v106, v229
 v_sub_f32 v107, v107, v229
 v_sub_f32 v108, v108, v229
 v_sub_f32 v109, v109, v229
 v_sub_f32 v110, v110, v229
 v_sub_f32 v111, v111, v229
 v_sub_f32 v128, v128, v229
 v_sub_f32 v129, v129, v229
 v_sub_f32 v130, v130, v229
 v_sub_f32 v131, v131, v229
 v_sub_f32 v132, v132, v229
 v_sub_f32 v133, v133, v229
 v_sub_f32 v134, v134, v229
 v_sub_f32 v135, v135, v229
 v_sub_f32 v136, v136, v229
 v_sub_f32 v137, v137, v229
 v_sub_f32 v138, v138, v229
 v_sub_f32 v139, v139, v229
 v_sub_f32 v140, v140, v229
 v_sub_f32 v141, v141, v229
 v_sub_f32 v142, v142, v229
 v_sub_f32 v143, v143, v229
 v_sub_f32 v112, v112, v229
 v_sub_f32 v113, v113, v229
 v_sub_f32 v114, v114, v229
 v_sub_f32 v115, v115, v229
 v_sub_f32 v116, v116, v229
 v_sub_f32 v117, v117, v229
 v_sub_f32 v118, v118, v229
 v_sub_f32 v119, v119, v229
 v_sub_f32 v120, v120, v229
 v_sub_f32 v121, v121, v229
 v_sub_f32 v122, v122, v229
 v_sub_f32 v123, v123, v229
 v_sub_f32 v124, v124, v229
 v_sub_f32 v125, v125, v229
 v_sub_f32 v126, v126, v229
 v_sub_f32 v127, v127, v229
 v_mul_f32 v228, v228, v231
 v_mul_f32 v0, v0, v231
 v_mul_f32 v1, v1, v231
 v_mul_f32 v2, v2, v231
 v_mul_f32 v3, v3, v231
 v_mul_f32 v4, v4, v231
 v_mul_f32 v5, v5, v231
 v_mul_f32 v6, v6, v231
 v_mul_f32 v7, v7, v231
 v_mul_f32 v8, v8, v231
 v_mul_f32 v9, v9, v231
 v_mul_f32 v10, v10, v231
 v_mul_f32 v11, v11, v231
 v_mul_f32 v12, v12, v231
 v_mul_f32 v13, v13, v231
 v_mul_f32 v14, v14, v231
 v_mul_f32 v15, v15, v231
 v_mul_f32 v16, v16, v231
 v_mul_f32 v17, v17, v231
 v_mul_f32 v18, v18, v231
 v_mul_f32 v19, v19, v231
 v_mul_f32 v20, v20, v231
 v_mul_f32 v21, v21, v231
 v_mul_f32 v22, v22, v231
 v_mul_f32 v23, v23, v231
 v_mul_f32 v24, v24, v231
 v_mul_f32 v25, v25, v231
 v_mul_f32 v26, v26, v231
 v_mul_f32 v27, v27, v231
 v_mul_f32 v28, v28, v231
 v_mul_f32 v29, v29, v231
 v_mul_f32 v30, v30, v231
 v_mul_f32 v31, v31, v231
 v_mul_f32 v32, v32, v231
 v_mul_f32 v33, v33, v231
 v_mul_f32 v34, v34, v231
 v_mul_f32 v35, v35, v231
 v_mul_f32 v36, v36, v231
 v_mul_f32 v37, v37, v231
 v_mul_f32 v38, v38, v231
 v_mul_f32 v39, v39, v231
 v_mul_f32 v40, v40, v231
 v_mul_f32 v41, v41, v231
 v_mul_f32 v42, v42, v231
 v_mul_f32 v43, v43, v231
 v_mul_f32 v44, v44, v231
 v_mul_f32 v45, v45, v231
 v_mul_f32 v46, v46, v231
 v_mul_f32 v47, v47, v231
 v_mul_f32 v48, v48, v231
 v_mul_f32 v49, v49, v231
 v_mul_f32 v50, v50, v231
 v_mul_f32 v51, v51, v231
 v_mul_f32 v52, v52, v231
 v_mul_f32 v53, v53, v231
 v_mul_f32 v54, v54, v231
 v_mul_f32 v55, v55, v231
 v_mul_f32 v56, v56, v231
 v_mul_f32 v57, v57, v231
 v_mul_f32 v58, v58, v231
 v_mul_f32 v59, v59, v231
 v_mul_f32 v60, v60, v231
 v_mul_f32 v61, v61, v231
 v_mul_f32 v62, v62, v231
 v_mul_f32 v63, v63, v231
 v_exp_f32 v244, v96
 v_exp_f32 v245, v97
 v_exp_f32 v246, v98
 v_exp_f32 v247, v99
 v_add_f32 v230, v244, v245
 v_cvt_pk_bf16_f32 v144, v244, v245
 v_exp_f32 v248, v100
 v_add_f32 v231, v246, v247
 v_exp_f32 v249, v101
 v_cvt_pk_bf16_f32 v145, v246, v247
 v_exp_f32 v244, v102
 v_add_f32 v230, v230, v248
 v_exp_f32 v245, v103
 v_add_f32 v231, v231, v249
 v_cvt_pk_bf16_f32 v146, v248, v249
 v_exp_f32 v246, v104
 v_add_f32 v230, v230, v244
 v_exp_f32 v247, v105
 v_add_f32 v231, v231, v245
 v_cvt_pk_bf16_f32 v147, v244, v245
 v_exp_f32 v248, v106
 v_add_f32 v230, v230, v246
 v_exp_f32 v249, v107
 v_add_f32 v231, v231, v247
 v_cvt_pk_bf16_f32 v148, v246, v247
 v_exp_f32 v244, v108
 v_add_f32 v230, v230, v248
 v_exp_f32 v245, v109
 v_add_f32 v231, v231, v249
 v_cvt_pk_bf16_f32 v149, v248, v249
 v_exp_f32 v246, v110
 v_add_f32 v230, v230, v244
 v_exp_f32 v247, v111
 v_add_f32 v231, v231, v245
 v_cvt_pk_bf16_f32 v150, v244, v245
 v_add_f32 v230, v230, v246
 v_add_f32 v231, v231, v247
 v_cvt_pk_bf16_f32 v151, v246, v247
 v_add_f32 v230, v230, v231
 s_nop 1
 s_branch K_back_2022
K_rare_2023:
 v_max3_f32 v244, v112, v113, v114
 v_max3_f32 v245, v115, v116, v117
 v_max3_f32 v246, v118, v119, v120
 v_max3_f32 v247, v121, v122, v123
 v_max3_f32 v248, v124, v125, v126
 v_max3_f32 v244, v244, v245, v127
 v_max3_f32 v246, v246, v247, v248
 v_max_f32 v244, v244, v246
 v_mov_b32 v245, v244
 s_nop 1
 v_permlane32_swap_b32 v244, v245
 v_max_f32 v244, v244, v245
 v_max_f32 v229, 0, v244
 v_sub_f32 v231, 0, v229
 v_exp_f32 v231, v231
 s_nop 4
 v_sub_f32 v112, v112, v229
 v_sub_f32 v113, v113, v229
 v_sub_f32 v114, v114, v229
 v_sub_f32 v115, v115, v229
 v_sub_f32 v116, v116, v229
 v_sub_f32 v117, v117, v229
 v_sub_f32 v118, v118, v229
 v_sub_f32 v119, v119, v229
 v_sub_f32 v120, v120, v229
 v_sub_f32 v121, v121, v229
 v_sub_f32 v122, v122, v229
 v_sub_f32 v123, v123, v229
 v_sub_f32 v124, v124, v229
 v_sub_f32 v125, v125, v229
 v_sub_f32 v126, v126, v229
 v_sub_f32 v127, v127, v229
 v_sub_f32 v128, v128, v229
 v_sub_f32 v129, v129, v229
 v_sub_f32 v130, v130, v229
 v_sub_f32 v131, v131, v229
 v_sub_f32 v132, v132, v229
 v_sub_f32 v133, v133, v229
 v_sub_f32 v134, v134, v229
 v_sub_f32 v135, v135, v229
 v_sub_f32 v136, v136, v229
 v_sub_f32 v137, v137, v229
 v_sub_f32 v138, v138, v229
 v_sub_f32 v139, v139, v229
 v_sub_f32 v140, v140, v229
 v_sub_f32 v141, v141, v229
 v_sub_f32 v142, v142, v229
 v_sub_f32 v143, v143, v229
 v_sub_f32 v96, v96, v229
 v_sub_f32 v97, v97, v229
 v_sub_f32 v98, v98, v229
 v_sub_f32 v99, v99, v229
 v_sub_f32 v100, v100, v229
 v_sub_f32 v101, v101, v229
 v_sub_f32 v102, v102, v229
 v_sub_f32 v103, v103, v229
 v_sub_f32 v104, v104, v229
 v_sub_f32 v105, v105, v229
 v_sub_f32 v106, v106, v229
 v_sub_f32 v107, v107, v229
 v_sub_f32 v108, v108, v229
 v_sub_f32 v109, v109, v229
 v_sub_f32 v110, v110, v229
 v_sub_f32 v111, v111, v229
 v_mul_f32 v228, v228, v231
 v_mul_f32 v0, v0, v231
 v_mul_f32 v1, v1, v231
 v_mul_f32 v2, v2, v231
 v_mul_f32 v3, v3, v231
 v_mul_f32 v4, v4, v231
 v_mul_f32 v5, v5, v231
 v_mul_f32 v6, v6, v231
 v_mul_f32 v7, v7, v231
 v_mul_f32 v8, v8, v231
 v_mul_f32 v9, v9, v231
 v_mul_f32 v10, v10, v231
 v_mul_f32 v11, v11, v231
 v_mul_f32 v12, v12, v231
 v_mul_f32 v13, v13, v231
 v_mul_f32 v14, v14, v231
 v_mul_f32 v15, v15, v231
 v_mul_f32 v16, v16, v231
 v_mul_f32 v17, v17, v231
 v_mul_f32 v18, v18, v231
 v_mul_f32 v19, v19, v231
 v_mul_f32 v20, v20, v231
 v_mul_f32 v21, v21, v231
 v_mul_f32 v22, v22, v231
 v_mul_f32 v23, v23, v231
 v_mul_f32 v24, v24, v231
 v_mul_f32 v25, v25, v231
 v_mul_f32 v26, v26, v231
 v_mul_f32 v27, v27, v231
 v_mul_f32 v28, v28, v231
 v_mul_f32 v29, v29, v231
 v_mul_f32 v30, v30, v231
 v_mul_f32 v31, v31, v231
 v_mul_f32 v32, v32, v231
 v_mul_f32 v33, v33, v231
 v_mul_f32 v34, v34, v231
 v_mul_f32 v35, v35, v231
 v_mul_f32 v36, v36, v231
 v_mul_f32 v37, v37, v231
 v_mul_f32 v38, v38, v231
 v_mul_f32 v39, v39, v231
 v_mul_f32 v40, v40, v231
 v_mul_f32 v41, v41, v231
 v_mul_f32 v42, v42, v231
 v_mul_f32 v43, v43, v231
 v_mul_f32 v44, v44, v231
 v_mul_f32 v45, v45, v231
 v_mul_f32 v46, v46, v231
 v_mul_f32 v47, v47, v231
 v_mul_f32 v48, v48, v231
 v_mul_f32 v49, v49, v231
 v_mul_f32 v50, v50, v231
 v_mul_f32 v51, v51, v231
 v_mul_f32 v52, v52, v231
 v_mul_f32 v53, v53, v231
 v_mul_f32 v54, v54, v231
 v_mul_f32 v55, v55, v231
 v_mul_f32 v56, v56, v231
 v_mul_f32 v57, v57, v231
 v_mul_f32 v58, v58, v231
 v_mul_f32 v59, v59, v231
 v_mul_f32 v60, v60, v231
 v_mul_f32 v61, v61, v231
 v_mul_f32 v62, v62, v231
 v_mul_f32 v63, v63, v231
 v_exp_f32 v244, v112
 v_exp_f32 v245, v113
 v_exp_f32 v246, v114
 v_exp_f32 v247, v115
 v_add_f32 v230, v244, v245
 v_cvt_pk_bf16_f32 v232, v244, v245
 v_exp_f32 v248, v116
 v_add_f32 v231, v246, v247
 v_exp_f32 v249, v117
 v_cvt_pk_bf16_f32 v233, v246, v247
 v_exp_f32 v244, v118
 v_add_f32 v230, v230, v248
 v_exp_f32 v245, v119
 v_add_f32 v231, v231, v249
 v_cvt_pk_bf16_f32 v234, v248, v249
 v_exp_f32 v246, v120
 v_add_f32 v230, v230, v244
 v_exp_f32 v247, v121
 v_add_f32 v231, v231, v245
 v_cvt_pk_bf16_f32 v235, v244, v245
 v_exp_f32 v248, v122
 v_add_f32 v230, v230, v246
 v_exp_f32 v249, v123
 v_add_f32 v231, v231, v247
 v_cvt_pk_bf16_f32 v236, v246, v247
 v_exp_f32 v244, v124
 v_add_f32 v230, v230, v248
 v_exp_f32 v245, v125
 v_add_f32 v231, v231, v249
 v_cvt_pk_bf16_f32 v237, v248, v249
 v_exp_f32 v246, v126
 v_add_f32 v230, v230, v244
 v_exp_f32 v247, v127
 v_add_f32 v231, v231, v245
 v_cvt_pk_bf16_f32 v238, v244, v245
 v_add_f32 v230, v230, v246
 v_add_f32 v231, v231, v247
 v_cvt_pk_bf16_f32 v239, v246, v247
 v_add_f32 v230, v230, v231
 s_nop 1
 s_branch K_back_2024
K_rare_2025:
 v_max3_f32 v244, v96, v97, v98
 v_max3_f32 v245, v99, v100, v101
 v_max3_f32 v246, v102, v103, v104
 v_max3_f32 v247, v105, v106, v107
 v_max3_f32 v248, v108, v109, v110
 v_max3_f32 v244, v244, v245, v111
 v_max3_f32 v246, v246, v247, v248
 v_max_f32 v244, v244, v246
 v_mov_b32 v245, v244
 s_nop 1
 v_permlane32_swap_b32 v244, v245
 v_max_f32 v244, v244, v245
 v_max_f32 v229, 0, v244
 v_sub_f32 v231, 0, v229
 v_exp_f32 v231, v231
 s_nop 4
 v_sub_f32 v96, v96, v229
 v_sub_f32 v97, v97, v229
 v_sub_f32 v98, v98, v229
 v_sub_f32 v99, v99, v229
 v_sub_f32 v100, v100, v229
 v_sub_f32 v101, v101, v229
 v_sub_f32 v102, v102, v229
 v_sub_f32 v103, v103, v229
 v_sub_f32 v104, v104, v229
 v_sub_f32 v105, v105, v229
 v_sub_f32 v106, v106, v229
 v_sub_f32 v107, v107, v229
 v_sub_f32 v108, v108, v229
 v_sub_f32 v109, v109, v229
 v_sub_f32 v110, v110, v229
 v_sub_f32 v111, v111, v229
 v_sub_f32 v128, v128, v229
 v_sub_f32 v129, v129, v229
 v_sub_f32 v130, v130, v229
 v_sub_f32 v131, v131, v229
 v_sub_f32 v132, v132, v229
 v_sub_f32 v133, v133, v229
 v_sub_f32 v134, v134, v229
 v_sub_f32 v135, v135, v229
 v_sub_f32 v136, v136, v229
 v_sub_f32 v137, v137, v229
 v_sub_f32 v138, v138, v229
 v_sub_f32 v139, v139, v229
 v_sub_f32 v140, v140, v229
 v_sub_f32 v141, v141, v229
 v_sub_f32 v142, v142, v229
 v_sub_f32 v143, v143, v229
 v_sub_f32 v112, v112, v229
 v_sub_f32 v113, v113, v229
 v_sub_f32 v114, v114, v229
 v_sub_f32 v115, v115, v229
 v_sub_f32 v116, v116, v229
 v_sub_f32 v117, v117, v229
 v_sub_f32 v118, v118, v229
 v_sub_f32 v119, v119, v229
 v_sub_f32 v120, v120, v229
 v_sub_f32 v121, v121, v229
 v_sub_f32 v122, v122, v229
 v_sub_f32 v123, v123, v229
 v_sub_f32 v124, v124, v229
 v_sub_f32 v125, v125, v229
 v_sub_f32 v126, v126, v229
 v_sub_f32 v127, v127, v229
 v_mul_f32 v228, v228, v231
 v_mul_f32 v0, v0, v231
 v_mul_f32 v1, v1, v231
 v_mul_f32 v2, v2, v231
 v_mul_f32 v3, v3, v231
 v_mul_f32 v4, v4, v231
 v_mul_f32 v5, v5, v231
 v_mul_f32 v6, v6, v231
 v_mul_f32 v7, v7, v231
 v_mul_f32 v8, v8, v231
 v_mul_f32 v9, v9, v231
 v_mul_f32 v10, v10, v231
 v_mul_f32 v11, v11, v231
 v_mul_f32 v12, v12, v231
 v_mul_f32 v13, v13, v231
 v_mul_f32 v14, v14, v231
 v_mul_f32 v15, v15, v231
 v_mul_f32 v16, v16, v231
 v_mul_f32 v17, v17, v231
 v_mul_f32 v18, v18, v231
 v_mul_f32 v19, v19, v231
 v_mul_f32 v20, v20, v231
 v_mul_f32 v21, v21, v231
 v_mul_f32 v22, v22, v231
 v_mul_f32 v23, v23, v231
 v_mul_f32 v24, v24, v231
 v_mul_f32 v25, v25, v231
 v_mul_f32 v26, v26, v231
 v_mul_f32 v27, v27, v231
 v_mul_f32 v28, v28, v231
 v_mul_f32 v29, v29, v231
 v_mul_f32 v30, v30, v231
 v_mul_f32 v31, v31, v231
 v_mul_f32 v32, v32, v231
 v_mul_f32 v33, v33, v231
 v_mul_f32 v34, v34, v231
 v_mul_f32 v35, v35, v231
 v_mul_f32 v36, v36, v231
 v_mul_f32 v37, v37, v231
 v_mul_f32 v38, v38, v231
 v_mul_f32 v39, v39, v231
 v_mul_f32 v40, v40, v231
 v_mul_f32 v41, v41, v231
 v_mul_f32 v42, v42, v231
 v_mul_f32 v43, v43, v231
 v_mul_f32 v44, v44, v231
 v_mul_f32 v45, v45, v231
 v_mul_f32 v46, v46, v231
 v_mul_f32 v47, v47, v231
 v_mul_f32 v48, v48, v231
 v_mul_f32 v49, v49, v231
 v_mul_f32 v50, v50, v231
 v_mul_f32 v51, v51, v231
 v_mul_f32 v52, v52, v231
 v_mul_f32 v53, v53, v231
 v_mul_f32 v54, v54, v231
 v_mul_f32 v55, v55, v231
 v_mul_f32 v56, v56, v231
 v_mul_f32 v57, v57, v231
 v_mul_f32 v58, v58, v231
 v_mul_f32 v59, v59, v231
 v_mul_f32 v60, v60, v231
 v_mul_f32 v61, v61, v231
 v_mul_f32 v62, v62, v231
 v_mul_f32 v63, v63, v231
 v_exp_f32 v244, v96
 v_exp_f32 v245, v97
 v_exp_f32 v246, v98
 v_exp_f32 v247, v99
 v_add_f32 v230, v244, v245
 v_cvt_pk_bf16_f32 v144, v244, v245
 v_exp_f32 v248, v100
 v_add_f32 v231, v246, v247
 v_exp_f32 v249, v101
 v_cvt_pk_bf16_f32 v145, v246, v247
 v_exp_f32 v244, v102
 v_add_f32 v230, v230, v248
 v_exp_f32 v245, v103
 v_add_f32 v231, v231, v249
 v_cvt_pk_bf16_f32 v146, v248, v249
 v_exp_f32 v246, v104
 v_add_f32 v230, v230, v244
 v_exp_f32 v247, v105
 v_add_f32 v231, v231, v245
 v_cvt_pk_bf16_f32 v147, v244, v245
 v_exp_f32 v248, v106
 v_add_f32 v230, v230, v246
 v_exp_f32 v249, v107
 v_add_f32 v231, v231, v247
 v_cvt_pk_bf16_f32 v148, v246, v247
 v_exp_f32 v244, v108
 v_add_f32 v230, v230, v248
 v_exp_f32 v245, v109
 v_add_f32 v231, v231, v249
 v_cvt_pk_bf16_f32 v149, v248, v249
 v_exp_f32 v246, v110
 v_add_f32 v230, v230, v244
 v_exp_f32 v247, v111
 v_add_f32 v231, v231, v245
 v_cvt_pk_bf16_f32 v150, v244, v245
 v_add_f32 v230, v230, v246
 v_add_f32 v231, v231, v247
 v_cvt_pk_bf16_f32 v151, v246, v247
 v_add_f32 v230, v230, v231
 s_nop 1
 s_branch K_back_2026
K_rare_2027:
 v_max3_f32 v244, v112, v113, v114
 v_max3_f32 v245, v115, v116, v117
 v_max3_f32 v246, v118, v119, v120
 v_max3_f32 v247, v121, v122, v123
 v_max3_f32 v248, v124, v125, v126
 v_max3_f32 v244, v244, v245, v127
 v_max3_f32 v246, v246, v247, v248
 v_max_f32 v244, v244, v246
 v_mov_b32 v245, v244
 s_nop 1
 v_permlane32_swap_b32 v244, v245
 v_max_f32 v244, v244, v245
 v_max_f32 v229, 0, v244
 v_sub_f32 v231, 0, v229
 v_exp_f32 v231, v231
 s_nop 4
 v_sub_f32 v112, v112, v229
 v_sub_f32 v113, v113, v229
 v_sub_f32 v114, v114, v229
 v_sub_f32 v115, v115, v229
 v_sub_f32 v116, v116, v229
 v_sub_f32 v117, v117, v229
 v_sub_f32 v118, v118, v229
 v_sub_f32 v119, v119, v229
 v_sub_f32 v120, v120, v229
 v_sub_f32 v121, v121, v229
 v_sub_f32 v122, v122, v229
 v_sub_f32 v123, v123, v229
 v_sub_f32 v124, v124, v229
 v_sub_f32 v125, v125, v229
 v_sub_f32 v126, v126, v229
 v_sub_f32 v127, v127, v229
 v_sub_f32 v128, v128, v229
 v_sub_f32 v129, v129, v229
 v_sub_f32 v130, v130, v229
 v_sub_f32 v131, v131, v229
 v_sub_f32 v132, v132, v229
 v_sub_f32 v133, v133, v229
 v_sub_f32 v134, v134, v229
 v_sub_f32 v135, v135, v229
 v_sub_f32 v136, v136, v229
 v_sub_f32 v137, v137, v229
 v_sub_f32 v138, v138, v229
 v_sub_f32 v139, v139, v229
 v_sub_f32 v140, v140, v229
 v_sub_f32 v141, v141, v229
 v_sub_f32 v142, v142, v229
 v_sub_f32 v143, v143, v229
 v_sub_f32 v96, v96, v229
 v_sub_f32 v97, v97, v229
 v_sub_f32 v98, v98, v229
 v_sub_f32 v99, v99, v229
 v_sub_f32 v100, v100, v229
 v_sub_f32 v101, v101, v229
 v_sub_f32 v102, v102, v229
 v_sub_f32 v103, v103, v229
 v_sub_f32 v104, v104, v229
 v_sub_f32 v105, v105, v229
 v_sub_f32 v106, v106, v229
 v_sub_f32 v107, v107, v229
 v_sub_f32 v108, v108, v229
 v_sub_f32 v109, v109, v229
 v_sub_f32 v110, v110, v229
 v_sub_f32 v111, v111, v229
 v_mul_f32 v228, v228, v231
 v_mul_f32 v0, v0, v231
 v_mul_f32 v1, v1, v231
 v_mul_f32 v2, v2, v231
 v_mul_f32 v3, v3, v231
 v_mul_f32 v4, v4, v231
 v_mul_f32 v5, v5, v231
 v_mul_f32 v6, v6, v231
 v_mul_f32 v7, v7, v231
 v_mul_f32 v8, v8, v231
 v_mul_f32 v9, v9, v231
 v_mul_f32 v10, v10, v231
 v_mul_f32 v11, v11, v231
 v_mul_f32 v12, v12, v231
 v_mul_f32 v13, v13, v231
 v_mul_f32 v14, v14, v231
 v_mul_f32 v15, v15, v231
 v_mul_f32 v16, v16, v231
 v_mul_f32 v17, v17, v231
 v_mul_f32 v18, v18, v231
 v_mul_f32 v19, v19, v231
 v_mul_f32 v20, v20, v231
 v_mul_f32 v21, v21, v231
 v_mul_f32 v22, v22, v231
 v_mul_f32 v23, v23, v231
 v_mul_f32 v24, v24, v231
 v_mul_f32 v25, v25, v231
 v_mul_f32 v26, v26, v231
 v_mul_f32 v27, v27, v231
 v_mul_f32 v28, v28, v231
 v_mul_f32 v29, v29, v231
 v_mul_f32 v30, v30, v231
 v_mul_f32 v31, v31, v231
 v_mul_f32 v32, v32, v231
 v_mul_f32 v33, v33, v231
 v_mul_f32 v34, v34, v231
 v_mul_f32 v35, v35, v231
 v_mul_f32 v36, v36, v231
 v_mul_f32 v37, v37, v231
 v_mul_f32 v38, v38, v231
 v_mul_f32 v39, v39, v231
 v_mul_f32 v40, v40, v231
 v_mul_f32 v41, v41, v231
 v_mul_f32 v42, v42, v231
 v_mul_f32 v43, v43, v231
 v_mul_f32 v44, v44, v231
 v_mul_f32 v45, v45, v231
 v_mul_f32 v46, v46, v231
 v_mul_f32 v47, v47, v231
 v_mul_f32 v48, v48, v231
 v_mul_f32 v49, v49, v231
 v_mul_f32 v50, v50, v231
 v_mul_f32 v51, v51, v231
 v_mul_f32 v52, v52, v231
 v_mul_f32 v53, v53, v231
 v_mul_f32 v54, v54, v231
 v_mul_f32 v55, v55, v231
 v_mul_f32 v56, v56, v231
 v_mul_f32 v57, v57, v231
 v_mul_f32 v58, v58, v231
 v_mul_f32 v59, v59, v231
 v_mul_f32 v60, v60, v231
 v_mul_f32 v61, v61, v231
 v_mul_f32 v62, v62, v231
 v_mul_f32 v63, v63, v231
 v_exp_f32 v244, v112
 v_exp_f32 v245, v113
 v_exp_f32 v246, v114
 v_exp_f32 v247, v115
 v_add_f32 v230, v244, v245
 v_cvt_pk_bf16_f32 v232, v244, v245
 v_exp_f32 v248, v116
 v_add_f32 v231, v246, v247
 v_exp_f32 v249, v117
 v_cvt_pk_bf16_f32 v233, v246, v247
 v_exp_f32 v244, v118
 v_add_f32 v230, v230, v248
 v_exp_f32 v245, v119
 v_add_f32 v231, v231, v249
 v_cvt_pk_bf16_f32 v234, v248, v249
 v_exp_f32 v246, v120
 v_add_f32 v230, v230, v244
 v_exp_f32 v247, v121
 v_add_f32 v231, v231, v245
 v_cvt_pk_bf16_f32 v235, v244, v245
 v_exp_f32 v248, v122
 v_add_f32 v230, v230, v246
 v_exp_f32 v249, v123
 v_add_f32 v231, v231, v247
 v_cvt_pk_bf16_f32 v236, v246, v247
 v_exp_f32 v244, v124
 v_add_f32 v230, v230, v248
 v_exp_f32 v245, v125
 v_add_f32 v231, v231, v249
 v_cvt_pk_bf16_f32 v237, v248, v249
 v_exp_f32 v246, v126
 v_add_f32 v230, v230, v244
 v_exp_f32 v247, v127
 v_add_f32 v231, v231, v245
 v_cvt_pk_bf16_f32 v238, v244, v245
 v_add_f32 v230, v230, v246
 v_add_f32 v231, v231, v247
 v_cvt_pk_bf16_f32 v239, v246, v247
 v_add_f32 v230, v230, v231
 s_nop 1
 s_branch K_back_2028
K_rare_2029:
 v_max3_f32 v244, v96, v97, v98
 v_max3_f32 v245, v99, v100, v101
 v_max3_f32 v246, v102, v103, v104
 v_max3_f32 v247, v105, v106, v107
 v_max3_f32 v248, v108, v109, v110
 v_max3_f32 v244, v244, v245, v111
 v_max3_f32 v246, v246, v247, v248
 v_max_f32 v244, v244, v246
 v_mov_b32 v245, v244
 s_nop 1
 v_permlane32_swap_b32 v244, v245
 v_max_f32 v244, v244, v245
 v_max_f32 v229, 0, v244
 v_sub_f32 v231, 0, v229
 v_exp_f32 v231, v231
 s_nop 4
 v_sub_f32 v96, v96, v229
 v_sub_f32 v97, v97, v229
 v_sub_f32 v98, v98, v229
 v_sub_f32 v99, v99, v229
 v_sub_f32 v100, v100, v229
 v_sub_f32 v101, v101, v229
 v_sub_f32 v102, v102, v229
 v_sub_f32 v103, v103, v229
 v_sub_f32 v104, v104, v229
 v_sub_f32 v105, v105, v229
 v_sub_f32 v106, v106, v229
 v_sub_f32 v107, v107, v229
 v_sub_f32 v108, v108, v229
 v_sub_f32 v109, v109, v229
 v_sub_f32 v110, v110, v229
 v_sub_f32 v111, v111, v229
 v_sub_f32 v128, v128, v229
 v_sub_f32 v129, v129, v229
 v_sub_f32 v130, v130, v229
 v_sub_f32 v131, v131, v229
 v_sub_f32 v132, v132, v229
 v_sub_f32 v133, v133, v229
 v_sub_f32 v134, v134, v229
 v_sub_f32 v135, v135, v229
 v_sub_f32 v136, v136, v229
 v_sub_f32 v137, v137, v229
 v_sub_f32 v138, v138, v229
 v_sub_f32 v139, v139, v229
 v_sub_f32 v140, v140, v229
 v_sub_f32 v141, v141, v229
 v_sub_f32 v142, v142, v229
 v_sub_f32 v143, v143, v229
 v_sub_f32 v112, v112, v229
 v_sub_f32 v113, v113, v229
 v_sub_f32 v114, v114, v229
 v_sub_f32 v115, v115, v229
 v_sub_f32 v116, v116, v229
 v_sub_f32 v117, v117, v229
 v_sub_f32 v118, v118, v229
 v_sub_f32 v119, v119, v229
 v_sub_f32 v120, v120, v229
 v_sub_f32 v121, v121, v229
 v_sub_f32 v122, v122, v229
 v_sub_f32 v123, v123, v229
 v_sub_f32 v124, v124, v229
 v_sub_f32 v125, v125, v229
 v_sub_f32 v126, v126, v229
 v_sub_f32 v127, v127, v229
 v_mul_f32 v228, v228, v231
 v_mul_f32 v0, v0, v231
 v_mul_f32 v1, v1, v231
 v_mul_f32 v2, v2, v231
 v_mul_f32 v3, v3, v231
 v_mul_f32 v4, v4, v231
 v_mul_f32 v5, v5, v231
 v_mul_f32 v6, v6, v231
 v_mul_f32 v7, v7, v231
 v_mul_f32 v8, v8, v231
 v_mul_f32 v9, v9, v231
 v_mul_f32 v10, v10, v231
 v_mul_f32 v11, v11, v231
 v_mul_f32 v12, v12, v231
 v_mul_f32 v13, v13, v231
 v_mul_f32 v14, v14, v231
 v_mul_f32 v15, v15, v231
 v_mul_f32 v16, v16, v231
 v_mul_f32 v17, v17, v231
 v_mul_f32 v18, v18, v231
 v_mul_f32 v19, v19, v231
 v_mul_f32 v20, v20, v231
 v_mul_f32 v21, v21, v231
 v_mul_f32 v22, v22, v231
 v_mul_f32 v23, v23, v231
 v_mul_f32 v24, v24, v231
 v_mul_f32 v25, v25, v231
 v_mul_f32 v26, v26, v231
 v_mul_f32 v27, v27, v231
 v_mul_f32 v28, v28, v231
 v_mul_f32 v29, v29, v231
 v_mul_f32 v30, v30, v231
 v_mul_f32 v31, v31, v231
 v_mul_f32 v32, v32, v231
 v_mul_f32 v33, v33, v231
 v_mul_f32 v34, v34, v231
 v_mul_f32 v35, v35, v231
 v_mul_f32 v36, v36, v231
 v_mul_f32 v37, v37, v231
 v_mul_f32 v38, v38, v231
 v_mul_f32 v39, v39, v231
 v_mul_f32 v40, v40, v231
 v_mul_f32 v41, v41, v231
 v_mul_f32 v42, v42, v231
 v_mul_f32 v43, v43, v231
 v_mul_f32 v44, v44, v231
 v_mul_f32 v45, v45, v231
 v_mul_f32 v46, v46, v231
 v_mul_f32 v47, v47, v231
 v_mul_f32 v48, v48, v231
 v_mul_f32 v49, v49, v231
 v_mul_f32 v50, v50, v231
 v_mul_f32 v51, v51, v231
 v_mul_f32 v52, v52, v231
 v_mul_f32 v53, v53, v231
 v_mul_f32 v54, v54, v231
 v_mul_f32 v55, v55, v231
 v_mul_f32 v56, v56, v231
 v_mul_f32 v57, v57, v231
 v_mul_f32 v58, v58, v231
 v_mul_f32 v59, v59, v231
 v_mul_f32 v60, v60, v231
 v_mul_f32 v61, v61, v231
 v_mul_f32 v62, v62, v231
 v_mul_f32 v63, v63, v231
 v_exp_f32 v244, v96
 v_exp_f32 v245, v97
 v_exp_f32 v246, v98
 v_exp_f32 v247, v99
 v_add_f32 v230, v244, v245
 v_cvt_pk_bf16_f32 v144, v244, v245
 v_exp_f32 v248, v100
 v_add_f32 v231, v246, v247
 v_exp_f32 v249, v101
 v_cvt_pk_bf16_f32 v145, v246, v247
 v_exp_f32 v244, v102
 v_add_f32 v230, v230, v248
 v_exp_f32 v245, v103
 v_add_f32 v231, v231, v249
 v_cvt_pk_bf16_f32 v146, v248, v249
 v_exp_f32 v246, v104
 v_add_f32 v230, v230, v244
 v_exp_f32 v247, v105
 v_add_f32 v231, v231, v245
 v_cvt_pk_bf16_f32 v147, v244, v245
 v_exp_f32 v248, v106
 v_add_f32 v230, v230, v246
 v_exp_f32 v249, v107
 v_add_f32 v231, v231, v247
 v_cvt_pk_bf16_f32 v148, v246, v247
 v_exp_f32 v244, v108
 v_add_f32 v230, v230, v248
 v_exp_f32 v245, v109
 v_add_f32 v231, v231, v249
 v_cvt_pk_bf16_f32 v149, v248, v249
 v_exp_f32 v246, v110
 v_add_f32 v230, v230, v244
 v_exp_f32 v247, v111
 v_add_f32 v231, v231, v245
 v_cvt_pk_bf16_f32 v150, v244, v245
 v_add_f32 v230, v230, v246
 v_add_f32 v231, v231, v247
 v_cvt_pk_bf16_f32 v151, v246, v247
 v_add_f32 v230, v230, v231
 s_nop 1
 s_branch K_back_2030
K_rare_2031:
 v_max3_f32 v244, v112, v113, v114
 v_max3_f32 v245, v115, v116, v117
 v_max3_f32 v246, v118, v119, v120
 v_max3_f32 v247, v121, v122, v123
 v_max3_f32 v248, v124, v125, v126
 v_max3_f32 v244, v244, v245, v127
 v_max3_f32 v246, v246, v247, v248
 v_max_f32 v244, v244, v246
 v_mov_b32 v245, v244
 s_nop 1
 v_permlane32_swap_b32 v244, v245
 v_max_f32 v244, v244, v245
 v_max_f32 v229, 0, v244
 v_sub_f32 v231, 0, v229
 v_exp_f32 v231, v231
 s_nop 4
 v_sub_f32 v112, v112, v229
 v_sub_f32 v113, v113, v229
 v_sub_f32 v114, v114, v229
 v_sub_f32 v115, v115, v229
 v_sub_f32 v116, v116, v229
 v_sub_f32 v117, v117, v229
 v_sub_f32 v118, v118, v229
 v_sub_f32 v119, v119, v229
 v_sub_f32 v120, v120, v229
 v_sub_f32 v121, v121, v229
 v_sub_f32 v122, v122, v229
 v_sub_f32 v123, v123, v229
 v_sub_f32 v124, v124, v229
 v_sub_f32 v125, v125, v229
 v_sub_f32 v126, v126, v229
 v_sub_f32 v127, v127, v229
 v_sub_f32 v128, v128, v229
 v_sub_f32 v129, v129, v229
 v_sub_f32 v130, v130, v229
 v_sub_f32 v131, v131, v229
 v_sub_f32 v132, v132, v229
 v_sub_f32 v133, v133, v229
 v_sub_f32 v134, v134, v229
 v_sub_f32 v135, v135, v229
 v_sub_f32 v136, v136, v229
 v_sub_f32 v137, v137, v229
 v_sub_f32 v138, v138, v229
 v_sub_f32 v139, v139, v229
 v_sub_f32 v140, v140, v229
 v_sub_f32 v141, v141, v229
 v_sub_f32 v142, v142, v229
 v_sub_f32 v143, v143, v229
 v_mul_f32 v228, v228, v231
 v_mul_f32 v0, v0, v231
 v_mul_f32 v1, v1, v231
 v_mul_f32 v2, v2, v231
 v_mul_f32 v3, v3, v231
 v_mul_f32 v4, v4, v231
 v_mul_f32 v5, v5, v231
 v_mul_f32 v6, v6, v231
 v_mul_f32 v7, v7, v231
 v_mul_f32 v8, v8, v231
 v_mul_f32 v9, v9, v231
 v_mul_f32 v10, v10, v231
 v_mul_f32 v11, v11, v231
 v_mul_f32 v12, v12, v231
 v_mul_f32 v13, v13, v231
 v_mul_f32 v14, v14, v231
 v_mul_f32 v15, v15, v231
 v_mul_f32 v16, v16, v231
 v_mul_f32 v17, v17, v231
 v_mul_f32 v18, v18, v231
 v_mul_f32 v19, v19, v231
 v_mul_f32 v20, v20, v231
 v_mul_f32 v21, v21, v231
 v_mul_f32 v22, v22, v231
 v_mul_f32 v23, v23, v231
 v_mul_f32 v24, v24, v231
 v_mul_f32 v25, v25, v231
 v_mul_f32 v26, v26, v231
 v_mul_f32 v27, v27, v231
 v_mul_f32 v28, v28, v231
 v_mul_f32 v29, v29, v231
 v_mul_f32 v30, v30, v231
 v_mul_f32 v31, v31, v231
 v_mul_f32 v32, v32, v231
 v_mul_f32 v33, v33, v231
 v_mul_f32 v34, v34, v231
 v_mul_f32 v35, v35, v231
 v_mul_f32 v36, v36, v231
 v_mul_f32 v37, v37, v231
 v_mul_f32 v38, v38, v231
 v_mul_f32 v39, v39, v231
 v_mul_f32 v40, v40, v231
 v_mul_f32 v41, v41, v231
 v_mul_f32 v42, v42, v231
 v_mul_f32 v43, v43, v231
 v_mul_f32 v44, v44, v231
 v_mul_f32 v45, v45, v231
 v_mul_f32 v46, v46, v231
 v_mul_f32 v47, v47, v231
 v_mul_f32 v48, v48, v231
 v_mul_f32 v49, v49, v231
 v_mul_f32 v50, v50, v231
 v_mul_f32 v51, v51, v231
 v_mul_f32 v52, v52, v231
 v_mul_f32 v53, v53, v231
 v_mul_f32 v54, v54, v231
 v_mul_f32 v55, v55, v231
 v_mul_f32 v56, v56, v231
 v_mul_f32 v57, v57, v231
 v_mul_f32 v58, v58, v231
 v_mul_f32 v59, v59, v231
 v_mul_f32 v60, v60, v231
 v_mul_f32 v61, v61, v231
 v_mul_f32 v62, v62, v231
 v_mul_f32 v63, v63, v231
 v_exp_f32 v244, v112
 v_exp_f32 v245, v113
 v_exp_f32 v246, v114
 v_exp_f32 v247, v115
 v_add_f32 v230, v244, v245
 v_cvt_pk_bf16_f32 v232, v244, v245
 v_exp_f32 v248, v116
 v_add_f32 v231, v246, v247
 v_exp_f32 v249, v117
 v_cvt_pk_bf16_f32 v233, v246, v247
 v_exp_f32 v244, v118
 v_add_f32 v230, v230, v248
 v_exp_f32 v245, v119
 v_add_f32 v231, v231, v249
 v_cvt_pk_bf16_f32 v234, v248, v249
 v_exp_f32 v246, v120
 v_add_f32 v230, v230, v244
 v_exp_f32 v247, v121
 v_add_f32 v231, v231, v245
 v_cvt_pk_bf16_f32 v235, v244, v245
 v_exp_f32 v248, v122
 v_add_f32 v230, v230, v246
 v_exp_f32 v249, v123
 v_add_f32 v231, v231, v247
 v_cvt_pk_bf16_f32 v236, v246, v247
 v_exp_f32 v244, v124
 v_add_f32 v230, v230, v248
 v_exp_f32 v245, v125
 v_add_f32 v231, v231, v249
 v_cvt_pk_bf16_f32 v237, v248, v249
 v_exp_f32 v246, v126
 v_add_f32 v230, v230, v244
 v_exp_f32 v247, v127
 v_add_f32 v231, v231, v245
 v_cvt_pk_bf16_f32 v238, v244, v245
 v_add_f32 v230, v230, v246
 v_add_f32 v231, v231, v247
 v_cvt_pk_bf16_f32 v239, v246, v247
 v_add_f32 v230, v230, v231
 s_nop 1
 s_branch K_back_2032

.section .rodata,"a"
.p2align 6
.amdhsa_kernel concat_heads__gqa_block_cached__mha_block_cached__near_ridge_kernel
  .amdhsa_next_free_vgpr 256
  .amdhsa_next_free_sgpr 102
  .amdhsa_accum_offset 256
  .amdhsa_group_segment_fixed_size 0
  .amdhsa_kernarg_size 104
  .amdhsa_user_sgpr_count 2
  .amdhsa_user_sgpr_kernarg_segment_ptr 1
  .amdhsa_system_sgpr_workgroup_id_x 1
.end_amdhsa_kernel
```
